```python
import torch

def _softmax(x, axis=-1):
    return torch.softmax(x, dim=axis)

def _gelu(x):
    return torch.nn.functional.gelu(x, approximate='tanh')

def _silu(x):
    return torch.nn.functional.silu(x)

def _sigmoid(x):
    return torch.sigmoid(x)

def _layernorm(x, axis=-1, eps=1e-05):
    m = x.mean(dim=axis, keepdim=True)
    v = x.var(dim=axis, keepdim=True, unbiased=False)
    return (x - m) / torch.sqrt(v + eps)

def _scatter_add(tgt, idx, src, axis=0):
    return tgt.clone().index_add_(axis, idx, src)

def _segment_sum(src, seg, n):
    out = torch.zeros((n,) + src.shape[1:], dtype=src.dtype)
    return out.index_add_(0, seg, src)

def _pad(x, pw):
    flat = tuple((v for pair in reversed(pw) for v in pair))
    return torch.nn.functional.pad(x, flat)
kernel_name = 'concat_heads__memory_aug_recurrent_mem_tr__linear_kernel_hedgehog__prompt'

def setup_inputs():

    _w = lambda a: (lambda t: t.to(torch.bfloat16) if t.is_floating_point() else t)(torch.as_tensor(a))

    def _A_setup():
        B, S, Dm = (1, 2048, 448)
        H, Dh = (16, 256)
        M, seg = (8, 32)
        seg = min(seg, S)
        S = S // seg * seg
        return {'x': _w((lambda *s: torch.randn(*s, dtype=torch.bfloat16) * 0.05)(B, S, Dm)), 'mem0': _w((lambda *s: torch.randn(*s, dtype=torch.bfloat16) * 0.8)(B, M, Dm)), 'Wq': _w((lambda *s: torch.randn(*s, dtype=torch.bfloat16) * 1.6)(Dm, H, Dh) * Dm ** (-0.5)), 'Wk': _w((lambda *s: torch.randn(*s, dtype=torch.bfloat16) * 1.6)(Dm, H, Dh) * Dm ** (-0.5)), 'Wv': _w((lambda *s: torch.randn(*s, dtype=torch.bfloat16) * 0.8)(Dm, H, Dh) * Dm ** (-0.5)), 'Wo': _w((lambda *s: torch.randn(*s, dtype=torch.bfloat16) * 0.8)(H, Dh, Dm) * (H * Dh) ** (-0.5)), 'seg_len': seg}
    _A_in = _A_setup()

    def _B_setup():
        B, S, D, H = (1, 2048, 448, 16)
        Dh = D // H
        return {'x': _w((lambda *s: torch.randn(*s, dtype=torch.bfloat16) * 0.4)(B, S, D)), 'wqkv': _w((lambda *s: torch.randn(*s, dtype=torch.bfloat16) * 0.4)(D, 3 * D)), 'w_phi': _w((lambda *s: torch.randn(*s, dtype=torch.bfloat16) * 0.4)(H, Dh, Dh) * Dh ** (-0.5)), 'wo': _w((lambda *s: torch.randn(*s, dtype=torch.bfloat16) * 0.05)(D, D))}
    _B_in = _B_setup()
    return {'A_x': _A_in['x'], 'A_mem0': _A_in['mem0'], 'A_Wq': _A_in['Wq'], 'A_Wk': _A_in['Wk'], 'A_Wv': _A_in['Wv'], 'A_Wo': _A_in['Wo'], 'A_seg_len': _A_in['seg_len'], 'B_x': _B_in['x'], 'B_wqkv': _B_in['wqkv'], 'B_w_phi': _B_in['w_phi'], 'B_wo': _B_in['wo']}

def reference(A_x, A_mem0, A_Wq, A_Wk, A_Wv, A_Wo, A_seg_len, B_x, B_wqkv, B_w_phi, B_wo):

    def _A_ref(x, mem0, Wq, Wk, Wv, Wo, seg_len):
        B, S, Dm = x.shape
        H, Dh = (Wq.shape[1], Wq.shape[2])
        M = mem0.shape[1]
        scale = Dh ** (-0.5)
        n_seg = S // seg_len
        L = M + seg_len
        idx = torch.arange(L)
        mask = (idx[:, None] < M) | (idx[:, None] >= idx[None, :])
        mem = mem0
        outs = []
        for s in range(n_seg):
            xs = x[:, s * seg_len:(s + 1) * seg_len, :].clone()
            h = torch.concatenate([mem, xs], axis=1)
            q = torch.einsum('btd,dhe->bhte', h, Wq)
            k = torch.einsum('btd,dhe->bhte', h, Wk)
            v = torch.einsum('btd,dhe->bhte', h, Wv)
            scores = torch.einsum('bhqe,bhke->bhqk', q, k) * scale
            scores = torch.where(mask[None, None], scores, -1000000000.0)
            p = _softmax(scores, axis=-1)
            o = torch.einsum('bhqk,bhke->bhqe', p, v)
            o = torch.einsum('bhte,hed->btd', o, Wo)
            mem = o[:, :M, :].clone()
            outs.append(o[:, M:, :])
        return torch.concatenate(outs, axis=1)

    def _B_ref(x, wqkv, w_phi, wo):
        B, S, D = x.shape
        H = 16
        Dh = D // H
        qkv = (lambda x, *d: x.permute(*d))((x @ wqkv).reshape(B, S, 3, H, Dh), 2, 0, 3, 1, 4)
        q, k, v = (qkv[0], qkv[1], qkv[2])
        pq = torch.einsum('bhsd,hdf->bhsf', q, w_phi)
        pk = torch.einsum('bhsd,hdf->bhsf', k, w_phi)
        phi_q = torch.concatenate([_softmax(pq, axis=-1), _softmax(-pq, axis=-1)], axis=-1)
        phi_k = torch.concatenate([_softmax(pk, axis=-1), _softmax(-pk, axis=-1)], axis=-1)
        kv = torch.einsum('bhsf,bhsd->bhfd', phi_k, v)
        z = torch.einsum('bhsf->bhf', phi_k)
        num = torch.einsum('bhqf,bhfd->bhqd', phi_q, kv)
        den = torch.einsum('bhqf,bhf->bhq', phi_q, z)[..., None] + 1e-06
        o = num / den
        return (lambda x, *d: x.permute(*d))(o, 0, 2, 1, 3).reshape(B, S, D) @ wo
    a = _A_ref(A_x, A_mem0, A_Wq, A_Wk, A_Wv, A_Wo, A_seg_len)
    b = _B_ref(B_x, B_wqkv, B_w_phi, B_wo)
    return torch.concatenate([a, b], axis=-1)
```

```asm
; @launch kernel=prep_kernel grid=(256,1,1) block=(256,1,1) lds=32768
; @launch kernel=main_kernel grid=(256,1,1) block=(256,1,1) lds=90112
.amdgcn_target "amdgcn-amd-amdhsa--gfx950"
.text
.globl prep_kernel
.p2align 8
.type prep_kernel,@function
prep_kernel:
    s_cmp_ge_u32 s2, 256
    s_cbranch_scc1 L_prep_end2
    s_load_dwordx4 s[4:7], s[0:1], 8
    s_load_dwordx4 s[8:11], s[0:1], 24
    s_load_dwordx2 s[12:13], s[0:1], 40
    s_load_dwordx4 s[16:19], s[0:1], 64
    s_load_dwordx2 s[20:21], s[0:1], 80
    s_load_dwordx2 s[22:23], s[0:1], 104
    v_lshrrev_b32 v3, 6, v0
    v_and_b32 v1, 63, v0
    v_readfirstlane_b32 s3, v3
    v_lshrrev_b32 v3, 4, v1
    v_and_b32 v4, 15, v1
    s_waitcnt lgkmcnt(0)
    s_mov_b32 s24, s22
    s_mov_b32 s25, s23
    s_mov_b32 s26, 268435456
    s_mov_b32 s27, 0x00020000
    v_mov_b32 v240, 0
    v_mov_b32 v241, 0
    s_mov_b32 s56, 0
    s_mov_b32 s57, 0
    s_cmp_lg_u32 s3, 3
    s_cbranch_scc1 L_prep_noxf
    s_load_dwordx2 s[14:15], s[0:1], 0
    s_waitcnt lgkmcnt(0)
    s_mov_b32 s28, s14
    s_mov_b32 s29, s15
    s_mov_b32 s30, 1835008
    s_mov_b32 s31, 0x00020000
    s_lshr_b32 s40, s2, 2
    s_and_b32 s41, s2, 3
    s_mul_i32 s40, s40, 28672
    s_mul_i32 s42, s41, 224
    s_add_u32 s42, s42, s40
    s_add_u32 s43, s42, 14336
    v_mul_u32_u24 v5, 896, v4
    v_lshl_add_u32 v6, v3, 3, v5
    v_lshl_add_u32 v5, v3, 4, v5
    s_mul_i32 s44, s41, 7168
    s_add_u32 s44, s44, s40
    s_add_u32 s44, s44, 83886080
    s_add_u32 s45, s44, 3584
    v_lshlrev_b32 v7, 4, v1
    v_lshlrev_b32 v8, 3, v1
    buffer_load_dwordx4 v[208:211], v5, s[28:31], s42 offen offset:0
    buffer_load_dwordx4 v[212:215], v5, s[28:31], s42 offen offset:64
    buffer_load_dwordx4 v[216:219], v5, s[28:31], s42 offen offset:128
    buffer_load_dwordx2 v[220:221], v6, s[28:31], s42 offen offset:192
    buffer_load_dwordx4 v[224:227], v5, s[28:31], s43 offen offset:0
    buffer_load_dwordx4 v[228:231], v5, s[28:31], s43 offen offset:64
    buffer_load_dwordx4 v[232:235], v5, s[28:31], s43 offen offset:128
    buffer_load_dwordx2 v[236:237], v6, s[28:31], s43 offen offset:192
    s_mov_b32 s56, s44
    s_mov_b32 s57, s45
    v_mov_b32 v240, v7
    v_mov_b32 v241, v8
L_prep_noxf:
    s_cmp_ge_u32 s2, 224
    s_cbranch_scc1 L_prep_b
    s_and_b32 s40, s2, 7
    s_lshr_b32 s41, s2, 3
    s_mul_i32 s42, s41, 37
    s_lshr_b32 s42, s42, 8
    s_mul_i32 s43, s42, 7
    s_sub_u32 s43, s41, s43
    s_lshl_b32 s40, s40, 2
    s_add_u32 s40, s40, s42
    s_and_b32 s42, s40, 1
    s_lshr_b32 s40, s40, 1
    s_lshl_b32 s44, s43, 6
    s_lshl_b32 s45, s40, 9
    s_cmp_eq_u32 s42, 0
    s_cselect_b32 s28, s6, s10
    s_cselect_b32 s29, s7, s11
    s_mov_b32 s30, 3670016
    s_mov_b32 s31, 0x00020000
    s_mov_b32 s32, s8
    s_mov_b32 s33, s9
    s_mov_b32 s34, 3670016
    s_mov_b32 s35, 0x00020000
    s_mov_b32 s36, s12
    s_mov_b32 s37, s13
    s_mov_b32 s38, 3670016
    s_mov_b32 s39, 0x00020000
    v_lshlrev_b32 v6, 13, v4
    v_lshl_add_u32 v6, v3, 4, v6
    v_add_u32 v6, s45, v6
    s_mul_i32 s49, s3, 917504
    s_cmp_eq_u32 s42, 0
    s_cbranch_scc0 L_prep_bo
    s_lshl_b32 s46, s44, 13
    buffer_load_dwordx4 v[16:19], v6, s[32:35], s46 offen offset:0
    buffer_load_dwordx4 v[20:23], v6, s[32:35], s46 offen offset:64
    buffer_load_dwordx4 v[24:27], v6, s[32:35], s46 offen offset:128
    buffer_load_dwordx4 v[28:31], v6, s[32:35], s46 offen offset:192
    buffer_load_dwordx4 v[32:35], v6, s[32:35], s46 offen offset:256
    buffer_load_dwordx4 v[36:39], v6, s[32:35], s46 offen offset:320
    buffer_load_dwordx4 v[40:43], v6, s[32:35], s46 offen offset:384
    buffer_load_dwordx4 v[44:47], v6, s[32:35], s46 offen offset:448
    s_add_u32 s46, s46, 131072
    buffer_load_dwordx4 v[48:51], v6, s[32:35], s46 offen offset:0
    buffer_load_dwordx4 v[52:55], v6, s[32:35], s46 offen offset:64
    buffer_load_dwordx4 v[56:59], v6, s[32:35], s46 offen offset:128
    buffer_load_dwordx4 v[60:63], v6, s[32:35], s46 offen offset:192
    buffer_load_dwordx4 v[64:67], v6, s[32:35], s46 offen offset:256
    buffer_load_dwordx4 v[68:71], v6, s[32:35], s46 offen offset:320
    buffer_load_dwordx4 v[72:75], v6, s[32:35], s46 offen offset:384
    buffer_load_dwordx4 v[76:79], v6, s[32:35], s46 offen offset:448
    s_add_u32 s46, s46, 131072
    buffer_load_dwordx4 v[80:83], v6, s[32:35], s46 offen offset:0
    buffer_load_dwordx4 v[84:87], v6, s[32:35], s46 offen offset:64
    buffer_load_dwordx4 v[88:91], v6, s[32:35], s46 offen offset:128
    buffer_load_dwordx4 v[92:95], v6, s[32:35], s46 offen offset:192
    buffer_load_dwordx4 v[96:99], v6, s[32:35], s46 offen offset:256
    buffer_load_dwordx4 v[100:103], v6, s[32:35], s46 offen offset:320
    buffer_load_dwordx4 v[104:107], v6, s[32:35], s46 offen offset:384
    buffer_load_dwordx4 v[108:111], v6, s[32:35], s46 offen offset:448
    s_add_u32 s46, s46, 131072
    buffer_load_dwordx4 v[112:115], v6, s[32:35], s46 offen offset:0
    buffer_load_dwordx4 v[116:119], v6, s[32:35], s46 offen offset:64
    buffer_load_dwordx4 v[120:123], v6, s[32:35], s46 offen offset:128
    buffer_load_dwordx4 v[124:127], v6, s[32:35], s46 offen offset:192
    buffer_load_dwordx4 v[128:131], v6, s[32:35], s46 offen offset:256
    buffer_load_dwordx4 v[132:135], v6, s[32:35], s46 offen offset:320
    buffer_load_dwordx4 v[136:139], v6, s[32:35], s46 offen offset:384
    buffer_load_dwordx4 v[140:143], v6, s[32:35], s46 offen offset:448
    s_add_u32 s46, s46, 131072
    buffer_load_dwordx4 a[0:3], v6, s[28:31], s49 offen offset:0
    buffer_load_dwordx4 a[4:7], v6, s[28:31], s49 offen offset:64
    buffer_load_dwordx4 a[8:11], v6, s[28:31], s49 offen offset:128
    buffer_load_dwordx4 a[12:15], v6, s[28:31], s49 offen offset:192
    buffer_load_dwordx4 a[16:19], v6, s[28:31], s49 offen offset:256
    buffer_load_dwordx4 a[20:23], v6, s[28:31], s49 offen offset:320
    buffer_load_dwordx4 a[24:27], v6, s[28:31], s49 offen offset:384
    buffer_load_dwordx4 a[28:31], v6, s[28:31], s49 offen offset:448
    s_add_u32 s49, s49, 131072
    buffer_load_dwordx4 a[32:35], v6, s[28:31], s49 offen offset:0
    buffer_load_dwordx4 a[36:39], v6, s[28:31], s49 offen offset:64
    buffer_load_dwordx4 a[40:43], v6, s[28:31], s49 offen offset:128
    buffer_load_dwordx4 a[44:47], v6, s[28:31], s49 offen offset:192
    buffer_load_dwordx4 a[48:51], v6, s[28:31], s49 offen offset:256
    buffer_load_dwordx4 a[52:55], v6, s[28:31], s49 offen offset:320
    buffer_load_dwordx4 a[56:59], v6, s[28:31], s49 offen offset:384
    buffer_load_dwordx4 a[60:63], v6, s[28:31], s49 offen offset:448
    s_add_u32 s49, s49, 131072
    buffer_load_dwordx4 a[64:67], v6, s[28:31], s49 offen offset:0
    buffer_load_dwordx4 a[68:71], v6, s[28:31], s49 offen offset:64
    buffer_load_dwordx4 a[72:75], v6, s[28:31], s49 offen offset:128
    buffer_load_dwordx4 a[76:79], v6, s[28:31], s49 offen offset:192
    buffer_load_dwordx4 a[80:83], v6, s[28:31], s49 offen offset:256
    buffer_load_dwordx4 a[84:87], v6, s[28:31], s49 offen offset:320
    buffer_load_dwordx4 a[88:91], v6, s[28:31], s49 offen offset:384
    buffer_load_dwordx4 a[92:95], v6, s[28:31], s49 offen offset:448
    s_add_u32 s49, s49, 131072
    buffer_load_dwordx4 a[96:99], v6, s[28:31], s49 offen offset:0
    buffer_load_dwordx4 a[100:103], v6, s[28:31], s49 offen offset:64
    buffer_load_dwordx4 a[104:107], v6, s[28:31], s49 offen offset:128
    buffer_load_dwordx4 a[108:111], v6, s[28:31], s49 offen offset:192
    buffer_load_dwordx4 a[112:115], v6, s[28:31], s49 offen offset:256
    buffer_load_dwordx4 a[116:119], v6, s[28:31], s49 offen offset:320
    buffer_load_dwordx4 a[120:123], v6, s[28:31], s49 offen offset:384
    buffer_load_dwordx4 a[124:127], v6, s[28:31], s49 offen offset:448
    s_add_u32 s49, s49, 131072
    buffer_load_dwordx4 a[128:131], v6, s[28:31], s49 offen offset:0
    buffer_load_dwordx4 a[132:135], v6, s[28:31], s49 offen offset:64
    buffer_load_dwordx4 a[136:139], v6, s[28:31], s49 offen offset:128
    buffer_load_dwordx4 a[140:143], v6, s[28:31], s49 offen offset:192
    buffer_load_dwordx4 a[144:147], v6, s[28:31], s49 offen offset:256
    buffer_load_dwordx4 a[148:151], v6, s[28:31], s49 offen offset:320
    buffer_load_dwordx4 a[152:155], v6, s[28:31], s49 offen offset:384
    buffer_load_dwordx4 a[156:159], v6, s[28:31], s49 offen offset:448
    s_add_u32 s49, s49, 131072
    buffer_load_dwordx4 a[160:163], v6, s[28:31], s49 offen offset:0
    buffer_load_dwordx4 a[164:167], v6, s[28:31], s49 offen offset:64
    buffer_load_dwordx4 a[168:171], v6, s[28:31], s49 offen offset:128
    buffer_load_dwordx4 a[172:175], v6, s[28:31], s49 offen offset:192
    buffer_load_dwordx4 a[176:179], v6, s[28:31], s49 offen offset:256
    buffer_load_dwordx4 a[180:183], v6, s[28:31], s49 offen offset:320
    buffer_load_dwordx4 a[184:187], v6, s[28:31], s49 offen offset:384
    buffer_load_dwordx4 a[188:191], v6, s[28:31], s49 offen offset:448
    s_add_u32 s49, s49, 131072
    buffer_load_dwordx4 a[192:195], v6, s[28:31], s49 offen offset:0
    buffer_load_dwordx4 a[196:199], v6, s[28:31], s49 offen offset:64
    buffer_load_dwordx4 a[200:203], v6, s[28:31], s49 offen offset:128
    buffer_load_dwordx4 a[204:207], v6, s[28:31], s49 offen offset:192
    buffer_load_dwordx4 a[208:211], v6, s[28:31], s49 offen offset:256
    buffer_load_dwordx4 a[212:215], v6, s[28:31], s49 offen offset:320
    buffer_load_dwordx4 a[216:219], v6, s[28:31], s49 offen offset:384
    buffer_load_dwordx4 a[220:223], v6, s[28:31], s49 offen offset:448
    s_add_u32 s49, s49, 131072
    s_branch L_prep_bdone
L_prep_bo:
    s_mul_i32 s46, s40, 229376
    s_lshl_b32 s47, s43, 7
    s_add_u32 s46, s46, s47
    v_lshrrev_b32 v5, 3, v0
    v_mul_u32_u24 v5, 896, v5
    v_and_b32 v7, 7, v0
    v_lshl_add_u32 v5, v7, 4, v5
    v_lshlrev_b32 v7, 4, v0
    buffer_load_dwordx4 v[144:147], v5, s[36:39], s46 offen
    s_add_u32 s46, s46, 28672
    buffer_load_dwordx4 v[148:151], v5, s[36:39], s46 offen
    s_add_u32 s46, s46, 28672
    buffer_load_dwordx4 v[152:155], v5, s[36:39], s46 offen
    s_add_u32 s46, s46, 28672
    buffer_load_dwordx4 v[156:159], v5, s[36:39], s46 offen
    s_add_u32 s46, s46, 28672
    buffer_load_dwordx4 v[160:163], v5, s[36:39], s46 offen
    s_add_u32 s46, s46, 28672
    buffer_load_dwordx4 v[164:167], v5, s[36:39], s46 offen
    s_add_u32 s46, s46, 28672
    buffer_load_dwordx4 v[168:171], v5, s[36:39], s46 offen
    s_add_u32 s46, s46, 28672
    buffer_load_dwordx4 v[172:175], v5, s[36:39], s46 offen
    s_add_u32 s46, s46, 28672
    buffer_load_dwordx4 a[0:3], v6, s[28:31], s49 offen offset:0
    buffer_load_dwordx4 a[4:7], v6, s[28:31], s49 offen offset:64
    buffer_load_dwordx4 a[8:11], v6, s[28:31], s49 offen offset:128
    buffer_load_dwordx4 a[12:15], v6, s[28:31], s49 offen offset:192
    buffer_load_dwordx4 a[16:19], v6, s[28:31], s49 offen offset:256
    buffer_load_dwordx4 a[20:23], v6, s[28:31], s49 offen offset:320
    buffer_load_dwordx4 a[24:27], v6, s[28:31], s49 offen offset:384
    buffer_load_dwordx4 a[28:31], v6, s[28:31], s49 offen offset:448
    s_add_u32 s49, s49, 131072
    buffer_load_dwordx4 a[32:35], v6, s[28:31], s49 offen offset:0
    buffer_load_dwordx4 a[36:39], v6, s[28:31], s49 offen offset:64
    buffer_load_dwordx4 a[40:43], v6, s[28:31], s49 offen offset:128
    buffer_load_dwordx4 a[44:47], v6, s[28:31], s49 offen offset:192
    buffer_load_dwordx4 a[48:51], v6, s[28:31], s49 offen offset:256
    buffer_load_dwordx4 a[52:55], v6, s[28:31], s49 offen offset:320
    buffer_load_dwordx4 a[56:59], v6, s[28:31], s49 offen offset:384
    buffer_load_dwordx4 a[60:63], v6, s[28:31], s49 offen offset:448
    s_add_u32 s49, s49, 131072
    buffer_load_dwordx4 a[64:67], v6, s[28:31], s49 offen offset:0
    buffer_load_dwordx4 a[68:71], v6, s[28:31], s49 offen offset:64
    buffer_load_dwordx4 a[72:75], v6, s[28:31], s49 offen offset:128
    buffer_load_dwordx4 a[76:79], v6, s[28:31], s49 offen offset:192
    buffer_load_dwordx4 a[80:83], v6, s[28:31], s49 offen offset:256
    buffer_load_dwordx4 a[84:87], v6, s[28:31], s49 offen offset:320
    buffer_load_dwordx4 a[88:91], v6, s[28:31], s49 offen offset:384
    buffer_load_dwordx4 a[92:95], v6, s[28:31], s49 offen offset:448
    s_add_u32 s49, s49, 131072
    buffer_load_dwordx4 a[96:99], v6, s[28:31], s49 offen offset:0
    buffer_load_dwordx4 a[100:103], v6, s[28:31], s49 offen offset:64
    buffer_load_dwordx4 a[104:107], v6, s[28:31], s49 offen offset:128
    buffer_load_dwordx4 a[108:111], v6, s[28:31], s49 offen offset:192
    buffer_load_dwordx4 a[112:115], v6, s[28:31], s49 offen offset:256
    buffer_load_dwordx4 a[116:119], v6, s[28:31], s49 offen offset:320
    buffer_load_dwordx4 a[120:123], v6, s[28:31], s49 offen offset:384
    buffer_load_dwordx4 a[124:127], v6, s[28:31], s49 offen offset:448
    s_add_u32 s49, s49, 131072
    buffer_load_dwordx4 a[128:131], v6, s[28:31], s49 offen offset:0
    buffer_load_dwordx4 a[132:135], v6, s[28:31], s49 offen offset:64
    buffer_load_dwordx4 a[136:139], v6, s[28:31], s49 offen offset:128
    buffer_load_dwordx4 a[140:143], v6, s[28:31], s49 offen offset:192
    buffer_load_dwordx4 a[144:147], v6, s[28:31], s49 offen offset:256
    buffer_load_dwordx4 a[148:151], v6, s[28:31], s49 offen offset:320
    buffer_load_dwordx4 a[152:155], v6, s[28:31], s49 offen offset:384
    buffer_load_dwordx4 a[156:159], v6, s[28:31], s49 offen offset:448
    s_add_u32 s49, s49, 131072
    buffer_load_dwordx4 a[160:163], v6, s[28:31], s49 offen offset:0
    buffer_load_dwordx4 a[164:167], v6, s[28:31], s49 offen offset:64
    buffer_load_dwordx4 a[168:171], v6, s[28:31], s49 offen offset:128
    buffer_load_dwordx4 a[172:175], v6, s[28:31], s49 offen offset:192
    buffer_load_dwordx4 a[176:179], v6, s[28:31], s49 offen offset:256
    buffer_load_dwordx4 a[180:183], v6, s[28:31], s49 offen offset:320
    buffer_load_dwordx4 a[184:187], v6, s[28:31], s49 offen offset:384
    buffer_load_dwordx4 a[188:191], v6, s[28:31], s49 offen offset:448
    s_add_u32 s49, s49, 131072
    buffer_load_dwordx4 a[192:195], v6, s[28:31], s49 offen offset:0
    buffer_load_dwordx4 a[196:199], v6, s[28:31], s49 offen offset:64
    buffer_load_dwordx4 a[200:203], v6, s[28:31], s49 offen offset:128
    buffer_load_dwordx4 a[204:207], v6, s[28:31], s49 offen offset:192
    buffer_load_dwordx4 a[208:211], v6, s[28:31], s49 offen offset:256
    buffer_load_dwordx4 a[212:215], v6, s[28:31], s49 offen offset:320
    buffer_load_dwordx4 a[216:219], v6, s[28:31], s49 offen offset:384
    buffer_load_dwordx4 a[220:223], v6, s[28:31], s49 offen offset:448
    s_add_u32 s49, s49, 131072
    s_waitcnt vmcnt(56)
    ds_write_b128 v7, v[144:147] offset:0
    ds_write_b128 v7, v[148:151] offset:4096
    ds_write_b128 v7, v[152:155] offset:8192
    ds_write_b128 v7, v[156:159] offset:12288
    ds_write_b128 v7, v[160:163] offset:16384
    ds_write_b128 v7, v[164:167] offset:20480
    ds_write_b128 v7, v[168:171] offset:24576
    ds_write_b128 v7, v[172:175] offset:28672
    s_waitcnt lgkmcnt(0)
    s_barrier
    v_lshrrev_b32 v5, 2, v4
    v_lshl_add_u32 v5, v3, 3, v5
    v_lshlrev_b32 v5, 7, v5
    v_and_b32 v7, 3, v4
    v_lshl_add_u32 v5, v7, 3, v5
    ds_read_b64_tr_b16 v[16:17], v5 offset:0
    ds_read_b64_tr_b16 v[18:19], v5 offset:512
    ds_read_b64_tr_b16 v[20:21], v5 offset:4096
    ds_read_b64_tr_b16 v[22:23], v5 offset:4608
    ds_read_b64_tr_b16 v[24:25], v5 offset:8192
    ds_read_b64_tr_b16 v[26:27], v5 offset:8704
    ds_read_b64_tr_b16 v[28:29], v5 offset:12288
    ds_read_b64_tr_b16 v[30:31], v5 offset:12800
    ds_read_b64_tr_b16 v[32:33], v5 offset:16384
    ds_read_b64_tr_b16 v[34:35], v5 offset:16896
    ds_read_b64_tr_b16 v[36:37], v5 offset:20480
    ds_read_b64_tr_b16 v[38:39], v5 offset:20992
    ds_read_b64_tr_b16 v[40:41], v5 offset:24576
    ds_read_b64_tr_b16 v[42:43], v5 offset:25088
    ds_read_b64_tr_b16 v[44:45], v5 offset:28672
    ds_read_b64_tr_b16 v[46:47], v5 offset:29184
    s_waitcnt lgkmcnt(0)
    ds_read_b64_tr_b16 v[48:49], v5 offset:32
    ds_read_b64_tr_b16 v[50:51], v5 offset:544
    ds_read_b64_tr_b16 v[52:53], v5 offset:4128
    ds_read_b64_tr_b16 v[54:55], v5 offset:4640
    ds_read_b64_tr_b16 v[56:57], v5 offset:8224
    ds_read_b64_tr_b16 v[58:59], v5 offset:8736
    ds_read_b64_tr_b16 v[60:61], v5 offset:12320
    ds_read_b64_tr_b16 v[62:63], v5 offset:12832
    ds_read_b64_tr_b16 v[64:65], v5 offset:16416
    ds_read_b64_tr_b16 v[66:67], v5 offset:16928
    ds_read_b64_tr_b16 v[68:69], v5 offset:20512
    ds_read_b64_tr_b16 v[70:71], v5 offset:21024
    ds_read_b64_tr_b16 v[72:73], v5 offset:24608
    ds_read_b64_tr_b16 v[74:75], v5 offset:25120
    ds_read_b64_tr_b16 v[76:77], v5 offset:28704
    ds_read_b64_tr_b16 v[78:79], v5 offset:29216
    s_waitcnt lgkmcnt(0)
    ds_read_b64_tr_b16 v[80:81], v5 offset:64
    ds_read_b64_tr_b16 v[82:83], v5 offset:576
    ds_read_b64_tr_b16 v[84:85], v5 offset:4160
    ds_read_b64_tr_b16 v[86:87], v5 offset:4672
    ds_read_b64_tr_b16 v[88:89], v5 offset:8256
    ds_read_b64_tr_b16 v[90:91], v5 offset:8768
    ds_read_b64_tr_b16 v[92:93], v5 offset:12352
    ds_read_b64_tr_b16 v[94:95], v5 offset:12864
    ds_read_b64_tr_b16 v[96:97], v5 offset:16448
    ds_read_b64_tr_b16 v[98:99], v5 offset:16960
    ds_read_b64_tr_b16 v[100:101], v5 offset:20544
    ds_read_b64_tr_b16 v[102:103], v5 offset:21056
    ds_read_b64_tr_b16 v[104:105], v5 offset:24640
    ds_read_b64_tr_b16 v[106:107], v5 offset:25152
    ds_read_b64_tr_b16 v[108:109], v5 offset:28736
    ds_read_b64_tr_b16 v[110:111], v5 offset:29248
    s_waitcnt lgkmcnt(0)
    ds_read_b64_tr_b16 v[112:113], v5 offset:96
    ds_read_b64_tr_b16 v[114:115], v5 offset:608
    ds_read_b64_tr_b16 v[116:117], v5 offset:4192
    ds_read_b64_tr_b16 v[118:119], v5 offset:4704
    ds_read_b64_tr_b16 v[120:121], v5 offset:8288
    ds_read_b64_tr_b16 v[122:123], v5 offset:8800
    ds_read_b64_tr_b16 v[124:125], v5 offset:12384
    ds_read_b64_tr_b16 v[126:127], v5 offset:12896
    ds_read_b64_tr_b16 v[128:129], v5 offset:16480
    ds_read_b64_tr_b16 v[130:131], v5 offset:16992
    ds_read_b64_tr_b16 v[132:133], v5 offset:20576
    ds_read_b64_tr_b16 v[134:135], v5 offset:21088
    ds_read_b64_tr_b16 v[136:137], v5 offset:24672
    ds_read_b64_tr_b16 v[138:139], v5 offset:25184
    ds_read_b64_tr_b16 v[140:141], v5 offset:28768
    ds_read_b64_tr_b16 v[142:143], v5 offset:29280
    s_waitcnt lgkmcnt(0)
L_prep_bdone:
    s_mul_i32 s46, s40, 896
    s_mul_i32 s47, s42, 448
    s_add_u32 s46, s46, s47
    s_add_u32 s46, s46, s44
    v_add_u32 v7, s46, v4
    s_movk_i32 s47, 896
    v_mul_lo_u32 v7, v7, s47
    v_lshl_add_u32 v7, v3, 3, v7
    s_mul_i32 s47, s3, 224
    s_add_u32 s47, s47, 0
    v_add_u32 v7, s47, v7
    s_mov_b32 s48, 1035512379
    s_cmp_eq_u32 s42, 0
    s_cselect_b32 s48, s48, 1.0
    s_waitcnt vmcnt(48)
    v_mfma_f32_16x16x32_bf16 v[144:147], a[0:3], v[16:19], 0
    v_mfma_f32_16x16x32_bf16 v[148:151], a[0:3], v[48:51], 0
    v_mfma_f32_16x16x32_bf16 v[152:155], a[0:3], v[80:83], 0
    v_mfma_f32_16x16x32_bf16 v[156:159], a[0:3], v[112:115], 0
    v_mfma_f32_16x16x32_bf16 v[144:147], a[4:7], v[20:23], v[144:147]
    v_mfma_f32_16x16x32_bf16 v[148:151], a[4:7], v[52:55], v[148:151]
    v_mfma_f32_16x16x32_bf16 v[152:155], a[4:7], v[84:87], v[152:155]
    v_mfma_f32_16x16x32_bf16 v[156:159], a[4:7], v[116:119], v[156:159]
    v_mfma_f32_16x16x32_bf16 v[144:147], a[8:11], v[24:27], v[144:147]
    v_mfma_f32_16x16x32_bf16 v[148:151], a[8:11], v[56:59], v[148:151]
    v_mfma_f32_16x16x32_bf16 v[152:155], a[8:11], v[88:91], v[152:155]
    v_mfma_f32_16x16x32_bf16 v[156:159], a[8:11], v[120:123], v[156:159]
    v_mfma_f32_16x16x32_bf16 v[144:147], a[12:15], v[28:31], v[144:147]
    v_mfma_f32_16x16x32_bf16 v[148:151], a[12:15], v[60:63], v[148:151]
    v_mfma_f32_16x16x32_bf16 v[152:155], a[12:15], v[92:95], v[152:155]
    v_mfma_f32_16x16x32_bf16 v[156:159], a[12:15], v[124:127], v[156:159]
    v_mfma_f32_16x16x32_bf16 v[144:147], a[16:19], v[32:35], v[144:147]
    v_mfma_f32_16x16x32_bf16 v[148:151], a[16:19], v[64:67], v[148:151]
    v_mfma_f32_16x16x32_bf16 v[152:155], a[16:19], v[96:99], v[152:155]
    v_mfma_f32_16x16x32_bf16 v[156:159], a[16:19], v[128:131], v[156:159]
    v_mfma_f32_16x16x32_bf16 v[144:147], a[20:23], v[36:39], v[144:147]
    v_mfma_f32_16x16x32_bf16 v[148:151], a[20:23], v[68:71], v[148:151]
    v_mfma_f32_16x16x32_bf16 v[152:155], a[20:23], v[100:103], v[152:155]
    v_mfma_f32_16x16x32_bf16 v[156:159], a[20:23], v[132:135], v[156:159]
    v_mfma_f32_16x16x32_bf16 v[144:147], a[24:27], v[40:43], v[144:147]
    v_mfma_f32_16x16x32_bf16 v[148:151], a[24:27], v[72:75], v[148:151]
    v_mfma_f32_16x16x32_bf16 v[152:155], a[24:27], v[104:107], v[152:155]
    v_mfma_f32_16x16x32_bf16 v[156:159], a[24:27], v[136:139], v[156:159]
    v_mfma_f32_16x16x32_bf16 v[144:147], a[28:31], v[44:47], v[144:147]
    v_mfma_f32_16x16x32_bf16 v[148:151], a[28:31], v[76:79], v[148:151]
    v_mfma_f32_16x16x32_bf16 v[152:155], a[28:31], v[108:111], v[152:155]
    v_mfma_f32_16x16x32_bf16 v[156:159], a[28:31], v[140:143], v[156:159]
    s_nop 4
    v_mul_f32 v144, s48, v144
    v_mul_f32 v145, s48, v145
    v_mul_f32 v146, s48, v146
    v_mul_f32 v147, s48, v147
    v_cvt_pk_bf16_f32 v176, v144, v145
    v_cvt_pk_bf16_f32 v177, v146, v147
    s_mov_b32 s50, 0
    buffer_store_dwordx2 v[176:177], v7, s[24:27], s50 offen offset:0
    v_mul_f32 v148, s48, v148
    v_mul_f32 v149, s48, v149
    v_mul_f32 v150, s48, v150
    v_mul_f32 v151, s48, v151
    v_cvt_pk_bf16_f32 v178, v148, v149
    v_cvt_pk_bf16_f32 v179, v150, v151
    s_mov_b32 s50, 14336
    buffer_store_dwordx2 v[178:179], v7, s[24:27], s50 offen offset:0
    v_mul_f32 v152, s48, v152
    v_mul_f32 v153, s48, v153
    v_mul_f32 v154, s48, v154
    v_mul_f32 v155, s48, v155
    v_cvt_pk_bf16_f32 v180, v152, v153
    v_cvt_pk_bf16_f32 v181, v154, v155
    s_mov_b32 s50, 28672
    buffer_store_dwordx2 v[180:181], v7, s[24:27], s50 offen offset:0
    v_mul_f32 v156, s48, v156
    v_mul_f32 v157, s48, v157
    v_mul_f32 v158, s48, v158
    v_mul_f32 v159, s48, v159
    v_cvt_pk_bf16_f32 v182, v156, v157
    v_cvt_pk_bf16_f32 v183, v158, v159
    s_mov_b32 s50, 43008
    buffer_store_dwordx2 v[182:183], v7, s[24:27], s50 offen offset:0
    s_waitcnt vmcnt(44)
    v_mfma_f32_16x16x32_bf16 v[160:163], a[32:35], v[16:19], 0
    v_mfma_f32_16x16x32_bf16 v[164:167], a[32:35], v[48:51], 0
    v_mfma_f32_16x16x32_bf16 v[168:171], a[32:35], v[80:83], 0
    v_mfma_f32_16x16x32_bf16 v[172:175], a[32:35], v[112:115], 0
    v_mfma_f32_16x16x32_bf16 v[160:163], a[36:39], v[20:23], v[160:163]
    v_mfma_f32_16x16x32_bf16 v[164:167], a[36:39], v[52:55], v[164:167]
    v_mfma_f32_16x16x32_bf16 v[168:171], a[36:39], v[84:87], v[168:171]
    v_mfma_f32_16x16x32_bf16 v[172:175], a[36:39], v[116:119], v[172:175]
    v_mfma_f32_16x16x32_bf16 v[160:163], a[40:43], v[24:27], v[160:163]
    v_mfma_f32_16x16x32_bf16 v[164:167], a[40:43], v[56:59], v[164:167]
    v_mfma_f32_16x16x32_bf16 v[168:171], a[40:43], v[88:91], v[168:171]
    v_mfma_f32_16x16x32_bf16 v[172:175], a[40:43], v[120:123], v[172:175]
    v_mfma_f32_16x16x32_bf16 v[160:163], a[44:47], v[28:31], v[160:163]
    v_mfma_f32_16x16x32_bf16 v[164:167], a[44:47], v[60:63], v[164:167]
    v_mfma_f32_16x16x32_bf16 v[168:171], a[44:47], v[92:95], v[168:171]
    v_mfma_f32_16x16x32_bf16 v[172:175], a[44:47], v[124:127], v[172:175]
    v_mfma_f32_16x16x32_bf16 v[160:163], a[48:51], v[32:35], v[160:163]
    v_mfma_f32_16x16x32_bf16 v[164:167], a[48:51], v[64:67], v[164:167]
    v_mfma_f32_16x16x32_bf16 v[168:171], a[48:51], v[96:99], v[168:171]
    v_mfma_f32_16x16x32_bf16 v[172:175], a[48:51], v[128:131], v[172:175]
    v_mfma_f32_16x16x32_bf16 v[160:163], a[52:55], v[36:39], v[160:163]
    v_mfma_f32_16x16x32_bf16 v[164:167], a[52:55], v[68:71], v[164:167]
    v_mfma_f32_16x16x32_bf16 v[168:171], a[52:55], v[100:103], v[168:171]
    v_mfma_f32_16x16x32_bf16 v[172:175], a[52:55], v[132:135], v[172:175]
    v_mfma_f32_16x16x32_bf16 v[160:163], a[56:59], v[40:43], v[160:163]
    v_mfma_f32_16x16x32_bf16 v[164:167], a[56:59], v[72:75], v[164:167]
    v_mfma_f32_16x16x32_bf16 v[168:171], a[56:59], v[104:107], v[168:171]
    v_mfma_f32_16x16x32_bf16 v[172:175], a[56:59], v[136:139], v[172:175]
    v_mfma_f32_16x16x32_bf16 v[160:163], a[60:63], v[44:47], v[160:163]
    v_mfma_f32_16x16x32_bf16 v[164:167], a[60:63], v[76:79], v[164:167]
    v_mfma_f32_16x16x32_bf16 v[168:171], a[60:63], v[108:111], v[168:171]
    v_mfma_f32_16x16x32_bf16 v[172:175], a[60:63], v[140:143], v[172:175]
    s_nop 4
    v_mul_f32 v160, s48, v160
    v_mul_f32 v161, s48, v161
    v_mul_f32 v162, s48, v162
    v_mul_f32 v163, s48, v163
    v_cvt_pk_bf16_f32 v184, v160, v161
    v_cvt_pk_bf16_f32 v185, v162, v163
    s_mov_b32 s50, 0
    buffer_store_dwordx2 v[184:185], v7, s[24:27], s50 offen offset:32
    v_mul_f32 v164, s48, v164
    v_mul_f32 v165, s48, v165
    v_mul_f32 v166, s48, v166
    v_mul_f32 v167, s48, v167
    v_cvt_pk_bf16_f32 v186, v164, v165
    v_cvt_pk_bf16_f32 v187, v166, v167
    s_mov_b32 s50, 14336
    buffer_store_dwordx2 v[186:187], v7, s[24:27], s50 offen offset:32
    v_mul_f32 v168, s48, v168
    v_mul_f32 v169, s48, v169
    v_mul_f32 v170, s48, v170
    v_mul_f32 v171, s48, v171
    v_cvt_pk_bf16_f32 v188, v168, v169
    v_cvt_pk_bf16_f32 v189, v170, v171
    s_mov_b32 s50, 28672
    buffer_store_dwordx2 v[188:189], v7, s[24:27], s50 offen offset:32
    v_mul_f32 v172, s48, v172
    v_mul_f32 v173, s48, v173
    v_mul_f32 v174, s48, v174
    v_mul_f32 v175, s48, v175
    v_cvt_pk_bf16_f32 v190, v172, v173
    v_cvt_pk_bf16_f32 v191, v174, v175
    s_mov_b32 s50, 43008
    buffer_store_dwordx2 v[190:191], v7, s[24:27], s50 offen offset:32
    s_waitcnt vmcnt(40)
    v_mfma_f32_16x16x32_bf16 v[144:147], a[64:67], v[16:19], 0
    v_mfma_f32_16x16x32_bf16 v[148:151], a[64:67], v[48:51], 0
    v_mfma_f32_16x16x32_bf16 v[152:155], a[64:67], v[80:83], 0
    v_mfma_f32_16x16x32_bf16 v[156:159], a[64:67], v[112:115], 0
    v_mfma_f32_16x16x32_bf16 v[144:147], a[68:71], v[20:23], v[144:147]
    v_mfma_f32_16x16x32_bf16 v[148:151], a[68:71], v[52:55], v[148:151]
    v_mfma_f32_16x16x32_bf16 v[152:155], a[68:71], v[84:87], v[152:155]
    v_mfma_f32_16x16x32_bf16 v[156:159], a[68:71], v[116:119], v[156:159]
    v_mfma_f32_16x16x32_bf16 v[144:147], a[72:75], v[24:27], v[144:147]
    v_mfma_f32_16x16x32_bf16 v[148:151], a[72:75], v[56:59], v[148:151]
    v_mfma_f32_16x16x32_bf16 v[152:155], a[72:75], v[88:91], v[152:155]
    v_mfma_f32_16x16x32_bf16 v[156:159], a[72:75], v[120:123], v[156:159]
    v_mfma_f32_16x16x32_bf16 v[144:147], a[76:79], v[28:31], v[144:147]
    v_mfma_f32_16x16x32_bf16 v[148:151], a[76:79], v[60:63], v[148:151]
    v_mfma_f32_16x16x32_bf16 v[152:155], a[76:79], v[92:95], v[152:155]
    v_mfma_f32_16x16x32_bf16 v[156:159], a[76:79], v[124:127], v[156:159]
    v_mfma_f32_16x16x32_bf16 v[144:147], a[80:83], v[32:35], v[144:147]
    v_mfma_f32_16x16x32_bf16 v[148:151], a[80:83], v[64:67], v[148:151]
    v_mfma_f32_16x16x32_bf16 v[152:155], a[80:83], v[96:99], v[152:155]
    v_mfma_f32_16x16x32_bf16 v[156:159], a[80:83], v[128:131], v[156:159]
    v_mfma_f32_16x16x32_bf16 v[144:147], a[84:87], v[36:39], v[144:147]
    v_mfma_f32_16x16x32_bf16 v[148:151], a[84:87], v[68:71], v[148:151]
    v_mfma_f32_16x16x32_bf16 v[152:155], a[84:87], v[100:103], v[152:155]
    v_mfma_f32_16x16x32_bf16 v[156:159], a[84:87], v[132:135], v[156:159]
    v_mfma_f32_16x16x32_bf16 v[144:147], a[88:91], v[40:43], v[144:147]
    v_mfma_f32_16x16x32_bf16 v[148:151], a[88:91], v[72:75], v[148:151]
    v_mfma_f32_16x16x32_bf16 v[152:155], a[88:91], v[104:107], v[152:155]
    v_mfma_f32_16x16x32_bf16 v[156:159], a[88:91], v[136:139], v[156:159]
    v_mfma_f32_16x16x32_bf16 v[144:147], a[92:95], v[44:47], v[144:147]
    v_mfma_f32_16x16x32_bf16 v[148:151], a[92:95], v[76:79], v[148:151]
    v_mfma_f32_16x16x32_bf16 v[152:155], a[92:95], v[108:111], v[152:155]
    v_mfma_f32_16x16x32_bf16 v[156:159], a[92:95], v[140:143], v[156:159]
    s_nop 4
    v_mul_f32 v144, s48, v144
    v_mul_f32 v145, s48, v145
    v_mul_f32 v146, s48, v146
    v_mul_f32 v147, s48, v147
    v_cvt_pk_bf16_f32 v176, v144, v145
    v_cvt_pk_bf16_f32 v177, v146, v147
    s_mov_b32 s50, 0
    buffer_store_dwordx2 v[176:177], v7, s[24:27], s50 offen offset:64
    v_mul_f32 v148, s48, v148
    v_mul_f32 v149, s48, v149
    v_mul_f32 v150, s48, v150
    v_mul_f32 v151, s48, v151
    v_cvt_pk_bf16_f32 v178, v148, v149
    v_cvt_pk_bf16_f32 v179, v150, v151
    s_mov_b32 s50, 14336
    buffer_store_dwordx2 v[178:179], v7, s[24:27], s50 offen offset:64
    v_mul_f32 v152, s48, v152
    v_mul_f32 v153, s48, v153
    v_mul_f32 v154, s48, v154
    v_mul_f32 v155, s48, v155
    v_cvt_pk_bf16_f32 v180, v152, v153
    v_cvt_pk_bf16_f32 v181, v154, v155
    s_mov_b32 s50, 28672
    buffer_store_dwordx2 v[180:181], v7, s[24:27], s50 offen offset:64
    v_mul_f32 v156, s48, v156
    v_mul_f32 v157, s48, v157
    v_mul_f32 v158, s48, v158
    v_mul_f32 v159, s48, v159
    v_cvt_pk_bf16_f32 v182, v156, v157
    v_cvt_pk_bf16_f32 v183, v158, v159
    s_mov_b32 s50, 43008
    buffer_store_dwordx2 v[182:183], v7, s[24:27], s50 offen offset:64
    s_waitcnt vmcnt(36)
    v_mfma_f32_16x16x32_bf16 v[160:163], a[96:99], v[16:19], 0
    v_mfma_f32_16x16x32_bf16 v[164:167], a[96:99], v[48:51], 0
    v_mfma_f32_16x16x32_bf16 v[168:171], a[96:99], v[80:83], 0
    v_mfma_f32_16x16x32_bf16 v[172:175], a[96:99], v[112:115], 0
    v_mfma_f32_16x16x32_bf16 v[160:163], a[100:103], v[20:23], v[160:163]
    v_mfma_f32_16x16x32_bf16 v[164:167], a[100:103], v[52:55], v[164:167]
    v_mfma_f32_16x16x32_bf16 v[168:171], a[100:103], v[84:87], v[168:171]
    v_mfma_f32_16x16x32_bf16 v[172:175], a[100:103], v[116:119], v[172:175]
    v_mfma_f32_16x16x32_bf16 v[160:163], a[104:107], v[24:27], v[160:163]
    v_mfma_f32_16x16x32_bf16 v[164:167], a[104:107], v[56:59], v[164:167]
    v_mfma_f32_16x16x32_bf16 v[168:171], a[104:107], v[88:91], v[168:171]
    v_mfma_f32_16x16x32_bf16 v[172:175], a[104:107], v[120:123], v[172:175]
    v_mfma_f32_16x16x32_bf16 v[160:163], a[108:111], v[28:31], v[160:163]
    v_mfma_f32_16x16x32_bf16 v[164:167], a[108:111], v[60:63], v[164:167]
    v_mfma_f32_16x16x32_bf16 v[168:171], a[108:111], v[92:95], v[168:171]
    v_mfma_f32_16x16x32_bf16 v[172:175], a[108:111], v[124:127], v[172:175]
    v_mfma_f32_16x16x32_bf16 v[160:163], a[112:115], v[32:35], v[160:163]
    v_mfma_f32_16x16x32_bf16 v[164:167], a[112:115], v[64:67], v[164:167]
    v_mfma_f32_16x16x32_bf16 v[168:171], a[112:115], v[96:99], v[168:171]
    v_mfma_f32_16x16x32_bf16 v[172:175], a[112:115], v[128:131], v[172:175]
    v_mfma_f32_16x16x32_bf16 v[160:163], a[116:119], v[36:39], v[160:163]
    v_mfma_f32_16x16x32_bf16 v[164:167], a[116:119], v[68:71], v[164:167]
    v_mfma_f32_16x16x32_bf16 v[168:171], a[116:119], v[100:103], v[168:171]
    v_mfma_f32_16x16x32_bf16 v[172:175], a[116:119], v[132:135], v[172:175]
    v_mfma_f32_16x16x32_bf16 v[160:163], a[120:123], v[40:43], v[160:163]
    v_mfma_f32_16x16x32_bf16 v[164:167], a[120:123], v[72:75], v[164:167]
    v_mfma_f32_16x16x32_bf16 v[168:171], a[120:123], v[104:107], v[168:171]
    v_mfma_f32_16x16x32_bf16 v[172:175], a[120:123], v[136:139], v[172:175]
    v_mfma_f32_16x16x32_bf16 v[160:163], a[124:127], v[44:47], v[160:163]
    v_mfma_f32_16x16x32_bf16 v[164:167], a[124:127], v[76:79], v[164:167]
    v_mfma_f32_16x16x32_bf16 v[168:171], a[124:127], v[108:111], v[168:171]
    v_mfma_f32_16x16x32_bf16 v[172:175], a[124:127], v[140:143], v[172:175]
    s_nop 4
    v_mul_f32 v160, s48, v160
    v_mul_f32 v161, s48, v161
    v_mul_f32 v162, s48, v162
    v_mul_f32 v163, s48, v163
    v_cvt_pk_bf16_f32 v184, v160, v161
    v_cvt_pk_bf16_f32 v185, v162, v163
    s_mov_b32 s50, 0
    buffer_store_dwordx2 v[184:185], v7, s[24:27], s50 offen offset:96
    v_mul_f32 v164, s48, v164
    v_mul_f32 v165, s48, v165
    v_mul_f32 v166, s48, v166
    v_mul_f32 v167, s48, v167
    v_cvt_pk_bf16_f32 v186, v164, v165
    v_cvt_pk_bf16_f32 v187, v166, v167
    s_mov_b32 s50, 14336
    buffer_store_dwordx2 v[186:187], v7, s[24:27], s50 offen offset:96
    v_mul_f32 v168, s48, v168
    v_mul_f32 v169, s48, v169
    v_mul_f32 v170, s48, v170
    v_mul_f32 v171, s48, v171
    v_cvt_pk_bf16_f32 v188, v168, v169
    v_cvt_pk_bf16_f32 v189, v170, v171
    s_mov_b32 s50, 28672
    buffer_store_dwordx2 v[188:189], v7, s[24:27], s50 offen offset:96
    v_mul_f32 v172, s48, v172
    v_mul_f32 v173, s48, v173
    v_mul_f32 v174, s48, v174
    v_mul_f32 v175, s48, v175
    v_cvt_pk_bf16_f32 v190, v172, v173
    v_cvt_pk_bf16_f32 v191, v174, v175
    s_mov_b32 s50, 43008
    buffer_store_dwordx2 v[190:191], v7, s[24:27], s50 offen offset:96
    s_waitcnt vmcnt(32)
    v_mfma_f32_16x16x32_bf16 v[144:147], a[128:131], v[16:19], 0
    v_mfma_f32_16x16x32_bf16 v[148:151], a[128:131], v[48:51], 0
    v_mfma_f32_16x16x32_bf16 v[152:155], a[128:131], v[80:83], 0
    v_mfma_f32_16x16x32_bf16 v[156:159], a[128:131], v[112:115], 0
    v_mfma_f32_16x16x32_bf16 v[144:147], a[132:135], v[20:23], v[144:147]
    v_mfma_f32_16x16x32_bf16 v[148:151], a[132:135], v[52:55], v[148:151]
    v_mfma_f32_16x16x32_bf16 v[152:155], a[132:135], v[84:87], v[152:155]
    v_mfma_f32_16x16x32_bf16 v[156:159], a[132:135], v[116:119], v[156:159]
    v_mfma_f32_16x16x32_bf16 v[144:147], a[136:139], v[24:27], v[144:147]
    v_mfma_f32_16x16x32_bf16 v[148:151], a[136:139], v[56:59], v[148:151]
    v_mfma_f32_16x16x32_bf16 v[152:155], a[136:139], v[88:91], v[152:155]
    v_mfma_f32_16x16x32_bf16 v[156:159], a[136:139], v[120:123], v[156:159]
    v_mfma_f32_16x16x32_bf16 v[144:147], a[140:143], v[28:31], v[144:147]
    v_mfma_f32_16x16x32_bf16 v[148:151], a[140:143], v[60:63], v[148:151]
    v_mfma_f32_16x16x32_bf16 v[152:155], a[140:143], v[92:95], v[152:155]
    v_mfma_f32_16x16x32_bf16 v[156:159], a[140:143], v[124:127], v[156:159]
    v_mfma_f32_16x16x32_bf16 v[144:147], a[144:147], v[32:35], v[144:147]
    v_mfma_f32_16x16x32_bf16 v[148:151], a[144:147], v[64:67], v[148:151]
    v_mfma_f32_16x16x32_bf16 v[152:155], a[144:147], v[96:99], v[152:155]
    v_mfma_f32_16x16x32_bf16 v[156:159], a[144:147], v[128:131], v[156:159]
    v_mfma_f32_16x16x32_bf16 v[144:147], a[148:151], v[36:39], v[144:147]
    v_mfma_f32_16x16x32_bf16 v[148:151], a[148:151], v[68:71], v[148:151]
    v_mfma_f32_16x16x32_bf16 v[152:155], a[148:151], v[100:103], v[152:155]
    v_mfma_f32_16x16x32_bf16 v[156:159], a[148:151], v[132:135], v[156:159]
    v_mfma_f32_16x16x32_bf16 v[144:147], a[152:155], v[40:43], v[144:147]
    v_mfma_f32_16x16x32_bf16 v[148:151], a[152:155], v[72:75], v[148:151]
    v_mfma_f32_16x16x32_bf16 v[152:155], a[152:155], v[104:107], v[152:155]
    v_mfma_f32_16x16x32_bf16 v[156:159], a[152:155], v[136:139], v[156:159]
    v_mfma_f32_16x16x32_bf16 v[144:147], a[156:159], v[44:47], v[144:147]
    v_mfma_f32_16x16x32_bf16 v[148:151], a[156:159], v[76:79], v[148:151]
    v_mfma_f32_16x16x32_bf16 v[152:155], a[156:159], v[108:111], v[152:155]
    v_mfma_f32_16x16x32_bf16 v[156:159], a[156:159], v[140:143], v[156:159]
    s_nop 4
    v_mul_f32 v144, s48, v144
    v_mul_f32 v145, s48, v145
    v_mul_f32 v146, s48, v146
    v_mul_f32 v147, s48, v147
    v_cvt_pk_bf16_f32 v176, v144, v145
    v_cvt_pk_bf16_f32 v177, v146, v147
    s_mov_b32 s50, 0
    buffer_store_dwordx2 v[176:177], v7, s[24:27], s50 offen offset:128
    v_mul_f32 v148, s48, v148
    v_mul_f32 v149, s48, v149
    v_mul_f32 v150, s48, v150
    v_mul_f32 v151, s48, v151
    v_cvt_pk_bf16_f32 v178, v148, v149
    v_cvt_pk_bf16_f32 v179, v150, v151
    s_mov_b32 s50, 14336
    buffer_store_dwordx2 v[178:179], v7, s[24:27], s50 offen offset:128
    v_mul_f32 v152, s48, v152
    v_mul_f32 v153, s48, v153
    v_mul_f32 v154, s48, v154
    v_mul_f32 v155, s48, v155
    v_cvt_pk_bf16_f32 v180, v152, v153
    v_cvt_pk_bf16_f32 v181, v154, v155
    s_mov_b32 s50, 28672
    buffer_store_dwordx2 v[180:181], v7, s[24:27], s50 offen offset:128
    v_mul_f32 v156, s48, v156
    v_mul_f32 v157, s48, v157
    v_mul_f32 v158, s48, v158
    v_mul_f32 v159, s48, v159
    v_cvt_pk_bf16_f32 v182, v156, v157
    v_cvt_pk_bf16_f32 v183, v158, v159
    s_mov_b32 s50, 43008
    buffer_store_dwordx2 v[182:183], v7, s[24:27], s50 offen offset:128
    s_waitcnt vmcnt(28)
    v_mfma_f32_16x16x32_bf16 v[160:163], a[160:163], v[16:19], 0
    v_mfma_f32_16x16x32_bf16 v[164:167], a[160:163], v[48:51], 0
    v_mfma_f32_16x16x32_bf16 v[168:171], a[160:163], v[80:83], 0
    v_mfma_f32_16x16x32_bf16 v[172:175], a[160:163], v[112:115], 0
    v_mfma_f32_16x16x32_bf16 v[160:163], a[164:167], v[20:23], v[160:163]
    v_mfma_f32_16x16x32_bf16 v[164:167], a[164:167], v[52:55], v[164:167]
    v_mfma_f32_16x16x32_bf16 v[168:171], a[164:167], v[84:87], v[168:171]
    v_mfma_f32_16x16x32_bf16 v[172:175], a[164:167], v[116:119], v[172:175]
    v_mfma_f32_16x16x32_bf16 v[160:163], a[168:171], v[24:27], v[160:163]
    v_mfma_f32_16x16x32_bf16 v[164:167], a[168:171], v[56:59], v[164:167]
    v_mfma_f32_16x16x32_bf16 v[168:171], a[168:171], v[88:91], v[168:171]
    v_mfma_f32_16x16x32_bf16 v[172:175], a[168:171], v[120:123], v[172:175]
    v_mfma_f32_16x16x32_bf16 v[160:163], a[172:175], v[28:31], v[160:163]
    v_mfma_f32_16x16x32_bf16 v[164:167], a[172:175], v[60:63], v[164:167]
    v_mfma_f32_16x16x32_bf16 v[168:171], a[172:175], v[92:95], v[168:171]
    v_mfma_f32_16x16x32_bf16 v[172:175], a[172:175], v[124:127], v[172:175]
    v_mfma_f32_16x16x32_bf16 v[160:163], a[176:179], v[32:35], v[160:163]
    v_mfma_f32_16x16x32_bf16 v[164:167], a[176:179], v[64:67], v[164:167]
    v_mfma_f32_16x16x32_bf16 v[168:171], a[176:179], v[96:99], v[168:171]
    v_mfma_f32_16x16x32_bf16 v[172:175], a[176:179], v[128:131], v[172:175]
    v_mfma_f32_16x16x32_bf16 v[160:163], a[180:183], v[36:39], v[160:163]
    v_mfma_f32_16x16x32_bf16 v[164:167], a[180:183], v[68:71], v[164:167]
    v_mfma_f32_16x16x32_bf16 v[168:171], a[180:183], v[100:103], v[168:171]
    v_mfma_f32_16x16x32_bf16 v[172:175], a[180:183], v[132:135], v[172:175]
    v_mfma_f32_16x16x32_bf16 v[160:163], a[184:187], v[40:43], v[160:163]
    v_mfma_f32_16x16x32_bf16 v[164:167], a[184:187], v[72:75], v[164:167]
    v_mfma_f32_16x16x32_bf16 v[168:171], a[184:187], v[104:107], v[168:171]
    v_mfma_f32_16x16x32_bf16 v[172:175], a[184:187], v[136:139], v[172:175]
    v_mfma_f32_16x16x32_bf16 v[160:163], a[188:191], v[44:47], v[160:163]
    v_mfma_f32_16x16x32_bf16 v[164:167], a[188:191], v[76:79], v[164:167]
    v_mfma_f32_16x16x32_bf16 v[168:171], a[188:191], v[108:111], v[168:171]
    v_mfma_f32_16x16x32_bf16 v[172:175], a[188:191], v[140:143], v[172:175]
    s_nop 4
    v_mul_f32 v160, s48, v160
    v_mul_f32 v161, s48, v161
    v_mul_f32 v162, s48, v162
    v_mul_f32 v163, s48, v163
    v_cvt_pk_bf16_f32 v184, v160, v161
    v_cvt_pk_bf16_f32 v185, v162, v163
    s_mov_b32 s50, 0
    buffer_store_dwordx2 v[184:185], v7, s[24:27], s50 offen offset:160
    v_mul_f32 v164, s48, v164
    v_mul_f32 v165, s48, v165
    v_mul_f32 v166, s48, v166
    v_mul_f32 v167, s48, v167
    v_cvt_pk_bf16_f32 v186, v164, v165
    v_cvt_pk_bf16_f32 v187, v166, v167
    s_mov_b32 s50, 14336
    buffer_store_dwordx2 v[186:187], v7, s[24:27], s50 offen offset:160
    v_mul_f32 v168, s48, v168
    v_mul_f32 v169, s48, v169
    v_mul_f32 v170, s48, v170
    v_mul_f32 v171, s48, v171
    v_cvt_pk_bf16_f32 v188, v168, v169
    v_cvt_pk_bf16_f32 v189, v170, v171
    s_mov_b32 s50, 28672
    buffer_store_dwordx2 v[188:189], v7, s[24:27], s50 offen offset:160
    v_mul_f32 v172, s48, v172
    v_mul_f32 v173, s48, v173
    v_mul_f32 v174, s48, v174
    v_mul_f32 v175, s48, v175
    v_cvt_pk_bf16_f32 v190, v172, v173
    v_cvt_pk_bf16_f32 v191, v174, v175
    s_mov_b32 s50, 43008
    buffer_store_dwordx2 v[190:191], v7, s[24:27], s50 offen offset:160
    s_waitcnt vmcnt(24)
    v_mfma_f32_16x16x32_bf16 v[144:147], a[192:195], v[16:19], 0
    v_mfma_f32_16x16x32_bf16 v[148:151], a[192:195], v[48:51], 0
    v_mfma_f32_16x16x32_bf16 v[152:155], a[192:195], v[80:83], 0
    v_mfma_f32_16x16x32_bf16 v[156:159], a[192:195], v[112:115], 0
    v_mfma_f32_16x16x32_bf16 v[144:147], a[196:199], v[20:23], v[144:147]
    v_mfma_f32_16x16x32_bf16 v[148:151], a[196:199], v[52:55], v[148:151]
    v_mfma_f32_16x16x32_bf16 v[152:155], a[196:199], v[84:87], v[152:155]
    v_mfma_f32_16x16x32_bf16 v[156:159], a[196:199], v[116:119], v[156:159]
    v_mfma_f32_16x16x32_bf16 v[144:147], a[200:203], v[24:27], v[144:147]
    v_mfma_f32_16x16x32_bf16 v[148:151], a[200:203], v[56:59], v[148:151]
    v_mfma_f32_16x16x32_bf16 v[152:155], a[200:203], v[88:91], v[152:155]
    v_mfma_f32_16x16x32_bf16 v[156:159], a[200:203], v[120:123], v[156:159]
    v_mfma_f32_16x16x32_bf16 v[144:147], a[204:207], v[28:31], v[144:147]
    v_mfma_f32_16x16x32_bf16 v[148:151], a[204:207], v[60:63], v[148:151]
    v_mfma_f32_16x16x32_bf16 v[152:155], a[204:207], v[92:95], v[152:155]
    v_mfma_f32_16x16x32_bf16 v[156:159], a[204:207], v[124:127], v[156:159]
    v_mfma_f32_16x16x32_bf16 v[144:147], a[208:211], v[32:35], v[144:147]
    v_mfma_f32_16x16x32_bf16 v[148:151], a[208:211], v[64:67], v[148:151]
    v_mfma_f32_16x16x32_bf16 v[152:155], a[208:211], v[96:99], v[152:155]
    v_mfma_f32_16x16x32_bf16 v[156:159], a[208:211], v[128:131], v[156:159]
    v_mfma_f32_16x16x32_bf16 v[144:147], a[212:215], v[36:39], v[144:147]
    v_mfma_f32_16x16x32_bf16 v[148:151], a[212:215], v[68:71], v[148:151]
    v_mfma_f32_16x16x32_bf16 v[152:155], a[212:215], v[100:103], v[152:155]
    v_mfma_f32_16x16x32_bf16 v[156:159], a[212:215], v[132:135], v[156:159]
    v_mfma_f32_16x16x32_bf16 v[144:147], a[216:219], v[40:43], v[144:147]
    v_mfma_f32_16x16x32_bf16 v[148:151], a[216:219], v[72:75], v[148:151]
    v_mfma_f32_16x16x32_bf16 v[152:155], a[216:219], v[104:107], v[152:155]
    v_mfma_f32_16x16x32_bf16 v[156:159], a[216:219], v[136:139], v[156:159]
    v_mfma_f32_16x16x32_bf16 v[144:147], a[220:223], v[44:47], v[144:147]
    v_mfma_f32_16x16x32_bf16 v[148:151], a[220:223], v[76:79], v[148:151]
    v_mfma_f32_16x16x32_bf16 v[152:155], a[220:223], v[108:111], v[152:155]
    v_mfma_f32_16x16x32_bf16 v[156:159], a[220:223], v[140:143], v[156:159]
    s_nop 4
    v_mul_f32 v144, s48, v144
    v_mul_f32 v145, s48, v145
    v_mul_f32 v146, s48, v146
    v_mul_f32 v147, s48, v147
    v_cvt_pk_bf16_f32 v176, v144, v145
    v_cvt_pk_bf16_f32 v177, v146, v147
    s_mov_b32 s50, 0
    buffer_store_dwordx2 v[176:177], v7, s[24:27], s50 offen offset:192
    v_mul_f32 v148, s48, v148
    v_mul_f32 v149, s48, v149
    v_mul_f32 v150, s48, v150
    v_mul_f32 v151, s48, v151
    v_cvt_pk_bf16_f32 v178, v148, v149
    v_cvt_pk_bf16_f32 v179, v150, v151
    s_mov_b32 s50, 14336
    buffer_store_dwordx2 v[178:179], v7, s[24:27], s50 offen offset:192
    v_mul_f32 v152, s48, v152
    v_mul_f32 v153, s48, v153
    v_mul_f32 v154, s48, v154
    v_mul_f32 v155, s48, v155
    v_cvt_pk_bf16_f32 v180, v152, v153
    v_cvt_pk_bf16_f32 v181, v154, v155
    s_mov_b32 s50, 28672
    buffer_store_dwordx2 v[180:181], v7, s[24:27], s50 offen offset:192
    v_mul_f32 v156, s48, v156
    v_mul_f32 v157, s48, v157
    v_mul_f32 v158, s48, v158
    v_mul_f32 v159, s48, v159
    v_cvt_pk_bf16_f32 v182, v156, v157
    v_cvt_pk_bf16_f32 v183, v158, v159
    s_mov_b32 s50, 43008
    buffer_store_dwordx2 v[182:183], v7, s[24:27], s50 offen offset:192
    v_mov_b32 v16, -1
    v_mov_b32 v17, -1
    v_mov_b32 v18, -1
    v_mov_b32 v19, -1
    v_lshlrev_b32 v5, 4, v0
    s_mul_i32 s46, s2, 36864
    s_add_u32 s46, s46, 104980480
    s_sub_u32 s46, s46, 114688
    buffer_store_dwordx4 v[16:19], v5, s[24:27], s46 offen
    s_add_u32 s46, s46, 4096
    buffer_store_dwordx4 v[16:19], v5, s[24:27], s46 offen
    s_add_u32 s46, s46, 4096
    buffer_store_dwordx4 v[16:19], v5, s[24:27], s46 offen
    s_add_u32 s46, s46, 4096
    buffer_store_dwordx4 v[16:19], v5, s[24:27], s46 offen
    s_add_u32 s46, s46, 4096
    buffer_store_dwordx4 v[16:19], v5, s[24:27], s46 offen
    s_add_u32 s46, s46, 4096
    buffer_store_dwordx4 v[16:19], v5, s[24:27], s46 offen
    s_add_u32 s46, s46, 4096
    buffer_store_dwordx4 v[16:19], v5, s[24:27], s46 offen
    s_add_u32 s46, s46, 4096
    buffer_store_dwordx4 v[16:19], v5, s[24:27], s46 offen
    s_add_u32 s46, s46, 4096
    buffer_store_dwordx4 v[16:19], v5, s[24:27], s46 offen
    s_add_u32 s46, s46, 4096
    s_branch L_prep_end
L_prep_b:
    s_cmp_ge_u32 s2, 236
    s_cbranch_scc1 L_prep_c
    s_mov_b32 s28, s16
    s_mov_b32 s29, s17
    s_mov_b32 s30, 1204224
    s_mov_b32 s31, 0x00020000
    s_mov_b32 s32, s18
    s_mov_b32 s33, s19
    s_mov_b32 s34, 25088
    s_mov_b32 s35, 0x00020000
    s_sub_u32 s40, s2, 224
    s_lshl_b32 s40, s40, 2
    s_add_u32 s40, s40, s3
    s_lshr_b32 s41, s40, 4
    s_and_b32 s42, s40, 15
    v_mov_b32 v16, 0
    v_mov_b32 v17, 0
    v_mov_b32 v18, 0
    v_mov_b32 v19, 0
    v_mov_b32 v20, 0
    v_mov_b32 v21, 0
    v_mov_b32 v22, 0
    v_mov_b32 v23, 0
    s_mul_i32 s43, s41, 896
    s_mul_i32 s44, s42, 56
    s_add_u32 s43, s43, s44
    s_movk_i32 s44, 2688
    v_mul_lo_u32 v9, v4, s44
    v_lshl_add_u32 v9, v3, 4, v9
    v_add_u32 v9, s43, v9
    s_mov_b32 s49, 0
    buffer_load_dwordx4 v[64:67], v9, s[28:31], s49 offen
    s_add_u32 s49, s49, 43008
    buffer_load_dwordx4 v[68:71], v9, s[28:31], s49 offen
    s_add_u32 s49, s49, 43008
    buffer_load_dwordx4 v[72:75], v9, s[28:31], s49 offen
    s_add_u32 s49, s49, 43008
    buffer_load_dwordx4 v[76:79], v9, s[28:31], s49 offen
    s_add_u32 s49, s49, 43008
    buffer_load_dwordx4 v[80:83], v9, s[28:31], s49 offen
    s_add_u32 s49, s49, 43008
    buffer_load_dwordx4 v[84:87], v9, s[28:31], s49 offen
    s_add_u32 s49, s49, 43008
    buffer_load_dwordx4 v[88:91], v9, s[28:31], s49 offen
    s_add_u32 s49, s49, 43008
    buffer_load_dwordx4 v[92:95], v9, s[28:31], s49 offen
    s_add_u32 s49, s49, 43008
    buffer_load_dwordx4 v[96:99], v9, s[28:31], s49 offen
    s_add_u32 s49, s49, 43008
    buffer_load_dwordx4 v[100:103], v9, s[28:31], s49 offen
    s_add_u32 s49, s49, 43008
    buffer_load_dwordx4 v[104:107], v9, s[28:31], s49 offen
    s_add_u32 s49, s49, 43008
    buffer_load_dwordx4 v[108:111], v9, s[28:31], s49 offen
    s_add_u32 s49, s49, 43008
    buffer_load_dwordx4 v[112:115], v9, s[28:31], s49 offen
    s_add_u32 s49, s49, 43008
    buffer_load_dwordx4 v[116:119], v9, s[28:31], s49 offen
    s_add_u32 s49, s49, 43008
    buffer_load_dwordx4 v[120:123], v9, s[28:31], s49 offen
    s_add_u32 s49, s49, 43008
    buffer_load_dwordx4 v[124:127], v9, s[28:31], s49 offen
    s_add_u32 s49, s49, 43008
    buffer_load_dwordx4 v[128:131], v9, s[28:31], s49 offen
    s_add_u32 s49, s49, 43008
    buffer_load_dwordx4 v[132:135], v9, s[28:31], s49 offen
    s_add_u32 s49, s49, 43008
    buffer_load_dwordx4 v[136:139], v9, s[28:31], s49 offen
    s_add_u32 s49, s49, 43008
    buffer_load_dwordx4 v[140:143], v9, s[28:31], s49 offen
    s_add_u32 s49, s49, 43008
    buffer_load_dwordx4 v[144:147], v9, s[28:31], s49 offen
    s_add_u32 s49, s49, 43008
    buffer_load_dwordx4 v[148:151], v9, s[28:31], s49 offen
    s_add_u32 s49, s49, 43008
    buffer_load_dwordx4 v[152:155], v9, s[28:31], s49 offen
    s_add_u32 s49, s49, 43008
    buffer_load_dwordx4 v[156:159], v9, s[28:31], s49 offen
    s_add_u32 s49, s49, 43008
    buffer_load_dwordx4 v[160:163], v9, s[28:31], s49 offen
    s_add_u32 s49, s49, 43008
    buffer_load_dwordx4 v[164:167], v9, s[28:31], s49 offen
    s_add_u32 s49, s49, 43008
    buffer_load_dwordx4 v[168:171], v9, s[28:31], s49 offen
    s_add_u32 s49, s49, 43008
    buffer_load_dwordx4 v[172:175], v9, s[28:31], s49 offen
    s_add_u32 s49, s49, 43008
    s_cmp_eq_u32 s41, 2
    s_cbranch_scc1 L_prep_ident
    s_mul_i32 s43, s42, 1568
    v_mul_u32_u24 v5, 448, v3
    v_lshl_add_u32 v5, v4, 1, v5
    v_add_u32 v5, s43, v5
    v_mov_b32 v8, 0x7ff00000
    v_mov_b32 v6, v5
    buffer_load_ushort v48, v6, s[32:35], 0 offen offset:0
    v_mov_b32 v6, v5
    buffer_load_ushort v49, v6, s[32:35], 0 offen offset:56
    v_mov_b32 v6, v5
    buffer_load_ushort v50, v6, s[32:35], 0 offen offset:112
    v_mov_b32 v6, v5
    buffer_load_ushort v51, v6, s[32:35], 0 offen offset:168
    v_mov_b32 v6, v5
    v_cmp_eq_u32 vcc, 3, v3
    s_nop 1
    v_cndmask_b32 v6, v6, v8, vcc
    buffer_load_ushort v52, v6, s[32:35], 0 offen offset:224
    v_mov_b32 v6, v5
    v_cmp_eq_u32 vcc, 3, v3
    s_nop 1
    v_cndmask_b32 v6, v6, v8, vcc
    buffer_load_ushort v53, v6, s[32:35], 0 offen offset:280
    v_mov_b32 v6, v5
    v_cmp_eq_u32 vcc, 3, v3
    s_nop 1
    v_cndmask_b32 v6, v6, v8, vcc
    buffer_load_ushort v54, v6, s[32:35], 0 offen offset:336
    v_mov_b32 v6, v5
    v_cmp_eq_u32 vcc, 3, v3
    s_nop 1
    v_cndmask_b32 v6, v6, v8, vcc
    buffer_load_ushort v55, v6, s[32:35], 0 offen offset:392
    v_mov_b32 v6, v5
    v_cmp_lt_u32 vcc, 11, v4
    s_nop 1
    v_cndmask_b32 v6, v6, v8, vcc
    buffer_load_ushort v56, v6, s[32:35], 0 offen offset:32
    v_mov_b32 v6, v5
    v_cmp_lt_u32 vcc, 11, v4
    s_nop 1
    v_cndmask_b32 v6, v6, v8, vcc
    buffer_load_ushort v57, v6, s[32:35], 0 offen offset:88
    v_mov_b32 v6, v5
    v_cmp_lt_u32 vcc, 11, v4
    s_nop 1
    v_cndmask_b32 v6, v6, v8, vcc
    buffer_load_ushort v58, v6, s[32:35], 0 offen offset:144
    v_mov_b32 v6, v5
    v_cmp_lt_u32 vcc, 11, v4
    s_nop 1
    v_cndmask_b32 v6, v6, v8, vcc
    buffer_load_ushort v59, v6, s[32:35], 0 offen offset:200
    v_mov_b32 v6, v5
    v_cmp_eq_u32 vcc, 3, v3
    s_nop 1
    v_cndmask_b32 v6, v6, v8, vcc
    v_cmp_lt_u32 vcc, 11, v4
    s_nop 1
    v_cndmask_b32 v6, v6, v8, vcc
    buffer_load_ushort v60, v6, s[32:35], 0 offen offset:256
    v_mov_b32 v6, v5
    v_cmp_eq_u32 vcc, 3, v3
    s_nop 1
    v_cndmask_b32 v6, v6, v8, vcc
    v_cmp_lt_u32 vcc, 11, v4
    s_nop 1
    v_cndmask_b32 v6, v6, v8, vcc
    buffer_load_ushort v61, v6, s[32:35], 0 offen offset:312
    v_mov_b32 v6, v5
    v_cmp_eq_u32 vcc, 3, v3
    s_nop 1
    v_cndmask_b32 v6, v6, v8, vcc
    v_cmp_lt_u32 vcc, 11, v4
    s_nop 1
    v_cndmask_b32 v6, v6, v8, vcc
    buffer_load_ushort v62, v6, s[32:35], 0 offen offset:368
    v_mov_b32 v6, v5
    v_cmp_eq_u32 vcc, 3, v3
    s_nop 1
    v_cndmask_b32 v6, v6, v8, vcc
    v_cmp_lt_u32 vcc, 11, v4
    s_nop 1
    v_cndmask_b32 v6, v6, v8, vcc
    buffer_load_ushort v63, v6, s[32:35], 0 offen offset:424
    s_waitcnt vmcnt(0)
    v_lshl_or_b32 v16, v49, 16, v48
    v_lshl_or_b32 v17, v51, 16, v50
    v_lshl_or_b32 v18, v53, 16, v52
    v_lshl_or_b32 v19, v55, 16, v54
    v_lshl_or_b32 v20, v57, 16, v56
    v_lshl_or_b32 v21, v59, 16, v58
    v_lshl_or_b32 v22, v61, 16, v60
    v_lshl_or_b32 v23, v63, 16, v62
    s_branch L_prep_identdone
L_prep_ident:
    v_lshlrev_b32 v5, 3, v3
    v_add_u32 v6, 0, v5
    v_cmp_eq_u32 vcc, v6, v4
    v_mov_b32 v7, 16256
    s_nop 0
    v_cndmask_b32 v7, 0, v7, vcc
    v_or_b32 v16, v16, v7
    v_add_u32 v6, 1, v5
    v_cmp_eq_u32 vcc, v6, v4
    v_mov_b32 v7, 1065353216
    s_nop 0
    v_cndmask_b32 v7, 0, v7, vcc
    v_or_b32 v16, v16, v7
    v_add_u32 v6, 2, v5
    v_cmp_eq_u32 vcc, v6, v4
    v_mov_b32 v7, 16256
    s_nop 0
    v_cndmask_b32 v7, 0, v7, vcc
    v_or_b32 v17, v17, v7
    v_add_u32 v6, 3, v5
    v_cmp_eq_u32 vcc, v6, v4
    v_mov_b32 v7, 1065353216
    s_nop 0
    v_cndmask_b32 v7, 0, v7, vcc
    v_or_b32 v17, v17, v7
    v_add_u32 v6, 4, v5
    v_cmp_eq_u32 vcc, v6, v4
    v_mov_b32 v7, 16256
    s_nop 0
    v_cndmask_b32 v7, 0, v7, vcc
    v_or_b32 v18, v18, v7
    v_add_u32 v6, 5, v5
    v_cmp_eq_u32 vcc, v6, v4
    v_mov_b32 v7, 1065353216
    s_nop 0
    v_cndmask_b32 v7, 0, v7, vcc
    v_or_b32 v18, v18, v7
    v_add_u32 v6, 6, v5
    v_cmp_eq_u32 vcc, v6, v4
    v_mov_b32 v7, 16256
    s_nop 0
    v_cndmask_b32 v7, 0, v7, vcc
    v_or_b32 v19, v19, v7
    v_add_u32 v6, 7, v5
    v_cmp_eq_u32 vcc, v6, v4
    v_mov_b32 v7, 1065353216
    s_nop 0
    v_cndmask_b32 v7, 0, v7, vcc
    v_or_b32 v19, v19, v7
    v_add_u32 v6, -16, v5
    v_cmp_eq_u32 vcc, v6, v4
    v_mov_b32 v7, 16256
    s_nop 0
    v_cndmask_b32 v7, 0, v7, vcc
    v_or_b32 v20, v20, v7
    v_add_u32 v6, -15, v5
    v_cmp_eq_u32 vcc, v6, v4
    v_mov_b32 v7, 1065353216
    s_nop 0
    v_cndmask_b32 v7, 0, v7, vcc
    v_or_b32 v20, v20, v7
    v_add_u32 v6, -14, v5
    v_cmp_eq_u32 vcc, v6, v4
    v_mov_b32 v7, 16256
    s_nop 0
    v_cndmask_b32 v7, 0, v7, vcc
    v_or_b32 v21, v21, v7
    v_add_u32 v6, -13, v5
    v_cmp_eq_u32 vcc, v6, v4
    v_mov_b32 v7, 1065353216
    s_nop 0
    v_cndmask_b32 v7, 0, v7, vcc
    v_or_b32 v21, v21, v7
    v_add_u32 v6, -12, v5
    v_cmp_eq_u32 vcc, v6, v4
    v_mov_b32 v7, 16256
    s_nop 0
    v_cndmask_b32 v7, 0, v7, vcc
    v_cmp_gt_u32 vcc, 3, v3
    s_nop 1
    v_cndmask_b32 v7, 0, v7, vcc
    v_or_b32 v22, v22, v7
    v_add_u32 v6, -11, v5
    v_cmp_eq_u32 vcc, v6, v4
    v_mov_b32 v7, 1065353216
    s_nop 0
    v_cndmask_b32 v7, 0, v7, vcc
    v_cmp_gt_u32 vcc, 3, v3
    s_nop 1
    v_cndmask_b32 v7, 0, v7, vcc
    v_or_b32 v22, v22, v7
    v_add_u32 v6, -10, v5
    v_cmp_eq_u32 vcc, v6, v4
    v_mov_b32 v7, 16256
    s_nop 0
    v_cndmask_b32 v7, 0, v7, vcc
    v_cmp_gt_u32 vcc, 3, v3
    s_nop 1
    v_cndmask_b32 v7, 0, v7, vcc
    v_or_b32 v23, v23, v7
    v_add_u32 v6, -9, v5
    v_cmp_eq_u32 vcc, v6, v4
    v_mov_b32 v7, 1065353216
    s_nop 0
    v_cndmask_b32 v7, 0, v7, vcc
    v_cmp_gt_u32 vcc, 3, v3
    s_nop 1
    v_cndmask_b32 v7, 0, v7, vcc
    v_or_b32 v23, v23, v7
L_prep_identdone:
    s_mul_i32 s43, s41, 896
    s_mul_i32 s44, s42, 56
    s_add_u32 s43, s43, s44
    s_movk_i32 s44, 2688
    v_mul_lo_u32 v6, v4, s44
    v_lshl_add_u32 v6, v3, 4, v6
    v_add_u32 v6, s43, v6
    s_lshl_b32 s43, s41, 9
    s_lshl_b32 s44, s42, 5
    s_add_u32 s43, s43, s44
    v_add_u32 v7, s43, v4
    s_movk_i32 s44, 896
    v_mul_lo_u32 v7, v7, s44
    v_lshl_add_u32 v7, v3, 3, v7
    v_add_u32 v7, 13631488, v7
    v_add_u32 v8, 14336, v7
    s_mov_b32 s49, 0
    s_mov_b32 s50, 0
    s_mov_b32 s51, 0
    s_waitcnt vmcnt(0)
    v_mfma_f32_16x16x32_bf16 v[36:39], v[64:67], v[16:19], 0
    v_mfma_f32_16x16x32_bf16 v[40:43], v[64:67], v[20:23], 0
    s_nop 6
    v_cvt_pk_bf16_f32 v44, v36, v37
    v_cvt_pk_bf16_f32 v45, v38, v39
    buffer_store_dwordx2 v[44:45], v7, s[24:27], 0 offen offset:0
    v_cvt_pk_bf16_f32 v46, v40, v41
    v_cvt_pk_bf16_f32 v47, v42, v43
    buffer_store_dwordx2 v[46:47], v8, s[24:27], 0 offen offset:0
    v_mfma_f32_16x16x32_bf16 v[36:39], v[68:71], v[16:19], 0
    v_mfma_f32_16x16x32_bf16 v[40:43], v[68:71], v[20:23], 0
    s_nop 6
    v_cvt_pk_bf16_f32 v44, v36, v37
    v_cvt_pk_bf16_f32 v45, v38, v39
    buffer_store_dwordx2 v[44:45], v7, s[24:27], 0 offen offset:32
    v_cvt_pk_bf16_f32 v46, v40, v41
    v_cvt_pk_bf16_f32 v47, v42, v43
    buffer_store_dwordx2 v[46:47], v8, s[24:27], 0 offen offset:32
    v_mfma_f32_16x16x32_bf16 v[36:39], v[72:75], v[16:19], 0
    v_mfma_f32_16x16x32_bf16 v[40:43], v[72:75], v[20:23], 0
    s_nop 6
    v_cvt_pk_bf16_f32 v44, v36, v37
    v_cvt_pk_bf16_f32 v45, v38, v39
    buffer_store_dwordx2 v[44:45], v7, s[24:27], 0 offen offset:64
    v_cvt_pk_bf16_f32 v46, v40, v41
    v_cvt_pk_bf16_f32 v47, v42, v43
    buffer_store_dwordx2 v[46:47], v8, s[24:27], 0 offen offset:64
    v_mfma_f32_16x16x32_bf16 v[36:39], v[76:79], v[16:19], 0
    v_mfma_f32_16x16x32_bf16 v[40:43], v[76:79], v[20:23], 0
    s_nop 6
    v_cvt_pk_bf16_f32 v44, v36, v37
    v_cvt_pk_bf16_f32 v45, v38, v39
    buffer_store_dwordx2 v[44:45], v7, s[24:27], 0 offen offset:96
    v_cvt_pk_bf16_f32 v46, v40, v41
    v_cvt_pk_bf16_f32 v47, v42, v43
    buffer_store_dwordx2 v[46:47], v8, s[24:27], 0 offen offset:96
    v_mfma_f32_16x16x32_bf16 v[36:39], v[80:83], v[16:19], 0
    v_mfma_f32_16x16x32_bf16 v[40:43], v[80:83], v[20:23], 0
    s_nop 6
    v_cvt_pk_bf16_f32 v44, v36, v37
    v_cvt_pk_bf16_f32 v45, v38, v39
    buffer_store_dwordx2 v[44:45], v7, s[24:27], 0 offen offset:128
    v_cvt_pk_bf16_f32 v46, v40, v41
    v_cvt_pk_bf16_f32 v47, v42, v43
    buffer_store_dwordx2 v[46:47], v8, s[24:27], 0 offen offset:128
    v_mfma_f32_16x16x32_bf16 v[36:39], v[84:87], v[16:19], 0
    v_mfma_f32_16x16x32_bf16 v[40:43], v[84:87], v[20:23], 0
    s_nop 6
    v_cvt_pk_bf16_f32 v44, v36, v37
    v_cvt_pk_bf16_f32 v45, v38, v39
    buffer_store_dwordx2 v[44:45], v7, s[24:27], 0 offen offset:160
    v_cvt_pk_bf16_f32 v46, v40, v41
    v_cvt_pk_bf16_f32 v47, v42, v43
    buffer_store_dwordx2 v[46:47], v8, s[24:27], 0 offen offset:160
    v_mfma_f32_16x16x32_bf16 v[36:39], v[88:91], v[16:19], 0
    v_mfma_f32_16x16x32_bf16 v[40:43], v[88:91], v[20:23], 0
    s_nop 6
    v_cvt_pk_bf16_f32 v44, v36, v37
    v_cvt_pk_bf16_f32 v45, v38, v39
    buffer_store_dwordx2 v[44:45], v7, s[24:27], 0 offen offset:192
    v_cvt_pk_bf16_f32 v46, v40, v41
    v_cvt_pk_bf16_f32 v47, v42, v43
    buffer_store_dwordx2 v[46:47], v8, s[24:27], 0 offen offset:192
    v_mfma_f32_16x16x32_bf16 v[36:39], v[92:95], v[16:19], 0
    v_mfma_f32_16x16x32_bf16 v[40:43], v[92:95], v[20:23], 0
    s_nop 6
    v_cvt_pk_bf16_f32 v44, v36, v37
    v_cvt_pk_bf16_f32 v45, v38, v39
    buffer_store_dwordx2 v[44:45], v7, s[24:27], 0 offen offset:224
    v_cvt_pk_bf16_f32 v46, v40, v41
    v_cvt_pk_bf16_f32 v47, v42, v43
    buffer_store_dwordx2 v[46:47], v8, s[24:27], 0 offen offset:224
    v_mfma_f32_16x16x32_bf16 v[36:39], v[96:99], v[16:19], 0
    v_mfma_f32_16x16x32_bf16 v[40:43], v[96:99], v[20:23], 0
    s_nop 6
    v_cvt_pk_bf16_f32 v44, v36, v37
    v_cvt_pk_bf16_f32 v45, v38, v39
    buffer_store_dwordx2 v[44:45], v7, s[24:27], 0 offen offset:256
    v_cvt_pk_bf16_f32 v46, v40, v41
    v_cvt_pk_bf16_f32 v47, v42, v43
    buffer_store_dwordx2 v[46:47], v8, s[24:27], 0 offen offset:256
    v_mfma_f32_16x16x32_bf16 v[36:39], v[100:103], v[16:19], 0
    v_mfma_f32_16x16x32_bf16 v[40:43], v[100:103], v[20:23], 0
    s_nop 6
    v_cvt_pk_bf16_f32 v44, v36, v37
    v_cvt_pk_bf16_f32 v45, v38, v39
    buffer_store_dwordx2 v[44:45], v7, s[24:27], 0 offen offset:288
    v_cvt_pk_bf16_f32 v46, v40, v41
    v_cvt_pk_bf16_f32 v47, v42, v43
    buffer_store_dwordx2 v[46:47], v8, s[24:27], 0 offen offset:288
    v_mfma_f32_16x16x32_bf16 v[36:39], v[104:107], v[16:19], 0
    v_mfma_f32_16x16x32_bf16 v[40:43], v[104:107], v[20:23], 0
    s_nop 6
    v_cvt_pk_bf16_f32 v44, v36, v37
    v_cvt_pk_bf16_f32 v45, v38, v39
    buffer_store_dwordx2 v[44:45], v7, s[24:27], 0 offen offset:320
    v_cvt_pk_bf16_f32 v46, v40, v41
    v_cvt_pk_bf16_f32 v47, v42, v43
    buffer_store_dwordx2 v[46:47], v8, s[24:27], 0 offen offset:320
    v_mfma_f32_16x16x32_bf16 v[36:39], v[108:111], v[16:19], 0
    v_mfma_f32_16x16x32_bf16 v[40:43], v[108:111], v[20:23], 0
    s_nop 6
    v_cvt_pk_bf16_f32 v44, v36, v37
    v_cvt_pk_bf16_f32 v45, v38, v39
    buffer_store_dwordx2 v[44:45], v7, s[24:27], 0 offen offset:352
    v_cvt_pk_bf16_f32 v46, v40, v41
    v_cvt_pk_bf16_f32 v47, v42, v43
    buffer_store_dwordx2 v[46:47], v8, s[24:27], 0 offen offset:352
    v_mfma_f32_16x16x32_bf16 v[36:39], v[112:115], v[16:19], 0
    v_mfma_f32_16x16x32_bf16 v[40:43], v[112:115], v[20:23], 0
    s_nop 6
    v_cvt_pk_bf16_f32 v44, v36, v37
    v_cvt_pk_bf16_f32 v45, v38, v39
    buffer_store_dwordx2 v[44:45], v7, s[24:27], 0 offen offset:384
    v_cvt_pk_bf16_f32 v46, v40, v41
    v_cvt_pk_bf16_f32 v47, v42, v43
    buffer_store_dwordx2 v[46:47], v8, s[24:27], 0 offen offset:384
    v_mfma_f32_16x16x32_bf16 v[36:39], v[116:119], v[16:19], 0
    v_mfma_f32_16x16x32_bf16 v[40:43], v[116:119], v[20:23], 0
    s_nop 6
    v_cvt_pk_bf16_f32 v44, v36, v37
    v_cvt_pk_bf16_f32 v45, v38, v39
    buffer_store_dwordx2 v[44:45], v7, s[24:27], 0 offen offset:416
    v_cvt_pk_bf16_f32 v46, v40, v41
    v_cvt_pk_bf16_f32 v47, v42, v43
    buffer_store_dwordx2 v[46:47], v8, s[24:27], 0 offen offset:416
    v_mfma_f32_16x16x32_bf16 v[36:39], v[120:123], v[16:19], 0
    v_mfma_f32_16x16x32_bf16 v[40:43], v[120:123], v[20:23], 0
    s_nop 6
    v_cvt_pk_bf16_f32 v44, v36, v37
    v_cvt_pk_bf16_f32 v45, v38, v39
    buffer_store_dwordx2 v[44:45], v7, s[24:27], 0 offen offset:448
    v_cvt_pk_bf16_f32 v46, v40, v41
    v_cvt_pk_bf16_f32 v47, v42, v43
    buffer_store_dwordx2 v[46:47], v8, s[24:27], 0 offen offset:448
    v_mfma_f32_16x16x32_bf16 v[36:39], v[124:127], v[16:19], 0
    v_mfma_f32_16x16x32_bf16 v[40:43], v[124:127], v[20:23], 0
    s_nop 6
    v_cvt_pk_bf16_f32 v44, v36, v37
    v_cvt_pk_bf16_f32 v45, v38, v39
    buffer_store_dwordx2 v[44:45], v7, s[24:27], 0 offen offset:480
    v_cvt_pk_bf16_f32 v46, v40, v41
    v_cvt_pk_bf16_f32 v47, v42, v43
    buffer_store_dwordx2 v[46:47], v8, s[24:27], 0 offen offset:480
    v_mfma_f32_16x16x32_bf16 v[36:39], v[128:131], v[16:19], 0
    v_mfma_f32_16x16x32_bf16 v[40:43], v[128:131], v[20:23], 0
    s_nop 6
    v_cvt_pk_bf16_f32 v44, v36, v37
    v_cvt_pk_bf16_f32 v45, v38, v39
    buffer_store_dwordx2 v[44:45], v7, s[24:27], 0 offen offset:512
    v_cvt_pk_bf16_f32 v46, v40, v41
    v_cvt_pk_bf16_f32 v47, v42, v43
    buffer_store_dwordx2 v[46:47], v8, s[24:27], 0 offen offset:512
    v_mfma_f32_16x16x32_bf16 v[36:39], v[132:135], v[16:19], 0
    v_mfma_f32_16x16x32_bf16 v[40:43], v[132:135], v[20:23], 0
    s_nop 6
    v_cvt_pk_bf16_f32 v44, v36, v37
    v_cvt_pk_bf16_f32 v45, v38, v39
    buffer_store_dwordx2 v[44:45], v7, s[24:27], 0 offen offset:544
    v_cvt_pk_bf16_f32 v46, v40, v41
    v_cvt_pk_bf16_f32 v47, v42, v43
    buffer_store_dwordx2 v[46:47], v8, s[24:27], 0 offen offset:544
    v_mfma_f32_16x16x32_bf16 v[36:39], v[136:139], v[16:19], 0
    v_mfma_f32_16x16x32_bf16 v[40:43], v[136:139], v[20:23], 0
    s_nop 6
    v_cvt_pk_bf16_f32 v44, v36, v37
    v_cvt_pk_bf16_f32 v45, v38, v39
    buffer_store_dwordx2 v[44:45], v7, s[24:27], 0 offen offset:576
    v_cvt_pk_bf16_f32 v46, v40, v41
    v_cvt_pk_bf16_f32 v47, v42, v43
    buffer_store_dwordx2 v[46:47], v8, s[24:27], 0 offen offset:576
    v_mfma_f32_16x16x32_bf16 v[36:39], v[140:143], v[16:19], 0
    v_mfma_f32_16x16x32_bf16 v[40:43], v[140:143], v[20:23], 0
    s_nop 6
    v_cvt_pk_bf16_f32 v44, v36, v37
    v_cvt_pk_bf16_f32 v45, v38, v39
    buffer_store_dwordx2 v[44:45], v7, s[24:27], 0 offen offset:608
    v_cvt_pk_bf16_f32 v46, v40, v41
    v_cvt_pk_bf16_f32 v47, v42, v43
    buffer_store_dwordx2 v[46:47], v8, s[24:27], 0 offen offset:608
    v_mfma_f32_16x16x32_bf16 v[36:39], v[144:147], v[16:19], 0
    v_mfma_f32_16x16x32_bf16 v[40:43], v[144:147], v[20:23], 0
    s_nop 6
    v_cvt_pk_bf16_f32 v44, v36, v37
    v_cvt_pk_bf16_f32 v45, v38, v39
    buffer_store_dwordx2 v[44:45], v7, s[24:27], 0 offen offset:640
    v_cvt_pk_bf16_f32 v46, v40, v41
    v_cvt_pk_bf16_f32 v47, v42, v43
    buffer_store_dwordx2 v[46:47], v8, s[24:27], 0 offen offset:640
    v_mfma_f32_16x16x32_bf16 v[36:39], v[148:151], v[16:19], 0
    v_mfma_f32_16x16x32_bf16 v[40:43], v[148:151], v[20:23], 0
    s_nop 6
    v_cvt_pk_bf16_f32 v44, v36, v37
    v_cvt_pk_bf16_f32 v45, v38, v39
    buffer_store_dwordx2 v[44:45], v7, s[24:27], 0 offen offset:672
    v_cvt_pk_bf16_f32 v46, v40, v41
    v_cvt_pk_bf16_f32 v47, v42, v43
    buffer_store_dwordx2 v[46:47], v8, s[24:27], 0 offen offset:672
    v_mfma_f32_16x16x32_bf16 v[36:39], v[152:155], v[16:19], 0
    v_mfma_f32_16x16x32_bf16 v[40:43], v[152:155], v[20:23], 0
    s_nop 6
    v_cvt_pk_bf16_f32 v44, v36, v37
    v_cvt_pk_bf16_f32 v45, v38, v39
    buffer_store_dwordx2 v[44:45], v7, s[24:27], 0 offen offset:704
    v_cvt_pk_bf16_f32 v46, v40, v41
    v_cvt_pk_bf16_f32 v47, v42, v43
    buffer_store_dwordx2 v[46:47], v8, s[24:27], 0 offen offset:704
    v_mfma_f32_16x16x32_bf16 v[36:39], v[156:159], v[16:19], 0
    v_mfma_f32_16x16x32_bf16 v[40:43], v[156:159], v[20:23], 0
    s_nop 6
    v_cvt_pk_bf16_f32 v44, v36, v37
    v_cvt_pk_bf16_f32 v45, v38, v39
    buffer_store_dwordx2 v[44:45], v7, s[24:27], 0 offen offset:736
    v_cvt_pk_bf16_f32 v46, v40, v41
    v_cvt_pk_bf16_f32 v47, v42, v43
    buffer_store_dwordx2 v[46:47], v8, s[24:27], 0 offen offset:736
    v_mfma_f32_16x16x32_bf16 v[36:39], v[160:163], v[16:19], 0
    v_mfma_f32_16x16x32_bf16 v[40:43], v[160:163], v[20:23], 0
    s_nop 6
    v_cvt_pk_bf16_f32 v44, v36, v37
    v_cvt_pk_bf16_f32 v45, v38, v39
    buffer_store_dwordx2 v[44:45], v7, s[24:27], 0 offen offset:768
    v_cvt_pk_bf16_f32 v46, v40, v41
    v_cvt_pk_bf16_f32 v47, v42, v43
    buffer_store_dwordx2 v[46:47], v8, s[24:27], 0 offen offset:768
    v_mfma_f32_16x16x32_bf16 v[36:39], v[164:167], v[16:19], 0
    v_mfma_f32_16x16x32_bf16 v[40:43], v[164:167], v[20:23], 0
    s_nop 6
    v_cvt_pk_bf16_f32 v44, v36, v37
    v_cvt_pk_bf16_f32 v45, v38, v39
    buffer_store_dwordx2 v[44:45], v7, s[24:27], 0 offen offset:800
    v_cvt_pk_bf16_f32 v46, v40, v41
    v_cvt_pk_bf16_f32 v47, v42, v43
    buffer_store_dwordx2 v[46:47], v8, s[24:27], 0 offen offset:800
    v_mfma_f32_16x16x32_bf16 v[36:39], v[168:171], v[16:19], 0
    v_mfma_f32_16x16x32_bf16 v[40:43], v[168:171], v[20:23], 0
    s_nop 6
    v_cvt_pk_bf16_f32 v44, v36, v37
    v_cvt_pk_bf16_f32 v45, v38, v39
    buffer_store_dwordx2 v[44:45], v7, s[24:27], 0 offen offset:832
    v_cvt_pk_bf16_f32 v46, v40, v41
    v_cvt_pk_bf16_f32 v47, v42, v43
    buffer_store_dwordx2 v[46:47], v8, s[24:27], 0 offen offset:832
    v_mfma_f32_16x16x32_bf16 v[36:39], v[172:175], v[16:19], 0
    v_mfma_f32_16x16x32_bf16 v[40:43], v[172:175], v[20:23], 0
    s_nop 6
    v_cvt_pk_bf16_f32 v44, v36, v37
    v_cvt_pk_bf16_f32 v45, v38, v39
    buffer_store_dwordx2 v[44:45], v7, s[24:27], 0 offen offset:864
    v_cvt_pk_bf16_f32 v46, v40, v41
    v_cvt_pk_bf16_f32 v47, v42, v43
    buffer_store_dwordx2 v[46:47], v8, s[24:27], 0 offen offset:864
    s_branch L_prep_end
L_prep_c:
    s_mov_b32 s28, s20
    s_mov_b32 s29, s21
    s_mov_b32 s30, 401408
    s_mov_b32 s31, 0x00020000
    s_mov_b32 s32, s4
    s_mov_b32 s33, s5
    s_mov_b32 s34, 7168
    s_mov_b32 s35, 0x00020000
    s_sub_u32 s40, s2, 236
    s_lshl_b32 s41, s40, 8
    v_add_u32 v5, s41, v0
    s_mov_b32 s51, 0
    v_mov_b32 v12, 0x7ff00000
    v_lshrrev_b32 v6, 8, v5
    v_and_b32 v7, 255, v5
    v_lshrrev_b32 v8, 4, v7
    v_and_b32 v9, 15, v7
    v_mul_u32_u24 v8, 28, v8
    v_and_b32 v10, 12, v9
    v_and_b32 v11, 1, v9
    v_lshl_add_u32 v10, v11, 1, v10
    v_bfe_u32 v11, v9, 1, 1
    v_lshl_add_u32 v10, v11, 4, v10
    v_add_u32 v8, v8, v10
    v_mul_u32_u24 v8, 896, v8
    v_lshl_add_u32 v8, v6, 1, v8
    v_cmp_lt_u32 vcc, 27, v10
    s_nop 1
    v_cndmask_b32 v8, v8, v12, vcc
    v_cmp_lt_u32 vcc, 447, v6
    s_nop 1
    v_cndmask_b32 v8, v8, v12, vcc
    buffer_load_ushort v64, v8, s[28:31], 0 offen
    buffer_load_ushort v96, v8, s[28:31], 0 offen offset:896
    v_lshlrev_b32 v128, 2, v5
    v_add_u32 v128, 15728640, v128
    v_cndmask_b32 v128, v128, v12, vcc
    v_add_u32 v5, 5120, v5
    v_lshrrev_b32 v6, 8, v5
    v_and_b32 v7, 255, v5
    v_lshrrev_b32 v8, 4, v7
    v_and_b32 v9, 15, v7
    v_mul_u32_u24 v8, 28, v8
    v_and_b32 v10, 12, v9
    v_and_b32 v11, 1, v9
    v_lshl_add_u32 v10, v11, 1, v10
    v_bfe_u32 v11, v9, 1, 1
    v_lshl_add_u32 v10, v11, 4, v10
    v_add_u32 v8, v8, v10
    v_mul_u32_u24 v8, 896, v8
    v_lshl_add_u32 v8, v6, 1, v8
    v_cmp_lt_u32 vcc, 27, v10
    s_nop 1
    v_cndmask_b32 v8, v8, v12, vcc
    v_cmp_lt_u32 vcc, 447, v6
    s_nop 1
    v_cndmask_b32 v8, v8, v12, vcc
    buffer_load_ushort v65, v8, s[28:31], 0 offen
    buffer_load_ushort v97, v8, s[28:31], 0 offen offset:896
    v_lshlrev_b32 v129, 2, v5
    v_add_u32 v129, 15728640, v129
    v_cndmask_b32 v129, v129, v12, vcc
    v_add_u32 v5, 5120, v5
    v_lshrrev_b32 v6, 8, v5
    v_and_b32 v7, 255, v5
    v_lshrrev_b32 v8, 4, v7
    v_and_b32 v9, 15, v7
    v_mul_u32_u24 v8, 28, v8
    v_and_b32 v10, 12, v9
    v_and_b32 v11, 1, v9
    v_lshl_add_u32 v10, v11, 1, v10
    v_bfe_u32 v11, v9, 1, 1
    v_lshl_add_u32 v10, v11, 4, v10
    v_add_u32 v8, v8, v10
    v_mul_u32_u24 v8, 896, v8
    v_lshl_add_u32 v8, v6, 1, v8
    v_cmp_lt_u32 vcc, 27, v10
    s_nop 1
    v_cndmask_b32 v8, v8, v12, vcc
    v_cmp_lt_u32 vcc, 447, v6
    s_nop 1
    v_cndmask_b32 v8, v8, v12, vcc
    buffer_load_ushort v66, v8, s[28:31], 0 offen
    buffer_load_ushort v98, v8, s[28:31], 0 offen offset:896
    v_lshlrev_b32 v130, 2, v5
    v_add_u32 v130, 15728640, v130
    v_cndmask_b32 v130, v130, v12, vcc
    v_add_u32 v5, 5120, v5
    v_lshrrev_b32 v6, 8, v5
    v_and_b32 v7, 255, v5
    v_lshrrev_b32 v8, 4, v7
    v_and_b32 v9, 15, v7
    v_mul_u32_u24 v8, 28, v8
    v_and_b32 v10, 12, v9
    v_and_b32 v11, 1, v9
    v_lshl_add_u32 v10, v11, 1, v10
    v_bfe_u32 v11, v9, 1, 1
    v_lshl_add_u32 v10, v11, 4, v10
    v_add_u32 v8, v8, v10
    v_mul_u32_u24 v8, 896, v8
    v_lshl_add_u32 v8, v6, 1, v8
    v_cmp_lt_u32 vcc, 27, v10
    s_nop 1
    v_cndmask_b32 v8, v8, v12, vcc
    v_cmp_lt_u32 vcc, 447, v6
    s_nop 1
    v_cndmask_b32 v8, v8, v12, vcc
    buffer_load_ushort v67, v8, s[28:31], 0 offen
    buffer_load_ushort v99, v8, s[28:31], 0 offen offset:896
    v_lshlrev_b32 v131, 2, v5
    v_add_u32 v131, 15728640, v131
    v_cndmask_b32 v131, v131, v12, vcc
    v_add_u32 v5, 5120, v5
    v_lshrrev_b32 v6, 8, v5
    v_and_b32 v7, 255, v5
    v_lshrrev_b32 v8, 4, v7
    v_and_b32 v9, 15, v7
    v_mul_u32_u24 v8, 28, v8
    v_and_b32 v10, 12, v9
    v_and_b32 v11, 1, v9
    v_lshl_add_u32 v10, v11, 1, v10
    v_bfe_u32 v11, v9, 1, 1
    v_lshl_add_u32 v10, v11, 4, v10
    v_add_u32 v8, v8, v10
    v_mul_u32_u24 v8, 896, v8
    v_lshl_add_u32 v8, v6, 1, v8
    v_cmp_lt_u32 vcc, 27, v10
    s_nop 1
    v_cndmask_b32 v8, v8, v12, vcc
    v_cmp_lt_u32 vcc, 447, v6
    s_nop 1
    v_cndmask_b32 v8, v8, v12, vcc
    buffer_load_ushort v68, v8, s[28:31], 0 offen
    buffer_load_ushort v100, v8, s[28:31], 0 offen offset:896
    v_lshlrev_b32 v132, 2, v5
    v_add_u32 v132, 15728640, v132
    v_cndmask_b32 v132, v132, v12, vcc
    v_add_u32 v5, 5120, v5
    v_lshrrev_b32 v6, 8, v5
    v_and_b32 v7, 255, v5
    v_lshrrev_b32 v8, 4, v7
    v_and_b32 v9, 15, v7
    v_mul_u32_u24 v8, 28, v8
    v_and_b32 v10, 12, v9
    v_and_b32 v11, 1, v9
    v_lshl_add_u32 v10, v11, 1, v10
    v_bfe_u32 v11, v9, 1, 1
    v_lshl_add_u32 v10, v11, 4, v10
    v_add_u32 v8, v8, v10
    v_mul_u32_u24 v8, 896, v8
    v_lshl_add_u32 v8, v6, 1, v8
    v_cmp_lt_u32 vcc, 27, v10
    s_nop 1
    v_cndmask_b32 v8, v8, v12, vcc
    v_cmp_lt_u32 vcc, 447, v6
    s_nop 1
    v_cndmask_b32 v8, v8, v12, vcc
    buffer_load_ushort v69, v8, s[28:31], 0 offen
    buffer_load_ushort v101, v8, s[28:31], 0 offen offset:896
    v_lshlrev_b32 v133, 2, v5
    v_add_u32 v133, 15728640, v133
    v_cndmask_b32 v133, v133, v12, vcc
    v_add_u32 v5, 5120, v5
    v_lshrrev_b32 v6, 8, v5
    v_and_b32 v7, 255, v5
    v_lshrrev_b32 v8, 4, v7
    v_and_b32 v9, 15, v7
    v_mul_u32_u24 v8, 28, v8
    v_and_b32 v10, 12, v9
    v_and_b32 v11, 1, v9
    v_lshl_add_u32 v10, v11, 1, v10
    v_bfe_u32 v11, v9, 1, 1
    v_lshl_add_u32 v10, v11, 4, v10
    v_add_u32 v8, v8, v10
    v_mul_u32_u24 v8, 896, v8
    v_lshl_add_u32 v8, v6, 1, v8
    v_cmp_lt_u32 vcc, 27, v10
    s_nop 1
    v_cndmask_b32 v8, v8, v12, vcc
    v_cmp_lt_u32 vcc, 447, v6
    s_nop 1
    v_cndmask_b32 v8, v8, v12, vcc
    buffer_load_ushort v70, v8, s[28:31], 0 offen
    buffer_load_ushort v102, v8, s[28:31], 0 offen offset:896
    v_lshlrev_b32 v134, 2, v5
    v_add_u32 v134, 15728640, v134
    v_cndmask_b32 v134, v134, v12, vcc
    v_add_u32 v5, 5120, v5
    v_lshrrev_b32 v6, 8, v5
    v_and_b32 v7, 255, v5
    v_lshrrev_b32 v8, 4, v7
    v_and_b32 v9, 15, v7
    v_mul_u32_u24 v8, 28, v8
    v_and_b32 v10, 12, v9
    v_and_b32 v11, 1, v9
    v_lshl_add_u32 v10, v11, 1, v10
    v_bfe_u32 v11, v9, 1, 1
    v_lshl_add_u32 v10, v11, 4, v10
    v_add_u32 v8, v8, v10
    v_mul_u32_u24 v8, 896, v8
    v_lshl_add_u32 v8, v6, 1, v8
    v_cmp_lt_u32 vcc, 27, v10
    s_nop 1
    v_cndmask_b32 v8, v8, v12, vcc
    v_cmp_lt_u32 vcc, 447, v6
    s_nop 1
    v_cndmask_b32 v8, v8, v12, vcc
    buffer_load_ushort v71, v8, s[28:31], 0 offen
    buffer_load_ushort v103, v8, s[28:31], 0 offen offset:896
    v_lshlrev_b32 v135, 2, v5
    v_add_u32 v135, 15728640, v135
    v_cndmask_b32 v135, v135, v12, vcc
    v_add_u32 v5, 5120, v5
    v_lshrrev_b32 v6, 8, v5
    v_and_b32 v7, 255, v5
    v_lshrrev_b32 v8, 4, v7
    v_and_b32 v9, 15, v7
    v_mul_u32_u24 v8, 28, v8
    v_and_b32 v10, 12, v9
    v_and_b32 v11, 1, v9
    v_lshl_add_u32 v10, v11, 1, v10
    v_bfe_u32 v11, v9, 1, 1
    v_lshl_add_u32 v10, v11, 4, v10
    v_add_u32 v8, v8, v10
    v_mul_u32_u24 v8, 896, v8
    v_lshl_add_u32 v8, v6, 1, v8
    v_cmp_lt_u32 vcc, 27, v10
    s_nop 1
    v_cndmask_b32 v8, v8, v12, vcc
    v_cmp_lt_u32 vcc, 447, v6
    s_nop 1
    v_cndmask_b32 v8, v8, v12, vcc
    buffer_load_ushort v72, v8, s[28:31], 0 offen
    buffer_load_ushort v104, v8, s[28:31], 0 offen offset:896
    v_lshlrev_b32 v136, 2, v5
    v_add_u32 v136, 15728640, v136
    v_cndmask_b32 v136, v136, v12, vcc
    v_add_u32 v5, 5120, v5
    v_lshrrev_b32 v6, 8, v5
    v_and_b32 v7, 255, v5
    v_lshrrev_b32 v8, 4, v7
    v_and_b32 v9, 15, v7
    v_mul_u32_u24 v8, 28, v8
    v_and_b32 v10, 12, v9
    v_and_b32 v11, 1, v9
    v_lshl_add_u32 v10, v11, 1, v10
    v_bfe_u32 v11, v9, 1, 1
    v_lshl_add_u32 v10, v11, 4, v10
    v_add_u32 v8, v8, v10
    v_mul_u32_u24 v8, 896, v8
    v_lshl_add_u32 v8, v6, 1, v8
    v_cmp_lt_u32 vcc, 27, v10
    s_nop 1
    v_cndmask_b32 v8, v8, v12, vcc
    v_cmp_lt_u32 vcc, 447, v6
    s_nop 1
    v_cndmask_b32 v8, v8, v12, vcc
    buffer_load_ushort v73, v8, s[28:31], 0 offen
    buffer_load_ushort v105, v8, s[28:31], 0 offen offset:896
    v_lshlrev_b32 v137, 2, v5
    v_add_u32 v137, 15728640, v137
    v_cndmask_b32 v137, v137, v12, vcc
    v_add_u32 v5, 5120, v5
    v_lshrrev_b32 v6, 8, v5
    v_and_b32 v7, 255, v5
    v_lshrrev_b32 v8, 4, v7
    v_and_b32 v9, 15, v7
    v_mul_u32_u24 v8, 28, v8
    v_and_b32 v10, 12, v9
    v_and_b32 v11, 1, v9
    v_lshl_add_u32 v10, v11, 1, v10
    v_bfe_u32 v11, v9, 1, 1
    v_lshl_add_u32 v10, v11, 4, v10
    v_add_u32 v8, v8, v10
    v_mul_u32_u24 v8, 896, v8
    v_lshl_add_u32 v8, v6, 1, v8
    v_cmp_lt_u32 vcc, 27, v10
    s_nop 1
    v_cndmask_b32 v8, v8, v12, vcc
    v_cmp_lt_u32 vcc, 447, v6
    s_nop 1
    v_cndmask_b32 v8, v8, v12, vcc
    buffer_load_ushort v74, v8, s[28:31], 0 offen
    buffer_load_ushort v106, v8, s[28:31], 0 offen offset:896
    v_lshlrev_b32 v138, 2, v5
    v_add_u32 v138, 15728640, v138
    v_cndmask_b32 v138, v138, v12, vcc
    v_add_u32 v5, 5120, v5
    v_lshrrev_b32 v6, 8, v5
    v_and_b32 v7, 255, v5
    v_lshrrev_b32 v8, 4, v7
    v_and_b32 v9, 15, v7
    v_mul_u32_u24 v8, 28, v8
    v_and_b32 v10, 12, v9
    v_and_b32 v11, 1, v9
    v_lshl_add_u32 v10, v11, 1, v10
    v_bfe_u32 v11, v9, 1, 1
    v_lshl_add_u32 v10, v11, 4, v10
    v_add_u32 v8, v8, v10
    v_mul_u32_u24 v8, 896, v8
    v_lshl_add_u32 v8, v6, 1, v8
    v_cmp_lt_u32 vcc, 27, v10
    s_nop 1
    v_cndmask_b32 v8, v8, v12, vcc
    v_cmp_lt_u32 vcc, 447, v6
    s_nop 1
    v_cndmask_b32 v8, v8, v12, vcc
    buffer_load_ushort v75, v8, s[28:31], 0 offen
    buffer_load_ushort v107, v8, s[28:31], 0 offen offset:896
    v_lshlrev_b32 v139, 2, v5
    v_add_u32 v139, 15728640, v139
    v_cndmask_b32 v139, v139, v12, vcc
    v_add_u32 v5, 5120, v5
    v_lshrrev_b32 v6, 8, v5
    v_and_b32 v7, 255, v5
    v_lshrrev_b32 v8, 4, v7
    v_and_b32 v9, 15, v7
    v_mul_u32_u24 v8, 28, v8
    v_and_b32 v10, 12, v9
    v_and_b32 v11, 1, v9
    v_lshl_add_u32 v10, v11, 1, v10
    v_bfe_u32 v11, v9, 1, 1
    v_lshl_add_u32 v10, v11, 4, v10
    v_add_u32 v8, v8, v10
    v_mul_u32_u24 v8, 896, v8
    v_lshl_add_u32 v8, v6, 1, v8
    v_cmp_lt_u32 vcc, 27, v10
    s_nop 1
    v_cndmask_b32 v8, v8, v12, vcc
    v_cmp_lt_u32 vcc, 447, v6
    s_nop 1
    v_cndmask_b32 v8, v8, v12, vcc
    buffer_load_ushort v76, v8, s[28:31], 0 offen
    buffer_load_ushort v108, v8, s[28:31], 0 offen offset:896
    v_lshlrev_b32 v140, 2, v5
    v_add_u32 v140, 15728640, v140
    v_cndmask_b32 v140, v140, v12, vcc
    v_add_u32 v5, 5120, v5
    v_lshrrev_b32 v6, 8, v5
    v_and_b32 v7, 255, v5
    v_lshrrev_b32 v8, 4, v7
    v_and_b32 v9, 15, v7
    v_mul_u32_u24 v8, 28, v8
    v_and_b32 v10, 12, v9
    v_and_b32 v11, 1, v9
    v_lshl_add_u32 v10, v11, 1, v10
    v_bfe_u32 v11, v9, 1, 1
    v_lshl_add_u32 v10, v11, 4, v10
    v_add_u32 v8, v8, v10
    v_mul_u32_u24 v8, 896, v8
    v_lshl_add_u32 v8, v6, 1, v8
    v_cmp_lt_u32 vcc, 27, v10
    s_nop 1
    v_cndmask_b32 v8, v8, v12, vcc
    v_cmp_lt_u32 vcc, 447, v6
    s_nop 1
    v_cndmask_b32 v8, v8, v12, vcc
    buffer_load_ushort v77, v8, s[28:31], 0 offen
    buffer_load_ushort v109, v8, s[28:31], 0 offen offset:896
    v_lshlrev_b32 v141, 2, v5
    v_add_u32 v141, 15728640, v141
    v_cndmask_b32 v141, v141, v12, vcc
    v_add_u32 v5, 5120, v5
    v_lshrrev_b32 v6, 8, v5
    v_and_b32 v7, 255, v5
    v_lshrrev_b32 v8, 4, v7
    v_and_b32 v9, 15, v7
    v_mul_u32_u24 v8, 28, v8
    v_and_b32 v10, 12, v9
    v_and_b32 v11, 1, v9
    v_lshl_add_u32 v10, v11, 1, v10
    v_bfe_u32 v11, v9, 1, 1
    v_lshl_add_u32 v10, v11, 4, v10
    v_add_u32 v8, v8, v10
    v_mul_u32_u24 v8, 896, v8
    v_lshl_add_u32 v8, v6, 1, v8
    v_cmp_lt_u32 vcc, 27, v10
    s_nop 1
    v_cndmask_b32 v8, v8, v12, vcc
    v_cmp_lt_u32 vcc, 447, v6
    s_nop 1
    v_cndmask_b32 v8, v8, v12, vcc
    buffer_load_ushort v78, v8, s[28:31], 0 offen
    buffer_load_ushort v110, v8, s[28:31], 0 offen offset:896
    v_lshlrev_b32 v142, 2, v5
    v_add_u32 v142, 15728640, v142
    v_cndmask_b32 v142, v142, v12, vcc
    v_add_u32 v5, 5120, v5
    v_lshrrev_b32 v6, 8, v5
    v_and_b32 v7, 255, v5
    v_lshrrev_b32 v8, 4, v7
    v_and_b32 v9, 15, v7
    v_mul_u32_u24 v8, 28, v8
    v_and_b32 v10, 12, v9
    v_and_b32 v11, 1, v9
    v_lshl_add_u32 v10, v11, 1, v10
    v_bfe_u32 v11, v9, 1, 1
    v_lshl_add_u32 v10, v11, 4, v10
    v_add_u32 v8, v8, v10
    v_mul_u32_u24 v8, 896, v8
    v_lshl_add_u32 v8, v6, 1, v8
    v_cmp_lt_u32 vcc, 27, v10
    s_nop 1
    v_cndmask_b32 v8, v8, v12, vcc
    v_cmp_lt_u32 vcc, 447, v6
    s_nop 1
    v_cndmask_b32 v8, v8, v12, vcc
    buffer_load_ushort v79, v8, s[28:31], 0 offen
    buffer_load_ushort v111, v8, s[28:31], 0 offen offset:896
    v_lshlrev_b32 v143, 2, v5
    v_add_u32 v143, 15728640, v143
    v_cndmask_b32 v143, v143, v12, vcc
    v_add_u32 v5, 5120, v5
    v_lshrrev_b32 v6, 8, v5
    v_and_b32 v7, 255, v5
    v_lshrrev_b32 v8, 4, v7
    v_and_b32 v9, 15, v7
    v_mul_u32_u24 v8, 28, v8
    v_and_b32 v10, 12, v9
    v_and_b32 v11, 1, v9
    v_lshl_add_u32 v10, v11, 1, v10
    v_bfe_u32 v11, v9, 1, 1
    v_lshl_add_u32 v10, v11, 4, v10
    v_add_u32 v8, v8, v10
    v_mul_u32_u24 v8, 896, v8
    v_lshl_add_u32 v8, v6, 1, v8
    v_cmp_lt_u32 vcc, 27, v10
    s_nop 1
    v_cndmask_b32 v8, v8, v12, vcc
    v_cmp_lt_u32 vcc, 447, v6
    s_nop 1
    v_cndmask_b32 v8, v8, v12, vcc
    buffer_load_ushort v80, v8, s[28:31], 0 offen
    buffer_load_ushort v112, v8, s[28:31], 0 offen offset:896
    v_lshlrev_b32 v144, 2, v5
    v_add_u32 v144, 15728640, v144
    v_cndmask_b32 v144, v144, v12, vcc
    v_add_u32 v5, 5120, v5
    v_lshrrev_b32 v6, 8, v5
    v_and_b32 v7, 255, v5
    v_lshrrev_b32 v8, 4, v7
    v_and_b32 v9, 15, v7
    v_mul_u32_u24 v8, 28, v8
    v_and_b32 v10, 12, v9
    v_and_b32 v11, 1, v9
    v_lshl_add_u32 v10, v11, 1, v10
    v_bfe_u32 v11, v9, 1, 1
    v_lshl_add_u32 v10, v11, 4, v10
    v_add_u32 v8, v8, v10
    v_mul_u32_u24 v8, 896, v8
    v_lshl_add_u32 v8, v6, 1, v8
    v_cmp_lt_u32 vcc, 27, v10
    s_nop 1
    v_cndmask_b32 v8, v8, v12, vcc
    v_cmp_lt_u32 vcc, 447, v6
    s_nop 1
    v_cndmask_b32 v8, v8, v12, vcc
    buffer_load_ushort v81, v8, s[28:31], 0 offen
    buffer_load_ushort v113, v8, s[28:31], 0 offen offset:896
    v_lshlrev_b32 v145, 2, v5
    v_add_u32 v145, 15728640, v145
    v_cndmask_b32 v145, v145, v12, vcc
    v_add_u32 v5, 5120, v5
    v_lshrrev_b32 v6, 8, v5
    v_and_b32 v7, 255, v5
    v_lshrrev_b32 v8, 4, v7
    v_and_b32 v9, 15, v7
    v_mul_u32_u24 v8, 28, v8
    v_and_b32 v10, 12, v9
    v_and_b32 v11, 1, v9
    v_lshl_add_u32 v10, v11, 1, v10
    v_bfe_u32 v11, v9, 1, 1
    v_lshl_add_u32 v10, v11, 4, v10
    v_add_u32 v8, v8, v10
    v_mul_u32_u24 v8, 896, v8
    v_lshl_add_u32 v8, v6, 1, v8
    v_cmp_lt_u32 vcc, 27, v10
    s_nop 1
    v_cndmask_b32 v8, v8, v12, vcc
    v_cmp_lt_u32 vcc, 447, v6
    s_nop 1
    v_cndmask_b32 v8, v8, v12, vcc
    buffer_load_ushort v82, v8, s[28:31], 0 offen
    buffer_load_ushort v114, v8, s[28:31], 0 offen offset:896
    v_lshlrev_b32 v146, 2, v5
    v_add_u32 v146, 15728640, v146
    v_cndmask_b32 v146, v146, v12, vcc
    v_add_u32 v5, 5120, v5
    v_lshrrev_b32 v6, 8, v5
    v_and_b32 v7, 255, v5
    v_lshrrev_b32 v8, 4, v7
    v_and_b32 v9, 15, v7
    v_mul_u32_u24 v8, 28, v8
    v_and_b32 v10, 12, v9
    v_and_b32 v11, 1, v9
    v_lshl_add_u32 v10, v11, 1, v10
    v_bfe_u32 v11, v9, 1, 1
    v_lshl_add_u32 v10, v11, 4, v10
    v_add_u32 v8, v8, v10
    v_mul_u32_u24 v8, 896, v8
    v_lshl_add_u32 v8, v6, 1, v8
    v_cmp_lt_u32 vcc, 27, v10
    s_nop 1
    v_cndmask_b32 v8, v8, v12, vcc
    v_cmp_lt_u32 vcc, 447, v6
    s_nop 1
    v_cndmask_b32 v8, v8, v12, vcc
    buffer_load_ushort v83, v8, s[28:31], 0 offen
    buffer_load_ushort v115, v8, s[28:31], 0 offen offset:896
    v_lshlrev_b32 v147, 2, v5
    v_add_u32 v147, 15728640, v147
    v_cndmask_b32 v147, v147, v12, vcc
    v_add_u32 v5, 5120, v5
    v_lshrrev_b32 v6, 8, v5
    v_and_b32 v7, 255, v5
    v_lshrrev_b32 v8, 4, v7
    v_and_b32 v9, 15, v7
    v_mul_u32_u24 v8, 28, v8
    v_and_b32 v10, 12, v9
    v_and_b32 v11, 1, v9
    v_lshl_add_u32 v10, v11, 1, v10
    v_bfe_u32 v11, v9, 1, 1
    v_lshl_add_u32 v10, v11, 4, v10
    v_add_u32 v8, v8, v10
    v_mul_u32_u24 v8, 896, v8
    v_lshl_add_u32 v8, v6, 1, v8
    v_cmp_lt_u32 vcc, 27, v10
    s_nop 1
    v_cndmask_b32 v8, v8, v12, vcc
    v_cmp_lt_u32 vcc, 447, v6
    s_nop 1
    v_cndmask_b32 v8, v8, v12, vcc
    buffer_load_ushort v84, v8, s[28:31], 0 offen
    buffer_load_ushort v116, v8, s[28:31], 0 offen offset:896
    v_lshlrev_b32 v148, 2, v5
    v_add_u32 v148, 15728640, v148
    v_cndmask_b32 v148, v148, v12, vcc
    v_add_u32 v5, 5120, v5
    v_lshrrev_b32 v6, 8, v5
    v_and_b32 v7, 255, v5
    v_lshrrev_b32 v8, 4, v7
    v_and_b32 v9, 15, v7
    v_mul_u32_u24 v8, 28, v8
    v_and_b32 v10, 12, v9
    v_and_b32 v11, 1, v9
    v_lshl_add_u32 v10, v11, 1, v10
    v_bfe_u32 v11, v9, 1, 1
    v_lshl_add_u32 v10, v11, 4, v10
    v_add_u32 v8, v8, v10
    v_mul_u32_u24 v8, 896, v8
    v_lshl_add_u32 v8, v6, 1, v8
    v_cmp_lt_u32 vcc, 27, v10
    s_nop 1
    v_cndmask_b32 v8, v8, v12, vcc
    v_cmp_lt_u32 vcc, 447, v6
    s_nop 1
    v_cndmask_b32 v8, v8, v12, vcc
    buffer_load_ushort v85, v8, s[28:31], 0 offen
    buffer_load_ushort v117, v8, s[28:31], 0 offen offset:896
    v_lshlrev_b32 v149, 2, v5
    v_add_u32 v149, 15728640, v149
    v_cndmask_b32 v149, v149, v12, vcc
    v_add_u32 v5, 5120, v5
    v_lshrrev_b32 v6, 8, v5
    v_and_b32 v7, 255, v5
    v_lshrrev_b32 v8, 4, v7
    v_and_b32 v9, 15, v7
    v_mul_u32_u24 v8, 28, v8
    v_and_b32 v10, 12, v9
    v_and_b32 v11, 1, v9
    v_lshl_add_u32 v10, v11, 1, v10
    v_bfe_u32 v11, v9, 1, 1
    v_lshl_add_u32 v10, v11, 4, v10
    v_add_u32 v8, v8, v10
    v_mul_u32_u24 v8, 896, v8
    v_lshl_add_u32 v8, v6, 1, v8
    v_cmp_lt_u32 vcc, 27, v10
    s_nop 1
    v_cndmask_b32 v8, v8, v12, vcc
    v_cmp_lt_u32 vcc, 447, v6
    s_nop 1
    v_cndmask_b32 v8, v8, v12, vcc
    buffer_load_ushort v86, v8, s[28:31], 0 offen
    buffer_load_ushort v118, v8, s[28:31], 0 offen offset:896
    v_lshlrev_b32 v150, 2, v5
    v_add_u32 v150, 15728640, v150
    v_cndmask_b32 v150, v150, v12, vcc
    v_add_u32 v5, 5120, v5
    s_waitcnt vmcnt(0)
    v_lshl_or_b32 v64, v96, 16, v64
    buffer_store_dword v64, v128, s[24:27], 0 offen
    v_lshl_or_b32 v65, v97, 16, v65
    buffer_store_dword v65, v129, s[24:27], 0 offen
    v_lshl_or_b32 v66, v98, 16, v66
    buffer_store_dword v66, v130, s[24:27], 0 offen
    v_lshl_or_b32 v67, v99, 16, v67
    buffer_store_dword v67, v131, s[24:27], 0 offen
    v_lshl_or_b32 v68, v100, 16, v68
    buffer_store_dword v68, v132, s[24:27], 0 offen
    v_lshl_or_b32 v69, v101, 16, v69
    buffer_store_dword v69, v133, s[24:27], 0 offen
    v_lshl_or_b32 v70, v102, 16, v70
    buffer_store_dword v70, v134, s[24:27], 0 offen
    v_lshl_or_b32 v71, v103, 16, v71
    buffer_store_dword v71, v135, s[24:27], 0 offen
    v_lshl_or_b32 v72, v104, 16, v72
    buffer_store_dword v72, v136, s[24:27], 0 offen
    v_lshl_or_b32 v73, v105, 16, v73
    buffer_store_dword v73, v137, s[24:27], 0 offen
    v_lshl_or_b32 v74, v106, 16, v74
    buffer_store_dword v74, v138, s[24:27], 0 offen
    v_lshl_or_b32 v75, v107, 16, v75
    buffer_store_dword v75, v139, s[24:27], 0 offen
    v_lshl_or_b32 v76, v108, 16, v76
    buffer_store_dword v76, v140, s[24:27], 0 offen
    v_lshl_or_b32 v77, v109, 16, v77
    buffer_store_dword v77, v141, s[24:27], 0 offen
    v_lshl_or_b32 v78, v110, 16, v78
    buffer_store_dword v78, v142, s[24:27], 0 offen
    v_lshl_or_b32 v79, v111, 16, v79
    buffer_store_dword v79, v143, s[24:27], 0 offen
    v_lshl_or_b32 v80, v112, 16, v80
    buffer_store_dword v80, v144, s[24:27], 0 offen
    v_lshl_or_b32 v81, v113, 16, v81
    buffer_store_dword v81, v145, s[24:27], 0 offen
    v_lshl_or_b32 v82, v114, 16, v82
    buffer_store_dword v82, v146, s[24:27], 0 offen
    v_lshl_or_b32 v83, v115, 16, v83
    buffer_store_dword v83, v147, s[24:27], 0 offen
    v_lshl_or_b32 v84, v116, 16, v84
    buffer_store_dword v84, v148, s[24:27], 0 offen
    v_lshl_or_b32 v85, v117, 16, v85
    buffer_store_dword v85, v149, s[24:27], 0 offen
    v_lshl_or_b32 v86, v118, 16, v86
    buffer_store_dword v86, v150, s[24:27], 0 offen
    v_mov_b32 v16, -1
    v_mov_b32 v17, -1
    v_mov_b32 v18, -1
    v_mov_b32 v19, -1
    v_lshlrev_b32 v5, 4, v0
    s_cmp_ge_u32 s40, 16
    s_cbranch_scc1 L_prep_c2
    s_cmp_eq_u32 s40, 0
    s_cbranch_scc1 L_prep_m0
    s_lshl_b32 s41, s40, 13
    s_add_u32 s41, s41, 100663296
    buffer_store_dwordx4 v[16:19], v5, s[24:27], s41 offen
    s_add_u32 s41, s41, 4096
    buffer_store_dwordx4 v[16:19], v5, s[24:27], s41 offen
    s_branch L_prep_end
L_prep_m0:
    v_bfe_u32 v6, v0, 6, 1
    v_lshlrev_b32 v7, 6, v6
    v_bfe_u32 v6, v0, 1, 1
    v_lshl_add_u32 v7, v6, 5, v7
    v_bfe_u32 v6, v0, 7, 1
    v_lshl_add_u32 v7, v6, 4, v7
    v_and_b32 v6, 1, v0
    v_lshl_add_u32 v7, v6, 3, v7
    v_bfe_u32 v6, v0, 5, 1
    v_lshl_add_u32 v7, v6, 2, v7
    v_bfe_u32 v6, v0, 2, 3
    v_mul_u32_u24 v6, 896, v6
    v_add_u32 v7, v7, v6
    v_lshlrev_b32 v8, 2, v0
    buffer_load_dword v20, v7, s[32:35], 0 offen offset:0
    buffer_load_dword v30, v8, s[32:35], 0 offen offset:0
    buffer_load_dword v21, v7, s[32:35], 0 offen offset:128
    buffer_load_dword v31, v8, s[32:35], 0 offen offset:1024
    buffer_load_dword v22, v7, s[32:35], 0 offen offset:256
    buffer_load_dword v32, v8, s[32:35], 0 offen offset:2048
    buffer_load_dword v23, v7, s[32:35], 0 offen offset:384
    buffer_load_dword v33, v8, s[32:35], 0 offen offset:3072
    v_add_u32 v9, 4096, v8
    buffer_load_dword v24, v7, s[32:35], 0 offen offset:512
    buffer_load_dword v34, v9, s[32:35], 0 offen offset:0
    buffer_load_dword v25, v7, s[32:35], 0 offen offset:640
    buffer_load_dword v35, v9, s[32:35], 0 offen offset:1024
    buffer_load_dword v26, v7, s[32:35], 0 offen offset:768
    buffer_load_dword v36, v9, s[32:35], 0 offen offset:2048
    s_waitcnt vmcnt(0)
    s_mov_b32 s41, 100663296
    s_mov_b32 s42, 104857600
    buffer_store_dword v20, v8, s[24:27], s41 offen
    buffer_store_dword v30, v8, s[24:27], s42 offen
    s_add_u32 s41, s41, 1024
    s_add_u32 s42, s42, 1024
    buffer_store_dword v21, v8, s[24:27], s41 offen
    buffer_store_dword v31, v8, s[24:27], s42 offen
    s_add_u32 s41, s41, 1024
    s_add_u32 s42, s42, 1024
    buffer_store_dword v22, v8, s[24:27], s41 offen
    buffer_store_dword v32, v8, s[24:27], s42 offen
    s_add_u32 s41, s41, 1024
    s_add_u32 s42, s42, 1024
    buffer_store_dword v23, v8, s[24:27], s41 offen
    buffer_store_dword v33, v8, s[24:27], s42 offen
    s_add_u32 s41, s41, 1024
    s_add_u32 s42, s42, 1024
    buffer_store_dword v24, v8, s[24:27], s41 offen
    buffer_store_dword v34, v8, s[24:27], s42 offen
    s_add_u32 s41, s41, 1024
    s_add_u32 s42, s42, 1024
    buffer_store_dword v25, v8, s[24:27], s41 offen
    buffer_store_dword v35, v8, s[24:27], s42 offen
    s_add_u32 s41, s41, 1024
    s_add_u32 s42, s42, 1024
    buffer_store_dword v26, v8, s[24:27], s41 offen
    buffer_store_dword v36, v8, s[24:27], s42 offen
    s_add_u32 s41, s41, 1024
    s_add_u32 s42, s42, 1024
    s_branch L_prep_end
L_prep_c2:
    s_cmp_lg_u32 s40, 16
    s_cbranch_scc1 L_prep_end
    v_mov_b32 v16, 0
    v_mov_b32 v17, 0
    v_mov_b32 v18, 0
    v_mov_b32 v19, 0
    s_mov_b32 s41, 100794368
    buffer_store_dwordx4 v[16:19], v5, s[24:27], s41 offen
    s_add_u32 s41, s41, 4096
    buffer_store_dwordx4 v[16:19], v5, s[24:27], s41 offen
    s_add_u32 s41, s41, 4096
    buffer_store_dwordx4 v[16:19], v5, s[24:27], s41 offen
    s_add_u32 s41, s41, 4096
    buffer_store_dwordx4 v[16:19], v5, s[24:27], s41 offen
    s_add_u32 s41, s41, 4096
    buffer_store_dwordx4 v[16:19], v5, s[24:27], s41 offen
    s_add_u32 s41, s41, 4096
    buffer_store_dwordx4 v[16:19], v5, s[24:27], s41 offen
    s_add_u32 s41, s41, 4096
    buffer_store_dwordx4 v[16:19], v5, s[24:27], s41 offen
    s_add_u32 s41, s41, 4096
    buffer_store_dwordx4 v[16:19], v5, s[24:27], s41 offen
    s_add_u32 s41, s41, 4096
    buffer_store_dwordx4 v[16:19], v5, s[24:27], s41 offen
    s_add_u32 s41, s41, 4096
    buffer_store_dwordx4 v[16:19], v5, s[24:27], s41 offen
    s_add_u32 s41, s41, 4096
    buffer_store_dwordx4 v[16:19], v5, s[24:27], s41 offen
    s_add_u32 s41, s41, 4096
    buffer_store_dwordx4 v[16:19], v5, s[24:27], s41 offen
    s_add_u32 s41, s41, 4096
    buffer_store_dwordx4 v[16:19], v5, s[24:27], s41 offen
    s_add_u32 s41, s41, 4096
    buffer_store_dwordx4 v[16:19], v5, s[24:27], s41 offen
    s_add_u32 s41, s41, 4096
    buffer_store_dwordx4 v[16:19], v5, s[24:27], s41 offen
    s_add_u32 s41, s41, 4096
    buffer_store_dwordx4 v[16:19], v5, s[24:27], s41 offen
    s_add_u32 s41, s41, 4096
L_prep_end:
    s_cmp_lg_u32 s3, 3
    s_cbranch_scc1 L_prep_noxf2
    s_waitcnt vmcnt(0)
    buffer_store_dwordx4 v[208:211], v240, s[24:27], s56 offen offset:0
    buffer_store_dwordx4 v[212:215], v240, s[24:27], s56 offen offset:1024
    buffer_store_dwordx4 v[216:219], v240, s[24:27], s56 offen offset:2048
    buffer_store_dwordx2 v[220:221], v241, s[24:27], s56 offen offset:3072
    buffer_store_dwordx4 v[224:227], v240, s[24:27], s57 offen offset:0
    buffer_store_dwordx4 v[228:231], v240, s[24:27], s57 offen offset:1024
    buffer_store_dwordx4 v[232:235], v240, s[24:27], s57 offen offset:2048
    buffer_store_dwordx2 v[236:237], v241, s[24:27], s57 offen offset:3072
L_prep_noxf2:
L_prep_end2:
    s_endpgm

.section .rodata,"a"
.p2align 6
.amdhsa_kernel prep_kernel
  .amdhsa_next_free_vgpr 512
  .amdhsa_next_free_sgpr 102
  .amdhsa_accum_offset 256
  .amdhsa_group_segment_fixed_size 0
  .amdhsa_kernarg_size 112
  .amdhsa_user_sgpr_count 2
  .amdhsa_user_sgpr_kernarg_segment_ptr 1
  .amdhsa_system_sgpr_workgroup_id_x 1
.end_amdhsa_kernel
.text
.globl main_kernel
.p2align 8
.type main_kernel,@function
main_kernel:
    s_cmp_ge_u32 s2, 256
    s_cbranch_scc1 L_chain_end
    s_load_dwordx2 s[4:5], s[0:1], 0
    s_load_dwordx2 s[6:7], s[0:1], 96
    s_load_dwordx2 s[8:9], s[0:1], 104
    v_lshrrev_b32 v3, 6, v0
    v_and_b32 v0, 63, v0
    v_readfirstlane_b32 s20, v3
    s_waitcnt lgkmcnt(0)
    s_mov_b32 s12, s4
    s_mov_b32 s13, s5
    s_mov_b32 s14, 1835008
    s_mov_b32 s15, 0x00020000
    s_mov_b32 s16, s8
    s_mov_b32 s17, s9
    s_mov_b32 s18, 268435456
    s_mov_b32 s19, 0x00020000
    s_mov_b32 s24, s6
    s_mov_b32 s25, s7
    s_mov_b32 s26, 256
    s_mov_b32 s27, 0x00020000
    s_getreg_b32 s21, hwreg(HW_REG_XCC_ID)
    s_and_b32 s21, s21, 7
    s_cmp_lg_u32 s20, 0
    s_cbranch_scc1 L_role_wait
    s_mov_b64 exec, 1
    v_mov_b32 v4, 1
    v_mov_b32 v9, 0
    s_lshl_b32 s36, s21, 7
    s_add_u32 s36, s36, 100835328
    buffer_atomic_add v4, v9, s[16:19], s36 offen sc0 sc1
    v_mov_b32 v5, 100836608
    s_waitcnt vmcnt(0)
    v_readfirstlane_b32 s22, v4
    s_mov_b32 s35, 100000
    s_cmp_lg_u32 s22, 31
    s_cbranch_scc1 L_role_poll
    s_add_u32 s36, s21, 1
    v_mov_b32 v6, s36
    v_mov_b32 v7, 0
    buffer_atomic_cmpswap v[6:7], v5, s[16:19], 0 offen sc0 sc1
    s_waitcnt vmcnt(0)
    s_branch L_role_poll
L_role_fb:
    v_mov_b32 v6, 100
    v_mov_b32 v7, 0
    buffer_atomic_cmpswap v[6:7], v5, s[16:19], 0 offen sc0 sc1
    s_waitcnt vmcnt(0)
    s_mov_b32 s35, 100000
L_role_poll:
    buffer_load_dword v4, v5, s[16:19], 0 offen sc1
    s_waitcnt vmcnt(0)
    v_readfirstlane_b32 s28, v4
    s_nop 0
    s_cmp_lg_u32 s28, 0
    s_cbranch_scc1 L_role_got
    s_sleep 2
    s_sub_u32 s35, s35, 1
    s_cmp_lg_u32 s35, 0
    s_cbranch_scc1 L_role_poll
    s_branch L_role_fb
L_role_got:
    s_mov_b32 s29, -1
    s_mov_b32 s30, 1
    s_mov_b32 s23, 0
    s_mov_b32 s37, 0
    s_cmp_gt_u32 s28, 8
    s_cbranch_scc1 L_role_scan
    s_mov_b32 s30, 0
    s_mov_b32 s37, 32
    s_mov_b32 s23, 32
    s_cmp_ge_u32 s22, 32
    s_cbranch_scc1 L_role_scan
    s_add_u32 s36, s21, 1
    s_cmp_lg_u32 s36, s28
    s_cbranch_scc1 L_role_spec
    s_mov_b32 s29, s22
    s_branch L_role_pub
L_role_spec:
    s_cmp_gt_u32 s36, s28
    s_cselect_b32 s38, 1, 0
    s_sub_u32 s38, s21, s38
    s_lshl_b32 s23, s38, 5
    s_add_u32 s23, s23, s22
    s_add_u32 s23, s23, 32
L_role_scan:
    s_cmp_ge_u32 s23, 256
    s_cbranch_scc1 L_role_claimed
    v_mov_b32 v4, 1
    s_lshl_b32 s36, s23, 6
    s_add_u32 s36, s36, 100839424
    buffer_atomic_add v4, v9, s[16:19], s36 offen sc0 sc1
    s_waitcnt vmcnt(0)
    v_readfirstlane_b32 s36, v4
    s_nop 0
    s_cmp_eq_u32 s36, 0
    s_cbranch_scc1 L_role_claimed
    s_mov_b32 s23, s37
    s_add_u32 s37, s37, 1
    s_branch L_role_scan
L_role_claimed:
    s_cmp_ge_u32 s23, 32
    s_cbranch_scc1 L_role_w
    s_mov_b32 s29, s23
L_role_w:
    s_sub_u32 s23, s23, 32
L_role_pub:
    v_mov_b32 v4, s29
    v_mov_b32 v5, s30
    v_mov_b32 v6, s23
    v_mov_b32 v7, 0
    v_mov_b32 v8, 28416
    ds_write_b128 v8, v[4:7]
    s_waitcnt lgkmcnt(0)
    s_mov_b64 exec, -1
L_role_wait:
    s_barrier
    v_mov_b32 v8, 28416
    ds_read_b128 v[4:7], v8
    s_waitcnt lgkmcnt(0)
    v_readfirstlane_b32 s29, v4
    v_readfirstlane_b32 s30, v5
    v_readfirstlane_b32 s23, v6
    s_barrier
    s_cmp_eq_u32 s29, -1
    s_cbranch_scc1 L_worker
    s_lshr_b32 s31, s29, 1
    v_lshrrev_b32 v3, 4, v0
    v_and_b32 v4, 15, v0
    v_mov_b32 v1, 0x4444
    v_mov_b32 v2, 0xeeee
    v_and_b32 v5, 8, v0
    v_cmp_ne_u32 vcc, 0, v5
    s_nop 1
    v_cndmask_b32 v1, v1, v2, vcc
    v_lshlrev_b32 v2, 4, v0
    v_add_u32 v5, 0x1000, v2
    s_mov_b32 s42, 0xff00ff00
    s_mov_b32 s43, 0xff00ff00
    s_mov_b32 s44, 0xaaaaaaaa
    s_mov_b32 s45, 0xaaaaaaaa
    s_lshr_b32 s36, s31, 2
    s_lshl_b32 s36, s36, 10
    s_and_b32 s38, s31, 2
    s_lshl_b32 s38, s38, 8
    s_add_u32 s36, s36, s38
    s_and_b32 s38, s31, 1
    s_lshl_b32 s38, s38, 2
    s_add_u32 s36, s36, s38
    s_add_u32 s36, s36, 163840
    v_and_b32 v9, 1, v3
    v_lshlrev_b32 v9, 8, v9
    v_lshl_add_u32 v9, v4, 4, v9
    v_lshrrev_b32 v10, 1, v3
    v_lshl_add_u32 v9, v10, 3, v9
    v_add_u32 v9, s36, v9
    s_and_b32 s36, s29, 1
    s_lshl_b32 s37, s30, 1
    s_or_b32 s36, s36, s37
    s_cmp_eq_u32 s36, 1
    s_cbranch_scc1 L_sec_fast
    s_cmp_eq_u32 s36, 2
    s_cbranch_scc1 L_prim_safe
    s_cmp_eq_u32 s36, 3
    s_cbranch_scc1 L_sec_safe
    s_mul_i32 s36, s20, 14
    s_add_u32 s36, s36, 0
    v_add_u32 v10, s36, v3
    v_lshrrev_b32 v6, 3, v10
    v_lshlrev_b32 v6, 10, v6
    v_bfe_u32 v11, v10, 2, 1
    v_lshl_add_u32 v6, v11, 8, v6
    v_and_b32 v11, 1, v10
    v_lshl_add_u32 v6, v11, 9, v6
    v_bfe_u32 v11, v10, 1, 1
    v_lshl_add_u32 v6, v11, 3, v6
    v_and_b32 v11, 7, v4
    v_lshl_add_u32 v6, v11, 4, v6
    v_add_u32 v6, 14336, v6
    s_mul_i32 s36, s20, 14
    s_add_u32 s36, s36, 4
    v_add_u32 v10, s36, v3
    v_lshrrev_b32 v15, 3, v10
    v_lshlrev_b32 v15, 10, v15
    v_bfe_u32 v11, v10, 2, 1
    v_lshl_add_u32 v15, v11, 8, v15
    v_and_b32 v11, 1, v10
    v_lshl_add_u32 v15, v11, 9, v15
    v_bfe_u32 v11, v10, 1, 1
    v_lshl_add_u32 v15, v11, 3, v15
    v_and_b32 v11, 7, v4
    v_lshl_add_u32 v15, v11, 4, v15
    v_add_u32 v15, 14336, v15
    s_mul_i32 s36, s20, 14
    s_add_u32 s36, s36, 8
    v_add_u32 v10, s36, v3
    v_lshrrev_b32 v14, 3, v10
    v_lshlrev_b32 v14, 10, v14
    v_bfe_u32 v11, v10, 2, 1
    v_lshl_add_u32 v14, v11, 8, v14
    v_and_b32 v11, 1, v10
    v_lshl_add_u32 v14, v11, 9, v14
    v_bfe_u32 v11, v10, 1, 1
    v_lshl_add_u32 v14, v11, 3, v14
    v_and_b32 v11, 7, v4
    v_lshl_add_u32 v14, v11, 4, v14
    v_add_u32 v14, 14336, v14
    s_mul_i32 s36, s20, 14
    s_add_u32 s36, s36, 12
    v_lshrrev_b32 v10, 1, v3
    v_add_u32 v10, s36, v10
    v_lshrrev_b32 v9, 3, v10
    v_lshlrev_b32 v9, 10, v9
    v_bfe_u32 v11, v10, 2, 1
    v_lshl_add_u32 v9, v11, 8, v9
    v_and_b32 v11, 1, v10
    v_lshl_add_u32 v9, v11, 9, v9
    v_bfe_u32 v11, v10, 1, 1
    v_lshl_add_u32 v9, v11, 3, v9
    v_and_b32 v11, 1, v3
    v_lshl_add_u32 v9, v11, 2, v9
    v_and_b32 v11, 7, v4
    v_lshl_add_u32 v9, v11, 4, v9
    v_add_u32 v9, 14336, v9
    s_mul_i32 s36, s20, 7168
    s_add_u32 s36, s36, 83886080
    s_movk_i32 s39, 896
    v_add_u32 v7, s36, v2
    v_add_u32 v8, 3584, v7
    v_lshlrev_b32 v114, 3, v0
    v_add_u32 v114, s36, v114
    v_add_u32 v114, 3072, v114
    v_add_u32 v115, 3584, v114
    s_mul_i32 s36, s20, 3584
    v_lshlrev_b32 v10, 5, v4
    v_lshl_add_u32 v10, v3, 3, v10
    v_add_u32 v10, s36, v10
    v_lshlrev_b32 v11, 8, v3
    v_lshl_add_u32 v11, v4, 3, v11
    v_add_u32 v11, s36, v11
    v_and_b32 v12, 1, v3
    v_lshlrev_b32 v12, 2, v12
    v_lshrrev_b32 v116, 1, v3
    v_lshl_add_u32 v12, v116, 1, v12
    s_lshl_b32 s36, s20, 3
    v_add_u32 v12, s36, v12
    v_mul_u32_u24 v12, 208, v12
    v_lshl_add_u32 v12, v4, 2, v12
    v_add_u32 v12, 21504, v12
    v_and_b32 v13, 7, v0
    v_lshrrev_b32 v118, 3, v0
    v_mul_u32_u24 v116, 208, v118
    v_lshl_add_u32 v119, v13, 2, v116
    v_add_u32 v119, 21632, v119
    v_lshl_add_u32 v116, v13, 4, v116
    v_add_u32 v116, 21504, v116
    s_lshr_b32 s36, s31, 1
    s_lshl_b32 s36, s36, 10
    s_and_b32 s37, s31, 1
    s_lshl_b32 s37, s37, 7
    s_add_u32 s36, s36, s37
    s_add_u32 s36, s36, 16384
    v_lshrrev_b32 v117, 1, v13
    v_lshlrev_b32 v117, 8, v117
    v_lshl_add_u32 v117, v118, 4, v117
    v_and_b32 v113, 1, v13
    v_lshl_add_u32 v117, v113, 3, v117
    v_add_u32 v117, s36, v117
    s_lshr_b32 s36, s31, 1
    s_lshl_b32 s36, s36, 8
    s_and_b32 s37, s31, 1
    s_lshl_b32 s37, s37, 3
    s_add_u32 s36, s36, s37
    s_add_u32 s36, s36, 24576
    v_lshlrev_b32 v118, 4, v118
    v_bfe_u32 v113, v13, 1, 1
    v_lshl_add_u32 v118, v113, 7, v118
    v_lshrrev_b32 v113, 2, v13
    v_lshl_add_u32 v118, v113, 2, v118
    v_add_u32 v118, s36, v118
    v_mov_b32 v16, 0
    v_mov_b32 v17, 0
    v_mov_b32 v18, 0
    v_mov_b32 v19, 0
    ds_write_b128 v2, v[16:19] offset:21504
    ds_write_b128 v2, v[16:19] offset:22528
    s_lshl_b32 s41, s31, 2
    s_add_u32 s41, s41, 100831232
    s_mul_i32 s36, s31, 896
    s_mul_i32 s37, s20, 112
    s_add_u32 s36, s36, s37
    s_add_u32 s36, s36, 0
    v_add_u32 v13, s36, v4
    s_movk_i32 s39, 896
    v_mul_lo_u32 v13, v13, s39
    v_lshl_add_u32 v13, v3, 5, v13
    buffer_load_dwordx4 a[0:3], v13, s[16:19], 0 offen offset:0
    buffer_load_dwordx4 a[4:7], v13, s[16:19], 0 offen offset:16
    buffer_load_dwordx4 a[8:11], v13, s[16:19], 0 offen offset:128
    buffer_load_dwordx4 a[12:15], v13, s[16:19], 0 offen offset:144
    buffer_load_dwordx4 a[16:19], v13, s[16:19], 0 offen offset:256
    buffer_load_dwordx4 a[20:23], v13, s[16:19], 0 offen offset:272
    buffer_load_dwordx4 a[24:27], v13, s[16:19], 0 offen offset:384
    buffer_load_dwordx4 a[28:31], v13, s[16:19], 0 offen offset:400
    buffer_load_dwordx4 a[32:35], v13, s[16:19], 0 offen offset:512
    buffer_load_dwordx4 a[36:39], v13, s[16:19], 0 offen offset:528
    buffer_load_dwordx4 a[40:43], v13, s[16:19], 0 offen offset:640
    buffer_load_dwordx4 a[44:47], v13, s[16:19], 0 offen offset:656
    buffer_load_dwordx4 a[48:51], v13, s[16:19], 0 offen offset:768
    buffer_load_dwordx4 a[52:55], v13, s[16:19], 0 offen offset:784
    s_mul_i32 s36, s31, 896
    s_mul_i32 s37, s20, 112
    s_add_u32 s36, s36, s37
    s_add_u32 s36, s36, 16
    v_add_u32 v13, s36, v4
    s_movk_i32 s39, 896
    v_mul_lo_u32 v13, v13, s39
    v_lshl_add_u32 v13, v3, 5, v13
    buffer_load_dwordx4 a[56:59], v13, s[16:19], 0 offen offset:0
    buffer_load_dwordx4 a[60:63], v13, s[16:19], 0 offen offset:16
    buffer_load_dwordx4 a[64:67], v13, s[16:19], 0 offen offset:128
    buffer_load_dwordx4 a[68:71], v13, s[16:19], 0 offen offset:144
    buffer_load_dwordx4 a[72:75], v13, s[16:19], 0 offen offset:256
    buffer_load_dwordx4 a[76:79], v13, s[16:19], 0 offen offset:272
    buffer_load_dwordx4 a[80:83], v13, s[16:19], 0 offen offset:384
    buffer_load_dwordx4 a[84:87], v13, s[16:19], 0 offen offset:400
    buffer_load_dwordx4 a[88:91], v13, s[16:19], 0 offen offset:512
    buffer_load_dwordx4 a[92:95], v13, s[16:19], 0 offen offset:528
    buffer_load_dwordx4 a[96:99], v13, s[16:19], 0 offen offset:640
    buffer_load_dwordx4 a[100:103], v13, s[16:19], 0 offen offset:656
    buffer_load_dwordx4 a[104:107], v13, s[16:19], 0 offen offset:768
    buffer_load_dwordx4 a[108:111], v13, s[16:19], 0 offen offset:784
    s_mul_i32 s36, s31, 896
    s_mul_i32 s37, s20, 112
    s_add_u32 s36, s36, s37
    s_add_u32 s36, s36, 32
    v_add_u32 v13, s36, v4
    s_movk_i32 s39, 896
    v_mul_lo_u32 v13, v13, s39
    v_lshl_add_u32 v13, v3, 5, v13
    buffer_load_dwordx4 a[112:115], v13, s[16:19], 0 offen offset:0
    buffer_load_dwordx4 a[116:119], v13, s[16:19], 0 offen offset:16
    buffer_load_dwordx4 a[120:123], v13, s[16:19], 0 offen offset:128
    buffer_load_dwordx4 a[124:127], v13, s[16:19], 0 offen offset:144
    buffer_load_dwordx4 a[128:131], v13, s[16:19], 0 offen offset:256
    buffer_load_dwordx4 a[132:135], v13, s[16:19], 0 offen offset:272
    buffer_load_dwordx4 a[136:139], v13, s[16:19], 0 offen offset:384
    buffer_load_dwordx4 a[140:143], v13, s[16:19], 0 offen offset:400
    buffer_load_dwordx4 a[144:147], v13, s[16:19], 0 offen offset:512
    buffer_load_dwordx4 a[148:151], v13, s[16:19], 0 offen offset:528
    buffer_load_dwordx4 a[152:155], v13, s[16:19], 0 offen offset:640
    buffer_load_dwordx4 a[156:159], v13, s[16:19], 0 offen offset:656
    buffer_load_dwordx4 a[160:163], v13, s[16:19], 0 offen offset:768
    buffer_load_dwordx4 a[164:167], v13, s[16:19], 0 offen offset:784
    s_mul_i32 s36, s31, 896
    s_mul_i32 s37, s20, 112
    s_add_u32 s36, s36, s37
    s_add_u32 s36, s36, 48
    v_add_u32 v13, s36, v4
    s_movk_i32 s39, 896
    v_mul_lo_u32 v13, v13, s39
    v_lshl_add_u32 v13, v3, 5, v13
    buffer_load_dwordx4 a[168:171], v13, s[16:19], 0 offen offset:0
    buffer_load_dwordx4 a[172:175], v13, s[16:19], 0 offen offset:16
    buffer_load_dwordx4 a[176:179], v13, s[16:19], 0 offen offset:128
    buffer_load_dwordx4 a[180:183], v13, s[16:19], 0 offen offset:144
    buffer_load_dwordx4 a[184:187], v13, s[16:19], 0 offen offset:256
    buffer_load_dwordx4 a[188:191], v13, s[16:19], 0 offen offset:272
    buffer_load_dwordx4 a[192:195], v13, s[16:19], 0 offen offset:384
    buffer_load_dwordx4 a[196:199], v13, s[16:19], 0 offen offset:400
    buffer_load_dwordx4 a[200:203], v13, s[16:19], 0 offen offset:512
    buffer_load_dwordx4 a[204:207], v13, s[16:19], 0 offen offset:528
    buffer_load_dwordx4 a[208:211], v13, s[16:19], 0 offen offset:640
    buffer_load_dwordx4 a[212:215], v13, s[16:19], 0 offen offset:656
    buffer_load_dwordx4 a[216:219], v13, s[16:19], 0 offen offset:768
    buffer_load_dwordx4 a[220:223], v13, s[16:19], 0 offen offset:784
    s_mul_i32 s36, s31, 896
    s_mul_i32 s37, s20, 112
    s_add_u32 s36, s36, s37
    s_add_u32 s36, s36, 64
    v_add_u32 v13, s36, v4
    s_movk_i32 s39, 896
    v_mul_lo_u32 v13, v13, s39
    v_lshl_add_u32 v13, v3, 5, v13
    buffer_load_dwordx4 a[224:227], v13, s[16:19], 0 offen offset:0
    buffer_load_dwordx4 a[228:231], v13, s[16:19], 0 offen offset:16
    buffer_load_dwordx4 a[232:235], v13, s[16:19], 0 offen offset:128
    buffer_load_dwordx4 a[236:239], v13, s[16:19], 0 offen offset:144
    buffer_load_dwordx4 a[240:243], v13, s[16:19], 0 offen offset:256
    buffer_load_dwordx4 a[244:247], v13, s[16:19], 0 offen offset:272
    buffer_load_dwordx4 a[248:251], v13, s[16:19], 0 offen offset:384
    buffer_load_dwordx4 a[252:255], v13, s[16:19], 0 offen offset:400
    buffer_load_dwordx4 v[120:123], v13, s[16:19], 0 offen offset:512
    buffer_load_dwordx4 v[124:127], v13, s[16:19], 0 offen offset:528
    buffer_load_dwordx4 v[128:131], v13, s[16:19], 0 offen offset:640
    buffer_load_dwordx4 v[132:135], v13, s[16:19], 0 offen offset:656
    buffer_load_dwordx4 v[136:139], v13, s[16:19], 0 offen offset:768
    buffer_load_dwordx4 v[140:143], v13, s[16:19], 0 offen offset:784
    s_mul_i32 s36, s31, 896
    s_mul_i32 s37, s20, 112
    s_add_u32 s36, s36, s37
    s_add_u32 s36, s36, 80
    v_add_u32 v13, s36, v4
    s_movk_i32 s39, 896
    v_mul_lo_u32 v13, v13, s39
    v_lshl_add_u32 v13, v3, 5, v13
    buffer_load_dwordx4 v[144:147], v13, s[16:19], 0 offen offset:0
    buffer_load_dwordx4 v[148:151], v13, s[16:19], 0 offen offset:16
    buffer_load_dwordx4 v[152:155], v13, s[16:19], 0 offen offset:128
    buffer_load_dwordx4 v[156:159], v13, s[16:19], 0 offen offset:144
    buffer_load_dwordx4 v[160:163], v13, s[16:19], 0 offen offset:256
    buffer_load_dwordx4 v[164:167], v13, s[16:19], 0 offen offset:272
    buffer_load_dwordx4 v[168:171], v13, s[16:19], 0 offen offset:384
    buffer_load_dwordx4 v[172:175], v13, s[16:19], 0 offen offset:400
    buffer_load_dwordx4 v[176:179], v13, s[16:19], 0 offen offset:512
    buffer_load_dwordx4 v[180:183], v13, s[16:19], 0 offen offset:528
    buffer_load_dwordx4 v[184:187], v13, s[16:19], 0 offen offset:640
    buffer_load_dwordx4 v[188:191], v13, s[16:19], 0 offen offset:656
    buffer_load_dwordx4 v[192:195], v13, s[16:19], 0 offen offset:768
    buffer_load_dwordx4 v[196:199], v13, s[16:19], 0 offen offset:784
    s_mul_i32 s36, s31, 896
    s_mul_i32 s37, s20, 112
    s_add_u32 s36, s36, s37
    s_add_u32 s36, s36, 96
    v_add_u32 v13, s36, v4
    s_movk_i32 s39, 896
    v_mul_lo_u32 v13, v13, s39
    v_lshl_add_u32 v13, v3, 5, v13
    buffer_load_dwordx4 v[200:203], v13, s[16:19], 0 offen offset:0
    buffer_load_dwordx4 v[204:207], v13, s[16:19], 0 offen offset:16
    buffer_load_dwordx4 v[208:211], v13, s[16:19], 0 offen offset:128
    buffer_load_dwordx4 v[212:215], v13, s[16:19], 0 offen offset:144
    buffer_load_dwordx4 v[216:219], v13, s[16:19], 0 offen offset:256
    buffer_load_dwordx4 v[220:223], v13, s[16:19], 0 offen offset:272
    buffer_load_dwordx4 v[224:227], v13, s[16:19], 0 offen offset:384
    buffer_load_dwordx4 v[228:231], v13, s[16:19], 0 offen offset:400
    buffer_load_dwordx4 v[232:235], v13, s[16:19], 0 offen offset:512
    buffer_load_dwordx4 v[236:239], v13, s[16:19], 0 offen offset:528
    buffer_load_dwordx4 v[240:243], v13, s[16:19], 0 offen offset:640
    buffer_load_dwordx4 v[244:247], v13, s[16:19], 0 offen offset:656
    buffer_load_dwordx4 v[248:251], v13, s[16:19], 0 offen offset:768
    buffer_load_dwordx4 v[252:255], v13, s[16:19], 0 offen offset:784
    s_waitcnt vmcnt(0)
    s_mul_i32 s36, s20, 3584
    v_lshlrev_b32 v4, 3, v0
    v_add_u32 v4, s36, v4
    s_lshl_b32 s36, s20, 10
    v_add_u32 v5, s36, v2
    s_cmp_lt_u32 s20, 3
    s_cselect_b32 s49, 4096, 0
    v_add_u32 v3, s49, v5
    v_min_u32 v0, 27, v0
    v_lshlrev_b32 v0, 2, v0
    s_lshl_b32 s36, s31, 8
    s_add_u32 s36, s36, 100827136
    v_add_u32 v0, s36, v0
    s_mov_b32 s65, 0
    v_min_u32 v19, 48, v2
    v_lshlrev_b32 v19, 3, v19
    v_add_u32 v19, 100802560, v19
    s_mov_b32 s35, 2000000
L_x0_pf_1:
    buffer_load_dword v16, v19, s[16:19], 0 offen sc1
    s_waitcnt vmcnt(0)
    v_cmp_gt_u32 vcc, 28, v16
    s_cbranch_vccz L_x0ok_pf_2
    s_sleep 4
    s_sub_u32 s35, s35, 1
    s_cmp_lg_u32 s35, 0
    s_cbranch_scc1 L_x0_pf_1
L_x0ok_pf_2:
    s_mov_b32 s34, 0
    buffer_load_dwordx4 v[58:61], v7, s[16:19], s34 offen offset:0
    buffer_load_dwordx4 v[62:65], v7, s[16:19], s34 offen offset:1024
    buffer_load_dwordx4 v[66:69], v7, s[16:19], s34 offen offset:2048
    buffer_load_dwordx2 v[70:71], v114, s[16:19], s34 offen
    buffer_load_dwordx4 v[72:75], v8, s[16:19], s34 offen offset:0
    buffer_load_dwordx4 v[76:79], v8, s[16:19], s34 offen offset:1024
    buffer_load_dwordx4 v[80:83], v8, s[16:19], s34 offen offset:2048
    buffer_load_dwordx2 v[84:85], v115, s[16:19], s34 offen
    s_mov_b32 s32, 0
    s_and_b32 s36, s32, 3
    s_mul_i32 s33, s36, 32768
    s_add_u32 s33, s33, 100663296
    s_add_u32 s36, s32, 3
    s_and_b32 s36, s36, 3
    s_mul_i32 s53, s36, 32768
    s_add_u32 s53, s53, 100663296
    s_add_u32 s36, s32, 1
    s_and_b32 s36, s36, 3
    s_mul_i32 s54, s36, 32768
    s_add_u32 s54, s54, 100663296
    s_mul_i32 s55, s32, 122880
    s_add_u32 s55, s55, 104857600
    s_lshl_b32 s36, s31, 2
    s_add_u32 s36, s36, s20
    s_mul_i32 s66, s31, 28672
    s_mul_i32 s37, s20, 1024
    s_add_u32 s66, s66, s37
    s_add_u32 s66, s66, 17719296
    s_mul_i32 s47, s31, 28672
    s_mul_i32 s37, s20, 8192
    s_add_u32 s47, s47, s37
    s_add_u32 s47, s47, 17686528
    s_mul_i32 s40, s36, 1792
    s_add_u32 s40, s40, 131072
    s_mul_i32 s59, s36, 448
    s_add_u32 s59, s59, 83914752
    s_cmp_eq_u32 s20, 0
    s_cbranch_scc1 L_pw_3
    s_sub_u32 s37, s47, 917504
    buffer_load_dwordx4 v[116:119], v2, s[16:19], s37 offen offset:0
    buffer_load_dwordx4 v[116:119], v2, s[16:19], s37 offen offset:1024
    buffer_load_dwordx4 v[116:119], v2, s[16:19], s37 offen offset:2048
    buffer_load_dwordx4 v[116:119], v2, s[16:19], s37 offen offset:3072
    s_sub_u32 s37, s47, 913408
    buffer_load_dwordx4 v[116:119], v2, s[16:19], s37 offen offset:0
    buffer_load_dwordx4 v[116:119], v2, s[16:19], s37 offen offset:1024
    buffer_load_dwordx4 v[116:119], v2, s[16:19], s37 offen offset:2048
    buffer_load_dwordx4 v[116:119], v2, s[16:19], s37 offen offset:3072
    s_sub_u32 s37, s47, 458752
    buffer_load_dwordx4 v[116:119], v2, s[16:19], s37 offen offset:0
    buffer_load_dwordx4 v[116:119], v2, s[16:19], s37 offen offset:1024
    buffer_load_dwordx4 v[116:119], v2, s[16:19], s37 offen offset:2048
    buffer_load_dwordx4 v[116:119], v2, s[16:19], s37 offen offset:3072
    s_sub_u32 s37, s47, 454656
    buffer_load_dwordx4 v[116:119], v2, s[16:19], s37 offen offset:0
    buffer_load_dwordx4 v[116:119], v2, s[16:19], s37 offen offset:1024
    buffer_load_dwordx4 v[116:119], v2, s[16:19], s37 offen offset:2048
    buffer_load_dwordx4 v[116:119], v2, s[16:19], s37 offen offset:3072
L_pw_3:
    v_lshlrev_b32 v96, 2, v2
    s_add_u32 s36, s55, s40
    s_sub_u32 s36, s36, 122880
    s_mov_b64 exec, 0xfffffff
    buffer_load_dword v13, v96, s[16:19], s36 offen
    s_mov_b64 exec, -1
L_prim_loop_f:
    s_nop 7
    v_mov_b64 v[86:87], 0
    v_mov_b64 v[88:89], 0
    v_mov_b64 v[90:91], 0
    v_mov_b64 v[92:93], 0
    v_mov_b64 v[94:95], 0
    v_mov_b64 v[96:97], 0
    v_mov_b64 v[106:107], 0
    v_mov_b64 v[108:109], 0
    v_mov_b32 v94, -1
    v_mov_b32 v95, -1
    s_add_u32 s48, s33, s49
    s_mov_b32 s35, 65536
L_fl_pmf_4:
    buffer_load_dword v13, v0, s[16:19], 0 offen sc1
    s_waitcnt vmcnt(0)
    v_cmp_gt_u32 vcc, s32, v13
    s_cbranch_vccz L_flok_pmf_5
    s_sub_u32 s35, s35, 1
    s_cmp_lg_u32 s35, 0
    s_cbranch_scc1 L_fl_pmf_4
L_flok_pmf_5:
    s_mov_b32 s35, 65536
    buffer_load_dwordx4 v[44:47], v5, s[16:19], s33 offen sc1
    buffer_load_dwordx4 v[48:51], v5, s[16:19], s48 offen sc1
    s_sleep 2
L_pp_pmf_6:
    buffer_load_dwordx4 v[98:101], v5, s[16:19], s33 offen sc1
    buffer_load_dwordx4 v[102:105], v5, s[16:19], s48 offen sc1
    s_waitcnt vmcnt(2)
    v_max3_u32 v13, v44, v45, v46
    v_max3_u32 v13, v13, v47, v48
    v_max3_u32 v13, v13, v49, v50
    v_max3_u32 v13, v13, v51, v51
    v_cmp_eq_u32 vcc, -1, v13
    s_cbranch_vccz L_ppa_pmf_7
    buffer_load_dwordx4 v[44:47], v5, s[16:19], s33 offen sc1
    buffer_load_dwordx4 v[48:51], v5, s[16:19], s48 offen sc1
    s_waitcnt vmcnt(2)
    v_max3_u32 v13, v98, v99, v100
    v_max3_u32 v13, v13, v101, v102
    v_max3_u32 v13, v13, v103, v104
    v_max3_u32 v13, v13, v105, v105
    v_cmp_eq_u32 vcc, -1, v13
    s_cbranch_vccz L_ppb_pmf_8
    s_sub_u32 s35, s35, 1
    s_cmp_lg_u32 s35, 0
    s_cbranch_scc1 L_pp_pmf_6
L_ppb_pmf_8:
    ds_write_b128 v5, v[98:101] offset:14336
    ds_write_b128 v3, v[102:105] offset:14336
    s_branch L_ppd_pmf_9
L_ppa_pmf_7:
    ds_write_b128 v5, v[44:47] offset:14336
    ds_write_b128 v3, v[48:51] offset:14336
L_ppd_pmf_9:
    s_waitcnt lgkmcnt(0)
    s_barrier
    ds_read_b128 v[16:19], v2 offset:14336
    ds_read_b128 v[20:23], v2 offset:15360
    ds_read_b128 v[24:27], v2 offset:16384
    ds_read_b128 v[28:31], v2 offset:17408
    ds_read_b128 v[32:35], v2 offset:18432
    ds_read_b128 v[36:39], v2 offset:19456
    ds_read_b128 v[40:43], v2 offset:20480
    s_cmp_lg_u32 s20, 0
    s_cbranch_scc1 L_prim_nora_f
    buffer_store_dwordx2 v[94:95], v117, s[16:19], s53 offen
    buffer_store_dword v94, v118, s[16:19], s53 offen
L_prim_nora_f:
    v_lshlrev_b32 v96, 2, v2
    s_add_u32 s36, s55, s40
    s_mov_b64 exec, 0xfffffff
    buffer_load_dword v13, v96, s[16:19], s36 offen
    s_add_u32 s36, s34, s59
    s_mov_b64 exec, 0x7f
    buffer_load_dword v13, v96, s[16:19], s36 offen
    s_mov_b64 exec, -1
    v_mov_b64 v[94:95], 0
    v_mov_b64 v[96:97], 0
    s_waitcnt lgkmcnt(6)
    v_smfmac_f32_16x16x64_bf16 v[86:89], v[16:19], a[0:7], v1
    v_smfmac_f32_16x16x64_bf16 v[90:93], v[16:19], a[56:63], v1
    v_smfmac_f32_16x16x64_bf16 v[94:97], v[16:19], a[112:119], v1
    s_waitcnt lgkmcnt(5)
    v_smfmac_f32_16x16x64_bf16 v[86:89], v[20:23], a[8:15], v1
    v_smfmac_f32_16x16x64_bf16 v[90:93], v[20:23], a[64:71], v1
    v_smfmac_f32_16x16x64_bf16 v[94:97], v[20:23], a[120:127], v1
    s_waitcnt lgkmcnt(4)
    v_smfmac_f32_16x16x64_bf16 v[86:89], v[24:27], a[16:23], v1
    v_smfmac_f32_16x16x64_bf16 v[90:93], v[24:27], a[72:79], v1
    v_smfmac_f32_16x16x64_bf16 v[94:97], v[24:27], a[128:135], v1
    s_waitcnt lgkmcnt(3)
    v_smfmac_f32_16x16x64_bf16 v[86:89], v[28:31], a[24:31], v1
    v_smfmac_f32_16x16x64_bf16 v[90:93], v[28:31], a[80:87], v1
    v_smfmac_f32_16x16x64_bf16 v[94:97], v[28:31], a[136:143], v1
    s_waitcnt lgkmcnt(2)
    v_smfmac_f32_16x16x64_bf16 v[86:89], v[32:35], a[32:39], v1
    s_waitcnt vmcnt(2)
    v_smfmac_f32_16x16x64_bf16 v[90:93], v[32:35], a[88:95], v1
    ds_read2_b32 v[44:45], v6 offset0:0 offset1:32
    v_smfmac_f32_16x16x64_bf16 v[94:97], v[32:35], a[144:151], v1
    ds_read2_b32 v[46:47], v6 offset0:1 offset1:33
    s_waitcnt lgkmcnt(3)
    v_smfmac_f32_16x16x64_bf16 v[86:89], v[36:39], a[40:47], v1
    ds_read2_b32 v[48:49], v15 offset0:0 offset1:32
    v_smfmac_f32_16x16x64_bf16 v[90:93], v[36:39], a[96:103], v1
    ds_read2_b32 v[50:51], v15 offset0:1 offset1:33
    v_smfmac_f32_16x16x64_bf16 v[94:97], v[36:39], a[152:159], v1
    ds_read2_b32 v[52:53], v14 offset0:0 offset1:32
    s_waitcnt lgkmcnt(5)
    v_smfmac_f32_16x16x64_bf16 v[86:89], v[40:43], a[48:55], v1
    ds_read2_b32 v[54:55], v14 offset0:1 offset1:33
    v_smfmac_f32_16x16x64_bf16 v[90:93], v[40:43], a[104:111], v1
    ds_read2_b32 v[56:57], v9 offset0:0 offset1:32
    v_smfmac_f32_16x16x64_bf16 v[94:97], v[40:43], a[160:167], v1
    v_mov_b64 v[98:99], 0
    v_smfmac_f32_16x16x64_bf16 v[106:109], v[16:19], a[168:175], v1
    v_mov_b64 v[100:101], 0
    v_mov_b64 v[102:103], 0
    s_add_u32 s68, s47, 0
    s_add_u32 s69, s47, 4096
    s_add_u32 s70, s47, 8192
    s_add_u32 s47, s47, 458752
    v_smfmac_f32_16x16x64_bf16 v[106:109], v[20:23], a[176:183], v1
    v_mov_b64 v[104:105], 0
    v_cvt_pk_bf16_f32 v86, v86, v87
    s_cmp_eq_u32 s20, 0
    s_cbranch_scc1 L_wt_10
    buffer_load_dwordx4 v[116:119], v2, s[16:19], s68 offen offset:0
L_wt_10:
    v_smfmac_f32_16x16x64_bf16 v[106:109], v[24:27], a[184:191], v1
    v_cvt_pk_bf16_f32 v87, v88, v89
    ds_write_b64 v10, v[86:87] offset:0
    s_cmp_eq_u32 s20, 0
    s_cbranch_scc1 L_wt_11
    buffer_load_dwordx4 v[116:119], v2, s[16:19], s68 offen offset:1024
L_wt_11:
    v_smfmac_f32_16x16x64_bf16 v[106:109], v[28:31], a[192:199], v1
    v_mov_b64 v[86:87], 0
    v_mov_b64 v[88:89], 0
    s_cmp_eq_u32 s20, 0
    s_cbranch_scc1 L_wt_12
    buffer_load_dwordx4 v[116:119], v2, s[16:19], s68 offen offset:2048
L_wt_12:
    v_smfmac_f32_16x16x64_bf16 v[106:109], v[32:35], a[200:207], v1
    v_cvt_pk_bf16_f32 v90, v90, v91
    v_cvt_pk_bf16_f32 v91, v92, v93
    s_cmp_eq_u32 s20, 0
    s_cbranch_scc1 L_wt_13
    buffer_load_dwordx4 v[116:119], v2, s[16:19], s68 offen offset:3072
L_wt_13:
    v_smfmac_f32_16x16x64_bf16 v[106:109], v[36:39], a[208:215], v1
    ds_write_b64 v10, v[90:91] offset:512
    ds_read_b64_tr_b16 v[110:111], v11 offset:0
    s_cmp_eq_u32 s20, 0
    s_cbranch_scc1 L_wt_14
    buffer_load_dwordx4 v[116:119], v2, s[16:19], s69 offen offset:0
L_wt_14:
    v_smfmac_f32_16x16x64_bf16 v[106:109], v[40:43], a[216:223], v1
    ds_read_b64_tr_b16 v[112:113], v11 offset:128
    s_cmp_eq_u32 s20, 0
    s_cbranch_scc1 L_wt_15
    buffer_load_dwordx4 v[116:119], v2, s[16:19], s69 offen offset:1024
L_wt_15:
    v_smfmac_f32_16x16x64_bf16 v[86:89], v[16:19], a[224:231], v1
    v_cvt_pk_bf16_f32 v94, v94, v95
    v_cvt_pk_bf16_f32 v95, v96, v97
    s_cmp_eq_u32 s20, 0
    s_cbranch_scc1 L_wt_16
    buffer_load_dwordx4 v[116:119], v2, s[16:19], s69 offen offset:2048
L_wt_16:
    v_smfmac_f32_16x16x64_bf16 v[86:89], v[20:23], a[232:239], v1
    ds_write_b64 v10, v[94:95] offset:1024
    v_mov_b64 v[90:91], 0
    s_cmp_eq_u32 s20, 0
    s_cbranch_scc1 L_wt_17
    buffer_load_dwordx4 v[116:119], v2, s[16:19], s69 offen offset:3072
L_wt_17:
    v_smfmac_f32_16x16x64_bf16 v[86:89], v[24:27], a[240:247], v1
    v_mov_b64 v[92:93], 0
    v_smfmac_f32_16x16x64_bf16 v[86:89], v[28:31], a[248:255], v1
    v_cvt_pk_bf16_f32 v106, v106, v107
    v_cvt_pk_bf16_f32 v107, v108, v109
    v_smfmac_f32_16x16x64_bf16 v[86:89], v[32:35], v[120:127], v1
    ds_write_b64 v10, v[106:107] offset:1536
    v_mov_b64 v[106:107], 0
    v_smfmac_f32_16x16x64_bf16 v[86:89], v[36:39], v[128:135], v1
    v_mov_b64 v[108:109], 0
    v_smfmac_f32_16x16x64_bf16 v[86:89], v[40:43], v[136:143], v1
    s_waitcnt lgkmcnt(2)
    v_mfma_f32_16x16x32_bf16 v[98:101], v[110:113], v[58:61], v[98:101]
    v_mfma_f32_16x16x32_bf16 v[102:105], v[110:113], v[72:75], v[102:105]
    v_mfma_f32_16x16x32_bf16 v[106:109], v[110:113], v[44:47], v[106:109]
    v_smfmac_f32_16x16x64_bf16 v[90:93], v[16:19], v[144:151], v1
    ds_read_b64_tr_b16 v[110:111], v11 offset:1024
    ds_read_b64_tr_b16 v[112:113], v11 offset:1152
    v_smfmac_f32_16x16x64_bf16 v[90:93], v[20:23], v[152:159], v1
    v_mov_b64 v[94:95], 0
    v_mov_b64 v[96:97], 0
    v_smfmac_f32_16x16x64_bf16 v[90:93], v[24:27], v[160:167], v1
    v_smfmac_f32_16x16x64_bf16 v[90:93], v[28:31], v[168:175], v1
    v_cvt_pk_bf16_f32 v86, v86, v87
    v_cvt_pk_bf16_f32 v87, v88, v89
    v_smfmac_f32_16x16x64_bf16 v[90:93], v[32:35], v[176:183], v1
    ds_write_b64 v10, v[86:87] offset:2048
    v_smfmac_f32_16x16x64_bf16 v[90:93], v[36:39], v[184:191], v1
    v_smfmac_f32_16x16x64_bf16 v[90:93], v[40:43], v[192:199], v1
    s_waitcnt lgkmcnt(1)
    v_mfma_f32_16x16x32_bf16 v[98:101], v[110:113], v[62:65], v[98:101]
    v_mfma_f32_16x16x32_bf16 v[102:105], v[110:113], v[76:79], v[102:105]
    v_mfma_f32_16x16x32_bf16 v[106:109], v[110:113], v[48:51], v[106:109]
    v_smfmac_f32_16x16x64_bf16 v[94:97], v[16:19], v[200:207], v1
    v_smfmac_f32_16x16x64_bf16 v[94:97], v[20:23], v[208:215], v1
    v_smfmac_f32_16x16x64_bf16 v[94:97], v[24:27], v[216:223], v1
    v_smfmac_f32_16x16x64_bf16 v[94:97], v[28:31], v[224:231], v1
    v_cvt_pk_bf16_f32 v90, v90, v91
    v_cvt_pk_bf16_f32 v91, v92, v93
    v_smfmac_f32_16x16x64_bf16 v[94:97], v[32:35], v[232:239], v1
    ds_write_b64 v10, v[90:91] offset:2560
    ds_read_b64_tr_b16 v[110:111], v11 offset:2048
    v_smfmac_f32_16x16x64_bf16 v[94:97], v[36:39], v[240:247], v1
    ds_read_b64_tr_b16 v[112:113], v11 offset:2176
    v_smfmac_f32_16x16x64_bf16 v[94:97], v[40:43], v[248:255], v1
    s_waitcnt lgkmcnt(0)
    v_mfma_f32_16x16x32_bf16 v[98:101], v[110:113], v[66:69], v[98:101]
    v_mfma_f32_16x16x32_bf16 v[102:105], v[110:113], v[80:83], v[102:105]
    v_mfma_f32_16x16x32_bf16 v[106:109], v[110:113], v[52:55], v[106:109]
    s_nop 3
    v_cvt_pk_bf16_f32 v94, v94, v95
    v_cvt_pk_bf16_f32 v95, v96, v97
    ds_write_b64 v10, v[94:95] offset:3072
    ds_read_b64_tr_b16 v[86:87], v4 offset:3072
    s_waitcnt lgkmcnt(0)
    v_mfma_f32_16x16x16_bf16 v[98:101], v[86:87], v[70:71], v[98:101]
    v_mfma_f32_16x16x16_bf16 v[102:105], v[86:87], v[84:85], v[102:105]
    v_mfma_f32_16x16x16_bf16 v[106:109], v[86:87], v[56:57], v[106:109]
    s_nop 5
    v_permlane32_swap_b32 v98, v100
    v_permlane32_swap_b32 v99, v101
    v_add_f32 v98, v98, v100
    v_add_f32 v99, v99, v101
    ds_write_b32 v12, v98 offset:0
    ds_write_b32 v12, v99 offset:208
    v_permlane32_swap_b32 v102, v104
    v_permlane32_swap_b32 v103, v105
    v_add_f32 v102, v102, v104
    v_add_f32 v103, v103, v105
    ds_write_b32 v12, v102 offset:64
    ds_write_b32 v12, v103 offset:272
    v_permlane32_swap_b32 v106, v108
    v_permlane32_swap_b32 v107, v109
    v_add_f32 v106, v106, v108
    v_add_f32 v107, v107, v109
    ds_write_b32 v12, v106 offset:128
    ds_write_b32 v12, v107 offset:336
    s_waitcnt lgkmcnt(0)
    s_barrier
    s_cmp_eq_u32 s20, 0
    s_cbranch_scc1 L_prim_sm_f
    s_sleep 10
    s_cmp_lg_u32 s20, 3
    s_cbranch_scc1 L_ppe_18
    s_cmp_lg_u32 s65, 0
    s_cbranch_scc1 L_ppe_18
    v_mov_b32 v21, 0
    s_add_u32 s36, s32, 4
    s_min_u32 s36, s36, 63
    s_lshl_b32 s36, s36, 7
    s_add_u32 s36, s36, 100802560
    s_mov_b32 s37, 100797184
    s_mov_b32 s35, 2000000
L_xc_19:
    buffer_load_dword v22, v21, s[16:19], s36 offen sc1
    buffer_load_dword v23, v21, s[16:19], s37 offen sc1
    s_waitcnt vmcnt(0)
    v_readfirstlane_b32 s38, v23
    s_nop 0
    s_cmp_ge_u32 s38, 224
    s_cselect_b32 s65, 1, 0
    v_cmp_gt_u32 vcc, 28, v22
    s_cbranch_vccz L_xcok_20
    s_sleep 4
    s_sub_u32 s35, s35, 1
    s_cmp_lg_u32 s35, 0
    s_cbranch_scc1 L_xc_19
L_xcok_20:
L_ppe_18:
    s_branch L_prim_nosm_f
L_prim_sm_f:
    ds_read_b128 v[28:31], v116 offset:0
    ds_read_b128 v[32:35], v116 offset:1664
    ds_read_b128 v[36:39], v116 offset:3328
    ds_read_b128 v[40:43], v116 offset:4992
    ds_read_b32 v44, v119 offset:0
    ds_read_b32 v45, v119 offset:1664
    ds_read_b32 v46, v119 offset:3328
    ds_read_b32 v47, v119 offset:4992
    s_waitcnt lgkmcnt(0)
    v_pk_add_f32 v[28:29], v[28:29], v[32:33]
    v_pk_add_f32 v[30:31], v[30:31], v[34:35]
    v_pk_add_f32 v[36:37], v[36:37], v[40:41]
    v_pk_add_f32 v[38:39], v[38:39], v[42:43]
    v_pk_add_f32 v[44:45], v[44:45], v[46:47]
    v_pk_add_f32 v[16:17], v[28:29], v[36:37]
    v_pk_add_f32 v[18:19], v[30:31], v[38:39]
    v_add_f32 v20, v44, v45
    v_max3_f32 v21, v16, v17, v18
    v_max3_f32 v21, v21, v19, v20
    s_nop 1
    v_max_f32_dpp v21, v21, v21 quad_perm:[1,0,3,2] row_mask:0xf bank_mask:0xf
    s_nop 1
    v_max_f32_dpp v21, v21, v21 quad_perm:[2,3,0,1] row_mask:0xf bank_mask:0xf
    s_nop 1
    v_max_f32_dpp v21, v21, v21 row_half_mirror row_mask:0xf bank_mask:0xf
    v_sub_f32 v16, v16, v21
    v_sub_f32 v17, v17, v21
    v_sub_f32 v18, v18, v21
    v_sub_f32 v19, v19, v21
    v_sub_f32 v20, v20, v21
    v_exp_f32 v16, v16
    v_exp_f32 v17, v17
    v_exp_f32 v18, v18
    v_exp_f32 v19, v19
    v_exp_f32 v20, v20
    v_add_f32 v21, v16, v17
    v_add_f32 v22, v18, v19
    v_add_f32 v21, v21, v20
    v_add_f32 v21, v21, v22
    s_nop 1
    v_add_f32_dpp v21, v21, v21 quad_perm:[1,0,3,2] row_mask:0xf bank_mask:0xf
    s_nop 1
    v_add_f32_dpp v21, v21, v21 quad_perm:[2,3,0,1] row_mask:0xf bank_mask:0xf
    s_nop 1
    v_add_f32_dpp v21, v21, v21 row_half_mirror row_mask:0xf bank_mask:0xf
    v_rcp_f32 v21, v21
    s_nop 0
    v_mul_f32 v16, v16, v21
    v_mul_f32 v17, v17, v21
    v_mul_f32 v18, v18, v21
    v_mul_f32 v19, v19, v21
    v_mul_f32 v20, v20, v21
    v_cvt_pk_bf16_f32 v16, v16, v17
    v_cvt_pk_bf16_f32 v17, v18, v19
    buffer_store_dwordx2 v[16:17], v117, s[16:19], s33 offen
    v_mov_b32_dpp v22, v20 quad_perm:[1,0,3,2] row_mask:0xf bank_mask:0xf
    v_cndmask_b32 v23, v20, v22, s[44:45]
    v_cndmask_b32 v22, v22, v20, s[44:45]
    v_cvt_pk_bf16_f32 v22, v23, v22
    buffer_store_dword v22, v118, s[16:19], s33 offen
L_prim_nosm_f:
    s_nop 1
    s_add_u32 s34, s34, 28672
    buffer_load_dwordx4 v[58:61], v7, s[16:19], s34 offen offset:0
    buffer_load_dwordx4 v[62:65], v7, s[16:19], s34 offen offset:1024
    buffer_load_dwordx4 v[66:69], v7, s[16:19], s34 offen offset:2048
    buffer_load_dwordx2 v[70:71], v114, s[16:19], s34 offen
    buffer_load_dwordx4 v[72:75], v8, s[16:19], s34 offen offset:0
    buffer_load_dwordx4 v[76:79], v8, s[16:19], s34 offen offset:1024
    buffer_load_dwordx4 v[80:83], v8, s[16:19], s34 offen offset:2048
    buffer_load_dwordx2 v[84:85], v115, s[16:19], s34 offen
    s_add_u32 s66, s66, 458752
    s_add_u32 s32, s32, 1
    s_and_b32 s36, s32, 3
    s_mul_i32 s33, s36, 32768
    s_add_u32 s33, s33, 100663296
    s_add_u32 s36, s32, 3
    s_and_b32 s36, s36, 3
    s_mul_i32 s53, s36, 32768
    s_add_u32 s53, s53, 100663296
    s_add_u32 s36, s32, 1
    s_and_b32 s36, s36, 3
    s_mul_i32 s54, s36, 32768
    s_add_u32 s54, s54, 100663296
    s_mul_i32 s55, s32, 122880
    s_add_u32 s55, s55, 104857600
    s_cmp_lt_u32 s32, 64
    s_cbranch_scc1 L_prim_loop_f
    s_waitcnt vmcnt(0)
    s_branch L_chain_end
L_sec_fast:
    s_movk_i32 s39, 896
    v_and_b32 v12, 1, v3
    v_lshlrev_b32 v12, 2, v12
    v_lshrrev_b32 v13, 1, v3
    v_lshl_add_u32 v12, v13, 1, v12
    s_lshl_b32 s36, s20, 3
    v_add_u32 v12, s36, v12
    v_mul_u32_u24 v12, 80, v12
    v_lshl_add_u32 v12, v4, 2, v12
    v_add_u32 v12, 0, v12
    s_mul_i32 s36, s20, 14336
    s_add_u32 s36, s36, 32768
    v_add_u32 v13, s36, v2
    v_lshlrev_b32 v14, 5, v0
    s_cmp_lt_u32 s31, 12
    s_cselect_b32 s46, 1, 0
    v_and_b32 v6, 1, v3
    v_lshlrev_b32 v6, 3, v6
    v_lshrrev_b32 v7, 1, v3
    v_lshl_add_u32 v6, v7, 2, v6
    v_lshl_add_u32 v6, v4, 4, v6
    s_mul_i32 s36, s31, 7168
    s_mul_i32 s37, s20, 1792
    s_add_u32 s36, s36, s37
    s_add_u32 s36, s36, 8192
    v_add_u32 v6, s36, v6
    s_and_b32 s38, s20, 1
    s_movk_i32 s36, 7168
    v_mul_lo_u32 v7, v3, s36
    v_lshl_add_u32 v7, v4, 4, v7
    s_mul_i32 s36, s20, 28672
    s_lshl_b32 s37, s31, 8
    s_add_u32 s36, s36, s37
    s_add_u32 s36, s36, 8192
    v_add_u32 v7, s36, v7
    s_lshl_b32 s40, s38, 4
    s_add_u32 s40, s40, s31
    v_and_b32 v108, 7, v0
    v_lshrrev_b32 v110, 3, v0
    v_mul_u32_u24 v109, 80, v108
    v_lshl_add_u32 v109, v110, 3, v109
    s_mul_i32 s36, s38, 2560
    s_add_u32 s36, s36, 0
    v_add_u32 v109, s36, v109
    v_lshrrev_b32 v111, 2, v110
    v_lshlrev_b32 v15, 9, v111
    v_and_b32 v111, 1, v110
    v_lshl_add_u32 v15, v111, 7, v15
    v_lshl_add_u32 v15, v108, 4, v15
    v_bfe_u32 v111, v110, 1, 1
    v_lshl_add_u32 v15, v111, 2, v15
    s_lshr_b32 s36, s40, 2
    s_lshl_b32 s36, s36, 10
    s_and_b32 s37, s40, 2
    s_lshl_b32 s37, s37, 7
    s_add_u32 s36, s36, s37
    s_and_b32 s37, s40, 1
    s_lshl_b32 s37, s37, 3
    s_add_u32 s36, s36, s37
    v_add_u32 v15, s36, v15
    v_mul_lo_u32 v111, v108, s39
    v_lshl_add_u32 v111, v110, 2, v111
    s_lshl_b32 s36, s40, 5
    v_add_u32 v111, s36, v111
    s_lshl_b32 s36, s20, 9
    s_add_u32 s36, s36, 24576
    v_add_u32 v110, s36, v2
    v_mov_b32 v108, 0x7ff00000
    v_cmp_lt_u32 vcc, 31, v0
    s_nop 1
    v_cndmask_b32 v110, v110, v108, vcc
    s_lshl_b32 s36, s20, 11
    s_add_u32 s36, s36, 16384
    v_add_u32 v11, s36, v2
    s_mul_i32 s36, s31, 896
    s_mul_i32 s37, s20, 112
    s_add_u32 s36, s36, s37
    s_add_u32 s36, s36, 448
    v_add_u32 v108, s36, v4
    s_movk_i32 s39, 896
    v_mul_lo_u32 v108, v108, s39
    v_lshl_add_u32 v108, v3, 5, v108
    buffer_load_dwordx4 a[0:3], v108, s[16:19], 0 offen offset:0
    buffer_load_dwordx4 a[4:7], v108, s[16:19], 0 offen offset:16
    buffer_load_dwordx4 a[8:11], v108, s[16:19], 0 offen offset:128
    buffer_load_dwordx4 a[12:15], v108, s[16:19], 0 offen offset:144
    buffer_load_dwordx4 a[16:19], v108, s[16:19], 0 offen offset:256
    buffer_load_dwordx4 a[20:23], v108, s[16:19], 0 offen offset:272
    buffer_load_dwordx4 a[24:27], v108, s[16:19], 0 offen offset:384
    buffer_load_dwordx4 a[28:31], v108, s[16:19], 0 offen offset:400
    buffer_load_dwordx4 a[32:35], v108, s[16:19], 0 offen offset:512
    buffer_load_dwordx4 a[36:39], v108, s[16:19], 0 offen offset:528
    buffer_load_dwordx4 a[40:43], v108, s[16:19], 0 offen offset:640
    buffer_load_dwordx4 a[44:47], v108, s[16:19], 0 offen offset:656
    buffer_load_dwordx4 a[48:51], v108, s[16:19], 0 offen offset:768
    buffer_load_dwordx4 a[52:55], v108, s[16:19], 0 offen offset:784
    s_mul_i32 s36, s31, 896
    s_mul_i32 s37, s20, 112
    s_add_u32 s36, s36, s37
    s_add_u32 s36, s36, 464
    v_add_u32 v108, s36, v4
    s_movk_i32 s39, 896
    v_mul_lo_u32 v108, v108, s39
    v_lshl_add_u32 v108, v3, 5, v108
    buffer_load_dwordx4 a[56:59], v108, s[16:19], 0 offen offset:0
    buffer_load_dwordx4 a[60:63], v108, s[16:19], 0 offen offset:16
    buffer_load_dwordx4 a[64:67], v108, s[16:19], 0 offen offset:128
    buffer_load_dwordx4 a[68:71], v108, s[16:19], 0 offen offset:144
    buffer_load_dwordx4 a[72:75], v108, s[16:19], 0 offen offset:256
    buffer_load_dwordx4 a[76:79], v108, s[16:19], 0 offen offset:272
    buffer_load_dwordx4 a[80:83], v108, s[16:19], 0 offen offset:384
    buffer_load_dwordx4 a[84:87], v108, s[16:19], 0 offen offset:400
    buffer_load_dwordx4 a[88:91], v108, s[16:19], 0 offen offset:512
    buffer_load_dwordx4 a[92:95], v108, s[16:19], 0 offen offset:528
    buffer_load_dwordx4 a[96:99], v108, s[16:19], 0 offen offset:640
    buffer_load_dwordx4 a[100:103], v108, s[16:19], 0 offen offset:656
    buffer_load_dwordx4 a[104:107], v108, s[16:19], 0 offen offset:768
    buffer_load_dwordx4 a[108:111], v108, s[16:19], 0 offen offset:784
    s_mul_i32 s36, s31, 896
    s_mul_i32 s37, s20, 112
    s_add_u32 s36, s36, s37
    s_add_u32 s36, s36, 480
    v_add_u32 v108, s36, v4
    s_movk_i32 s39, 896
    v_mul_lo_u32 v108, v108, s39
    v_lshl_add_u32 v108, v3, 5, v108
    buffer_load_dwordx4 a[112:115], v108, s[16:19], 0 offen offset:0
    buffer_load_dwordx4 a[116:119], v108, s[16:19], 0 offen offset:16
    buffer_load_dwordx4 a[120:123], v108, s[16:19], 0 offen offset:128
    buffer_load_dwordx4 a[124:127], v108, s[16:19], 0 offen offset:144
    buffer_load_dwordx4 a[128:131], v108, s[16:19], 0 offen offset:256
    buffer_load_dwordx4 a[132:135], v108, s[16:19], 0 offen offset:272
    buffer_load_dwordx4 a[136:139], v108, s[16:19], 0 offen offset:384
    buffer_load_dwordx4 a[140:143], v108, s[16:19], 0 offen offset:400
    buffer_load_dwordx4 a[144:147], v108, s[16:19], 0 offen offset:512
    buffer_load_dwordx4 a[148:151], v108, s[16:19], 0 offen offset:528
    buffer_load_dwordx4 a[152:155], v108, s[16:19], 0 offen offset:640
    buffer_load_dwordx4 a[156:159], v108, s[16:19], 0 offen offset:656
    buffer_load_dwordx4 a[160:163], v108, s[16:19], 0 offen offset:768
    buffer_load_dwordx4 a[164:167], v108, s[16:19], 0 offen offset:784
    s_mul_i32 s36, s31, 896
    s_mul_i32 s37, s20, 112
    s_add_u32 s36, s36, s37
    s_add_u32 s36, s36, 496
    v_add_u32 v108, s36, v4
    s_movk_i32 s39, 896
    v_mul_lo_u32 v108, v108, s39
    v_lshl_add_u32 v108, v3, 5, v108
    buffer_load_dwordx4 a[168:171], v108, s[16:19], 0 offen offset:0
    buffer_load_dwordx4 a[172:175], v108, s[16:19], 0 offen offset:16
    buffer_load_dwordx4 a[176:179], v108, s[16:19], 0 offen offset:128
    buffer_load_dwordx4 a[180:183], v108, s[16:19], 0 offen offset:144
    buffer_load_dwordx4 a[184:187], v108, s[16:19], 0 offen offset:256
    buffer_load_dwordx4 a[188:191], v108, s[16:19], 0 offen offset:272
    buffer_load_dwordx4 a[192:195], v108, s[16:19], 0 offen offset:384
    buffer_load_dwordx4 a[196:199], v108, s[16:19], 0 offen offset:400
    buffer_load_dwordx4 a[200:203], v108, s[16:19], 0 offen offset:512
    buffer_load_dwordx4 a[204:207], v108, s[16:19], 0 offen offset:528
    buffer_load_dwordx4 a[208:211], v108, s[16:19], 0 offen offset:640
    buffer_load_dwordx4 a[212:215], v108, s[16:19], 0 offen offset:656
    buffer_load_dwordx4 a[216:219], v108, s[16:19], 0 offen offset:768
    buffer_load_dwordx4 a[220:223], v108, s[16:19], 0 offen offset:784
    s_mul_i32 s36, s31, 896
    s_mul_i32 s37, s20, 112
    s_add_u32 s36, s36, s37
    s_add_u32 s36, s36, 512
    v_add_u32 v108, s36, v4
    s_movk_i32 s39, 896
    v_mul_lo_u32 v108, v108, s39
    v_lshl_add_u32 v108, v3, 5, v108
    buffer_load_dwordx4 a[224:227], v108, s[16:19], 0 offen offset:0
    buffer_load_dwordx4 a[228:231], v108, s[16:19], 0 offen offset:16
    buffer_load_dwordx4 a[232:235], v108, s[16:19], 0 offen offset:128
    buffer_load_dwordx4 a[236:239], v108, s[16:19], 0 offen offset:144
    buffer_load_dwordx4 a[240:243], v108, s[16:19], 0 offen offset:256
    buffer_load_dwordx4 a[244:247], v108, s[16:19], 0 offen offset:272
    buffer_load_dwordx4 a[248:251], v108, s[16:19], 0 offen offset:384
    buffer_load_dwordx4 a[252:255], v108, s[16:19], 0 offen offset:400
    buffer_load_dwordx4 v[176:179], v108, s[16:19], 0 offen offset:512
    buffer_load_dwordx4 v[180:183], v108, s[16:19], 0 offen offset:528
    buffer_load_dwordx4 v[184:187], v108, s[16:19], 0 offen offset:640
    buffer_load_dwordx4 v[188:191], v108, s[16:19], 0 offen offset:656
    buffer_load_dwordx4 v[192:195], v108, s[16:19], 0 offen offset:768
    buffer_load_dwordx4 v[196:199], v108, s[16:19], 0 offen offset:784
    s_mul_i32 s36, s31, 896
    s_mul_i32 s37, s20, 112
    s_add_u32 s36, s36, s37
    s_add_u32 s36, s36, 528
    v_add_u32 v108, s36, v4
    s_movk_i32 s39, 896
    v_mul_lo_u32 v108, v108, s39
    v_lshl_add_u32 v108, v3, 5, v108
    buffer_load_dwordx4 v[200:203], v108, s[16:19], 0 offen offset:0
    buffer_load_dwordx4 v[204:207], v108, s[16:19], 0 offen offset:16
    buffer_load_dwordx4 v[208:211], v108, s[16:19], 0 offen offset:128
    buffer_load_dwordx4 v[212:215], v108, s[16:19], 0 offen offset:144
    buffer_load_dwordx4 v[216:219], v108, s[16:19], 0 offen offset:256
    buffer_load_dwordx4 v[220:223], v108, s[16:19], 0 offen offset:272
    buffer_load_dwordx4 v[224:227], v108, s[16:19], 0 offen offset:384
    buffer_load_dwordx4 v[228:231], v108, s[16:19], 0 offen offset:400
    buffer_load_dwordx4 v[232:235], v108, s[16:19], 0 offen offset:512
    buffer_load_dwordx4 v[236:239], v108, s[16:19], 0 offen offset:528
    buffer_load_dwordx4 v[240:243], v108, s[16:19], 0 offen offset:640
    buffer_load_dwordx4 v[244:247], v108, s[16:19], 0 offen offset:656
    buffer_load_dwordx4 v[248:251], v108, s[16:19], 0 offen offset:768
    buffer_load_dwordx4 v[252:255], v108, s[16:19], 0 offen offset:784
    s_mul_i32 s36, s31, 896
    s_mul_i32 s37, s20, 112
    s_add_u32 s36, s36, s37
    s_add_u32 s36, s36, 544
    v_add_u32 v108, s36, v4
    s_movk_i32 s39, 896
    v_mul_lo_u32 v108, v108, s39
    v_lshl_add_u32 v108, v3, 5, v108
    buffer_load_dwordx4 v[112:115], v108, s[16:19], 0 offen offset:0
    buffer_load_dwordx4 v[116:119], v108, s[16:19], 0 offen offset:16
    buffer_load_dwordx4 v[120:123], v108, s[16:19], 0 offen offset:128
    buffer_load_dwordx4 v[124:127], v108, s[16:19], 0 offen offset:144
    buffer_load_dwordx4 v[128:131], v108, s[16:19], 0 offen offset:256
    buffer_load_dwordx4 v[132:135], v108, s[16:19], 0 offen offset:272
    buffer_load_dwordx4 v[136:139], v108, s[16:19], 0 offen offset:384
    buffer_load_dwordx4 v[140:143], v108, s[16:19], 0 offen offset:400
    buffer_load_dwordx4 v[144:147], v108, s[16:19], 0 offen offset:512
    buffer_load_dwordx4 v[148:151], v108, s[16:19], 0 offen offset:528
    buffer_load_dwordx4 v[152:155], v108, s[16:19], 0 offen offset:640
    buffer_load_dwordx4 v[156:159], v108, s[16:19], 0 offen offset:656
    buffer_load_dwordx4 v[160:163], v108, s[16:19], 0 offen offset:768
    buffer_load_dwordx4 v[164:167], v108, s[16:19], 0 offen offset:784
    s_waitcnt vmcnt(0)
    ds_write_b128 v13, v[112:115] offset:0
    ds_write_b128 v13, v[116:119] offset:1024
    ds_write_b128 v13, v[120:123] offset:2048
    ds_write_b128 v13, v[124:127] offset:3072
    ds_write_b128 v13, v[128:131] offset:4096
    ds_write_b128 v13, v[132:135] offset:5120
    ds_write_b128 v13, v[136:139] offset:6144
    ds_write_b128 v13, v[140:143] offset:7168
    ds_write_b128 v13, v[144:147] offset:8192
    ds_write_b128 v13, v[148:151] offset:9216
    ds_write_b128 v13, v[152:155] offset:10240
    ds_write_b128 v13, v[156:159] offset:11264
    ds_write_b128 v13, v[160:163] offset:12288
    ds_write_b128 v13, v[164:167] offset:13312
    s_waitcnt lgkmcnt(0)
    s_cmp_lg_u32 s20, 3
    s_cbranch_scc1 L_sec_lk_f
    v_min_u32 v108, 27, v0
    s_mul_i32 s36, s31, 28
    v_add_u32 v108, s36, v108
    v_lshlrev_b32 v111, 4, v108
    s_mov_b32 s36, 0x04924925
    v_mul_hi_u32 v107, v108, s36
    v_mul_u32_u24 v106, 56, v107
    v_sub_u32 v108, v108, v106
    v_lshrrev_b32 v109, 3, v108
    v_lshlrev_b32 v109, 10, v109
    v_bfe_u32 v106, v108, 2, 1
    v_lshl_add_u32 v109, v106, 8, v109
    v_and_b32 v106, 1, v108
    v_lshl_add_u32 v109, v106, 9, v109
    v_bfe_u32 v106, v108, 1, 1
    v_lshl_add_u32 v109, v106, 3, v109
    v_lshl_add_u32 v109, v107, 4, v109
    v_add_u32 v109, 14336, v109
L_sec_lk_f:
    s_lshl_b32 s36, s20, 10
    v_add_u32 v5, s36, v2
    s_cmp_lt_u32 s20, 3
    s_cselect_b32 s49, 4096, 0
    v_add_u32 v3, s49, v5
    v_mov_b32 v8, -1
    v_and_b32 v9, 3, v0
    s_lshl_b32 s36, s20, 4
    s_lshl_b32 s37, s31, 8
    s_add_u32 s36, s36, s37
    s_add_u32 s36, s36, 100831232
    v_lshl_add_u32 v9, v9, 2, s36
    v_lshlrev_b32 v10, 8, v0
    v_min_u32 v0, 27, v0
    v_lshlrev_b32 v0, 2, v0
    s_add_u32 s37, s37, 100827136
    v_add_u32 v0, s37, v0
    s_lshl_b32 s58, s40, 2
    s_add_u32 s58, s58, 100827136
    s_mov_b32 s32, 0
    s_lshl_b32 s47, s31, 14
    s_lshl_b32 s36, s20, 12
    s_add_u32 s47, s47, s36
    s_add_u32 s47, s47, 16777216
    v_mov_b32 v72, 0
    v_mov_b32 v73, 0
    v_mov_b32 v74, 0
    v_mov_b32 v75, 0
    v_mov_b32 v76, 0
    v_mov_b32 v77, 0
    v_mov_b32 v78, 0
    v_mov_b32 v79, 0
    v_mov_b32 v80, 0
    v_mov_b32 v81, 0
    v_mov_b32 v82, 0
    v_mov_b32 v83, 0
    v_mov_b32 v84, 0
    v_mov_b32 v85, 0
    v_mov_b32 v86, 0
    v_mov_b32 v87, 0
    v_mov_b32 v112, 0
    v_mov_b32 v113, 0
    v_mov_b32 v114, 0
    v_mov_b32 v115, 0
    v_mov_b32 v116, 0
    v_mov_b32 v117, 0
    v_mov_b32 v118, 0
    v_mov_b32 v119, 0
    v_mov_b32 v120, 0
    v_mov_b32 v121, 0
    v_mov_b32 v122, 0
    v_mov_b32 v123, 0
    v_mov_b32 v124, 0
    v_mov_b32 v125, 0
    v_mov_b32 v126, 0
    v_mov_b32 v127, 0
    v_mov_b32 v128, 0
    v_mov_b32 v129, 0
    v_mov_b32 v130, 0
    v_mov_b32 v131, 0
    v_mov_b32 v132, 0
    v_mov_b32 v133, 0
    v_mov_b32 v134, 0
    v_mov_b32 v135, 0
    v_mov_b32 v136, 0
    v_mov_b32 v137, 0
    v_mov_b32 v138, 0
    v_mov_b32 v139, 0
    v_mov_b32 v140, 0
    v_mov_b32 v141, 0
    v_mov_b32 v142, 0
    v_mov_b32 v143, 0
    s_and_b32 s36, s32, 3
    s_mul_i32 s33, s36, 32768
    s_add_u32 s33, s33, 100663296
    s_add_u32 s36, s32, 3
    s_and_b32 s36, s36, 3
    s_mul_i32 s53, s36, 32768
    s_add_u32 s53, s53, 100663296
    s_add_u32 s36, s32, 1
    s_and_b32 s36, s36, 3
    s_mul_i32 s54, s36, 32768
    s_add_u32 s54, s54, 100663296
    s_mul_i32 s55, s32, 122880
    s_add_u32 s55, s55, 104857600
    s_mul_i32 s66, s31, 28672
    s_mul_i32 s37, s20, 1024
    s_add_u32 s66, s66, s37
    s_add_u32 s66, s66, 17719296
    v_min_u32 v19, 48, v2
    v_lshlrev_b32 v19, 3, v19
    v_add_u32 v19, 100802560, v19
    s_mov_b32 s35, 2000000
L_x0_sf_21:
    buffer_load_dword v16, v19, s[16:19], 0 offen sc1
    s_waitcnt vmcnt(0)
    v_cmp_gt_u32 vcc, 28, v16
    s_cbranch_vccz L_x0ok_sf_22
    s_sleep 4
    s_sub_u32 s35, s35, 1
    s_cmp_lg_u32 s35, 0
    s_cbranch_scc1 L_x0_sf_21
L_x0ok_sf_22:
L_sec_loop_f:
    s_nop 7
    v_mov_b64 v[44:45], 0
    v_mov_b64 v[46:47], 0
    v_mov_b64 v[48:49], 0
    v_mov_b64 v[50:51], 0
    v_mov_b64 v[52:53], 0
    v_mov_b64 v[54:55], 0
    v_mov_b64 v[56:57], 0
    v_mov_b64 v[58:59], 0
    v_mov_b64 v[60:61], 0
    v_mov_b64 v[62:63], 0
    v_mov_b64 v[64:65], 0
    v_mov_b64 v[66:67], 0
    v_mov_b64 v[68:69], 0
    v_mov_b64 v[70:71], 0
    s_add_u32 s48, s33, s49
    s_mov_b32 s35, 65536
    buffer_load_dwordx4 v[144:147], v5, s[16:19], s33 offen sc1
    buffer_load_dwordx4 v[148:151], v5, s[16:19], s48 offen sc1
    s_sleep 2
L_pp_smf_23:
    buffer_load_dwordx4 v[152:155], v5, s[16:19], s33 offen sc1
    buffer_load_dwordx4 v[156:159], v5, s[16:19], s48 offen sc1
    s_waitcnt vmcnt(2)
    v_max3_u32 v108, v144, v145, v146
    v_max3_u32 v108, v108, v147, v148
    v_max3_u32 v108, v108, v149, v150
    v_max3_u32 v108, v108, v151, v151
    v_cmp_eq_u32 vcc, -1, v108
    s_cbranch_vccz L_ppa_smf_24
    buffer_load_dwordx4 v[144:147], v5, s[16:19], s33 offen sc1
    buffer_load_dwordx4 v[148:151], v5, s[16:19], s48 offen sc1
    s_waitcnt vmcnt(2)
    v_max3_u32 v108, v152, v153, v154
    v_max3_u32 v108, v108, v155, v156
    v_max3_u32 v108, v108, v157, v158
    v_max3_u32 v108, v108, v159, v159
    v_cmp_eq_u32 vcc, -1, v108
    s_cbranch_vccz L_ppb_smf_25
    s_sub_u32 s35, s35, 1
    s_cmp_lg_u32 s35, 0
    s_cbranch_scc1 L_pp_smf_23
L_ppb_smf_25:
    ds_write_b128 v5, v[152:155] offset:14336
    ds_write_b128 v3, v[156:159] offset:14336
    s_branch L_ppd_smf_26
L_ppa_smf_24:
    ds_write_b128 v5, v[144:147] offset:14336
    ds_write_b128 v3, v[148:151] offset:14336
L_ppd_smf_26:
    s_waitcnt lgkmcnt(0)
    s_barrier
    ds_read_b128 v[16:19], v2 offset:14336
    ds_read_b128 v[20:23], v2 offset:15360
    ds_read_b128 v[24:27], v2 offset:16384
    ds_read_b128 v[28:31], v2 offset:17408
    ds_read_b128 v[32:35], v2 offset:18432
    ds_read_b128 v[36:39], v2 offset:19456
    ds_read_b128 v[40:43], v2 offset:20480
    buffer_load_dwordx4 v[112:115], v14, s[16:19], s47 offen offset:0
    buffer_load_dwordx4 v[116:119], v14, s[16:19], s47 offen offset:16
    buffer_load_dwordx4 v[120:123], v14, s[16:19], s47 offen offset:2048
    buffer_load_dwordx4 v[124:127], v14, s[16:19], s47 offen offset:2064
    s_cmp_eq_u32 s46, 0
    s_cbranch_scc1 L_sec_noxv_27
    s_add_u32 s36, s47, 262144
    buffer_load_dwordx4 v[128:131], v14, s[16:19], s36 offen offset:0
    buffer_load_dwordx4 v[132:135], v14, s[16:19], s36 offen offset:16
    buffer_load_dwordx4 v[136:139], v14, s[16:19], s36 offen offset:2048
    buffer_load_dwordx4 v[140:143], v14, s[16:19], s36 offen offset:2064
L_sec_noxv_27:
    s_add_u32 s37, s66, 0
    buffer_load_dwordx4 v[160:163], v2, s[16:19], s37 offen offset:0
    s_add_u32 s66, s66, 458752
    s_waitcnt lgkmcnt(6)
    v_smfmac_f32_16x16x64_bf16 v[44:47], v[16:19], a[0:7], v1
    s_waitcnt lgkmcnt(5)
    v_smfmac_f32_16x16x64_bf16 v[44:47], v[20:23], a[8:15], v1
    s_waitcnt lgkmcnt(4)
    v_smfmac_f32_16x16x64_bf16 v[44:47], v[24:27], a[16:23], v1
    s_waitcnt lgkmcnt(3)
    v_smfmac_f32_16x16x64_bf16 v[44:47], v[28:31], a[24:31], v1
    s_waitcnt lgkmcnt(2)
    v_smfmac_f32_16x16x64_bf16 v[44:47], v[32:35], a[32:39], v1
    s_waitcnt lgkmcnt(1)
    v_smfmac_f32_16x16x64_bf16 v[44:47], v[36:39], a[40:47], v1
    s_waitcnt lgkmcnt(0)
    v_smfmac_f32_16x16x64_bf16 v[44:47], v[40:43], a[48:55], v1
    s_cmp_gt_u32 s20, s46
    s_cbranch_scc1 L_sec_nora_f
    buffer_store_dword v8, v15, s[16:19], s53 offen
L_sec_nora_f:
    s_cmp_lg_u32 s20, 3
    s_cbranch_scc1 L_sec_mp_28
    ds_read2_b32 v[92:93], v109 offset0:0 offset1:32
    ds_read2_b32 v[94:95], v109 offset0:1 offset1:33
    s_waitcnt lgkmcnt(0)
    buffer_store_dwordx4 v[92:95], v111, s[16:19], s55 offen sc1
L_sec_mp_28:
    v_smfmac_f32_16x16x64_bf16 v[48:51], v[16:19], a[56:63], v1
    v_smfmac_f32_16x16x64_bf16 v[48:51], v[20:23], a[64:71], v1
    v_smfmac_f32_16x16x64_bf16 v[48:51], v[24:27], a[72:79], v1
    v_smfmac_f32_16x16x64_bf16 v[48:51], v[28:31], a[80:87], v1
    v_smfmac_f32_16x16x64_bf16 v[48:51], v[32:35], a[88:95], v1
    v_smfmac_f32_16x16x64_bf16 v[48:51], v[36:39], a[96:103], v1
    v_smfmac_f32_16x16x64_bf16 v[48:51], v[40:43], a[104:111], v1
    v_permlane32_swap_b32 v44, v46
    v_permlane32_swap_b32 v45, v47
    v_add_f32 v44, v44, v46
    v_add_f32 v45, v45, v47
    v_cvt_pk_bf16_f32 v44, v44, v45
    buffer_store_dword v44, v6, s[16:19], s55 offen offset:0
    v_smfmac_f32_16x16x64_bf16 v[52:55], v[16:19], a[112:119], v1
    v_smfmac_f32_16x16x64_bf16 v[52:55], v[20:23], a[120:127], v1
    v_smfmac_f32_16x16x64_bf16 v[52:55], v[24:27], a[128:135], v1
    v_smfmac_f32_16x16x64_bf16 v[52:55], v[28:31], a[136:143], v1
    v_smfmac_f32_16x16x64_bf16 v[52:55], v[32:35], a[144:151], v1
    v_smfmac_f32_16x16x64_bf16 v[52:55], v[36:39], a[152:159], v1
    v_smfmac_f32_16x16x64_bf16 v[52:55], v[40:43], a[160:167], v1
    v_permlane32_swap_b32 v48, v50
    v_permlane32_swap_b32 v49, v51
    v_add_f32 v48, v48, v50
    v_add_f32 v49, v49, v51
    v_cvt_pk_bf16_f32 v48, v48, v49
    buffer_store_dword v48, v6, s[16:19], s55 offen offset:256
    v_smfmac_f32_16x16x64_bf16 v[56:59], v[16:19], a[168:175], v1
    v_smfmac_f32_16x16x64_bf16 v[56:59], v[20:23], a[176:183], v1
    v_smfmac_f32_16x16x64_bf16 v[56:59], v[24:27], a[184:191], v1
    v_smfmac_f32_16x16x64_bf16 v[56:59], v[28:31], a[192:199], v1
    v_smfmac_f32_16x16x64_bf16 v[56:59], v[32:35], a[200:207], v1
    v_smfmac_f32_16x16x64_bf16 v[56:59], v[36:39], a[208:215], v1
    v_smfmac_f32_16x16x64_bf16 v[56:59], v[40:43], a[216:223], v1
    v_permlane32_swap_b32 v52, v54
    v_permlane32_swap_b32 v53, v55
    v_add_f32 v52, v52, v54
    v_add_f32 v53, v53, v55
    v_cvt_pk_bf16_f32 v52, v52, v53
    buffer_store_dword v52, v6, s[16:19], s55 offen offset:512
    ds_read_b128 v[92:95], v13 offset:0
    ds_read_b128 v[96:99], v13 offset:1024
    ds_read_b128 v[100:103], v13 offset:2048
    ds_read_b128 v[104:107], v13 offset:3072
    v_smfmac_f32_16x16x64_bf16 v[60:63], v[16:19], a[224:231], v1
    v_smfmac_f32_16x16x64_bf16 v[64:67], v[16:19], v[200:207], v1
    s_waitcnt lgkmcnt(2)
    v_smfmac_f32_16x16x64_bf16 v[68:71], v[16:19], v[92:99], v1
    ds_read_b128 v[92:95], v13 offset:4096
    ds_read_b128 v[96:99], v13 offset:5120
    v_smfmac_f32_16x16x64_bf16 v[60:63], v[20:23], a[232:239], v1
    v_smfmac_f32_16x16x64_bf16 v[64:67], v[20:23], v[208:215], v1
    s_waitcnt lgkmcnt(2)
    v_smfmac_f32_16x16x64_bf16 v[68:71], v[20:23], v[100:107], v1
    ds_read_b128 v[100:103], v13 offset:6144
    ds_read_b128 v[104:107], v13 offset:7168
    v_smfmac_f32_16x16x64_bf16 v[60:63], v[24:27], a[240:247], v1
    v_smfmac_f32_16x16x64_bf16 v[64:67], v[24:27], v[216:223], v1
    s_waitcnt lgkmcnt(2)
    v_smfmac_f32_16x16x64_bf16 v[68:71], v[24:27], v[92:99], v1
    ds_read_b128 v[92:95], v13 offset:8192
    ds_read_b128 v[96:99], v13 offset:9216
    v_smfmac_f32_16x16x64_bf16 v[60:63], v[28:31], a[248:255], v1
    v_smfmac_f32_16x16x64_bf16 v[64:67], v[28:31], v[224:231], v1
    s_waitcnt lgkmcnt(2)
    v_smfmac_f32_16x16x64_bf16 v[68:71], v[28:31], v[100:107], v1
    ds_read_b128 v[100:103], v13 offset:10240
    ds_read_b128 v[104:107], v13 offset:11264
    v_permlane32_swap_b32 v56, v58
    v_permlane32_swap_b32 v57, v59
    v_add_f32 v56, v56, v58
    v_add_f32 v57, v57, v59
    v_cvt_pk_bf16_f32 v56, v56, v57
    buffer_store_dword v56, v6, s[16:19], s55 offen offset:768
    v_smfmac_f32_16x16x64_bf16 v[60:63], v[32:35], v[176:183], v1
    v_smfmac_f32_16x16x64_bf16 v[64:67], v[32:35], v[232:239], v1
    s_waitcnt lgkmcnt(2)
    v_smfmac_f32_16x16x64_bf16 v[68:71], v[32:35], v[92:99], v1
    ds_read_b128 v[92:95], v13 offset:12288
    ds_read_b128 v[96:99], v13 offset:13312
    v_smfmac_f32_16x16x64_bf16 v[60:63], v[36:39], v[184:191], v1
    v_smfmac_f32_16x16x64_bf16 v[64:67], v[36:39], v[240:247], v1
    s_waitcnt lgkmcnt(2)
    v_smfmac_f32_16x16x64_bf16 v[68:71], v[36:39], v[100:107], v1
    v_smfmac_f32_16x16x64_bf16 v[60:63], v[40:43], v[192:199], v1
    v_smfmac_f32_16x16x64_bf16 v[64:67], v[40:43], v[248:255], v1
    s_waitcnt lgkmcnt(0)
    v_smfmac_f32_16x16x64_bf16 v[68:71], v[40:43], v[92:99], v1
    s_nop 4
    v_permlane32_swap_b32 v60, v62
    v_permlane32_swap_b32 v61, v63
    v_add_f32 v60, v60, v62
    v_add_f32 v61, v61, v63
    v_cvt_pk_bf16_f32 v60, v60, v61
    buffer_store_dword v60, v6, s[16:19], s55 offen offset:1024
    v_permlane32_swap_b32 v64, v66
    v_permlane32_swap_b32 v65, v67
    v_add_f32 v64, v64, v66
    v_add_f32 v65, v65, v67
    v_cvt_pk_bf16_f32 v64, v64, v65
    buffer_store_dword v64, v6, s[16:19], s55 offen offset:1280
    v_permlane32_swap_b32 v68, v70
    v_permlane32_swap_b32 v69, v71
    v_add_f32 v68, v68, v70
    v_add_f32 v69, v69, v71
    v_cvt_pk_bf16_f32 v68, v68, v69
    buffer_store_dword v68, v6, s[16:19], s55 offen offset:1536
    s_lshl_b32 s37, s46, 12
    s_add_u32 s37, s37, s55
    v_mov_b64 v[32:33], 0
    v_mov_b64 v[34:35], 0
    v_mov_b64 v[36:37], 0
    v_mov_b64 v[38:39], 0
    s_add_u32 s39, s32, 1
    v_mov_b32 v107, s39
    s_mov_b32 s35, 65536
L_poll_ubf_29:
    buffer_load_dwordx4 v[72:75], v7, s[16:19], s55 offen sc1
    buffer_load_dwordx4 v[80:83], v7, s[16:19], s37 offen sc1
    s_waitcnt vmcnt(0)
    v_max3_u32 v108, v72, v73, v74
    v_max3_u32 v108, v108, v75, v80
    v_max3_u32 v108, v108, v81, v82
    v_max3_u32 v108, v108, v83, v83
    v_cmp_eq_u32 vcc, -1, v108
    s_cbranch_vccz L_ok_ubf_30
    s_sleep 1
    s_sub_u32 s35, s35, 1
    s_cmp_lg_u32 s35, 0
    s_cbranch_scc1 L_poll_ubf_29
L_ok_ubf_30:
L_fo_31:
    s_mov_b32 s35, 65536
    buffer_load_dwordx4 v[16:19], v11, s[16:19], s33 offen offset:0 sc1
    buffer_load_dwordx4 v[20:23], v11, s[16:19], s33 offen offset:1024 sc1
    buffer_load_dwordx4 v[24:27], v110, s[16:19], s33 offen sc1
    s_sleep 2
L_pp_pxf_32:
    buffer_load_dwordx4 v[160:163], v11, s[16:19], s33 offen offset:0 sc1
    buffer_load_dwordx4 v[164:167], v11, s[16:19], s33 offen offset:1024 sc1
    buffer_load_dwordx4 v[168:171], v110, s[16:19], s33 offen sc1
    s_waitcnt vmcnt(3)
    v_max3_u32 v108, v16, v17, v18
    v_max3_u32 v108, v108, v19, v20
    v_max3_u32 v108, v108, v21, v22
    v_max3_u32 v108, v108, v23, v24
    v_max3_u32 v108, v108, v25, v26
    v_max3_u32 v108, v108, v27, v27
    v_cmp_eq_u32 vcc, -1, v108
    s_cbranch_vccz L_ppa_pxf_33
    buffer_load_dwordx4 v[16:19], v11, s[16:19], s33 offen offset:0 sc1
    buffer_load_dwordx4 v[20:23], v11, s[16:19], s33 offen offset:1024 sc1
    buffer_load_dwordx4 v[24:27], v110, s[16:19], s33 offen sc1
    s_waitcnt vmcnt(3)
    v_max3_u32 v108, v160, v161, v162
    v_max3_u32 v108, v108, v163, v164
    v_max3_u32 v108, v108, v165, v166
    v_max3_u32 v108, v108, v167, v168
    v_max3_u32 v108, v108, v169, v170
    v_max3_u32 v108, v108, v171, v171
    v_cmp_eq_u32 vcc, -1, v108
    s_cbranch_vccz L_ppb_pxf_34
    s_sub_u32 s35, s35, 1
    s_cmp_lg_u32 s35, 0
    s_cbranch_scc1 L_pp_pxf_32
L_ppb_pxf_34:
    s_cmp_gt_u32 s20, s46
    s_cbranch_scc1 L_sec_nopf_36
    s_mov_b64 exec, 0xffff
    buffer_store_dword v107, v10, s[16:19], s58 offen
    s_mov_b64 exec, -1
L_sec_nopf_36:
    v_smfmac_f32_16x16x64_bf16 v[32:35], v[160:163], v[112:119], v1
    v_smfmac_f32_16x16x64_bf16 v[32:35], v[164:167], v[120:127], v1
    v_smfmac_f32_16x16x64_bf16 v[32:35], v[168:171], v[72:79], v1
    v_smfmac_f32_16x16x64_bf16 v[36:39], v[160:163], v[128:135], v1
    v_smfmac_f32_16x16x64_bf16 v[36:39], v[164:167], v[136:143], v1
    v_smfmac_f32_16x16x64_bf16 v[36:39], v[168:171], v[80:87], v1
    s_branch L_ppd_pxf_35
L_ppa_pxf_33:
    s_cmp_gt_u32 s20, s46
    s_cbranch_scc1 L_sec_nopf_37
    s_mov_b64 exec, 0xffff
    buffer_store_dword v107, v10, s[16:19], s58 offen
    s_mov_b64 exec, -1
L_sec_nopf_37:
    v_smfmac_f32_16x16x64_bf16 v[32:35], v[16:19], v[112:119], v1
    v_smfmac_f32_16x16x64_bf16 v[32:35], v[20:23], v[120:127], v1
    v_smfmac_f32_16x16x64_bf16 v[32:35], v[24:27], v[72:79], v1
    v_smfmac_f32_16x16x64_bf16 v[36:39], v[16:19], v[128:135], v1
    v_smfmac_f32_16x16x64_bf16 v[36:39], v[20:23], v[136:143], v1
    v_smfmac_f32_16x16x64_bf16 v[36:39], v[24:27], v[80:87], v1
L_ppd_pxf_35:
    s_nop 7
    v_permlane32_swap_b32 v32, v34
    v_permlane32_swap_b32 v33, v35
    v_add_f32 v32, v32, v34
    v_add_f32 v33, v33, v35
    ds_write_b32 v12, v32 offset:0
    ds_write_b32 v12, v33 offset:80
    v_permlane32_swap_b32 v36, v38
    v_permlane32_swap_b32 v37, v39
    v_add_f32 v36, v36, v38
    v_add_f32 v37, v37, v39
    ds_write_b32 v12, v36 offset:2560
    ds_write_b32 v12, v37 offset:2640
    s_waitcnt lgkmcnt(0)
    s_barrier
    s_cmp_gt_u32 s20, s46
    s_cbranch_scc1 L_sec_join_f
    ds_read_b64 v[92:93], v109 offset:0
    ds_read_b64 v[94:95], v109 offset:640
    ds_read_b64 v[96:97], v109 offset:1280
    ds_read_b64 v[98:99], v109 offset:1920
    s_waitcnt lgkmcnt(0)
    v_pk_add_f32 v[92:93], v[92:93], v[94:95]
    v_pk_add_f32 v[96:97], v[96:97], v[98:99]
    v_pk_add_f32 v[92:93], v[92:93], v[96:97]
    v_cvt_pk_bf16_f32 v92, v92, v93
    buffer_store_dword v92, v15, s[16:19], s54 offen
L_sec_join_f:
    s_nop 1
    s_add_u32 s47, s47, 458752
    s_add_u32 s32, s32, 1
    s_and_b32 s36, s32, 3
    s_mul_i32 s33, s36, 32768
    s_add_u32 s33, s33, 100663296
    s_add_u32 s36, s32, 3
    s_and_b32 s36, s36, 3
    s_mul_i32 s53, s36, 32768
    s_add_u32 s53, s53, 100663296
    s_add_u32 s36, s32, 1
    s_and_b32 s36, s36, 3
    s_mul_i32 s54, s36, 32768
    s_add_u32 s54, s54, 100663296
    s_mul_i32 s55, s32, 122880
    s_add_u32 s55, s55, 104857600
    s_cmp_lt_u32 s32, 64
    s_cbranch_scc1 L_sec_loop_f
    s_waitcnt vmcnt(0)
    s_branch L_chain_end
L_prim_safe:
    s_mul_i32 s36, s20, 14
    s_add_u32 s36, s36, 0
    v_add_u32 v10, s36, v3
    v_lshrrev_b32 v6, 3, v10
    v_lshlrev_b32 v6, 10, v6
    v_bfe_u32 v11, v10, 2, 1
    v_lshl_add_u32 v6, v11, 8, v6
    v_and_b32 v11, 1, v10
    v_lshl_add_u32 v6, v11, 9, v6
    v_bfe_u32 v11, v10, 1, 1
    v_lshl_add_u32 v6, v11, 3, v6
    v_and_b32 v11, 7, v4
    v_lshl_add_u32 v6, v11, 4, v6
    v_add_u32 v6, 14336, v6
    s_mul_i32 s36, s20, 14
    s_add_u32 s36, s36, 4
    v_add_u32 v10, s36, v3
    v_lshrrev_b32 v15, 3, v10
    v_lshlrev_b32 v15, 10, v15
    v_bfe_u32 v11, v10, 2, 1
    v_lshl_add_u32 v15, v11, 8, v15
    v_and_b32 v11, 1, v10
    v_lshl_add_u32 v15, v11, 9, v15
    v_bfe_u32 v11, v10, 1, 1
    v_lshl_add_u32 v15, v11, 3, v15
    v_and_b32 v11, 7, v4
    v_lshl_add_u32 v15, v11, 4, v15
    v_add_u32 v15, 14336, v15
    s_mul_i32 s36, s20, 14
    s_add_u32 s36, s36, 8
    v_add_u32 v10, s36, v3
    v_lshrrev_b32 v14, 3, v10
    v_lshlrev_b32 v14, 10, v14
    v_bfe_u32 v11, v10, 2, 1
    v_lshl_add_u32 v14, v11, 8, v14
    v_and_b32 v11, 1, v10
    v_lshl_add_u32 v14, v11, 9, v14
    v_bfe_u32 v11, v10, 1, 1
    v_lshl_add_u32 v14, v11, 3, v14
    v_and_b32 v11, 7, v4
    v_lshl_add_u32 v14, v11, 4, v14
    v_add_u32 v14, 14336, v14
    s_mul_i32 s36, s20, 14
    s_add_u32 s36, s36, 12
    v_lshrrev_b32 v10, 1, v3
    v_add_u32 v10, s36, v10
    v_lshrrev_b32 v9, 3, v10
    v_lshlrev_b32 v9, 10, v9
    v_bfe_u32 v11, v10, 2, 1
    v_lshl_add_u32 v9, v11, 8, v9
    v_and_b32 v11, 1, v10
    v_lshl_add_u32 v9, v11, 9, v9
    v_bfe_u32 v11, v10, 1, 1
    v_lshl_add_u32 v9, v11, 3, v9
    v_and_b32 v11, 1, v3
    v_lshl_add_u32 v9, v11, 2, v9
    v_and_b32 v11, 7, v4
    v_lshl_add_u32 v9, v11, 4, v9
    v_add_u32 v9, 14336, v9
    s_mul_i32 s36, s20, 7168
    s_add_u32 s36, s36, 83886080
    s_movk_i32 s39, 896
    v_add_u32 v7, s36, v2
    v_add_u32 v8, 3584, v7
    v_lshlrev_b32 v114, 3, v0
    v_add_u32 v114, s36, v114
    v_add_u32 v114, 3072, v114
    v_add_u32 v115, 3584, v114
    s_mul_i32 s36, s20, 3584
    v_lshlrev_b32 v10, 5, v4
    v_lshl_add_u32 v10, v3, 3, v10
    v_add_u32 v10, s36, v10
    v_lshlrev_b32 v11, 8, v3
    v_lshl_add_u32 v11, v4, 3, v11
    v_add_u32 v11, s36, v11
    v_and_b32 v12, 1, v3
    v_lshlrev_b32 v12, 2, v12
    v_lshrrev_b32 v116, 1, v3
    v_lshl_add_u32 v12, v116, 1, v12
    s_lshl_b32 s36, s20, 3
    v_add_u32 v12, s36, v12
    v_mul_u32_u24 v12, 208, v12
    v_lshl_add_u32 v12, v4, 2, v12
    v_add_u32 v12, 21504, v12
    v_and_b32 v13, 7, v0
    v_lshrrev_b32 v118, 3, v0
    v_mul_u32_u24 v116, 208, v118
    v_lshl_add_u32 v119, v13, 2, v116
    v_add_u32 v119, 21632, v119
    v_lshl_add_u32 v116, v13, 4, v116
    v_add_u32 v116, 21504, v116
    s_lshr_b32 s36, s31, 1
    s_lshl_b32 s36, s36, 10
    s_and_b32 s37, s31, 1
    s_lshl_b32 s37, s37, 7
    s_add_u32 s36, s36, s37
    s_add_u32 s36, s36, 16384
    v_lshrrev_b32 v117, 1, v13
    v_lshlrev_b32 v117, 8, v117
    v_lshl_add_u32 v117, v118, 4, v117
    v_and_b32 v113, 1, v13
    v_lshl_add_u32 v117, v113, 3, v117
    v_add_u32 v117, s36, v117
    s_lshr_b32 s36, s31, 1
    s_lshl_b32 s36, s36, 8
    s_and_b32 s37, s31, 1
    s_lshl_b32 s37, s37, 3
    s_add_u32 s36, s36, s37
    s_add_u32 s36, s36, 24576
    v_lshlrev_b32 v118, 4, v118
    v_bfe_u32 v113, v13, 1, 1
    v_lshl_add_u32 v118, v113, 7, v118
    v_lshrrev_b32 v113, 2, v13
    v_lshl_add_u32 v118, v113, 2, v118
    v_add_u32 v118, s36, v118
    v_mov_b32 v16, 0
    v_mov_b32 v17, 0
    v_mov_b32 v18, 0
    v_mov_b32 v19, 0
    ds_write_b128 v2, v[16:19] offset:21504
    ds_write_b128 v2, v[16:19] offset:22528
    s_lshl_b32 s41, s31, 2
    s_add_u32 s41, s41, 100831232
    s_mul_i32 s36, s31, 896
    s_mul_i32 s37, s20, 112
    s_add_u32 s36, s36, s37
    s_add_u32 s36, s36, 0
    v_add_u32 v13, s36, v4
    s_movk_i32 s39, 896
    v_mul_lo_u32 v13, v13, s39
    v_lshl_add_u32 v13, v3, 5, v13
    buffer_load_dwordx4 a[0:3], v13, s[16:19], 0 offen offset:0
    buffer_load_dwordx4 a[4:7], v13, s[16:19], 0 offen offset:16
    buffer_load_dwordx4 a[8:11], v13, s[16:19], 0 offen offset:128
    buffer_load_dwordx4 a[12:15], v13, s[16:19], 0 offen offset:144
    buffer_load_dwordx4 a[16:19], v13, s[16:19], 0 offen offset:256
    buffer_load_dwordx4 a[20:23], v13, s[16:19], 0 offen offset:272
    buffer_load_dwordx4 a[24:27], v13, s[16:19], 0 offen offset:384
    buffer_load_dwordx4 a[28:31], v13, s[16:19], 0 offen offset:400
    buffer_load_dwordx4 a[32:35], v13, s[16:19], 0 offen offset:512
    buffer_load_dwordx4 a[36:39], v13, s[16:19], 0 offen offset:528
    buffer_load_dwordx4 a[40:43], v13, s[16:19], 0 offen offset:640
    buffer_load_dwordx4 a[44:47], v13, s[16:19], 0 offen offset:656
    buffer_load_dwordx4 a[48:51], v13, s[16:19], 0 offen offset:768
    buffer_load_dwordx4 a[52:55], v13, s[16:19], 0 offen offset:784
    s_mul_i32 s36, s31, 896
    s_mul_i32 s37, s20, 112
    s_add_u32 s36, s36, s37
    s_add_u32 s36, s36, 16
    v_add_u32 v13, s36, v4
    s_movk_i32 s39, 896
    v_mul_lo_u32 v13, v13, s39
    v_lshl_add_u32 v13, v3, 5, v13
    buffer_load_dwordx4 a[56:59], v13, s[16:19], 0 offen offset:0
    buffer_load_dwordx4 a[60:63], v13, s[16:19], 0 offen offset:16
    buffer_load_dwordx4 a[64:67], v13, s[16:19], 0 offen offset:128
    buffer_load_dwordx4 a[68:71], v13, s[16:19], 0 offen offset:144
    buffer_load_dwordx4 a[72:75], v13, s[16:19], 0 offen offset:256
    buffer_load_dwordx4 a[76:79], v13, s[16:19], 0 offen offset:272
    buffer_load_dwordx4 a[80:83], v13, s[16:19], 0 offen offset:384
    buffer_load_dwordx4 a[84:87], v13, s[16:19], 0 offen offset:400
    buffer_load_dwordx4 a[88:91], v13, s[16:19], 0 offen offset:512
    buffer_load_dwordx4 a[92:95], v13, s[16:19], 0 offen offset:528
    buffer_load_dwordx4 a[96:99], v13, s[16:19], 0 offen offset:640
    buffer_load_dwordx4 a[100:103], v13, s[16:19], 0 offen offset:656
    buffer_load_dwordx4 a[104:107], v13, s[16:19], 0 offen offset:768
    buffer_load_dwordx4 a[108:111], v13, s[16:19], 0 offen offset:784
    s_mul_i32 s36, s31, 896
    s_mul_i32 s37, s20, 112
    s_add_u32 s36, s36, s37
    s_add_u32 s36, s36, 32
    v_add_u32 v13, s36, v4
    s_movk_i32 s39, 896
    v_mul_lo_u32 v13, v13, s39
    v_lshl_add_u32 v13, v3, 5, v13
    buffer_load_dwordx4 a[112:115], v13, s[16:19], 0 offen offset:0
    buffer_load_dwordx4 a[116:119], v13, s[16:19], 0 offen offset:16
    buffer_load_dwordx4 a[120:123], v13, s[16:19], 0 offen offset:128
    buffer_load_dwordx4 a[124:127], v13, s[16:19], 0 offen offset:144
    buffer_load_dwordx4 a[128:131], v13, s[16:19], 0 offen offset:256
    buffer_load_dwordx4 a[132:135], v13, s[16:19], 0 offen offset:272
    buffer_load_dwordx4 a[136:139], v13, s[16:19], 0 offen offset:384
    buffer_load_dwordx4 a[140:143], v13, s[16:19], 0 offen offset:400
    buffer_load_dwordx4 a[144:147], v13, s[16:19], 0 offen offset:512
    buffer_load_dwordx4 a[148:151], v13, s[16:19], 0 offen offset:528
    buffer_load_dwordx4 a[152:155], v13, s[16:19], 0 offen offset:640
    buffer_load_dwordx4 a[156:159], v13, s[16:19], 0 offen offset:656
    buffer_load_dwordx4 a[160:163], v13, s[16:19], 0 offen offset:768
    buffer_load_dwordx4 a[164:167], v13, s[16:19], 0 offen offset:784
    s_mul_i32 s36, s31, 896
    s_mul_i32 s37, s20, 112
    s_add_u32 s36, s36, s37
    s_add_u32 s36, s36, 48
    v_add_u32 v13, s36, v4
    s_movk_i32 s39, 896
    v_mul_lo_u32 v13, v13, s39
    v_lshl_add_u32 v13, v3, 5, v13
    buffer_load_dwordx4 a[168:171], v13, s[16:19], 0 offen offset:0
    buffer_load_dwordx4 a[172:175], v13, s[16:19], 0 offen offset:16
    buffer_load_dwordx4 a[176:179], v13, s[16:19], 0 offen offset:128
    buffer_load_dwordx4 a[180:183], v13, s[16:19], 0 offen offset:144
    buffer_load_dwordx4 a[184:187], v13, s[16:19], 0 offen offset:256
    buffer_load_dwordx4 a[188:191], v13, s[16:19], 0 offen offset:272
    buffer_load_dwordx4 a[192:195], v13, s[16:19], 0 offen offset:384
    buffer_load_dwordx4 a[196:199], v13, s[16:19], 0 offen offset:400
    buffer_load_dwordx4 a[200:203], v13, s[16:19], 0 offen offset:512
    buffer_load_dwordx4 a[204:207], v13, s[16:19], 0 offen offset:528
    buffer_load_dwordx4 a[208:211], v13, s[16:19], 0 offen offset:640
    buffer_load_dwordx4 a[212:215], v13, s[16:19], 0 offen offset:656
    buffer_load_dwordx4 a[216:219], v13, s[16:19], 0 offen offset:768
    buffer_load_dwordx4 a[220:223], v13, s[16:19], 0 offen offset:784
    s_mul_i32 s36, s31, 896
    s_mul_i32 s37, s20, 112
    s_add_u32 s36, s36, s37
    s_add_u32 s36, s36, 64
    v_add_u32 v13, s36, v4
    s_movk_i32 s39, 896
    v_mul_lo_u32 v13, v13, s39
    v_lshl_add_u32 v13, v3, 5, v13
    buffer_load_dwordx4 a[224:227], v13, s[16:19], 0 offen offset:0
    buffer_load_dwordx4 a[228:231], v13, s[16:19], 0 offen offset:16
    buffer_load_dwordx4 a[232:235], v13, s[16:19], 0 offen offset:128
    buffer_load_dwordx4 a[236:239], v13, s[16:19], 0 offen offset:144
    buffer_load_dwordx4 a[240:243], v13, s[16:19], 0 offen offset:256
    buffer_load_dwordx4 a[244:247], v13, s[16:19], 0 offen offset:272
    buffer_load_dwordx4 a[248:251], v13, s[16:19], 0 offen offset:384
    buffer_load_dwordx4 a[252:255], v13, s[16:19], 0 offen offset:400
    buffer_load_dwordx4 v[120:123], v13, s[16:19], 0 offen offset:512
    buffer_load_dwordx4 v[124:127], v13, s[16:19], 0 offen offset:528
    buffer_load_dwordx4 v[128:131], v13, s[16:19], 0 offen offset:640
    buffer_load_dwordx4 v[132:135], v13, s[16:19], 0 offen offset:656
    buffer_load_dwordx4 v[136:139], v13, s[16:19], 0 offen offset:768
    buffer_load_dwordx4 v[140:143], v13, s[16:19], 0 offen offset:784
    s_mul_i32 s36, s31, 896
    s_mul_i32 s37, s20, 112
    s_add_u32 s36, s36, s37
    s_add_u32 s36, s36, 80
    v_add_u32 v13, s36, v4
    s_movk_i32 s39, 896
    v_mul_lo_u32 v13, v13, s39
    v_lshl_add_u32 v13, v3, 5, v13
    buffer_load_dwordx4 v[144:147], v13, s[16:19], 0 offen offset:0
    buffer_load_dwordx4 v[148:151], v13, s[16:19], 0 offen offset:16
    buffer_load_dwordx4 v[152:155], v13, s[16:19], 0 offen offset:128
    buffer_load_dwordx4 v[156:159], v13, s[16:19], 0 offen offset:144
    buffer_load_dwordx4 v[160:163], v13, s[16:19], 0 offen offset:256
    buffer_load_dwordx4 v[164:167], v13, s[16:19], 0 offen offset:272
    buffer_load_dwordx4 v[168:171], v13, s[16:19], 0 offen offset:384
    buffer_load_dwordx4 v[172:175], v13, s[16:19], 0 offen offset:400
    buffer_load_dwordx4 v[176:179], v13, s[16:19], 0 offen offset:512
    buffer_load_dwordx4 v[180:183], v13, s[16:19], 0 offen offset:528
    buffer_load_dwordx4 v[184:187], v13, s[16:19], 0 offen offset:640
    buffer_load_dwordx4 v[188:191], v13, s[16:19], 0 offen offset:656
    buffer_load_dwordx4 v[192:195], v13, s[16:19], 0 offen offset:768
    buffer_load_dwordx4 v[196:199], v13, s[16:19], 0 offen offset:784
    s_mul_i32 s36, s31, 896
    s_mul_i32 s37, s20, 112
    s_add_u32 s36, s36, s37
    s_add_u32 s36, s36, 96
    v_add_u32 v13, s36, v4
    s_movk_i32 s39, 896
    v_mul_lo_u32 v13, v13, s39
    v_lshl_add_u32 v13, v3, 5, v13
    buffer_load_dwordx4 v[200:203], v13, s[16:19], 0 offen offset:0
    buffer_load_dwordx4 v[204:207], v13, s[16:19], 0 offen offset:16
    buffer_load_dwordx4 v[208:211], v13, s[16:19], 0 offen offset:128
    buffer_load_dwordx4 v[212:215], v13, s[16:19], 0 offen offset:144
    buffer_load_dwordx4 v[216:219], v13, s[16:19], 0 offen offset:256
    buffer_load_dwordx4 v[220:223], v13, s[16:19], 0 offen offset:272
    buffer_load_dwordx4 v[224:227], v13, s[16:19], 0 offen offset:384
    buffer_load_dwordx4 v[228:231], v13, s[16:19], 0 offen offset:400
    buffer_load_dwordx4 v[232:235], v13, s[16:19], 0 offen offset:512
    buffer_load_dwordx4 v[236:239], v13, s[16:19], 0 offen offset:528
    buffer_load_dwordx4 v[240:243], v13, s[16:19], 0 offen offset:640
    buffer_load_dwordx4 v[244:247], v13, s[16:19], 0 offen offset:656
    buffer_load_dwordx4 v[248:251], v13, s[16:19], 0 offen offset:768
    buffer_load_dwordx4 v[252:255], v13, s[16:19], 0 offen offset:784
    s_waitcnt vmcnt(0)
    s_mul_i32 s36, s20, 3584
    v_lshlrev_b32 v4, 3, v0
    v_add_u32 v4, s36, v4
    s_lshl_b32 s36, s20, 10
    v_add_u32 v5, s36, v2
    s_cmp_lt_u32 s20, 3
    s_cselect_b32 s49, 4096, 0
    v_add_u32 v3, s49, v5
    v_min_u32 v0, 27, v0
    v_lshlrev_b32 v0, 2, v0
    s_lshl_b32 s36, s31, 8
    s_add_u32 s36, s36, 100827136
    v_add_u32 v0, s36, v0
    s_mov_b32 s65, 0
    v_min_u32 v19, 48, v2
    v_lshlrev_b32 v19, 3, v19
    v_add_u32 v19, 100802560, v19
    s_mov_b32 s35, 2000000
L_x0_ps_38:
    buffer_load_dword v16, v19, s[16:19], 0 offen sc1
    s_waitcnt vmcnt(0)
    v_cmp_gt_u32 vcc, 28, v16
    s_cbranch_vccz L_x0ok_ps_39
    s_sleep 4
    s_sub_u32 s35, s35, 1
    s_cmp_lg_u32 s35, 0
    s_cbranch_scc1 L_x0_ps_38
L_x0ok_ps_39:
    s_mov_b32 s34, 0
    buffer_load_dwordx4 v[58:61], v7, s[16:19], s34 offen offset:0
    buffer_load_dwordx4 v[62:65], v7, s[16:19], s34 offen offset:1024
    buffer_load_dwordx4 v[66:69], v7, s[16:19], s34 offen offset:2048
    buffer_load_dwordx2 v[70:71], v114, s[16:19], s34 offen
    buffer_load_dwordx4 v[72:75], v8, s[16:19], s34 offen offset:0
    buffer_load_dwordx4 v[76:79], v8, s[16:19], s34 offen offset:1024
    buffer_load_dwordx4 v[80:83], v8, s[16:19], s34 offen offset:2048
    buffer_load_dwordx2 v[84:85], v115, s[16:19], s34 offen
    s_mov_b32 s32, 0
    s_and_b32 s36, s32, 3
    s_mul_i32 s33, s36, 32768
    s_add_u32 s33, s33, 100663296
    s_add_u32 s36, s32, 3
    s_and_b32 s36, s36, 3
    s_mul_i32 s53, s36, 32768
    s_add_u32 s53, s53, 100663296
    s_add_u32 s36, s32, 1
    s_and_b32 s36, s36, 3
    s_mul_i32 s54, s36, 32768
    s_add_u32 s54, s54, 100663296
    s_mul_i32 s55, s32, 122880
    s_add_u32 s55, s55, 104857600
    s_lshl_b32 s36, s31, 2
    s_add_u32 s36, s36, s20
    s_mul_i32 s66, s31, 28672
    s_mul_i32 s37, s20, 1024
    s_add_u32 s66, s66, s37
    s_add_u32 s66, s66, 17719296
    s_mul_i32 s47, s31, 28672
    s_mul_i32 s37, s20, 8192
    s_add_u32 s47, s47, s37
    s_add_u32 s47, s47, 17686528
    s_mul_i32 s40, s36, 1792
    s_add_u32 s40, s40, 131072
    s_mul_i32 s59, s36, 448
    s_add_u32 s59, s59, 83914752
    s_cmp_eq_u32 s20, 0
    s_cbranch_scc1 L_pw_40
    s_sub_u32 s37, s47, 917504
    buffer_load_dwordx4 v[116:119], v2, s[16:19], s37 offen offset:0
    buffer_load_dwordx4 v[116:119], v2, s[16:19], s37 offen offset:1024
    buffer_load_dwordx4 v[116:119], v2, s[16:19], s37 offen offset:2048
    buffer_load_dwordx4 v[116:119], v2, s[16:19], s37 offen offset:3072
    s_sub_u32 s37, s47, 913408
    buffer_load_dwordx4 v[116:119], v2, s[16:19], s37 offen offset:0
    buffer_load_dwordx4 v[116:119], v2, s[16:19], s37 offen offset:1024
    buffer_load_dwordx4 v[116:119], v2, s[16:19], s37 offen offset:2048
    buffer_load_dwordx4 v[116:119], v2, s[16:19], s37 offen offset:3072
    s_sub_u32 s37, s47, 458752
    buffer_load_dwordx4 v[116:119], v2, s[16:19], s37 offen offset:0
    buffer_load_dwordx4 v[116:119], v2, s[16:19], s37 offen offset:1024
    buffer_load_dwordx4 v[116:119], v2, s[16:19], s37 offen offset:2048
    buffer_load_dwordx4 v[116:119], v2, s[16:19], s37 offen offset:3072
    s_sub_u32 s37, s47, 454656
    buffer_load_dwordx4 v[116:119], v2, s[16:19], s37 offen offset:0
    buffer_load_dwordx4 v[116:119], v2, s[16:19], s37 offen offset:1024
    buffer_load_dwordx4 v[116:119], v2, s[16:19], s37 offen offset:2048
    buffer_load_dwordx4 v[116:119], v2, s[16:19], s37 offen offset:3072
L_pw_40:
    v_lshlrev_b32 v96, 2, v2
    s_add_u32 s36, s55, s40
    s_sub_u32 s36, s36, 122880
    s_mov_b64 exec, 0xfffffff
    buffer_load_dword v13, v96, s[16:19], s36 offen
    s_mov_b64 exec, -1
L_prim_loop_s:
    s_nop 7
    v_mov_b64 v[86:87], 0
    v_mov_b64 v[88:89], 0
    v_mov_b64 v[90:91], 0
    v_mov_b64 v[92:93], 0
    v_mov_b64 v[94:95], 0
    v_mov_b64 v[96:97], 0
    v_mov_b64 v[106:107], 0
    v_mov_b64 v[108:109], 0
    v_mov_b32 v94, -1
    v_mov_b32 v95, -1
    s_add_u32 s48, s33, s49
    s_mov_b32 s35, 65536
L_fl_pms_41:
    buffer_load_dword v13, v0, s[16:19], 0 offen sc1
    s_waitcnt vmcnt(0)
    v_cmp_gt_u32 vcc, s32, v13
    s_cbranch_vccz L_flok_pms_42
    s_sub_u32 s35, s35, 1
    s_cmp_lg_u32 s35, 0
    s_cbranch_scc1 L_fl_pms_41
L_flok_pms_42:
    s_mov_b32 s35, 65536
    buffer_load_dwordx4 v[44:47], v5, s[16:19], s33 offen sc1
    buffer_load_dwordx4 v[48:51], v5, s[16:19], s48 offen sc1
    s_sleep 2
L_pp_pms_43:
    buffer_load_dwordx4 v[98:101], v5, s[16:19], s33 offen sc1
    buffer_load_dwordx4 v[102:105], v5, s[16:19], s48 offen sc1
    s_waitcnt vmcnt(2)
    v_max3_u32 v13, v44, v45, v46
    v_max3_u32 v13, v13, v47, v48
    v_max3_u32 v13, v13, v49, v50
    v_max3_u32 v13, v13, v51, v51
    v_cmp_eq_u32 vcc, -1, v13
    s_cbranch_vccz L_ppa_pms_44
    buffer_load_dwordx4 v[44:47], v5, s[16:19], s33 offen sc1
    buffer_load_dwordx4 v[48:51], v5, s[16:19], s48 offen sc1
    s_waitcnt vmcnt(2)
    v_max3_u32 v13, v98, v99, v100
    v_max3_u32 v13, v13, v101, v102
    v_max3_u32 v13, v13, v103, v104
    v_max3_u32 v13, v13, v105, v105
    v_cmp_eq_u32 vcc, -1, v13
    s_cbranch_vccz L_ppb_pms_45
    s_sub_u32 s35, s35, 1
    s_cmp_lg_u32 s35, 0
    s_cbranch_scc1 L_pp_pms_43
L_ppb_pms_45:
    ds_write_b128 v5, v[98:101] offset:14336
    ds_write_b128 v3, v[102:105] offset:14336
    s_branch L_ppd_pms_46
L_ppa_pms_44:
    ds_write_b128 v5, v[44:47] offset:14336
    ds_write_b128 v3, v[48:51] offset:14336
L_ppd_pms_46:
    s_waitcnt lgkmcnt(0)
    s_barrier
    ds_read_b128 v[16:19], v2 offset:14336
    ds_read_b128 v[20:23], v2 offset:15360
    ds_read_b128 v[24:27], v2 offset:16384
    ds_read_b128 v[28:31], v2 offset:17408
    ds_read_b128 v[32:35], v2 offset:18432
    ds_read_b128 v[36:39], v2 offset:19456
    ds_read_b128 v[40:43], v2 offset:20480
    s_cmp_lg_u32 s20, 0
    s_cbranch_scc1 L_prim_nora_s
    buffer_store_dwordx2 v[94:95], v117, s[16:19], s53 offen sc1
    buffer_store_dword v94, v118, s[16:19], s53 offen sc1
L_prim_nora_s:
    v_lshlrev_b32 v96, 2, v2
    s_add_u32 s36, s55, s40
    s_mov_b64 exec, 0xfffffff
    buffer_load_dword v13, v96, s[16:19], s36 offen
    s_add_u32 s36, s34, s59
    s_mov_b64 exec, 0x7f
    buffer_load_dword v13, v96, s[16:19], s36 offen
    s_mov_b64 exec, -1
    v_mov_b64 v[94:95], 0
    v_mov_b64 v[96:97], 0
    s_waitcnt lgkmcnt(6)
    v_smfmac_f32_16x16x64_bf16 v[86:89], v[16:19], a[0:7], v1
    v_smfmac_f32_16x16x64_bf16 v[90:93], v[16:19], a[56:63], v1
    v_smfmac_f32_16x16x64_bf16 v[94:97], v[16:19], a[112:119], v1
    s_waitcnt lgkmcnt(5)
    v_smfmac_f32_16x16x64_bf16 v[86:89], v[20:23], a[8:15], v1
    v_smfmac_f32_16x16x64_bf16 v[90:93], v[20:23], a[64:71], v1
    v_smfmac_f32_16x16x64_bf16 v[94:97], v[20:23], a[120:127], v1
    s_waitcnt lgkmcnt(4)
    v_smfmac_f32_16x16x64_bf16 v[86:89], v[24:27], a[16:23], v1
    v_smfmac_f32_16x16x64_bf16 v[90:93], v[24:27], a[72:79], v1
    v_smfmac_f32_16x16x64_bf16 v[94:97], v[24:27], a[128:135], v1
    s_waitcnt lgkmcnt(3)
    v_smfmac_f32_16x16x64_bf16 v[86:89], v[28:31], a[24:31], v1
    v_smfmac_f32_16x16x64_bf16 v[90:93], v[28:31], a[80:87], v1
    v_smfmac_f32_16x16x64_bf16 v[94:97], v[28:31], a[136:143], v1
    s_waitcnt lgkmcnt(2)
    v_smfmac_f32_16x16x64_bf16 v[86:89], v[32:35], a[32:39], v1
    s_waitcnt vmcnt(2)
    v_smfmac_f32_16x16x64_bf16 v[90:93], v[32:35], a[88:95], v1
    ds_read2_b32 v[44:45], v6 offset0:0 offset1:32
    v_smfmac_f32_16x16x64_bf16 v[94:97], v[32:35], a[144:151], v1
    ds_read2_b32 v[46:47], v6 offset0:1 offset1:33
    s_waitcnt lgkmcnt(3)
    v_smfmac_f32_16x16x64_bf16 v[86:89], v[36:39], a[40:47], v1
    ds_read2_b32 v[48:49], v15 offset0:0 offset1:32
    v_smfmac_f32_16x16x64_bf16 v[90:93], v[36:39], a[96:103], v1
    ds_read2_b32 v[50:51], v15 offset0:1 offset1:33
    v_smfmac_f32_16x16x64_bf16 v[94:97], v[36:39], a[152:159], v1
    ds_read2_b32 v[52:53], v14 offset0:0 offset1:32
    s_waitcnt lgkmcnt(5)
    v_smfmac_f32_16x16x64_bf16 v[86:89], v[40:43], a[48:55], v1
    ds_read2_b32 v[54:55], v14 offset0:1 offset1:33
    v_smfmac_f32_16x16x64_bf16 v[90:93], v[40:43], a[104:111], v1
    ds_read2_b32 v[56:57], v9 offset0:0 offset1:32
    v_smfmac_f32_16x16x64_bf16 v[94:97], v[40:43], a[160:167], v1
    v_mov_b64 v[98:99], 0
    v_smfmac_f32_16x16x64_bf16 v[106:109], v[16:19], a[168:175], v1
    v_mov_b64 v[100:101], 0
    v_mov_b64 v[102:103], 0
    s_add_u32 s68, s47, 0
    s_add_u32 s69, s47, 4096
    s_add_u32 s70, s47, 8192
    s_add_u32 s47, s47, 458752
    v_smfmac_f32_16x16x64_bf16 v[106:109], v[20:23], a[176:183], v1
    v_mov_b64 v[104:105], 0
    v_cvt_pk_bf16_f32 v86, v86, v87
    s_cmp_eq_u32 s20, 0
    s_cbranch_scc1 L_wt_47
    buffer_load_dwordx4 v[116:119], v2, s[16:19], s68 offen offset:0
L_wt_47:
    v_smfmac_f32_16x16x64_bf16 v[106:109], v[24:27], a[184:191], v1
    v_cvt_pk_bf16_f32 v87, v88, v89
    ds_write_b64 v10, v[86:87] offset:0
    s_cmp_eq_u32 s20, 0
    s_cbranch_scc1 L_wt_48
    buffer_load_dwordx4 v[116:119], v2, s[16:19], s68 offen offset:1024
L_wt_48:
    v_smfmac_f32_16x16x64_bf16 v[106:109], v[28:31], a[192:199], v1
    v_mov_b64 v[86:87], 0
    v_mov_b64 v[88:89], 0
    s_cmp_eq_u32 s20, 0
    s_cbranch_scc1 L_wt_49
    buffer_load_dwordx4 v[116:119], v2, s[16:19], s68 offen offset:2048
L_wt_49:
    v_smfmac_f32_16x16x64_bf16 v[106:109], v[32:35], a[200:207], v1
    v_cvt_pk_bf16_f32 v90, v90, v91
    v_cvt_pk_bf16_f32 v91, v92, v93
    s_cmp_eq_u32 s20, 0
    s_cbranch_scc1 L_wt_50
    buffer_load_dwordx4 v[116:119], v2, s[16:19], s68 offen offset:3072
L_wt_50:
    v_smfmac_f32_16x16x64_bf16 v[106:109], v[36:39], a[208:215], v1
    ds_write_b64 v10, v[90:91] offset:512
    ds_read_b64_tr_b16 v[110:111], v11 offset:0
    s_cmp_eq_u32 s20, 0
    s_cbranch_scc1 L_wt_51
    buffer_load_dwordx4 v[116:119], v2, s[16:19], s69 offen offset:0
L_wt_51:
    v_smfmac_f32_16x16x64_bf16 v[106:109], v[40:43], a[216:223], v1
    ds_read_b64_tr_b16 v[112:113], v11 offset:128
    s_cmp_eq_u32 s20, 0
    s_cbranch_scc1 L_wt_52
    buffer_load_dwordx4 v[116:119], v2, s[16:19], s69 offen offset:1024
L_wt_52:
    v_smfmac_f32_16x16x64_bf16 v[86:89], v[16:19], a[224:231], v1
    v_cvt_pk_bf16_f32 v94, v94, v95
    v_cvt_pk_bf16_f32 v95, v96, v97
    s_cmp_eq_u32 s20, 0
    s_cbranch_scc1 L_wt_53
    buffer_load_dwordx4 v[116:119], v2, s[16:19], s69 offen offset:2048
L_wt_53:
    v_smfmac_f32_16x16x64_bf16 v[86:89], v[20:23], a[232:239], v1
    ds_write_b64 v10, v[94:95] offset:1024
    v_mov_b64 v[90:91], 0
    s_cmp_eq_u32 s20, 0
    s_cbranch_scc1 L_wt_54
    buffer_load_dwordx4 v[116:119], v2, s[16:19], s69 offen offset:3072
L_wt_54:
    v_smfmac_f32_16x16x64_bf16 v[86:89], v[24:27], a[240:247], v1
    v_mov_b64 v[92:93], 0
    v_smfmac_f32_16x16x64_bf16 v[86:89], v[28:31], a[248:255], v1
    v_cvt_pk_bf16_f32 v106, v106, v107
    v_cvt_pk_bf16_f32 v107, v108, v109
    v_smfmac_f32_16x16x64_bf16 v[86:89], v[32:35], v[120:127], v1
    ds_write_b64 v10, v[106:107] offset:1536
    v_mov_b64 v[106:107], 0
    v_smfmac_f32_16x16x64_bf16 v[86:89], v[36:39], v[128:135], v1
    v_mov_b64 v[108:109], 0
    v_smfmac_f32_16x16x64_bf16 v[86:89], v[40:43], v[136:143], v1
    s_waitcnt lgkmcnt(2)
    v_mfma_f32_16x16x32_bf16 v[98:101], v[110:113], v[58:61], v[98:101]
    v_mfma_f32_16x16x32_bf16 v[102:105], v[110:113], v[72:75], v[102:105]
    v_mfma_f32_16x16x32_bf16 v[106:109], v[110:113], v[44:47], v[106:109]
    v_smfmac_f32_16x16x64_bf16 v[90:93], v[16:19], v[144:151], v1
    ds_read_b64_tr_b16 v[110:111], v11 offset:1024
    ds_read_b64_tr_b16 v[112:113], v11 offset:1152
    v_smfmac_f32_16x16x64_bf16 v[90:93], v[20:23], v[152:159], v1
    v_mov_b64 v[94:95], 0
    v_mov_b64 v[96:97], 0
    v_smfmac_f32_16x16x64_bf16 v[90:93], v[24:27], v[160:167], v1
    v_smfmac_f32_16x16x64_bf16 v[90:93], v[28:31], v[168:175], v1
    v_cvt_pk_bf16_f32 v86, v86, v87
    v_cvt_pk_bf16_f32 v87, v88, v89
    v_smfmac_f32_16x16x64_bf16 v[90:93], v[32:35], v[176:183], v1
    ds_write_b64 v10, v[86:87] offset:2048
    v_smfmac_f32_16x16x64_bf16 v[90:93], v[36:39], v[184:191], v1
    v_smfmac_f32_16x16x64_bf16 v[90:93], v[40:43], v[192:199], v1
    s_waitcnt lgkmcnt(1)
    v_mfma_f32_16x16x32_bf16 v[98:101], v[110:113], v[62:65], v[98:101]
    v_mfma_f32_16x16x32_bf16 v[102:105], v[110:113], v[76:79], v[102:105]
    v_mfma_f32_16x16x32_bf16 v[106:109], v[110:113], v[48:51], v[106:109]
    v_smfmac_f32_16x16x64_bf16 v[94:97], v[16:19], v[200:207], v1
    v_smfmac_f32_16x16x64_bf16 v[94:97], v[20:23], v[208:215], v1
    v_smfmac_f32_16x16x64_bf16 v[94:97], v[24:27], v[216:223], v1
    v_smfmac_f32_16x16x64_bf16 v[94:97], v[28:31], v[224:231], v1
    v_cvt_pk_bf16_f32 v90, v90, v91
    v_cvt_pk_bf16_f32 v91, v92, v93
    v_smfmac_f32_16x16x64_bf16 v[94:97], v[32:35], v[232:239], v1
    ds_write_b64 v10, v[90:91] offset:2560
    ds_read_b64_tr_b16 v[110:111], v11 offset:2048
    v_smfmac_f32_16x16x64_bf16 v[94:97], v[36:39], v[240:247], v1
    ds_read_b64_tr_b16 v[112:113], v11 offset:2176
    v_smfmac_f32_16x16x64_bf16 v[94:97], v[40:43], v[248:255], v1
    s_waitcnt lgkmcnt(0)
    v_mfma_f32_16x16x32_bf16 v[98:101], v[110:113], v[66:69], v[98:101]
    v_mfma_f32_16x16x32_bf16 v[102:105], v[110:113], v[80:83], v[102:105]
    v_mfma_f32_16x16x32_bf16 v[106:109], v[110:113], v[52:55], v[106:109]
    s_nop 3
    v_cvt_pk_bf16_f32 v94, v94, v95
    v_cvt_pk_bf16_f32 v95, v96, v97
    ds_write_b64 v10, v[94:95] offset:3072
    ds_read_b64_tr_b16 v[86:87], v4 offset:3072
    s_waitcnt lgkmcnt(0)
    v_mfma_f32_16x16x16_bf16 v[98:101], v[86:87], v[70:71], v[98:101]
    v_mfma_f32_16x16x16_bf16 v[102:105], v[86:87], v[84:85], v[102:105]
    v_mfma_f32_16x16x16_bf16 v[106:109], v[86:87], v[56:57], v[106:109]
    s_nop 5
    v_permlane32_swap_b32 v98, v100
    v_permlane32_swap_b32 v99, v101
    v_add_f32 v98, v98, v100
    v_add_f32 v99, v99, v101
    ds_write_b32 v12, v98 offset:0
    ds_write_b32 v12, v99 offset:208
    v_permlane32_swap_b32 v102, v104
    v_permlane32_swap_b32 v103, v105
    v_add_f32 v102, v102, v104
    v_add_f32 v103, v103, v105
    ds_write_b32 v12, v102 offset:64
    ds_write_b32 v12, v103 offset:272
    v_permlane32_swap_b32 v106, v108
    v_permlane32_swap_b32 v107, v109
    v_add_f32 v106, v106, v108
    v_add_f32 v107, v107, v109
    ds_write_b32 v12, v106 offset:128
    ds_write_b32 v12, v107 offset:336
    s_waitcnt lgkmcnt(0)
    s_barrier
    s_cmp_eq_u32 s20, 0
    s_cbranch_scc1 L_prim_sm_s
    s_sleep 10
    s_cmp_lg_u32 s20, 3
    s_cbranch_scc1 L_ppe_55
    s_cmp_lg_u32 s65, 0
    s_cbranch_scc1 L_ppe_55
    v_mov_b32 v21, 0
    s_add_u32 s36, s32, 4
    s_min_u32 s36, s36, 63
    s_lshl_b32 s36, s36, 7
    s_add_u32 s36, s36, 100802560
    s_mov_b32 s37, 100797184
    s_mov_b32 s35, 2000000
L_xc_56:
    buffer_load_dword v22, v21, s[16:19], s36 offen sc1
    buffer_load_dword v23, v21, s[16:19], s37 offen sc1
    s_waitcnt vmcnt(0)
    v_readfirstlane_b32 s38, v23
    s_nop 0
    s_cmp_ge_u32 s38, 224
    s_cselect_b32 s65, 1, 0
    v_cmp_gt_u32 vcc, 28, v22
    s_cbranch_vccz L_xcok_57
    s_sleep 4
    s_sub_u32 s35, s35, 1
    s_cmp_lg_u32 s35, 0
    s_cbranch_scc1 L_xc_56
L_xcok_57:
L_ppe_55:
    s_branch L_prim_nosm_s
L_prim_sm_s:
    ds_read_b128 v[28:31], v116 offset:0
    ds_read_b128 v[32:35], v116 offset:1664
    ds_read_b128 v[36:39], v116 offset:3328
    ds_read_b128 v[40:43], v116 offset:4992
    ds_read_b32 v44, v119 offset:0
    ds_read_b32 v45, v119 offset:1664
    ds_read_b32 v46, v119 offset:3328
    ds_read_b32 v47, v119 offset:4992
    s_waitcnt lgkmcnt(0)
    v_pk_add_f32 v[28:29], v[28:29], v[32:33]
    v_pk_add_f32 v[30:31], v[30:31], v[34:35]
    v_pk_add_f32 v[36:37], v[36:37], v[40:41]
    v_pk_add_f32 v[38:39], v[38:39], v[42:43]
    v_pk_add_f32 v[44:45], v[44:45], v[46:47]
    v_pk_add_f32 v[16:17], v[28:29], v[36:37]
    v_pk_add_f32 v[18:19], v[30:31], v[38:39]
    v_add_f32 v20, v44, v45
    v_max3_f32 v21, v16, v17, v18
    v_max3_f32 v21, v21, v19, v20
    s_nop 1
    v_max_f32_dpp v21, v21, v21 quad_perm:[1,0,3,2] row_mask:0xf bank_mask:0xf
    s_nop 1
    v_max_f32_dpp v21, v21, v21 quad_perm:[2,3,0,1] row_mask:0xf bank_mask:0xf
    s_nop 1
    v_max_f32_dpp v21, v21, v21 row_half_mirror row_mask:0xf bank_mask:0xf
    v_sub_f32 v16, v16, v21
    v_sub_f32 v17, v17, v21
    v_sub_f32 v18, v18, v21
    v_sub_f32 v19, v19, v21
    v_sub_f32 v20, v20, v21
    v_exp_f32 v16, v16
    v_exp_f32 v17, v17
    v_exp_f32 v18, v18
    v_exp_f32 v19, v19
    v_exp_f32 v20, v20
    v_add_f32 v21, v16, v17
    v_add_f32 v22, v18, v19
    v_add_f32 v21, v21, v20
    v_add_f32 v21, v21, v22
    s_nop 1
    v_add_f32_dpp v21, v21, v21 quad_perm:[1,0,3,2] row_mask:0xf bank_mask:0xf
    s_nop 1
    v_add_f32_dpp v21, v21, v21 quad_perm:[2,3,0,1] row_mask:0xf bank_mask:0xf
    s_nop 1
    v_add_f32_dpp v21, v21, v21 row_half_mirror row_mask:0xf bank_mask:0xf
    v_rcp_f32 v21, v21
    s_nop 0
    v_mul_f32 v16, v16, v21
    v_mul_f32 v17, v17, v21
    v_mul_f32 v18, v18, v21
    v_mul_f32 v19, v19, v21
    v_mul_f32 v20, v20, v21
    v_cvt_pk_bf16_f32 v16, v16, v17
    v_cvt_pk_bf16_f32 v17, v18, v19
    buffer_store_dwordx2 v[16:17], v117, s[16:19], s33 offen sc1
    v_mov_b32_dpp v22, v20 quad_perm:[1,0,3,2] row_mask:0xf bank_mask:0xf
    v_cndmask_b32 v23, v20, v22, s[44:45]
    v_cndmask_b32 v22, v22, v20, s[44:45]
    v_cvt_pk_bf16_f32 v22, v23, v22
    buffer_store_dword v22, v118, s[16:19], s33 offen sc1
L_prim_nosm_s:
    s_nop 1
    s_add_u32 s34, s34, 28672
    buffer_load_dwordx4 v[58:61], v7, s[16:19], s34 offen offset:0
    buffer_load_dwordx4 v[62:65], v7, s[16:19], s34 offen offset:1024
    buffer_load_dwordx4 v[66:69], v7, s[16:19], s34 offen offset:2048
    buffer_load_dwordx2 v[70:71], v114, s[16:19], s34 offen
    buffer_load_dwordx4 v[72:75], v8, s[16:19], s34 offen offset:0
    buffer_load_dwordx4 v[76:79], v8, s[16:19], s34 offen offset:1024
    buffer_load_dwordx4 v[80:83], v8, s[16:19], s34 offen offset:2048
    buffer_load_dwordx2 v[84:85], v115, s[16:19], s34 offen
    s_add_u32 s66, s66, 458752
    s_add_u32 s32, s32, 1
    s_and_b32 s36, s32, 3
    s_mul_i32 s33, s36, 32768
    s_add_u32 s33, s33, 100663296
    s_add_u32 s36, s32, 3
    s_and_b32 s36, s36, 3
    s_mul_i32 s53, s36, 32768
    s_add_u32 s53, s53, 100663296
    s_add_u32 s36, s32, 1
    s_and_b32 s36, s36, 3
    s_mul_i32 s54, s36, 32768
    s_add_u32 s54, s54, 100663296
    s_mul_i32 s55, s32, 122880
    s_add_u32 s55, s55, 104857600
    s_cmp_lt_u32 s32, 64
    s_cbranch_scc1 L_prim_loop_s
    s_waitcnt vmcnt(0)
    s_branch L_chain_end
L_sec_safe:
    s_movk_i32 s39, 896
    v_and_b32 v12, 1, v3
    v_lshlrev_b32 v12, 2, v12
    v_lshrrev_b32 v13, 1, v3
    v_lshl_add_u32 v12, v13, 1, v12
    s_lshl_b32 s36, s20, 3
    v_add_u32 v12, s36, v12
    v_mul_u32_u24 v12, 80, v12
    v_lshl_add_u32 v12, v4, 2, v12
    v_add_u32 v12, 0, v12
    s_mul_i32 s36, s20, 14336
    s_add_u32 s36, s36, 32768
    v_add_u32 v13, s36, v2
    v_lshlrev_b32 v14, 5, v0
    s_cmp_lt_u32 s31, 12
    s_cselect_b32 s46, 1, 0
    v_and_b32 v6, 1, v3
    v_lshlrev_b32 v6, 3, v6
    v_lshrrev_b32 v7, 1, v3
    v_lshl_add_u32 v6, v7, 2, v6
    v_lshl_add_u32 v6, v4, 4, v6
    s_mul_i32 s36, s31, 7168
    s_mul_i32 s37, s20, 1792
    s_add_u32 s36, s36, s37
    s_add_u32 s36, s36, 8192
    v_add_u32 v6, s36, v6
    s_and_b32 s38, s20, 1
    s_movk_i32 s36, 7168
    v_mul_lo_u32 v7, v3, s36
    v_lshl_add_u32 v7, v4, 4, v7
    s_mul_i32 s36, s20, 28672
    s_lshl_b32 s37, s31, 8
    s_add_u32 s36, s36, s37
    s_add_u32 s36, s36, 8192
    v_add_u32 v7, s36, v7
    s_lshl_b32 s40, s38, 4
    s_add_u32 s40, s40, s31
    v_and_b32 v108, 7, v0
    v_lshrrev_b32 v110, 3, v0
    v_mul_u32_u24 v109, 80, v108
    v_lshl_add_u32 v109, v110, 3, v109
    s_mul_i32 s36, s38, 2560
    s_add_u32 s36, s36, 0
    v_add_u32 v109, s36, v109
    v_lshrrev_b32 v111, 2, v110
    v_lshlrev_b32 v15, 9, v111
    v_and_b32 v111, 1, v110
    v_lshl_add_u32 v15, v111, 7, v15
    v_lshl_add_u32 v15, v108, 4, v15
    v_bfe_u32 v111, v110, 1, 1
    v_lshl_add_u32 v15, v111, 2, v15
    s_lshr_b32 s36, s40, 2
    s_lshl_b32 s36, s36, 10
    s_and_b32 s37, s40, 2
    s_lshl_b32 s37, s37, 7
    s_add_u32 s36, s36, s37
    s_and_b32 s37, s40, 1
    s_lshl_b32 s37, s37, 3
    s_add_u32 s36, s36, s37
    v_add_u32 v15, s36, v15
    v_mul_lo_u32 v111, v108, s39
    v_lshl_add_u32 v111, v110, 2, v111
    s_lshl_b32 s36, s40, 5
    v_add_u32 v111, s36, v111
    s_lshl_b32 s36, s20, 9
    s_add_u32 s36, s36, 24576
    v_add_u32 v110, s36, v2
    v_mov_b32 v108, 0x7ff00000
    v_cmp_lt_u32 vcc, 31, v0
    s_nop 1
    v_cndmask_b32 v110, v110, v108, vcc
    s_lshl_b32 s36, s20, 11
    s_add_u32 s36, s36, 16384
    v_add_u32 v11, s36, v2
    s_mul_i32 s36, s31, 896
    s_mul_i32 s37, s20, 112
    s_add_u32 s36, s36, s37
    s_add_u32 s36, s36, 448
    v_add_u32 v108, s36, v4
    s_movk_i32 s39, 896
    v_mul_lo_u32 v108, v108, s39
    v_lshl_add_u32 v108, v3, 5, v108
    buffer_load_dwordx4 a[0:3], v108, s[16:19], 0 offen offset:0
    buffer_load_dwordx4 a[4:7], v108, s[16:19], 0 offen offset:16
    buffer_load_dwordx4 a[8:11], v108, s[16:19], 0 offen offset:128
    buffer_load_dwordx4 a[12:15], v108, s[16:19], 0 offen offset:144
    buffer_load_dwordx4 a[16:19], v108, s[16:19], 0 offen offset:256
    buffer_load_dwordx4 a[20:23], v108, s[16:19], 0 offen offset:272
    buffer_load_dwordx4 a[24:27], v108, s[16:19], 0 offen offset:384
    buffer_load_dwordx4 a[28:31], v108, s[16:19], 0 offen offset:400
    buffer_load_dwordx4 a[32:35], v108, s[16:19], 0 offen offset:512
    buffer_load_dwordx4 a[36:39], v108, s[16:19], 0 offen offset:528
    buffer_load_dwordx4 a[40:43], v108, s[16:19], 0 offen offset:640
    buffer_load_dwordx4 a[44:47], v108, s[16:19], 0 offen offset:656
    buffer_load_dwordx4 a[48:51], v108, s[16:19], 0 offen offset:768
    buffer_load_dwordx4 a[52:55], v108, s[16:19], 0 offen offset:784
    s_mul_i32 s36, s31, 896
    s_mul_i32 s37, s20, 112
    s_add_u32 s36, s36, s37
    s_add_u32 s36, s36, 464
    v_add_u32 v108, s36, v4
    s_movk_i32 s39, 896
    v_mul_lo_u32 v108, v108, s39
    v_lshl_add_u32 v108, v3, 5, v108
    buffer_load_dwordx4 a[56:59], v108, s[16:19], 0 offen offset:0
    buffer_load_dwordx4 a[60:63], v108, s[16:19], 0 offen offset:16
    buffer_load_dwordx4 a[64:67], v108, s[16:19], 0 offen offset:128
    buffer_load_dwordx4 a[68:71], v108, s[16:19], 0 offen offset:144
    buffer_load_dwordx4 a[72:75], v108, s[16:19], 0 offen offset:256
    buffer_load_dwordx4 a[76:79], v108, s[16:19], 0 offen offset:272
    buffer_load_dwordx4 a[80:83], v108, s[16:19], 0 offen offset:384
    buffer_load_dwordx4 a[84:87], v108, s[16:19], 0 offen offset:400
    buffer_load_dwordx4 a[88:91], v108, s[16:19], 0 offen offset:512
    buffer_load_dwordx4 a[92:95], v108, s[16:19], 0 offen offset:528
    buffer_load_dwordx4 a[96:99], v108, s[16:19], 0 offen offset:640
    buffer_load_dwordx4 a[100:103], v108, s[16:19], 0 offen offset:656
    buffer_load_dwordx4 a[104:107], v108, s[16:19], 0 offen offset:768
    buffer_load_dwordx4 a[108:111], v108, s[16:19], 0 offen offset:784
    s_mul_i32 s36, s31, 896
    s_mul_i32 s37, s20, 112
    s_add_u32 s36, s36, s37
    s_add_u32 s36, s36, 480
    v_add_u32 v108, s36, v4
    s_movk_i32 s39, 896
    v_mul_lo_u32 v108, v108, s39
    v_lshl_add_u32 v108, v3, 5, v108
    buffer_load_dwordx4 a[112:115], v108, s[16:19], 0 offen offset:0
    buffer_load_dwordx4 a[116:119], v108, s[16:19], 0 offen offset:16
    buffer_load_dwordx4 a[120:123], v108, s[16:19], 0 offen offset:128
    buffer_load_dwordx4 a[124:127], v108, s[16:19], 0 offen offset:144
    buffer_load_dwordx4 a[128:131], v108, s[16:19], 0 offen offset:256
    buffer_load_dwordx4 a[132:135], v108, s[16:19], 0 offen offset:272
    buffer_load_dwordx4 a[136:139], v108, s[16:19], 0 offen offset:384
    buffer_load_dwordx4 a[140:143], v108, s[16:19], 0 offen offset:400
    buffer_load_dwordx4 a[144:147], v108, s[16:19], 0 offen offset:512
    buffer_load_dwordx4 a[148:151], v108, s[16:19], 0 offen offset:528
    buffer_load_dwordx4 a[152:155], v108, s[16:19], 0 offen offset:640
    buffer_load_dwordx4 a[156:159], v108, s[16:19], 0 offen offset:656
    buffer_load_dwordx4 a[160:163], v108, s[16:19], 0 offen offset:768
    buffer_load_dwordx4 a[164:167], v108, s[16:19], 0 offen offset:784
    s_mul_i32 s36, s31, 896
    s_mul_i32 s37, s20, 112
    s_add_u32 s36, s36, s37
    s_add_u32 s36, s36, 496
    v_add_u32 v108, s36, v4
    s_movk_i32 s39, 896
    v_mul_lo_u32 v108, v108, s39
    v_lshl_add_u32 v108, v3, 5, v108
    buffer_load_dwordx4 a[168:171], v108, s[16:19], 0 offen offset:0
    buffer_load_dwordx4 a[172:175], v108, s[16:19], 0 offen offset:16
    buffer_load_dwordx4 a[176:179], v108, s[16:19], 0 offen offset:128
    buffer_load_dwordx4 a[180:183], v108, s[16:19], 0 offen offset:144
    buffer_load_dwordx4 a[184:187], v108, s[16:19], 0 offen offset:256
    buffer_load_dwordx4 a[188:191], v108, s[16:19], 0 offen offset:272
    buffer_load_dwordx4 a[192:195], v108, s[16:19], 0 offen offset:384
    buffer_load_dwordx4 a[196:199], v108, s[16:19], 0 offen offset:400
    buffer_load_dwordx4 a[200:203], v108, s[16:19], 0 offen offset:512
    buffer_load_dwordx4 a[204:207], v108, s[16:19], 0 offen offset:528
    buffer_load_dwordx4 a[208:211], v108, s[16:19], 0 offen offset:640
    buffer_load_dwordx4 a[212:215], v108, s[16:19], 0 offen offset:656
    buffer_load_dwordx4 a[216:219], v108, s[16:19], 0 offen offset:768
    buffer_load_dwordx4 a[220:223], v108, s[16:19], 0 offen offset:784
    s_mul_i32 s36, s31, 896
    s_mul_i32 s37, s20, 112
    s_add_u32 s36, s36, s37
    s_add_u32 s36, s36, 512
    v_add_u32 v108, s36, v4
    s_movk_i32 s39, 896
    v_mul_lo_u32 v108, v108, s39
    v_lshl_add_u32 v108, v3, 5, v108
    buffer_load_dwordx4 a[224:227], v108, s[16:19], 0 offen offset:0
    buffer_load_dwordx4 a[228:231], v108, s[16:19], 0 offen offset:16
    buffer_load_dwordx4 a[232:235], v108, s[16:19], 0 offen offset:128
    buffer_load_dwordx4 a[236:239], v108, s[16:19], 0 offen offset:144
    buffer_load_dwordx4 a[240:243], v108, s[16:19], 0 offen offset:256
    buffer_load_dwordx4 a[244:247], v108, s[16:19], 0 offen offset:272
    buffer_load_dwordx4 a[248:251], v108, s[16:19], 0 offen offset:384
    buffer_load_dwordx4 a[252:255], v108, s[16:19], 0 offen offset:400
    buffer_load_dwordx4 v[176:179], v108, s[16:19], 0 offen offset:512
    buffer_load_dwordx4 v[180:183], v108, s[16:19], 0 offen offset:528
    buffer_load_dwordx4 v[184:187], v108, s[16:19], 0 offen offset:640
    buffer_load_dwordx4 v[188:191], v108, s[16:19], 0 offen offset:656
    buffer_load_dwordx4 v[192:195], v108, s[16:19], 0 offen offset:768
    buffer_load_dwordx4 v[196:199], v108, s[16:19], 0 offen offset:784
    s_mul_i32 s36, s31, 896
    s_mul_i32 s37, s20, 112
    s_add_u32 s36, s36, s37
    s_add_u32 s36, s36, 528
    v_add_u32 v108, s36, v4
    s_movk_i32 s39, 896
    v_mul_lo_u32 v108, v108, s39
    v_lshl_add_u32 v108, v3, 5, v108
    buffer_load_dwordx4 v[200:203], v108, s[16:19], 0 offen offset:0
    buffer_load_dwordx4 v[204:207], v108, s[16:19], 0 offen offset:16
    buffer_load_dwordx4 v[208:211], v108, s[16:19], 0 offen offset:128
    buffer_load_dwordx4 v[212:215], v108, s[16:19], 0 offen offset:144
    buffer_load_dwordx4 v[216:219], v108, s[16:19], 0 offen offset:256
    buffer_load_dwordx4 v[220:223], v108, s[16:19], 0 offen offset:272
    buffer_load_dwordx4 v[224:227], v108, s[16:19], 0 offen offset:384
    buffer_load_dwordx4 v[228:231], v108, s[16:19], 0 offen offset:400
    buffer_load_dwordx4 v[232:235], v108, s[16:19], 0 offen offset:512
    buffer_load_dwordx4 v[236:239], v108, s[16:19], 0 offen offset:528
    buffer_load_dwordx4 v[240:243], v108, s[16:19], 0 offen offset:640
    buffer_load_dwordx4 v[244:247], v108, s[16:19], 0 offen offset:656
    buffer_load_dwordx4 v[248:251], v108, s[16:19], 0 offen offset:768
    buffer_load_dwordx4 v[252:255], v108, s[16:19], 0 offen offset:784
    s_mul_i32 s36, s31, 896
    s_mul_i32 s37, s20, 112
    s_add_u32 s36, s36, s37
    s_add_u32 s36, s36, 544
    v_add_u32 v108, s36, v4
    s_movk_i32 s39, 896
    v_mul_lo_u32 v108, v108, s39
    v_lshl_add_u32 v108, v3, 5, v108
    buffer_load_dwordx4 v[112:115], v108, s[16:19], 0 offen offset:0
    buffer_load_dwordx4 v[116:119], v108, s[16:19], 0 offen offset:16
    buffer_load_dwordx4 v[120:123], v108, s[16:19], 0 offen offset:128
    buffer_load_dwordx4 v[124:127], v108, s[16:19], 0 offen offset:144
    buffer_load_dwordx4 v[128:131], v108, s[16:19], 0 offen offset:256
    buffer_load_dwordx4 v[132:135], v108, s[16:19], 0 offen offset:272
    buffer_load_dwordx4 v[136:139], v108, s[16:19], 0 offen offset:384
    buffer_load_dwordx4 v[140:143], v108, s[16:19], 0 offen offset:400
    buffer_load_dwordx4 v[144:147], v108, s[16:19], 0 offen offset:512
    buffer_load_dwordx4 v[148:151], v108, s[16:19], 0 offen offset:528
    buffer_load_dwordx4 v[152:155], v108, s[16:19], 0 offen offset:640
    buffer_load_dwordx4 v[156:159], v108, s[16:19], 0 offen offset:656
    buffer_load_dwordx4 v[160:163], v108, s[16:19], 0 offen offset:768
    buffer_load_dwordx4 v[164:167], v108, s[16:19], 0 offen offset:784
    s_waitcnt vmcnt(0)
    ds_write_b128 v13, v[112:115] offset:0
    ds_write_b128 v13, v[116:119] offset:1024
    ds_write_b128 v13, v[120:123] offset:2048
    ds_write_b128 v13, v[124:127] offset:3072
    ds_write_b128 v13, v[128:131] offset:4096
    ds_write_b128 v13, v[132:135] offset:5120
    ds_write_b128 v13, v[136:139] offset:6144
    ds_write_b128 v13, v[140:143] offset:7168
    ds_write_b128 v13, v[144:147] offset:8192
    ds_write_b128 v13, v[148:151] offset:9216
    ds_write_b128 v13, v[152:155] offset:10240
    ds_write_b128 v13, v[156:159] offset:11264
    ds_write_b128 v13, v[160:163] offset:12288
    ds_write_b128 v13, v[164:167] offset:13312
    s_waitcnt lgkmcnt(0)
    s_cmp_lg_u32 s20, 3
    s_cbranch_scc1 L_sec_lk_s
    v_min_u32 v108, 27, v0
    s_mul_i32 s36, s31, 28
    v_add_u32 v108, s36, v108
    v_lshlrev_b32 v111, 4, v108
    s_mov_b32 s36, 0x04924925
    v_mul_hi_u32 v107, v108, s36
    v_mul_u32_u24 v106, 56, v107
    v_sub_u32 v108, v108, v106
    v_lshrrev_b32 v109, 3, v108
    v_lshlrev_b32 v109, 10, v109
    v_bfe_u32 v106, v108, 2, 1
    v_lshl_add_u32 v109, v106, 8, v109
    v_and_b32 v106, 1, v108
    v_lshl_add_u32 v109, v106, 9, v109
    v_bfe_u32 v106, v108, 1, 1
    v_lshl_add_u32 v109, v106, 3, v109
    v_lshl_add_u32 v109, v107, 4, v109
    v_add_u32 v109, 14336, v109
L_sec_lk_s:
    s_lshl_b32 s36, s20, 10
    v_add_u32 v5, s36, v2
    s_cmp_lt_u32 s20, 3
    s_cselect_b32 s49, 4096, 0
    v_add_u32 v3, s49, v5
    v_mov_b32 v8, -1
    v_and_b32 v9, 3, v0
    s_lshl_b32 s36, s20, 4
    s_lshl_b32 s37, s31, 8
    s_add_u32 s36, s36, s37
    s_add_u32 s36, s36, 100831232
    v_lshl_add_u32 v9, v9, 2, s36
    v_lshlrev_b32 v10, 8, v0
    v_min_u32 v0, 27, v0
    v_lshlrev_b32 v0, 2, v0
    s_add_u32 s37, s37, 100827136
    v_add_u32 v0, s37, v0
    s_lshl_b32 s58, s40, 2
    s_add_u32 s58, s58, 100827136
    s_mov_b32 s32, 0
    s_lshl_b32 s47, s31, 14
    s_lshl_b32 s36, s20, 12
    s_add_u32 s47, s47, s36
    s_add_u32 s47, s47, 16777216
    v_mov_b32 v72, 0
    v_mov_b32 v73, 0
    v_mov_b32 v74, 0
    v_mov_b32 v75, 0
    v_mov_b32 v76, 0
    v_mov_b32 v77, 0
    v_mov_b32 v78, 0
    v_mov_b32 v79, 0
    v_mov_b32 v80, 0
    v_mov_b32 v81, 0
    v_mov_b32 v82, 0
    v_mov_b32 v83, 0
    v_mov_b32 v84, 0
    v_mov_b32 v85, 0
    v_mov_b32 v86, 0
    v_mov_b32 v87, 0
    v_mov_b32 v112, 0
    v_mov_b32 v113, 0
    v_mov_b32 v114, 0
    v_mov_b32 v115, 0
    v_mov_b32 v116, 0
    v_mov_b32 v117, 0
    v_mov_b32 v118, 0
    v_mov_b32 v119, 0
    v_mov_b32 v120, 0
    v_mov_b32 v121, 0
    v_mov_b32 v122, 0
    v_mov_b32 v123, 0
    v_mov_b32 v124, 0
    v_mov_b32 v125, 0
    v_mov_b32 v126, 0
    v_mov_b32 v127, 0
    v_mov_b32 v128, 0
    v_mov_b32 v129, 0
    v_mov_b32 v130, 0
    v_mov_b32 v131, 0
    v_mov_b32 v132, 0
    v_mov_b32 v133, 0
    v_mov_b32 v134, 0
    v_mov_b32 v135, 0
    v_mov_b32 v136, 0
    v_mov_b32 v137, 0
    v_mov_b32 v138, 0
    v_mov_b32 v139, 0
    v_mov_b32 v140, 0
    v_mov_b32 v141, 0
    v_mov_b32 v142, 0
    v_mov_b32 v143, 0
    s_and_b32 s36, s32, 3
    s_mul_i32 s33, s36, 32768
    s_add_u32 s33, s33, 100663296
    s_add_u32 s36, s32, 3
    s_and_b32 s36, s36, 3
    s_mul_i32 s53, s36, 32768
    s_add_u32 s53, s53, 100663296
    s_add_u32 s36, s32, 1
    s_and_b32 s36, s36, 3
    s_mul_i32 s54, s36, 32768
    s_add_u32 s54, s54, 100663296
    s_mul_i32 s55, s32, 122880
    s_add_u32 s55, s55, 104857600
    s_mul_i32 s66, s31, 28672
    s_mul_i32 s37, s20, 1024
    s_add_u32 s66, s66, s37
    s_add_u32 s66, s66, 17719296
    v_min_u32 v19, 48, v2
    v_lshlrev_b32 v19, 3, v19
    v_add_u32 v19, 100802560, v19
    s_mov_b32 s35, 2000000
L_x0_ss_58:
    buffer_load_dword v16, v19, s[16:19], 0 offen sc1
    s_waitcnt vmcnt(0)
    v_cmp_gt_u32 vcc, 28, v16
    s_cbranch_vccz L_x0ok_ss_59
    s_sleep 4
    s_sub_u32 s35, s35, 1
    s_cmp_lg_u32 s35, 0
    s_cbranch_scc1 L_x0_ss_58
L_x0ok_ss_59:
L_sec_loop_s:
    s_nop 7
    v_mov_b64 v[44:45], 0
    v_mov_b64 v[46:47], 0
    v_mov_b64 v[48:49], 0
    v_mov_b64 v[50:51], 0
    v_mov_b64 v[52:53], 0
    v_mov_b64 v[54:55], 0
    v_mov_b64 v[56:57], 0
    v_mov_b64 v[58:59], 0
    v_mov_b64 v[60:61], 0
    v_mov_b64 v[62:63], 0
    v_mov_b64 v[64:65], 0
    v_mov_b64 v[66:67], 0
    v_mov_b64 v[68:69], 0
    v_mov_b64 v[70:71], 0
    s_add_u32 s48, s33, s49
    s_mov_b32 s35, 65536
    buffer_load_dwordx4 v[144:147], v5, s[16:19], s33 offen sc1
    buffer_load_dwordx4 v[148:151], v5, s[16:19], s48 offen sc1
    s_sleep 2
L_pp_sms_60:
    buffer_load_dwordx4 v[152:155], v5, s[16:19], s33 offen sc1
    buffer_load_dwordx4 v[156:159], v5, s[16:19], s48 offen sc1
    s_waitcnt vmcnt(2)
    v_max3_u32 v108, v144, v145, v146
    v_max3_u32 v108, v108, v147, v148
    v_max3_u32 v108, v108, v149, v150
    v_max3_u32 v108, v108, v151, v151
    v_cmp_eq_u32 vcc, -1, v108
    s_cbranch_vccz L_ppa_sms_61
    buffer_load_dwordx4 v[144:147], v5, s[16:19], s33 offen sc1
    buffer_load_dwordx4 v[148:151], v5, s[16:19], s48 offen sc1
    s_waitcnt vmcnt(2)
    v_max3_u32 v108, v152, v153, v154
    v_max3_u32 v108, v108, v155, v156
    v_max3_u32 v108, v108, v157, v158
    v_max3_u32 v108, v108, v159, v159
    v_cmp_eq_u32 vcc, -1, v108
    s_cbranch_vccz L_ppb_sms_62
    s_sub_u32 s35, s35, 1
    s_cmp_lg_u32 s35, 0
    s_cbranch_scc1 L_pp_sms_60
L_ppb_sms_62:
    ds_write_b128 v5, v[152:155] offset:14336
    ds_write_b128 v3, v[156:159] offset:14336
    s_branch L_ppd_sms_63
L_ppa_sms_61:
    ds_write_b128 v5, v[144:147] offset:14336
    ds_write_b128 v3, v[148:151] offset:14336
L_ppd_sms_63:
    s_waitcnt lgkmcnt(0)
    s_barrier
    ds_read_b128 v[16:19], v2 offset:14336
    ds_read_b128 v[20:23], v2 offset:15360
    ds_read_b128 v[24:27], v2 offset:16384
    ds_read_b128 v[28:31], v2 offset:17408
    ds_read_b128 v[32:35], v2 offset:18432
    ds_read_b128 v[36:39], v2 offset:19456
    ds_read_b128 v[40:43], v2 offset:20480
    buffer_load_dwordx4 v[112:115], v14, s[16:19], s47 offen offset:0
    buffer_load_dwordx4 v[116:119], v14, s[16:19], s47 offen offset:16
    buffer_load_dwordx4 v[120:123], v14, s[16:19], s47 offen offset:2048
    buffer_load_dwordx4 v[124:127], v14, s[16:19], s47 offen offset:2064
    s_cmp_eq_u32 s46, 0
    s_cbranch_scc1 L_sec_noxv_64
    s_add_u32 s36, s47, 262144
    buffer_load_dwordx4 v[128:131], v14, s[16:19], s36 offen offset:0
    buffer_load_dwordx4 v[132:135], v14, s[16:19], s36 offen offset:16
    buffer_load_dwordx4 v[136:139], v14, s[16:19], s36 offen offset:2048
    buffer_load_dwordx4 v[140:143], v14, s[16:19], s36 offen offset:2064
L_sec_noxv_64:
    s_add_u32 s37, s66, 0
    buffer_load_dwordx4 v[160:163], v2, s[16:19], s37 offen offset:0
    s_add_u32 s66, s66, 458752
    s_waitcnt lgkmcnt(6)
    v_smfmac_f32_16x16x64_bf16 v[44:47], v[16:19], a[0:7], v1
    s_waitcnt lgkmcnt(5)
    v_smfmac_f32_16x16x64_bf16 v[44:47], v[20:23], a[8:15], v1
    s_waitcnt lgkmcnt(4)
    v_smfmac_f32_16x16x64_bf16 v[44:47], v[24:27], a[16:23], v1
    s_waitcnt lgkmcnt(3)
    v_smfmac_f32_16x16x64_bf16 v[44:47], v[28:31], a[24:31], v1
    s_waitcnt lgkmcnt(2)
    v_smfmac_f32_16x16x64_bf16 v[44:47], v[32:35], a[32:39], v1
    s_waitcnt lgkmcnt(1)
    v_smfmac_f32_16x16x64_bf16 v[44:47], v[36:39], a[40:47], v1
    s_waitcnt lgkmcnt(0)
    v_smfmac_f32_16x16x64_bf16 v[44:47], v[40:43], a[48:55], v1
    s_cmp_gt_u32 s20, s46
    s_cbranch_scc1 L_sec_nora_s
    buffer_store_dword v8, v15, s[16:19], s53 offen sc1
L_sec_nora_s:
    s_cmp_lg_u32 s20, 3
    s_cbranch_scc1 L_sec_mp_65
    ds_read2_b32 v[92:93], v109 offset0:0 offset1:32
    ds_read2_b32 v[94:95], v109 offset0:1 offset1:33
    s_waitcnt lgkmcnt(0)
    buffer_store_dwordx4 v[92:95], v111, s[16:19], s55 offen sc1
L_sec_mp_65:
    v_smfmac_f32_16x16x64_bf16 v[48:51], v[16:19], a[56:63], v1
    v_smfmac_f32_16x16x64_bf16 v[48:51], v[20:23], a[64:71], v1
    v_smfmac_f32_16x16x64_bf16 v[48:51], v[24:27], a[72:79], v1
    v_smfmac_f32_16x16x64_bf16 v[48:51], v[28:31], a[80:87], v1
    v_smfmac_f32_16x16x64_bf16 v[48:51], v[32:35], a[88:95], v1
    v_smfmac_f32_16x16x64_bf16 v[48:51], v[36:39], a[96:103], v1
    v_smfmac_f32_16x16x64_bf16 v[48:51], v[40:43], a[104:111], v1
    v_permlane32_swap_b32 v44, v46
    v_permlane32_swap_b32 v45, v47
    v_add_f32 v44, v44, v46
    v_add_f32 v45, v45, v47
    v_cvt_pk_bf16_f32 v44, v44, v45
    buffer_store_dword v44, v6, s[16:19], s55 offen offset:0 sc1
    v_smfmac_f32_16x16x64_bf16 v[52:55], v[16:19], a[112:119], v1
    v_smfmac_f32_16x16x64_bf16 v[52:55], v[20:23], a[120:127], v1
    v_smfmac_f32_16x16x64_bf16 v[52:55], v[24:27], a[128:135], v1
    v_smfmac_f32_16x16x64_bf16 v[52:55], v[28:31], a[136:143], v1
    v_smfmac_f32_16x16x64_bf16 v[52:55], v[32:35], a[144:151], v1
    v_smfmac_f32_16x16x64_bf16 v[52:55], v[36:39], a[152:159], v1
    v_smfmac_f32_16x16x64_bf16 v[52:55], v[40:43], a[160:167], v1
    v_permlane32_swap_b32 v48, v50
    v_permlane32_swap_b32 v49, v51
    v_add_f32 v48, v48, v50
    v_add_f32 v49, v49, v51
    v_cvt_pk_bf16_f32 v48, v48, v49
    buffer_store_dword v48, v6, s[16:19], s55 offen offset:256 sc1
    v_smfmac_f32_16x16x64_bf16 v[56:59], v[16:19], a[168:175], v1
    v_smfmac_f32_16x16x64_bf16 v[56:59], v[20:23], a[176:183], v1
    v_smfmac_f32_16x16x64_bf16 v[56:59], v[24:27], a[184:191], v1
    v_smfmac_f32_16x16x64_bf16 v[56:59], v[28:31], a[192:199], v1
    v_smfmac_f32_16x16x64_bf16 v[56:59], v[32:35], a[200:207], v1
    v_smfmac_f32_16x16x64_bf16 v[56:59], v[36:39], a[208:215], v1
    v_smfmac_f32_16x16x64_bf16 v[56:59], v[40:43], a[216:223], v1
    v_permlane32_swap_b32 v52, v54
    v_permlane32_swap_b32 v53, v55
    v_add_f32 v52, v52, v54
    v_add_f32 v53, v53, v55
    v_cvt_pk_bf16_f32 v52, v52, v53
    buffer_store_dword v52, v6, s[16:19], s55 offen offset:512 sc1
    ds_read_b128 v[92:95], v13 offset:0
    ds_read_b128 v[96:99], v13 offset:1024
    ds_read_b128 v[100:103], v13 offset:2048
    ds_read_b128 v[104:107], v13 offset:3072
    v_smfmac_f32_16x16x64_bf16 v[60:63], v[16:19], a[224:231], v1
    v_smfmac_f32_16x16x64_bf16 v[64:67], v[16:19], v[200:207], v1
    s_waitcnt lgkmcnt(2)
    v_smfmac_f32_16x16x64_bf16 v[68:71], v[16:19], v[92:99], v1
    ds_read_b128 v[92:95], v13 offset:4096
    ds_read_b128 v[96:99], v13 offset:5120
    v_smfmac_f32_16x16x64_bf16 v[60:63], v[20:23], a[232:239], v1
    v_smfmac_f32_16x16x64_bf16 v[64:67], v[20:23], v[208:215], v1
    s_waitcnt lgkmcnt(2)
    v_smfmac_f32_16x16x64_bf16 v[68:71], v[20:23], v[100:107], v1
    ds_read_b128 v[100:103], v13 offset:6144
    ds_read_b128 v[104:107], v13 offset:7168
    v_smfmac_f32_16x16x64_bf16 v[60:63], v[24:27], a[240:247], v1
    v_smfmac_f32_16x16x64_bf16 v[64:67], v[24:27], v[216:223], v1
    s_waitcnt lgkmcnt(2)
    v_smfmac_f32_16x16x64_bf16 v[68:71], v[24:27], v[92:99], v1
    ds_read_b128 v[92:95], v13 offset:8192
    ds_read_b128 v[96:99], v13 offset:9216
    v_smfmac_f32_16x16x64_bf16 v[60:63], v[28:31], a[248:255], v1
    v_smfmac_f32_16x16x64_bf16 v[64:67], v[28:31], v[224:231], v1
    s_waitcnt lgkmcnt(2)
    v_smfmac_f32_16x16x64_bf16 v[68:71], v[28:31], v[100:107], v1
    ds_read_b128 v[100:103], v13 offset:10240
    ds_read_b128 v[104:107], v13 offset:11264
    v_permlane32_swap_b32 v56, v58
    v_permlane32_swap_b32 v57, v59
    v_add_f32 v56, v56, v58
    v_add_f32 v57, v57, v59
    v_cvt_pk_bf16_f32 v56, v56, v57
    buffer_store_dword v56, v6, s[16:19], s55 offen offset:768 sc1
    v_smfmac_f32_16x16x64_bf16 v[60:63], v[32:35], v[176:183], v1
    v_smfmac_f32_16x16x64_bf16 v[64:67], v[32:35], v[232:239], v1
    s_waitcnt lgkmcnt(2)
    v_smfmac_f32_16x16x64_bf16 v[68:71], v[32:35], v[92:99], v1
    ds_read_b128 v[92:95], v13 offset:12288
    ds_read_b128 v[96:99], v13 offset:13312
    v_smfmac_f32_16x16x64_bf16 v[60:63], v[36:39], v[184:191], v1
    v_smfmac_f32_16x16x64_bf16 v[64:67], v[36:39], v[240:247], v1
    s_waitcnt lgkmcnt(2)
    v_smfmac_f32_16x16x64_bf16 v[68:71], v[36:39], v[100:107], v1
    v_smfmac_f32_16x16x64_bf16 v[60:63], v[40:43], v[192:199], v1
    v_smfmac_f32_16x16x64_bf16 v[64:67], v[40:43], v[248:255], v1
    s_waitcnt lgkmcnt(0)
    v_smfmac_f32_16x16x64_bf16 v[68:71], v[40:43], v[92:99], v1
    s_nop 4
    v_permlane32_swap_b32 v60, v62
    v_permlane32_swap_b32 v61, v63
    v_add_f32 v60, v60, v62
    v_add_f32 v61, v61, v63
    v_cvt_pk_bf16_f32 v60, v60, v61
    buffer_store_dword v60, v6, s[16:19], s55 offen offset:1024 sc1
    v_permlane32_swap_b32 v64, v66
    v_permlane32_swap_b32 v65, v67
    v_add_f32 v64, v64, v66
    v_add_f32 v65, v65, v67
    v_cvt_pk_bf16_f32 v64, v64, v65
    buffer_store_dword v64, v6, s[16:19], s55 offen offset:1280 sc1
    v_permlane32_swap_b32 v68, v70
    v_permlane32_swap_b32 v69, v71
    v_add_f32 v68, v68, v70
    v_add_f32 v69, v69, v71
    v_cvt_pk_bf16_f32 v68, v68, v69
    buffer_store_dword v68, v6, s[16:19], s55 offen offset:1536 sc1
    s_lshl_b32 s37, s46, 12
    s_add_u32 s37, s37, s55
    v_mov_b64 v[32:33], 0
    v_mov_b64 v[34:35], 0
    v_mov_b64 v[36:37], 0
    v_mov_b64 v[38:39], 0
    s_add_u32 s39, s32, 1
    v_mov_b32 v107, s39
    s_mov_b32 s35, 65536
L_poll_ubs_66:
    buffer_load_dwordx4 v[72:75], v7, s[16:19], s55 offen sc1
    buffer_load_dwordx4 v[80:83], v7, s[16:19], s37 offen sc1
    s_waitcnt vmcnt(0)
    v_max3_u32 v108, v72, v73, v74
    v_max3_u32 v108, v108, v75, v80
    v_max3_u32 v108, v108, v81, v82
    v_max3_u32 v108, v108, v83, v83
    v_cmp_eq_u32 vcc, -1, v108
    s_cbranch_vccz L_ok_ubs_67
    s_sleep 1
    s_sub_u32 s35, s35, 1
    s_cmp_lg_u32 s35, 0
    s_cbranch_scc1 L_poll_ubs_66
L_ok_ubs_67:
L_fo_68:
    s_mov_b32 s35, 65536
    buffer_load_dwordx4 v[16:19], v11, s[16:19], s33 offen offset:0 sc1
    buffer_load_dwordx4 v[20:23], v11, s[16:19], s33 offen offset:1024 sc1
    buffer_load_dwordx4 v[24:27], v110, s[16:19], s33 offen sc1
    s_sleep 2
L_pp_pxs_69:
    buffer_load_dwordx4 v[160:163], v11, s[16:19], s33 offen offset:0 sc1
    buffer_load_dwordx4 v[164:167], v11, s[16:19], s33 offen offset:1024 sc1
    buffer_load_dwordx4 v[168:171], v110, s[16:19], s33 offen sc1
    s_waitcnt vmcnt(3)
    v_max3_u32 v108, v16, v17, v18
    v_max3_u32 v108, v108, v19, v20
    v_max3_u32 v108, v108, v21, v22
    v_max3_u32 v108, v108, v23, v24
    v_max3_u32 v108, v108, v25, v26
    v_max3_u32 v108, v108, v27, v27
    v_cmp_eq_u32 vcc, -1, v108
    s_cbranch_vccz L_ppa_pxs_70
    buffer_load_dwordx4 v[16:19], v11, s[16:19], s33 offen offset:0 sc1
    buffer_load_dwordx4 v[20:23], v11, s[16:19], s33 offen offset:1024 sc1
    buffer_load_dwordx4 v[24:27], v110, s[16:19], s33 offen sc1
    s_waitcnt vmcnt(3)
    v_max3_u32 v108, v160, v161, v162
    v_max3_u32 v108, v108, v163, v164
    v_max3_u32 v108, v108, v165, v166
    v_max3_u32 v108, v108, v167, v168
    v_max3_u32 v108, v108, v169, v170
    v_max3_u32 v108, v108, v171, v171
    v_cmp_eq_u32 vcc, -1, v108
    s_cbranch_vccz L_ppb_pxs_71
    s_sub_u32 s35, s35, 1
    s_cmp_lg_u32 s35, 0
    s_cbranch_scc1 L_pp_pxs_69
L_ppb_pxs_71:
    s_cmp_gt_u32 s20, s46
    s_cbranch_scc1 L_sec_nopf_73
    s_mov_b64 exec, 0xffff
    buffer_store_dword v107, v10, s[16:19], s58 offen sc1
    s_mov_b64 exec, -1
L_sec_nopf_73:
    v_smfmac_f32_16x16x64_bf16 v[32:35], v[160:163], v[112:119], v1
    v_smfmac_f32_16x16x64_bf16 v[32:35], v[164:167], v[120:127], v1
    v_smfmac_f32_16x16x64_bf16 v[32:35], v[168:171], v[72:79], v1
    v_smfmac_f32_16x16x64_bf16 v[36:39], v[160:163], v[128:135], v1
    v_smfmac_f32_16x16x64_bf16 v[36:39], v[164:167], v[136:143], v1
    v_smfmac_f32_16x16x64_bf16 v[36:39], v[168:171], v[80:87], v1
    s_branch L_ppd_pxs_72
L_ppa_pxs_70:
    s_cmp_gt_u32 s20, s46
    s_cbranch_scc1 L_sec_nopf_74
    s_mov_b64 exec, 0xffff
    buffer_store_dword v107, v10, s[16:19], s58 offen sc1
    s_mov_b64 exec, -1
L_sec_nopf_74:
    v_smfmac_f32_16x16x64_bf16 v[32:35], v[16:19], v[112:119], v1
    v_smfmac_f32_16x16x64_bf16 v[32:35], v[20:23], v[120:127], v1
    v_smfmac_f32_16x16x64_bf16 v[32:35], v[24:27], v[72:79], v1
    v_smfmac_f32_16x16x64_bf16 v[36:39], v[16:19], v[128:135], v1
    v_smfmac_f32_16x16x64_bf16 v[36:39], v[20:23], v[136:143], v1
    v_smfmac_f32_16x16x64_bf16 v[36:39], v[24:27], v[80:87], v1
L_ppd_pxs_72:
    s_nop 7
    v_permlane32_swap_b32 v32, v34
    v_permlane32_swap_b32 v33, v35
    v_add_f32 v32, v32, v34
    v_add_f32 v33, v33, v35
    ds_write_b32 v12, v32 offset:0
    ds_write_b32 v12, v33 offset:80
    v_permlane32_swap_b32 v36, v38
    v_permlane32_swap_b32 v37, v39
    v_add_f32 v36, v36, v38
    v_add_f32 v37, v37, v39
    ds_write_b32 v12, v36 offset:2560
    ds_write_b32 v12, v37 offset:2640
    s_waitcnt lgkmcnt(0)
    s_barrier
    s_cmp_gt_u32 s20, s46
    s_cbranch_scc1 L_sec_join_s
    ds_read_b64 v[92:93], v109 offset:0
    ds_read_b64 v[94:95], v109 offset:640
    ds_read_b64 v[96:97], v109 offset:1280
    ds_read_b64 v[98:99], v109 offset:1920
    s_waitcnt lgkmcnt(0)
    v_pk_add_f32 v[92:93], v[92:93], v[94:95]
    v_pk_add_f32 v[96:97], v[96:97], v[98:99]
    v_pk_add_f32 v[92:93], v[92:93], v[96:97]
    v_cvt_pk_bf16_f32 v92, v92, v93
    buffer_store_dword v92, v15, s[16:19], s54 offen sc1
L_sec_join_s:
    s_nop 1
    s_add_u32 s47, s47, 458752
    s_add_u32 s32, s32, 1
    s_and_b32 s36, s32, 3
    s_mul_i32 s33, s36, 32768
    s_add_u32 s33, s33, 100663296
    s_add_u32 s36, s32, 3
    s_and_b32 s36, s36, 3
    s_mul_i32 s53, s36, 32768
    s_add_u32 s53, s53, 100663296
    s_add_u32 s36, s32, 1
    s_and_b32 s36, s36, 3
    s_mul_i32 s54, s36, 32768
    s_add_u32 s54, s54, 100663296
    s_mul_i32 s55, s32, 122880
    s_add_u32 s55, s55, 104857600
    s_cmp_lt_u32 s32, 64
    s_cbranch_scc1 L_sec_loop_s
    s_waitcnt vmcnt(0)
    s_branch L_chain_end
L_worker:
    s_mov_b32 s21, s23
    v_mov_b32 v1, v0
    s_lshl_b32 s3, s20, 6
    v_add_u32 v0, s3, v1
    v_lshrrev_b32 v3, 4, v1
    v_and_b32 v4, 15, v1
    s_load_dwordx2 s[4:5], s[0:1], 56
    s_load_dwordx2 s[6:7], s[0:1], 88
    s_cmp_ge_u32 s21, 224
    s_cbranch_scc1 L_chain_end
    s_and_b32 s30, s21, 7
    s_lshr_b32 s31, s21, 3
    s_lshl_b32 s31, s31, 2
    s_add_u32 s31, s31, s20
    s_mul_hi_u32 s32, s31, 0x12492493
    s_mul_i32 s33, s32, 14
    s_sub_u32 s35, s31, s33
    s_mul_i32 s36, s32, 1792
    s_lshl_b32 s37, s35, 5
    s_add_u32 s36, s36, s37
    s_add_u32 s36, s36, 448
    v_add_u32 v5, s36, v4
    s_movk_i32 s37, 896
    v_mul_lo_u32 v5, v5, s37
    v_lshl_add_u32 v5, v3, 4, v5
    v_lshlrev_b32 v15, 4, v0
    s_mul_i32 s39, s30, 28672
    s_add_u32 s37, s39, 0
    buffer_load_dwordx4 v[16:19], v15, s[12:15], s37 offen
    s_add_u32 s37, s39, 4096
    buffer_load_dwordx4 v[20:23], v15, s[12:15], s37 offen
    s_add_u32 s37, s39, 8192
    buffer_load_dwordx4 v[24:27], v15, s[12:15], s37 offen
    s_add_u32 s37, s39, 12288
    buffer_load_dwordx4 v[28:31], v15, s[12:15], s37 offen
    s_add_u32 s37, s39, 16384
    buffer_load_dwordx4 v[32:35], v15, s[12:15], s37 offen
    s_add_u32 s37, s39, 20480
    buffer_load_dwordx4 v[36:39], v15, s[12:15], s37 offen
    s_add_u32 s37, s39, 24576
    buffer_load_dwordx4 v[40:43], v15, s[12:15], s37 offen
    s_add_u32 s39, s39, 229376
    s_add_u32 s37, s39, 0
    buffer_load_dwordx4 v[44:47], v15, s[12:15], s37 offen
    s_add_u32 s37, s39, 4096
    buffer_load_dwordx4 v[48:51], v15, s[12:15], s37 offen
    s_add_u32 s37, s39, 8192
    buffer_load_dwordx4 v[52:55], v15, s[12:15], s37 offen
    s_add_u32 s37, s39, 12288
    buffer_load_dwordx4 v[56:59], v15, s[12:15], s37 offen
    s_add_u32 s37, s39, 16384
    buffer_load_dwordx4 v[60:63], v15, s[12:15], s37 offen
    s_add_u32 s37, s39, 20480
    buffer_load_dwordx4 v[64:67], v15, s[12:15], s37 offen
    s_add_u32 s37, s39, 24576
    buffer_load_dwordx4 v[68:71], v15, s[12:15], s37 offen
    s_add_u32 s39, s39, 229376
    s_mov_b32 s37, 0
    buffer_load_dwordx4 a[0:3], v5, s[16:19], s37 offen offset:0
    buffer_load_dwordx4 a[4:7], v5, s[16:19], s37 offen offset:64
    buffer_load_dwordx4 a[8:11], v5, s[16:19], s37 offen offset:128
    buffer_load_dwordx4 a[12:15], v5, s[16:19], s37 offen offset:192
    buffer_load_dwordx4 a[16:19], v5, s[16:19], s37 offen offset:256
    buffer_load_dwordx4 a[20:23], v5, s[16:19], s37 offen offset:320
    buffer_load_dwordx4 a[24:27], v5, s[16:19], s37 offen offset:384
    buffer_load_dwordx4 a[28:31], v5, s[16:19], s37 offen offset:448
    buffer_load_dwordx4 a[32:35], v5, s[16:19], s37 offen offset:512
    buffer_load_dwordx4 a[36:39], v5, s[16:19], s37 offen offset:576
    buffer_load_dwordx4 a[40:43], v5, s[16:19], s37 offen offset:640
    buffer_load_dwordx4 a[44:47], v5, s[16:19], s37 offen offset:704
    buffer_load_dwordx4 a[48:51], v5, s[16:19], s37 offen offset:768
    buffer_load_dwordx4 a[52:55], v5, s[16:19], s37 offen offset:832
    s_mov_b32 s37, 14336
    buffer_load_dwordx4 a[56:59], v5, s[16:19], s37 offen offset:0
    buffer_load_dwordx4 a[60:63], v5, s[16:19], s37 offen offset:64
    buffer_load_dwordx4 a[64:67], v5, s[16:19], s37 offen offset:128
    buffer_load_dwordx4 a[68:71], v5, s[16:19], s37 offen offset:192
    buffer_load_dwordx4 a[72:75], v5, s[16:19], s37 offen offset:256
    buffer_load_dwordx4 a[76:79], v5, s[16:19], s37 offen offset:320
    buffer_load_dwordx4 a[80:83], v5, s[16:19], s37 offen offset:384
    buffer_load_dwordx4 a[84:87], v5, s[16:19], s37 offen offset:448
    buffer_load_dwordx4 a[88:91], v5, s[16:19], s37 offen offset:512
    buffer_load_dwordx4 a[92:95], v5, s[16:19], s37 offen offset:576
    buffer_load_dwordx4 a[96:99], v5, s[16:19], s37 offen offset:640
    buffer_load_dwordx4 a[100:103], v5, s[16:19], s37 offen offset:704
    buffer_load_dwordx4 a[104:107], v5, s[16:19], s37 offen offset:768
    buffer_load_dwordx4 a[108:111], v5, s[16:19], s37 offen offset:832
    s_mov_b32 s37, 802816
    buffer_load_dwordx4 a[112:115], v5, s[16:19], s37 offen offset:0
    buffer_load_dwordx4 a[116:119], v5, s[16:19], s37 offen offset:64
    buffer_load_dwordx4 a[120:123], v5, s[16:19], s37 offen offset:128
    buffer_load_dwordx4 a[124:127], v5, s[16:19], s37 offen offset:192
    buffer_load_dwordx4 a[128:131], v5, s[16:19], s37 offen offset:256
    buffer_load_dwordx4 a[132:135], v5, s[16:19], s37 offen offset:320
    buffer_load_dwordx4 a[136:139], v5, s[16:19], s37 offen offset:384
    buffer_load_dwordx4 a[140:143], v5, s[16:19], s37 offen offset:448
    buffer_load_dwordx4 a[144:147], v5, s[16:19], s37 offen offset:512
    buffer_load_dwordx4 a[148:151], v5, s[16:19], s37 offen offset:576
    buffer_load_dwordx4 a[152:155], v5, s[16:19], s37 offen offset:640
    buffer_load_dwordx4 a[156:159], v5, s[16:19], s37 offen offset:704
    buffer_load_dwordx4 a[160:163], v5, s[16:19], s37 offen offset:768
    buffer_load_dwordx4 a[164:167], v5, s[16:19], s37 offen offset:832
    s_mov_b32 s37, 817152
    buffer_load_dwordx4 a[168:171], v5, s[16:19], s37 offen offset:0
    buffer_load_dwordx4 a[172:175], v5, s[16:19], s37 offen offset:64
    buffer_load_dwordx4 a[176:179], v5, s[16:19], s37 offen offset:128
    buffer_load_dwordx4 a[180:183], v5, s[16:19], s37 offen offset:192
    buffer_load_dwordx4 a[184:187], v5, s[16:19], s37 offen offset:256
    buffer_load_dwordx4 a[188:191], v5, s[16:19], s37 offen offset:320
    buffer_load_dwordx4 a[192:195], v5, s[16:19], s37 offen offset:384
    buffer_load_dwordx4 a[196:199], v5, s[16:19], s37 offen offset:448
    buffer_load_dwordx4 a[200:203], v5, s[16:19], s37 offen offset:512
    buffer_load_dwordx4 a[204:207], v5, s[16:19], s37 offen offset:576
    buffer_load_dwordx4 a[208:211], v5, s[16:19], s37 offen offset:640
    buffer_load_dwordx4 a[212:215], v5, s[16:19], s37 offen offset:704
    buffer_load_dwordx4 a[216:219], v5, s[16:19], s37 offen offset:768
    buffer_load_dwordx4 a[220:223], v5, s[16:19], s37 offen offset:832
    v_add_u32 v6, 0, v0
    s_mov_b32 s37, 0x04924925
    v_mul_hi_u32 v7, v6, s37
    v_mul_u32_u24 v8, 56, v7
    v_sub_u32 v6, v6, v8
    v_mul_u32_u24 v8, 912, v7
    v_lshl_add_u32 v8, v6, 4, v8
    v_add_u32 v6, 256, v0
    s_mov_b32 s37, 0x04924925
    v_mul_hi_u32 v7, v6, s37
    v_mul_u32_u24 v9, 56, v7
    v_sub_u32 v6, v6, v9
    v_mul_u32_u24 v9, 912, v7
    v_lshl_add_u32 v9, v6, 4, v9
    v_add_u32 v6, 512, v0
    s_mov_b32 s37, 0x04924925
    v_mul_hi_u32 v7, v6, s37
    v_mul_u32_u24 v10, 56, v7
    v_sub_u32 v6, v6, v10
    v_mul_u32_u24 v10, 912, v7
    v_lshl_add_u32 v10, v6, 4, v10
    v_add_u32 v6, 768, v0
    s_mov_b32 s37, 0x04924925
    v_mul_hi_u32 v7, v6, s37
    v_mul_u32_u24 v11, 56, v7
    v_sub_u32 v6, v6, v11
    v_mul_u32_u24 v11, 912, v7
    v_lshl_add_u32 v11, v6, 4, v11
    v_add_u32 v6, 1024, v0
    s_mov_b32 s37, 0x04924925
    v_mul_hi_u32 v7, v6, s37
    v_mul_u32_u24 v12, 56, v7
    v_sub_u32 v6, v6, v12
    v_mul_u32_u24 v12, 912, v7
    v_lshl_add_u32 v12, v6, 4, v12
    v_add_u32 v6, 1280, v0
    s_mov_b32 s37, 0x04924925
    v_mul_hi_u32 v7, v6, s37
    v_mul_u32_u24 v13, 56, v7
    v_sub_u32 v6, v6, v13
    v_mul_u32_u24 v13, 912, v7
    v_lshl_add_u32 v13, v6, 4, v13
    v_add_u32 v6, 1536, v0
    s_mov_b32 s37, 0x04924925
    v_mul_hi_u32 v7, v6, s37
    v_mul_u32_u24 v14, 56, v7
    v_sub_u32 v6, v6, v14
    v_mul_u32_u24 v14, 912, v7
    v_lshl_add_u32 v14, v6, 4, v14
    v_mul_u32_u24 v6, 912, v4
    v_lshl_add_u32 v6, v3, 4, v6
    v_lshlrev_b32 v7, 5, v1
    v_mul_u32_u24 v2, 896, v4
    v_lshl_add_u32 v2, v3, 4, v2
    s_lshl_b32 s37, s35, 6
    v_add_u32 v2, s37, v2
    s_mov_b32 s40, 0
    s_mov_b32 s41, 0
    s_mov_b32 s42, s30
    s_barrier
    s_waitcnt vmcnt(63)
    v_add_u32 v5, s41, v8
    ds_write_b128 v5, v[16:19]
    v_add_u32 v5, s41, v9
    ds_write_b128 v5, v[20:23]
    v_add_u32 v5, s41, v10
    ds_write_b128 v5, v[24:27]
    v_add_u32 v5, s41, v11
    ds_write_b128 v5, v[28:31]
    v_add_u32 v5, s41, v12
    ds_write_b128 v5, v[32:35]
    v_add_u32 v5, s41, v13
    ds_write_b128 v5, v[36:39]
    v_add_u32 v5, s41, v14
    ds_write_b128 v5, v[40:43]
    s_waitcnt vmcnt(0) lgkmcnt(0)
    s_barrier
L_gemm_loop_wu:
    s_add_u32 s37, s39, 0
    buffer_load_dwordx4 v[16:19], v15, s[12:15], s37 offen
    s_add_u32 s37, s39, 4096
    buffer_load_dwordx4 v[20:23], v15, s[12:15], s37 offen
    s_add_u32 s37, s39, 8192
    buffer_load_dwordx4 v[24:27], v15, s[12:15], s37 offen
    s_add_u32 s37, s39, 12288
    buffer_load_dwordx4 v[28:31], v15, s[12:15], s37 offen
    s_add_u32 s37, s39, 16384
    buffer_load_dwordx4 v[32:35], v15, s[12:15], s37 offen
    s_add_u32 s37, s39, 20480
    buffer_load_dwordx4 v[36:39], v15, s[12:15], s37 offen
    s_add_u32 s37, s39, 24576
    buffer_load_dwordx4 v[40:43], v15, s[12:15], s37 offen
    s_add_u32 s39, s39, 229376
    v_add_u32 v5, s41, v6
    ds_read_b128 v[72:75], v5 offset:0
    ds_read_b128 v[76:79], v5 offset:14592
    ds_read_b128 v[80:83], v5 offset:64
    ds_read_b128 v[84:87], v5 offset:14656
    s_waitcnt lgkmcnt(2)
    v_mfma_f32_16x16x32_bf16 v[88:91], v[72:75], a[0:3], 0
    v_mfma_f32_16x16x32_bf16 v[92:95], v[72:75], a[56:59], 0
    v_mfma_f32_16x16x32_bf16 v[96:99], v[72:75], a[112:115], 0
    v_mfma_f32_16x16x32_bf16 v[100:103], v[72:75], a[168:171], 0
    v_mfma_f32_16x16x32_bf16 v[104:107], v[76:79], a[0:3], 0
    v_mfma_f32_16x16x32_bf16 v[108:111], v[76:79], a[56:59], 0
    v_mfma_f32_16x16x32_bf16 v[112:115], v[76:79], a[112:115], 0
    v_mfma_f32_16x16x32_bf16 v[116:119], v[76:79], a[168:171], 0
    ds_read_b128 v[72:75], v5 offset:128
    ds_read_b128 v[76:79], v5 offset:14720
    s_waitcnt lgkmcnt(2)
    v_mfma_f32_16x16x32_bf16 v[88:91], v[80:83], a[4:7], v[88:91]
    v_mfma_f32_16x16x32_bf16 v[92:95], v[80:83], a[60:63], v[92:95]
    v_mfma_f32_16x16x32_bf16 v[96:99], v[80:83], a[116:119], v[96:99]
    v_mfma_f32_16x16x32_bf16 v[100:103], v[80:83], a[172:175], v[100:103]
    v_mfma_f32_16x16x32_bf16 v[104:107], v[84:87], a[4:7], v[104:107]
    v_mfma_f32_16x16x32_bf16 v[108:111], v[84:87], a[60:63], v[108:111]
    v_mfma_f32_16x16x32_bf16 v[112:115], v[84:87], a[116:119], v[112:115]
    v_mfma_f32_16x16x32_bf16 v[116:119], v[84:87], a[172:175], v[116:119]
    ds_read_b128 v[80:83], v5 offset:192
    ds_read_b128 v[84:87], v5 offset:14784
    s_waitcnt lgkmcnt(2)
    v_mfma_f32_16x16x32_bf16 v[88:91], v[72:75], a[8:11], v[88:91]
    v_mfma_f32_16x16x32_bf16 v[92:95], v[72:75], a[64:67], v[92:95]
    v_mfma_f32_16x16x32_bf16 v[96:99], v[72:75], a[120:123], v[96:99]
    v_mfma_f32_16x16x32_bf16 v[100:103], v[72:75], a[176:179], v[100:103]
    v_mfma_f32_16x16x32_bf16 v[104:107], v[76:79], a[8:11], v[104:107]
    v_mfma_f32_16x16x32_bf16 v[108:111], v[76:79], a[64:67], v[108:111]
    v_mfma_f32_16x16x32_bf16 v[112:115], v[76:79], a[120:123], v[112:115]
    v_mfma_f32_16x16x32_bf16 v[116:119], v[76:79], a[176:179], v[116:119]
    ds_read_b128 v[72:75], v5 offset:256
    ds_read_b128 v[76:79], v5 offset:14848
    s_waitcnt lgkmcnt(2)
    v_mfma_f32_16x16x32_bf16 v[88:91], v[80:83], a[12:15], v[88:91]
    v_mfma_f32_16x16x32_bf16 v[92:95], v[80:83], a[68:71], v[92:95]
    v_mfma_f32_16x16x32_bf16 v[96:99], v[80:83], a[124:127], v[96:99]
    v_mfma_f32_16x16x32_bf16 v[100:103], v[80:83], a[180:183], v[100:103]
    v_mfma_f32_16x16x32_bf16 v[104:107], v[84:87], a[12:15], v[104:107]
    v_mfma_f32_16x16x32_bf16 v[108:111], v[84:87], a[68:71], v[108:111]
    v_mfma_f32_16x16x32_bf16 v[112:115], v[84:87], a[124:127], v[112:115]
    v_mfma_f32_16x16x32_bf16 v[116:119], v[84:87], a[180:183], v[116:119]
    ds_read_b128 v[80:83], v5 offset:320
    ds_read_b128 v[84:87], v5 offset:14912
    s_waitcnt lgkmcnt(2)
    v_mfma_f32_16x16x32_bf16 v[88:91], v[72:75], a[16:19], v[88:91]
    v_mfma_f32_16x16x32_bf16 v[92:95], v[72:75], a[72:75], v[92:95]
    v_mfma_f32_16x16x32_bf16 v[96:99], v[72:75], a[128:131], v[96:99]
    v_mfma_f32_16x16x32_bf16 v[100:103], v[72:75], a[184:187], v[100:103]
    v_mfma_f32_16x16x32_bf16 v[104:107], v[76:79], a[16:19], v[104:107]
    v_mfma_f32_16x16x32_bf16 v[108:111], v[76:79], a[72:75], v[108:111]
    v_mfma_f32_16x16x32_bf16 v[112:115], v[76:79], a[128:131], v[112:115]
    v_mfma_f32_16x16x32_bf16 v[116:119], v[76:79], a[184:187], v[116:119]
    ds_read_b128 v[72:75], v5 offset:384
    ds_read_b128 v[76:79], v5 offset:14976
    s_waitcnt lgkmcnt(2)
    v_mfma_f32_16x16x32_bf16 v[88:91], v[80:83], a[20:23], v[88:91]
    v_mfma_f32_16x16x32_bf16 v[92:95], v[80:83], a[76:79], v[92:95]
    v_mfma_f32_16x16x32_bf16 v[96:99], v[80:83], a[132:135], v[96:99]
    v_mfma_f32_16x16x32_bf16 v[100:103], v[80:83], a[188:191], v[100:103]
    v_mfma_f32_16x16x32_bf16 v[104:107], v[84:87], a[20:23], v[104:107]
    v_mfma_f32_16x16x32_bf16 v[108:111], v[84:87], a[76:79], v[108:111]
    v_mfma_f32_16x16x32_bf16 v[112:115], v[84:87], a[132:135], v[112:115]
    v_mfma_f32_16x16x32_bf16 v[116:119], v[84:87], a[188:191], v[116:119]
    ds_read_b128 v[80:83], v5 offset:448
    ds_read_b128 v[84:87], v5 offset:15040
    s_waitcnt lgkmcnt(2)
    v_mfma_f32_16x16x32_bf16 v[88:91], v[72:75], a[24:27], v[88:91]
    v_mfma_f32_16x16x32_bf16 v[92:95], v[72:75], a[80:83], v[92:95]
    v_mfma_f32_16x16x32_bf16 v[96:99], v[72:75], a[136:139], v[96:99]
    v_mfma_f32_16x16x32_bf16 v[100:103], v[72:75], a[192:195], v[100:103]
    v_mfma_f32_16x16x32_bf16 v[104:107], v[76:79], a[24:27], v[104:107]
    v_mfma_f32_16x16x32_bf16 v[108:111], v[76:79], a[80:83], v[108:111]
    v_mfma_f32_16x16x32_bf16 v[112:115], v[76:79], a[136:139], v[112:115]
    v_mfma_f32_16x16x32_bf16 v[116:119], v[76:79], a[192:195], v[116:119]
    ds_read_b128 v[72:75], v5 offset:512
    ds_read_b128 v[76:79], v5 offset:15104
    s_waitcnt lgkmcnt(2)
    v_mfma_f32_16x16x32_bf16 v[88:91], v[80:83], a[28:31], v[88:91]
    v_mfma_f32_16x16x32_bf16 v[92:95], v[80:83], a[84:87], v[92:95]
    v_mfma_f32_16x16x32_bf16 v[96:99], v[80:83], a[140:143], v[96:99]
    v_mfma_f32_16x16x32_bf16 v[100:103], v[80:83], a[196:199], v[100:103]
    v_mfma_f32_16x16x32_bf16 v[104:107], v[84:87], a[28:31], v[104:107]
    v_mfma_f32_16x16x32_bf16 v[108:111], v[84:87], a[84:87], v[108:111]
    v_mfma_f32_16x16x32_bf16 v[112:115], v[84:87], a[140:143], v[112:115]
    v_mfma_f32_16x16x32_bf16 v[116:119], v[84:87], a[196:199], v[116:119]
    ds_read_b128 v[80:83], v5 offset:576
    ds_read_b128 v[84:87], v5 offset:15168
    s_waitcnt lgkmcnt(2)
    v_mfma_f32_16x16x32_bf16 v[88:91], v[72:75], a[32:35], v[88:91]
    v_mfma_f32_16x16x32_bf16 v[92:95], v[72:75], a[88:91], v[92:95]
    v_mfma_f32_16x16x32_bf16 v[96:99], v[72:75], a[144:147], v[96:99]
    v_mfma_f32_16x16x32_bf16 v[100:103], v[72:75], a[200:203], v[100:103]
    v_mfma_f32_16x16x32_bf16 v[104:107], v[76:79], a[32:35], v[104:107]
    v_mfma_f32_16x16x32_bf16 v[108:111], v[76:79], a[88:91], v[108:111]
    v_mfma_f32_16x16x32_bf16 v[112:115], v[76:79], a[144:147], v[112:115]
    v_mfma_f32_16x16x32_bf16 v[116:119], v[76:79], a[200:203], v[116:119]
    ds_read_b128 v[72:75], v5 offset:640
    ds_read_b128 v[76:79], v5 offset:15232
    s_waitcnt lgkmcnt(2)
    v_mfma_f32_16x16x32_bf16 v[88:91], v[80:83], a[36:39], v[88:91]
    v_mfma_f32_16x16x32_bf16 v[92:95], v[80:83], a[92:95], v[92:95]
    v_mfma_f32_16x16x32_bf16 v[96:99], v[80:83], a[148:151], v[96:99]
    v_mfma_f32_16x16x32_bf16 v[100:103], v[80:83], a[204:207], v[100:103]
    v_mfma_f32_16x16x32_bf16 v[104:107], v[84:87], a[36:39], v[104:107]
    v_mfma_f32_16x16x32_bf16 v[108:111], v[84:87], a[92:95], v[108:111]
    v_mfma_f32_16x16x32_bf16 v[112:115], v[84:87], a[148:151], v[112:115]
    v_mfma_f32_16x16x32_bf16 v[116:119], v[84:87], a[204:207], v[116:119]
    ds_read_b128 v[80:83], v5 offset:704
    ds_read_b128 v[84:87], v5 offset:15296
    s_waitcnt lgkmcnt(2)
    v_mfma_f32_16x16x32_bf16 v[88:91], v[72:75], a[40:43], v[88:91]
    v_mfma_f32_16x16x32_bf16 v[92:95], v[72:75], a[96:99], v[92:95]
    v_mfma_f32_16x16x32_bf16 v[96:99], v[72:75], a[152:155], v[96:99]
    v_mfma_f32_16x16x32_bf16 v[100:103], v[72:75], a[208:211], v[100:103]
    v_mfma_f32_16x16x32_bf16 v[104:107], v[76:79], a[40:43], v[104:107]
    v_mfma_f32_16x16x32_bf16 v[108:111], v[76:79], a[96:99], v[108:111]
    v_mfma_f32_16x16x32_bf16 v[112:115], v[76:79], a[152:155], v[112:115]
    v_mfma_f32_16x16x32_bf16 v[116:119], v[76:79], a[208:211], v[116:119]
    ds_read_b128 v[72:75], v5 offset:768
    ds_read_b128 v[76:79], v5 offset:15360
    s_waitcnt lgkmcnt(2)
    v_mfma_f32_16x16x32_bf16 v[88:91], v[80:83], a[44:47], v[88:91]
    v_mfma_f32_16x16x32_bf16 v[92:95], v[80:83], a[100:103], v[92:95]
    v_mfma_f32_16x16x32_bf16 v[96:99], v[80:83], a[156:159], v[96:99]
    v_mfma_f32_16x16x32_bf16 v[100:103], v[80:83], a[212:215], v[100:103]
    v_mfma_f32_16x16x32_bf16 v[104:107], v[84:87], a[44:47], v[104:107]
    v_mfma_f32_16x16x32_bf16 v[108:111], v[84:87], a[100:103], v[108:111]
    v_mfma_f32_16x16x32_bf16 v[112:115], v[84:87], a[156:159], v[112:115]
    v_mfma_f32_16x16x32_bf16 v[116:119], v[84:87], a[212:215], v[116:119]
    ds_read_b128 v[80:83], v5 offset:832
    ds_read_b128 v[84:87], v5 offset:15424
    s_waitcnt lgkmcnt(2)
    v_mfma_f32_16x16x32_bf16 v[88:91], v[72:75], a[48:51], v[88:91]
    v_mfma_f32_16x16x32_bf16 v[92:95], v[72:75], a[104:107], v[92:95]
    v_mfma_f32_16x16x32_bf16 v[96:99], v[72:75], a[160:163], v[96:99]
    v_mfma_f32_16x16x32_bf16 v[100:103], v[72:75], a[216:219], v[100:103]
    v_mfma_f32_16x16x32_bf16 v[104:107], v[76:79], a[48:51], v[104:107]
    v_mfma_f32_16x16x32_bf16 v[108:111], v[76:79], a[104:107], v[108:111]
    v_mfma_f32_16x16x32_bf16 v[112:115], v[76:79], a[160:163], v[112:115]
    v_mfma_f32_16x16x32_bf16 v[116:119], v[76:79], a[216:219], v[116:119]
    s_waitcnt lgkmcnt(0)
    v_mfma_f32_16x16x32_bf16 v[88:91], v[80:83], a[52:55], v[88:91]
    v_mfma_f32_16x16x32_bf16 v[92:95], v[80:83], a[108:111], v[92:95]
    v_mfma_f32_16x16x32_bf16 v[96:99], v[80:83], a[164:167], v[96:99]
    v_mfma_f32_16x16x32_bf16 v[100:103], v[80:83], a[220:223], v[100:103]
    v_mfma_f32_16x16x32_bf16 v[104:107], v[84:87], a[52:55], v[104:107]
    v_mfma_f32_16x16x32_bf16 v[108:111], v[84:87], a[108:111], v[108:111]
    v_mfma_f32_16x16x32_bf16 v[112:115], v[84:87], a[164:167], v[112:115]
    v_mfma_f32_16x16x32_bf16 v[116:119], v[84:87], a[220:223], v[116:119]
    s_waitcnt vmcnt(11)
    s_xor_b32 s41, s41, 29184
    v_add_u32 v5, s41, v8
    ds_write_b128 v5, v[44:47]
    v_add_u32 v5, s41, v9
    ds_write_b128 v5, v[48:51]
    v_add_u32 v5, s41, v10
    ds_write_b128 v5, v[52:55]
    v_add_u32 v5, s41, v11
    ds_write_b128 v5, v[56:59]
    v_add_u32 v5, s41, v12
    ds_write_b128 v5, v[60:63]
    v_add_u32 v5, s41, v13
    ds_write_b128 v5, v[64:67]
    v_add_u32 v5, s41, v14
    ds_write_b128 v5, v[68:71]
    s_mul_i32 s38, s42, 28
    s_lshl_b32 s37, s35, 1
    s_add_u32 s38, s38, s37
    s_lshl_b32 s38, s38, 3
    s_add_u32 s38, s38, s32
    s_lshl_b32 s38, s38, 11
    s_add_u32 s38, s38, 16777216
    v_cvt_pk_bf16_f32 v120, v88, v89
    v_cvt_pk_bf16_f32 v121, v96, v97
    v_cvt_pk_bf16_f32 v122, v90, v91
    v_cvt_pk_bf16_f32 v123, v98, v99
    buffer_store_dwordx4 v[120:123], v7, s[16:19], s38 offen offset:0 sc1
    v_cvt_pk_bf16_f32 v124, v104, v105
    v_cvt_pk_bf16_f32 v125, v112, v113
    v_cvt_pk_bf16_f32 v126, v106, v107
    v_cvt_pk_bf16_f32 v127, v114, v115
    buffer_store_dwordx4 v[124:127], v7, s[16:19], s38 offen offset:16 sc1
    s_add_u32 s38, s38, 16384
    v_cvt_pk_bf16_f32 v128, v92, v93
    v_cvt_pk_bf16_f32 v129, v100, v101
    v_cvt_pk_bf16_f32 v130, v94, v95
    v_cvt_pk_bf16_f32 v131, v102, v103
    buffer_store_dwordx4 v[128:131], v7, s[16:19], s38 offen offset:0 sc1
    v_cvt_pk_bf16_f32 v132, v108, v109
    v_cvt_pk_bf16_f32 v133, v116, v117
    v_cvt_pk_bf16_f32 v134, v110, v111
    v_cvt_pk_bf16_f32 v135, v118, v119
    buffer_store_dwordx4 v[132:135], v7, s[16:19], s38 offen offset:16 sc1
    s_cmp_eq_u32 s40, 0
    s_cbranch_scc1 L_gemm_f0_wu
    s_waitcnt vmcnt(11)
    s_lshl_b32 s37, s42, 7
    s_add_u32 s37, s37, 100801536
    s_branch L_gemm_j0_wu
L_gemm_f0_wu:
    s_waitcnt vmcnt(0)
    s_lshl_b32 s37, s42, 7
    s_add_u32 s37, s37, 100802560
L_gemm_j0_wu:
    s_waitcnt lgkmcnt(0)
    s_barrier
    s_cmp_eq_u32 s40, 1
    s_cbranch_scc1 L_gemm_n0_wu
    s_cmp_lg_u32 s20, 0
    s_cbranch_scc1 L_gemm_n0_wu
    v_mov_b32 v72, 1
    v_mov_b32 v73, 0
    s_mov_b64 exec, 1
    buffer_atomic_add v72, v73, s[16:19], s37 offen sc1
    s_mov_b64 exec, -1
L_gemm_n0_wu:
    s_add_u32 s42, s42, 8
    s_add_u32 s40, s40, 1
    s_add_u32 s37, s39, 0
    buffer_load_dwordx4 v[44:47], v15, s[12:15], s37 offen
    s_add_u32 s37, s39, 4096
    buffer_load_dwordx4 v[48:51], v15, s[12:15], s37 offen
    s_add_u32 s37, s39, 8192
    buffer_load_dwordx4 v[52:55], v15, s[12:15], s37 offen
    s_add_u32 s37, s39, 12288
    buffer_load_dwordx4 v[56:59], v15, s[12:15], s37 offen
    s_add_u32 s37, s39, 16384
    buffer_load_dwordx4 v[60:63], v15, s[12:15], s37 offen
    s_add_u32 s37, s39, 20480
    buffer_load_dwordx4 v[64:67], v15, s[12:15], s37 offen
    s_add_u32 s37, s39, 24576
    buffer_load_dwordx4 v[68:71], v15, s[12:15], s37 offen
    s_add_u32 s39, s39, 229376
    v_add_u32 v5, s41, v6
    ds_read_b128 v[72:75], v5 offset:0
    ds_read_b128 v[76:79], v5 offset:14592
    ds_read_b128 v[80:83], v5 offset:64
    ds_read_b128 v[84:87], v5 offset:14656
    s_waitcnt lgkmcnt(2)
    v_mfma_f32_16x16x32_bf16 v[88:91], v[72:75], a[0:3], 0
    v_mfma_f32_16x16x32_bf16 v[92:95], v[72:75], a[56:59], 0
    v_mfma_f32_16x16x32_bf16 v[96:99], v[72:75], a[112:115], 0
    v_mfma_f32_16x16x32_bf16 v[100:103], v[72:75], a[168:171], 0
    v_mfma_f32_16x16x32_bf16 v[104:107], v[76:79], a[0:3], 0
    v_mfma_f32_16x16x32_bf16 v[108:111], v[76:79], a[56:59], 0
    v_mfma_f32_16x16x32_bf16 v[112:115], v[76:79], a[112:115], 0
    v_mfma_f32_16x16x32_bf16 v[116:119], v[76:79], a[168:171], 0
    ds_read_b128 v[72:75], v5 offset:128
    ds_read_b128 v[76:79], v5 offset:14720
    s_waitcnt lgkmcnt(2)
    v_mfma_f32_16x16x32_bf16 v[88:91], v[80:83], a[4:7], v[88:91]
    v_mfma_f32_16x16x32_bf16 v[92:95], v[80:83], a[60:63], v[92:95]
    v_mfma_f32_16x16x32_bf16 v[96:99], v[80:83], a[116:119], v[96:99]
    v_mfma_f32_16x16x32_bf16 v[100:103], v[80:83], a[172:175], v[100:103]
    v_mfma_f32_16x16x32_bf16 v[104:107], v[84:87], a[4:7], v[104:107]
    v_mfma_f32_16x16x32_bf16 v[108:111], v[84:87], a[60:63], v[108:111]
    v_mfma_f32_16x16x32_bf16 v[112:115], v[84:87], a[116:119], v[112:115]
    v_mfma_f32_16x16x32_bf16 v[116:119], v[84:87], a[172:175], v[116:119]
    ds_read_b128 v[80:83], v5 offset:192
    ds_read_b128 v[84:87], v5 offset:14784
    s_waitcnt lgkmcnt(2)
    v_mfma_f32_16x16x32_bf16 v[88:91], v[72:75], a[8:11], v[88:91]
    v_mfma_f32_16x16x32_bf16 v[92:95], v[72:75], a[64:67], v[92:95]
    v_mfma_f32_16x16x32_bf16 v[96:99], v[72:75], a[120:123], v[96:99]
    v_mfma_f32_16x16x32_bf16 v[100:103], v[72:75], a[176:179], v[100:103]
    v_mfma_f32_16x16x32_bf16 v[104:107], v[76:79], a[8:11], v[104:107]
    v_mfma_f32_16x16x32_bf16 v[108:111], v[76:79], a[64:67], v[108:111]
    v_mfma_f32_16x16x32_bf16 v[112:115], v[76:79], a[120:123], v[112:115]
    v_mfma_f32_16x16x32_bf16 v[116:119], v[76:79], a[176:179], v[116:119]
    ds_read_b128 v[72:75], v5 offset:256
    ds_read_b128 v[76:79], v5 offset:14848
    s_waitcnt lgkmcnt(2)
    v_mfma_f32_16x16x32_bf16 v[88:91], v[80:83], a[12:15], v[88:91]
    v_mfma_f32_16x16x32_bf16 v[92:95], v[80:83], a[68:71], v[92:95]
    v_mfma_f32_16x16x32_bf16 v[96:99], v[80:83], a[124:127], v[96:99]
    v_mfma_f32_16x16x32_bf16 v[100:103], v[80:83], a[180:183], v[100:103]
    v_mfma_f32_16x16x32_bf16 v[104:107], v[84:87], a[12:15], v[104:107]
    v_mfma_f32_16x16x32_bf16 v[108:111], v[84:87], a[68:71], v[108:111]
    v_mfma_f32_16x16x32_bf16 v[112:115], v[84:87], a[124:127], v[112:115]
    v_mfma_f32_16x16x32_bf16 v[116:119], v[84:87], a[180:183], v[116:119]
    ds_read_b128 v[80:83], v5 offset:320
    ds_read_b128 v[84:87], v5 offset:14912
    s_waitcnt lgkmcnt(2)
    v_mfma_f32_16x16x32_bf16 v[88:91], v[72:75], a[16:19], v[88:91]
    v_mfma_f32_16x16x32_bf16 v[92:95], v[72:75], a[72:75], v[92:95]
    v_mfma_f32_16x16x32_bf16 v[96:99], v[72:75], a[128:131], v[96:99]
    v_mfma_f32_16x16x32_bf16 v[100:103], v[72:75], a[184:187], v[100:103]
    v_mfma_f32_16x16x32_bf16 v[104:107], v[76:79], a[16:19], v[104:107]
    v_mfma_f32_16x16x32_bf16 v[108:111], v[76:79], a[72:75], v[108:111]
    v_mfma_f32_16x16x32_bf16 v[112:115], v[76:79], a[128:131], v[112:115]
    v_mfma_f32_16x16x32_bf16 v[116:119], v[76:79], a[184:187], v[116:119]
    ds_read_b128 v[72:75], v5 offset:384
    ds_read_b128 v[76:79], v5 offset:14976
    s_waitcnt lgkmcnt(2)
    v_mfma_f32_16x16x32_bf16 v[88:91], v[80:83], a[20:23], v[88:91]
    v_mfma_f32_16x16x32_bf16 v[92:95], v[80:83], a[76:79], v[92:95]
    v_mfma_f32_16x16x32_bf16 v[96:99], v[80:83], a[132:135], v[96:99]
    v_mfma_f32_16x16x32_bf16 v[100:103], v[80:83], a[188:191], v[100:103]
    v_mfma_f32_16x16x32_bf16 v[104:107], v[84:87], a[20:23], v[104:107]
    v_mfma_f32_16x16x32_bf16 v[108:111], v[84:87], a[76:79], v[108:111]
    v_mfma_f32_16x16x32_bf16 v[112:115], v[84:87], a[132:135], v[112:115]
    v_mfma_f32_16x16x32_bf16 v[116:119], v[84:87], a[188:191], v[116:119]
    ds_read_b128 v[80:83], v5 offset:448
    ds_read_b128 v[84:87], v5 offset:15040
    s_waitcnt lgkmcnt(2)
    v_mfma_f32_16x16x32_bf16 v[88:91], v[72:75], a[24:27], v[88:91]
    v_mfma_f32_16x16x32_bf16 v[92:95], v[72:75], a[80:83], v[92:95]
    v_mfma_f32_16x16x32_bf16 v[96:99], v[72:75], a[136:139], v[96:99]
    v_mfma_f32_16x16x32_bf16 v[100:103], v[72:75], a[192:195], v[100:103]
    v_mfma_f32_16x16x32_bf16 v[104:107], v[76:79], a[24:27], v[104:107]
    v_mfma_f32_16x16x32_bf16 v[108:111], v[76:79], a[80:83], v[108:111]
    v_mfma_f32_16x16x32_bf16 v[112:115], v[76:79], a[136:139], v[112:115]
    v_mfma_f32_16x16x32_bf16 v[116:119], v[76:79], a[192:195], v[116:119]
    ds_read_b128 v[72:75], v5 offset:512
    ds_read_b128 v[76:79], v5 offset:15104
    s_waitcnt lgkmcnt(2)
    v_mfma_f32_16x16x32_bf16 v[88:91], v[80:83], a[28:31], v[88:91]
    v_mfma_f32_16x16x32_bf16 v[92:95], v[80:83], a[84:87], v[92:95]
    v_mfma_f32_16x16x32_bf16 v[96:99], v[80:83], a[140:143], v[96:99]
    v_mfma_f32_16x16x32_bf16 v[100:103], v[80:83], a[196:199], v[100:103]
    v_mfma_f32_16x16x32_bf16 v[104:107], v[84:87], a[28:31], v[104:107]
    v_mfma_f32_16x16x32_bf16 v[108:111], v[84:87], a[84:87], v[108:111]
    v_mfma_f32_16x16x32_bf16 v[112:115], v[84:87], a[140:143], v[112:115]
    v_mfma_f32_16x16x32_bf16 v[116:119], v[84:87], a[196:199], v[116:119]
    ds_read_b128 v[80:83], v5 offset:576
    ds_read_b128 v[84:87], v5 offset:15168
    s_waitcnt lgkmcnt(2)
    v_mfma_f32_16x16x32_bf16 v[88:91], v[72:75], a[32:35], v[88:91]
    v_mfma_f32_16x16x32_bf16 v[92:95], v[72:75], a[88:91], v[92:95]
    v_mfma_f32_16x16x32_bf16 v[96:99], v[72:75], a[144:147], v[96:99]
    v_mfma_f32_16x16x32_bf16 v[100:103], v[72:75], a[200:203], v[100:103]
    v_mfma_f32_16x16x32_bf16 v[104:107], v[76:79], a[32:35], v[104:107]
    v_mfma_f32_16x16x32_bf16 v[108:111], v[76:79], a[88:91], v[108:111]
    v_mfma_f32_16x16x32_bf16 v[112:115], v[76:79], a[144:147], v[112:115]
    v_mfma_f32_16x16x32_bf16 v[116:119], v[76:79], a[200:203], v[116:119]
    ds_read_b128 v[72:75], v5 offset:640
    ds_read_b128 v[76:79], v5 offset:15232
    s_waitcnt lgkmcnt(2)
    v_mfma_f32_16x16x32_bf16 v[88:91], v[80:83], a[36:39], v[88:91]
    v_mfma_f32_16x16x32_bf16 v[92:95], v[80:83], a[92:95], v[92:95]
    v_mfma_f32_16x16x32_bf16 v[96:99], v[80:83], a[148:151], v[96:99]
    v_mfma_f32_16x16x32_bf16 v[100:103], v[80:83], a[204:207], v[100:103]
    v_mfma_f32_16x16x32_bf16 v[104:107], v[84:87], a[36:39], v[104:107]
    v_mfma_f32_16x16x32_bf16 v[108:111], v[84:87], a[92:95], v[108:111]
    v_mfma_f32_16x16x32_bf16 v[112:115], v[84:87], a[148:151], v[112:115]
    v_mfma_f32_16x16x32_bf16 v[116:119], v[84:87], a[204:207], v[116:119]
    ds_read_b128 v[80:83], v5 offset:704
    ds_read_b128 v[84:87], v5 offset:15296
    s_waitcnt lgkmcnt(2)
    v_mfma_f32_16x16x32_bf16 v[88:91], v[72:75], a[40:43], v[88:91]
    v_mfma_f32_16x16x32_bf16 v[92:95], v[72:75], a[96:99], v[92:95]
    v_mfma_f32_16x16x32_bf16 v[96:99], v[72:75], a[152:155], v[96:99]
    v_mfma_f32_16x16x32_bf16 v[100:103], v[72:75], a[208:211], v[100:103]
    v_mfma_f32_16x16x32_bf16 v[104:107], v[76:79], a[40:43], v[104:107]
    v_mfma_f32_16x16x32_bf16 v[108:111], v[76:79], a[96:99], v[108:111]
    v_mfma_f32_16x16x32_bf16 v[112:115], v[76:79], a[152:155], v[112:115]
    v_mfma_f32_16x16x32_bf16 v[116:119], v[76:79], a[208:211], v[116:119]
    ds_read_b128 v[72:75], v5 offset:768
    ds_read_b128 v[76:79], v5 offset:15360
    s_waitcnt lgkmcnt(2)
    v_mfma_f32_16x16x32_bf16 v[88:91], v[80:83], a[44:47], v[88:91]
    v_mfma_f32_16x16x32_bf16 v[92:95], v[80:83], a[100:103], v[92:95]
    v_mfma_f32_16x16x32_bf16 v[96:99], v[80:83], a[156:159], v[96:99]
    v_mfma_f32_16x16x32_bf16 v[100:103], v[80:83], a[212:215], v[100:103]
    v_mfma_f32_16x16x32_bf16 v[104:107], v[84:87], a[44:47], v[104:107]
    v_mfma_f32_16x16x32_bf16 v[108:111], v[84:87], a[100:103], v[108:111]
    v_mfma_f32_16x16x32_bf16 v[112:115], v[84:87], a[156:159], v[112:115]
    v_mfma_f32_16x16x32_bf16 v[116:119], v[84:87], a[212:215], v[116:119]
    ds_read_b128 v[80:83], v5 offset:832
    ds_read_b128 v[84:87], v5 offset:15424
    s_waitcnt lgkmcnt(2)
    v_mfma_f32_16x16x32_bf16 v[88:91], v[72:75], a[48:51], v[88:91]
    v_mfma_f32_16x16x32_bf16 v[92:95], v[72:75], a[104:107], v[92:95]
    v_mfma_f32_16x16x32_bf16 v[96:99], v[72:75], a[160:163], v[96:99]
    v_mfma_f32_16x16x32_bf16 v[100:103], v[72:75], a[216:219], v[100:103]
    v_mfma_f32_16x16x32_bf16 v[104:107], v[76:79], a[48:51], v[104:107]
    v_mfma_f32_16x16x32_bf16 v[108:111], v[76:79], a[104:107], v[108:111]
    v_mfma_f32_16x16x32_bf16 v[112:115], v[76:79], a[160:163], v[112:115]
    v_mfma_f32_16x16x32_bf16 v[116:119], v[76:79], a[216:219], v[116:119]
    s_waitcnt lgkmcnt(0)
    v_mfma_f32_16x16x32_bf16 v[88:91], v[80:83], a[52:55], v[88:91]
    v_mfma_f32_16x16x32_bf16 v[92:95], v[80:83], a[108:111], v[92:95]
    v_mfma_f32_16x16x32_bf16 v[96:99], v[80:83], a[164:167], v[96:99]
    v_mfma_f32_16x16x32_bf16 v[100:103], v[80:83], a[220:223], v[100:103]
    v_mfma_f32_16x16x32_bf16 v[104:107], v[84:87], a[52:55], v[104:107]
    v_mfma_f32_16x16x32_bf16 v[108:111], v[84:87], a[108:111], v[108:111]
    v_mfma_f32_16x16x32_bf16 v[112:115], v[84:87], a[164:167], v[112:115]
    v_mfma_f32_16x16x32_bf16 v[116:119], v[84:87], a[220:223], v[116:119]
    s_waitcnt vmcnt(11)
    s_xor_b32 s41, s41, 29184
    v_add_u32 v5, s41, v8
    ds_write_b128 v5, v[16:19]
    v_add_u32 v5, s41, v9
    ds_write_b128 v5, v[20:23]
    v_add_u32 v5, s41, v10
    ds_write_b128 v5, v[24:27]
    v_add_u32 v5, s41, v11
    ds_write_b128 v5, v[28:31]
    v_add_u32 v5, s41, v12
    ds_write_b128 v5, v[32:35]
    v_add_u32 v5, s41, v13
    ds_write_b128 v5, v[36:39]
    v_add_u32 v5, s41, v14
    ds_write_b128 v5, v[40:43]
    s_mul_i32 s38, s42, 28
    s_lshl_b32 s37, s35, 1
    s_add_u32 s38, s38, s37
    s_lshl_b32 s38, s38, 3
    s_add_u32 s38, s38, s32
    s_lshl_b32 s38, s38, 11
    s_add_u32 s38, s38, 16777216
    v_cvt_pk_bf16_f32 v136, v88, v89
    v_cvt_pk_bf16_f32 v137, v96, v97
    v_cvt_pk_bf16_f32 v138, v90, v91
    v_cvt_pk_bf16_f32 v139, v98, v99
    buffer_store_dwordx4 v[136:139], v7, s[16:19], s38 offen offset:0 sc1
    v_cvt_pk_bf16_f32 v140, v104, v105
    v_cvt_pk_bf16_f32 v141, v112, v113
    v_cvt_pk_bf16_f32 v142, v106, v107
    v_cvt_pk_bf16_f32 v143, v114, v115
    buffer_store_dwordx4 v[140:143], v7, s[16:19], s38 offen offset:16 sc1
    s_add_u32 s38, s38, 16384
    v_cvt_pk_bf16_f32 v144, v92, v93
    v_cvt_pk_bf16_f32 v145, v100, v101
    v_cvt_pk_bf16_f32 v146, v94, v95
    v_cvt_pk_bf16_f32 v147, v102, v103
    buffer_store_dwordx4 v[144:147], v7, s[16:19], s38 offen offset:0 sc1
    v_cvt_pk_bf16_f32 v148, v108, v109
    v_cvt_pk_bf16_f32 v149, v116, v117
    v_cvt_pk_bf16_f32 v150, v110, v111
    v_cvt_pk_bf16_f32 v151, v118, v119
    buffer_store_dwordx4 v[148:151], v7, s[16:19], s38 offen offset:16 sc1
    s_cmp_eq_u32 s40, 0
    s_cbranch_scc1 L_gemm_f1_wu
    s_waitcnt vmcnt(11)
    s_lshl_b32 s37, s42, 7
    s_add_u32 s37, s37, 100801536
    s_branch L_gemm_j1_wu
L_gemm_f1_wu:
    s_waitcnt vmcnt(0)
    s_lshl_b32 s37, s42, 7
    s_add_u32 s37, s37, 100802560
L_gemm_j1_wu:
    s_waitcnt lgkmcnt(0)
    s_barrier
    s_cmp_eq_u32 s40, 1
    s_cbranch_scc1 L_gemm_n1_wu
    s_cmp_lg_u32 s20, 0
    s_cbranch_scc1 L_gemm_n1_wu
    v_mov_b32 v72, 1
    v_mov_b32 v73, 0
    s_mov_b64 exec, 1
    buffer_atomic_add v72, v73, s[16:19], s37 offen sc1
    s_mov_b64 exec, -1
L_gemm_n1_wu:
    s_add_u32 s42, s42, 8
    s_add_u32 s40, s40, 1
    s_cmp_lt_u32 s40, 8
    s_cbranch_scc1 L_gemm_loop_wu
    s_waitcnt vmcnt(0)
    s_barrier
    s_cmp_lg_u32 s20, 0
    s_cbranch_scc1 L_gemm_nf_wu
    s_lshl_b32 s37, s42, 7
    s_add_u32 s37, s37, 100801536
    v_mov_b32 v72, 1
    v_mov_b32 v73, 0
    s_mov_b64 exec, 1
    buffer_atomic_add v72, v73, s[16:19], s37 offen sc1
    s_mov_b64 exec, -1
L_gemm_nf_wu:
    s_cmp_lg_u32 s20, 0
    s_cbranch_scc1 L_w_nxa
    s_waitcnt vmcnt(0)
    s_mov_b32 s37, 100797184
    v_mov_b32 v16, 1
    v_mov_b32 v17, 0
    s_mov_b64 exec, 1
    buffer_atomic_add v16, v17, s[16:19], s37 offen sc1
    s_mov_b64 exec, -1
L_w_nxa:
    s_and_b32 s30, s21, 7
    s_lshr_b32 s31, s21, 3
    s_lshl_b32 s31, s31, 2
    s_add_u32 s31, s31, s20
    s_mul_hi_u32 s32, s31, 0x12492493
    s_mul_i32 s33, s32, 14
    s_sub_u32 s35, s31, s33
    s_mul_i32 s36, s32, 1792
    s_lshl_b32 s37, s35, 5
    s_add_u32 s36, s36, s37
    s_add_u32 s36, s36, 0
    v_lshrrev_b32 v5, 2, v4
    v_lshlrev_b32 v5, 3, v5
    v_and_b32 v6, 3, v4
    v_add_u32 v5, v5, v6
    v_add_u32 v5, s36, v5
    s_movk_i32 s37, 896
    v_mul_lo_u32 v5, v5, s37
    v_lshl_add_u32 v5, v3, 4, v5
    v_lshlrev_b32 v15, 4, v0
    s_mul_i32 s39, s30, 28672
    s_add_u32 s37, s39, 0
    buffer_load_dwordx4 v[16:19], v15, s[12:15], s37 offen
    s_add_u32 s37, s39, 4096
    buffer_load_dwordx4 v[20:23], v15, s[12:15], s37 offen
    s_add_u32 s37, s39, 8192
    buffer_load_dwordx4 v[24:27], v15, s[12:15], s37 offen
    s_add_u32 s37, s39, 12288
    buffer_load_dwordx4 v[28:31], v15, s[12:15], s37 offen
    s_add_u32 s37, s39, 16384
    buffer_load_dwordx4 v[32:35], v15, s[12:15], s37 offen
    s_add_u32 s37, s39, 20480
    buffer_load_dwordx4 v[36:39], v15, s[12:15], s37 offen
    s_add_u32 s37, s39, 24576
    buffer_load_dwordx4 v[40:43], v15, s[12:15], s37 offen
    s_add_u32 s39, s39, 229376
    s_add_u32 s37, s39, 0
    buffer_load_dwordx4 v[44:47], v15, s[12:15], s37 offen
    s_add_u32 s37, s39, 4096
    buffer_load_dwordx4 v[48:51], v15, s[12:15], s37 offen
    s_add_u32 s37, s39, 8192
    buffer_load_dwordx4 v[52:55], v15, s[12:15], s37 offen
    s_add_u32 s37, s39, 12288
    buffer_load_dwordx4 v[56:59], v15, s[12:15], s37 offen
    s_add_u32 s37, s39, 16384
    buffer_load_dwordx4 v[60:63], v15, s[12:15], s37 offen
    s_add_u32 s37, s39, 20480
    buffer_load_dwordx4 v[64:67], v15, s[12:15], s37 offen
    s_add_u32 s37, s39, 24576
    buffer_load_dwordx4 v[68:71], v15, s[12:15], s37 offen
    s_add_u32 s39, s39, 229376
    s_mov_b32 s37, 0
    buffer_load_dwordx4 a[0:3], v5, s[16:19], s37 offen offset:0
    buffer_load_dwordx4 a[4:7], v5, s[16:19], s37 offen offset:64
    buffer_load_dwordx4 a[8:11], v5, s[16:19], s37 offen offset:128
    buffer_load_dwordx4 a[12:15], v5, s[16:19], s37 offen offset:192
    buffer_load_dwordx4 a[16:19], v5, s[16:19], s37 offen offset:256
    buffer_load_dwordx4 a[20:23], v5, s[16:19], s37 offen offset:320
    buffer_load_dwordx4 a[24:27], v5, s[16:19], s37 offen offset:384
    buffer_load_dwordx4 a[28:31], v5, s[16:19], s37 offen offset:448
    buffer_load_dwordx4 a[32:35], v5, s[16:19], s37 offen offset:512
    buffer_load_dwordx4 a[36:39], v5, s[16:19], s37 offen offset:576
    buffer_load_dwordx4 a[40:43], v5, s[16:19], s37 offen offset:640
    buffer_load_dwordx4 a[44:47], v5, s[16:19], s37 offen offset:704
    buffer_load_dwordx4 a[48:51], v5, s[16:19], s37 offen offset:768
    buffer_load_dwordx4 a[52:55], v5, s[16:19], s37 offen offset:832
    s_mov_b32 s37, 3584
    buffer_load_dwordx4 a[56:59], v5, s[16:19], s37 offen offset:0
    buffer_load_dwordx4 a[60:63], v5, s[16:19], s37 offen offset:64
    buffer_load_dwordx4 a[64:67], v5, s[16:19], s37 offen offset:128
    buffer_load_dwordx4 a[68:71], v5, s[16:19], s37 offen offset:192
    buffer_load_dwordx4 a[72:75], v5, s[16:19], s37 offen offset:256
    buffer_load_dwordx4 a[76:79], v5, s[16:19], s37 offen offset:320
    buffer_load_dwordx4 a[80:83], v5, s[16:19], s37 offen offset:384
    buffer_load_dwordx4 a[84:87], v5, s[16:19], s37 offen offset:448
    buffer_load_dwordx4 a[88:91], v5, s[16:19], s37 offen offset:512
    buffer_load_dwordx4 a[92:95], v5, s[16:19], s37 offen offset:576
    buffer_load_dwordx4 a[96:99], v5, s[16:19], s37 offen offset:640
    buffer_load_dwordx4 a[100:103], v5, s[16:19], s37 offen offset:704
    buffer_load_dwordx4 a[104:107], v5, s[16:19], s37 offen offset:768
    buffer_load_dwordx4 a[108:111], v5, s[16:19], s37 offen offset:832
    s_mov_b32 s37, 802816
    buffer_load_dwordx4 a[112:115], v5, s[16:19], s37 offen offset:0
    buffer_load_dwordx4 a[116:119], v5, s[16:19], s37 offen offset:64
    buffer_load_dwordx4 a[120:123], v5, s[16:19], s37 offen offset:128
    buffer_load_dwordx4 a[124:127], v5, s[16:19], s37 offen offset:192
    buffer_load_dwordx4 a[128:131], v5, s[16:19], s37 offen offset:256
    buffer_load_dwordx4 a[132:135], v5, s[16:19], s37 offen offset:320
    buffer_load_dwordx4 a[136:139], v5, s[16:19], s37 offen offset:384
    buffer_load_dwordx4 a[140:143], v5, s[16:19], s37 offen offset:448
    buffer_load_dwordx4 a[144:147], v5, s[16:19], s37 offen offset:512
    buffer_load_dwordx4 a[148:151], v5, s[16:19], s37 offen offset:576
    buffer_load_dwordx4 a[152:155], v5, s[16:19], s37 offen offset:640
    buffer_load_dwordx4 a[156:159], v5, s[16:19], s37 offen offset:704
    buffer_load_dwordx4 a[160:163], v5, s[16:19], s37 offen offset:768
    buffer_load_dwordx4 a[164:167], v5, s[16:19], s37 offen offset:832
    s_mov_b32 s37, 806400
    buffer_load_dwordx4 a[168:171], v5, s[16:19], s37 offen offset:0
    buffer_load_dwordx4 a[172:175], v5, s[16:19], s37 offen offset:64
    buffer_load_dwordx4 a[176:179], v5, s[16:19], s37 offen offset:128
    buffer_load_dwordx4 a[180:183], v5, s[16:19], s37 offen offset:192
    buffer_load_dwordx4 a[184:187], v5, s[16:19], s37 offen offset:256
    buffer_load_dwordx4 a[188:191], v5, s[16:19], s37 offen offset:320
    buffer_load_dwordx4 a[192:195], v5, s[16:19], s37 offen offset:384
    buffer_load_dwordx4 a[196:199], v5, s[16:19], s37 offen offset:448
    buffer_load_dwordx4 a[200:203], v5, s[16:19], s37 offen offset:512
    buffer_load_dwordx4 a[204:207], v5, s[16:19], s37 offen offset:576
    buffer_load_dwordx4 a[208:211], v5, s[16:19], s37 offen offset:640
    buffer_load_dwordx4 a[212:215], v5, s[16:19], s37 offen offset:704
    buffer_load_dwordx4 a[216:219], v5, s[16:19], s37 offen offset:768
    buffer_load_dwordx4 a[220:223], v5, s[16:19], s37 offen offset:832
    v_add_u32 v6, 0, v0
    s_mov_b32 s37, 0x04924925
    v_mul_hi_u32 v7, v6, s37
    v_mul_u32_u24 v8, 56, v7
    v_sub_u32 v6, v6, v8
    v_mul_u32_u24 v8, 912, v7
    v_lshl_add_u32 v8, v6, 4, v8
    v_add_u32 v6, 256, v0
    s_mov_b32 s37, 0x04924925
    v_mul_hi_u32 v7, v6, s37
    v_mul_u32_u24 v9, 56, v7
    v_sub_u32 v6, v6, v9
    v_mul_u32_u24 v9, 912, v7
    v_lshl_add_u32 v9, v6, 4, v9
    v_add_u32 v6, 512, v0
    s_mov_b32 s37, 0x04924925
    v_mul_hi_u32 v7, v6, s37
    v_mul_u32_u24 v10, 56, v7
    v_sub_u32 v6, v6, v10
    v_mul_u32_u24 v10, 912, v7
    v_lshl_add_u32 v10, v6, 4, v10
    v_add_u32 v6, 768, v0
    s_mov_b32 s37, 0x04924925
    v_mul_hi_u32 v7, v6, s37
    v_mul_u32_u24 v11, 56, v7
    v_sub_u32 v6, v6, v11
    v_mul_u32_u24 v11, 912, v7
    v_lshl_add_u32 v11, v6, 4, v11
    v_add_u32 v6, 1024, v0
    s_mov_b32 s37, 0x04924925
    v_mul_hi_u32 v7, v6, s37
    v_mul_u32_u24 v12, 56, v7
    v_sub_u32 v6, v6, v12
    v_mul_u32_u24 v12, 912, v7
    v_lshl_add_u32 v12, v6, 4, v12
    v_add_u32 v6, 1280, v0
    s_mov_b32 s37, 0x04924925
    v_mul_hi_u32 v7, v6, s37
    v_mul_u32_u24 v13, 56, v7
    v_sub_u32 v6, v6, v13
    v_mul_u32_u24 v13, 912, v7
    v_lshl_add_u32 v13, v6, 4, v13
    v_add_u32 v6, 1536, v0
    s_mov_b32 s37, 0x04924925
    v_mul_hi_u32 v7, v6, s37
    v_mul_u32_u24 v14, 56, v7
    v_sub_u32 v6, v6, v14
    v_mul_u32_u24 v14, 912, v7
    v_lshl_add_u32 v14, v6, 4, v14
    v_mul_u32_u24 v6, 912, v4
    v_lshl_add_u32 v6, v3, 4, v6
    v_lshlrev_b32 v7, 5, v1
    v_mul_u32_u24 v2, 896, v4
    v_lshl_add_u32 v2, v3, 4, v2
    s_lshl_b32 s37, s35, 6
    v_add_u32 v2, s37, v2
    s_mov_b32 s40, 0
    s_mov_b32 s41, 0
    s_mov_b32 s42, s30
    s_barrier
    s_waitcnt vmcnt(63)
    v_add_u32 v5, s41, v8
    ds_write_b128 v5, v[16:19]
    v_add_u32 v5, s41, v9
    ds_write_b128 v5, v[20:23]
    v_add_u32 v5, s41, v10
    ds_write_b128 v5, v[24:27]
    v_add_u32 v5, s41, v11
    ds_write_b128 v5, v[28:31]
    v_add_u32 v5, s41, v12
    ds_write_b128 v5, v[32:35]
    v_add_u32 v5, s41, v13
    ds_write_b128 v5, v[36:39]
    v_add_u32 v5, s41, v14
    ds_write_b128 v5, v[40:43]
    s_waitcnt vmcnt(0) lgkmcnt(0)
    s_barrier
L_gemm_loop_wt:
    s_add_u32 s37, s39, 0
    buffer_load_dwordx4 v[16:19], v15, s[12:15], s37 offen
    s_add_u32 s37, s39, 4096
    buffer_load_dwordx4 v[20:23], v15, s[12:15], s37 offen
    s_add_u32 s37, s39, 8192
    buffer_load_dwordx4 v[24:27], v15, s[12:15], s37 offen
    s_add_u32 s37, s39, 12288
    buffer_load_dwordx4 v[28:31], v15, s[12:15], s37 offen
    s_add_u32 s37, s39, 16384
    buffer_load_dwordx4 v[32:35], v15, s[12:15], s37 offen
    s_add_u32 s37, s39, 20480
    buffer_load_dwordx4 v[36:39], v15, s[12:15], s37 offen
    s_add_u32 s37, s39, 24576
    buffer_load_dwordx4 v[40:43], v15, s[12:15], s37 offen
    s_add_u32 s39, s39, 229376
    v_add_u32 v5, s41, v6
    ds_read_b128 v[72:75], v5 offset:0
    ds_read_b128 v[76:79], v5 offset:14592
    ds_read_b128 v[80:83], v5 offset:64
    ds_read_b128 v[84:87], v5 offset:14656
    s_waitcnt lgkmcnt(2)
    v_mfma_f32_16x16x32_bf16 v[88:91], a[0:3], v[72:75], 0
    v_mfma_f32_16x16x32_bf16 v[92:95], a[56:59], v[72:75], 0
    v_mfma_f32_16x16x32_bf16 v[96:99], a[112:115], v[72:75], 0
    v_mfma_f32_16x16x32_bf16 v[100:103], a[168:171], v[72:75], 0
    v_mfma_f32_16x16x32_bf16 v[104:107], a[0:3], v[76:79], 0
    v_mfma_f32_16x16x32_bf16 v[108:111], a[56:59], v[76:79], 0
    v_mfma_f32_16x16x32_bf16 v[112:115], a[112:115], v[76:79], 0
    v_mfma_f32_16x16x32_bf16 v[116:119], a[168:171], v[76:79], 0
    ds_read_b128 v[72:75], v5 offset:128
    ds_read_b128 v[76:79], v5 offset:14720
    s_waitcnt lgkmcnt(2)
    v_mfma_f32_16x16x32_bf16 v[88:91], a[4:7], v[80:83], v[88:91]
    v_mfma_f32_16x16x32_bf16 v[92:95], a[60:63], v[80:83], v[92:95]
    v_mfma_f32_16x16x32_bf16 v[96:99], a[116:119], v[80:83], v[96:99]
    v_mfma_f32_16x16x32_bf16 v[100:103], a[172:175], v[80:83], v[100:103]
    v_mfma_f32_16x16x32_bf16 v[104:107], a[4:7], v[84:87], v[104:107]
    v_mfma_f32_16x16x32_bf16 v[108:111], a[60:63], v[84:87], v[108:111]
    v_mfma_f32_16x16x32_bf16 v[112:115], a[116:119], v[84:87], v[112:115]
    v_mfma_f32_16x16x32_bf16 v[116:119], a[172:175], v[84:87], v[116:119]
    ds_read_b128 v[80:83], v5 offset:192
    ds_read_b128 v[84:87], v5 offset:14784
    s_waitcnt lgkmcnt(2)
    v_mfma_f32_16x16x32_bf16 v[88:91], a[8:11], v[72:75], v[88:91]
    v_mfma_f32_16x16x32_bf16 v[92:95], a[64:67], v[72:75], v[92:95]
    v_mfma_f32_16x16x32_bf16 v[96:99], a[120:123], v[72:75], v[96:99]
    v_mfma_f32_16x16x32_bf16 v[100:103], a[176:179], v[72:75], v[100:103]
    v_mfma_f32_16x16x32_bf16 v[104:107], a[8:11], v[76:79], v[104:107]
    v_mfma_f32_16x16x32_bf16 v[108:111], a[64:67], v[76:79], v[108:111]
    v_mfma_f32_16x16x32_bf16 v[112:115], a[120:123], v[76:79], v[112:115]
    v_mfma_f32_16x16x32_bf16 v[116:119], a[176:179], v[76:79], v[116:119]
    ds_read_b128 v[72:75], v5 offset:256
    ds_read_b128 v[76:79], v5 offset:14848
    s_waitcnt lgkmcnt(2)
    v_mfma_f32_16x16x32_bf16 v[88:91], a[12:15], v[80:83], v[88:91]
    v_mfma_f32_16x16x32_bf16 v[92:95], a[68:71], v[80:83], v[92:95]
    v_mfma_f32_16x16x32_bf16 v[96:99], a[124:127], v[80:83], v[96:99]
    v_mfma_f32_16x16x32_bf16 v[100:103], a[180:183], v[80:83], v[100:103]
    v_mfma_f32_16x16x32_bf16 v[104:107], a[12:15], v[84:87], v[104:107]
    v_mfma_f32_16x16x32_bf16 v[108:111], a[68:71], v[84:87], v[108:111]
    v_mfma_f32_16x16x32_bf16 v[112:115], a[124:127], v[84:87], v[112:115]
    v_mfma_f32_16x16x32_bf16 v[116:119], a[180:183], v[84:87], v[116:119]
    ds_read_b128 v[80:83], v5 offset:320
    ds_read_b128 v[84:87], v5 offset:14912
    s_waitcnt lgkmcnt(2)
    v_mfma_f32_16x16x32_bf16 v[88:91], a[16:19], v[72:75], v[88:91]
    v_mfma_f32_16x16x32_bf16 v[92:95], a[72:75], v[72:75], v[92:95]
    v_mfma_f32_16x16x32_bf16 v[96:99], a[128:131], v[72:75], v[96:99]
    v_mfma_f32_16x16x32_bf16 v[100:103], a[184:187], v[72:75], v[100:103]
    v_mfma_f32_16x16x32_bf16 v[104:107], a[16:19], v[76:79], v[104:107]
    v_mfma_f32_16x16x32_bf16 v[108:111], a[72:75], v[76:79], v[108:111]
    v_mfma_f32_16x16x32_bf16 v[112:115], a[128:131], v[76:79], v[112:115]
    v_mfma_f32_16x16x32_bf16 v[116:119], a[184:187], v[76:79], v[116:119]
    ds_read_b128 v[72:75], v5 offset:384
    ds_read_b128 v[76:79], v5 offset:14976
    s_waitcnt lgkmcnt(2)
    v_mfma_f32_16x16x32_bf16 v[88:91], a[20:23], v[80:83], v[88:91]
    v_mfma_f32_16x16x32_bf16 v[92:95], a[76:79], v[80:83], v[92:95]
    v_mfma_f32_16x16x32_bf16 v[96:99], a[132:135], v[80:83], v[96:99]
    v_mfma_f32_16x16x32_bf16 v[100:103], a[188:191], v[80:83], v[100:103]
    v_mfma_f32_16x16x32_bf16 v[104:107], a[20:23], v[84:87], v[104:107]
    v_mfma_f32_16x16x32_bf16 v[108:111], a[76:79], v[84:87], v[108:111]
    v_mfma_f32_16x16x32_bf16 v[112:115], a[132:135], v[84:87], v[112:115]
    v_mfma_f32_16x16x32_bf16 v[116:119], a[188:191], v[84:87], v[116:119]
    ds_read_b128 v[80:83], v5 offset:448
    ds_read_b128 v[84:87], v5 offset:15040
    s_waitcnt lgkmcnt(2)
    v_mfma_f32_16x16x32_bf16 v[88:91], a[24:27], v[72:75], v[88:91]
    v_mfma_f32_16x16x32_bf16 v[92:95], a[80:83], v[72:75], v[92:95]
    v_mfma_f32_16x16x32_bf16 v[96:99], a[136:139], v[72:75], v[96:99]
    v_mfma_f32_16x16x32_bf16 v[100:103], a[192:195], v[72:75], v[100:103]
    v_mfma_f32_16x16x32_bf16 v[104:107], a[24:27], v[76:79], v[104:107]
    v_mfma_f32_16x16x32_bf16 v[108:111], a[80:83], v[76:79], v[108:111]
    v_mfma_f32_16x16x32_bf16 v[112:115], a[136:139], v[76:79], v[112:115]
    v_mfma_f32_16x16x32_bf16 v[116:119], a[192:195], v[76:79], v[116:119]
    ds_read_b128 v[72:75], v5 offset:512
    ds_read_b128 v[76:79], v5 offset:15104
    s_waitcnt lgkmcnt(2)
    v_mfma_f32_16x16x32_bf16 v[88:91], a[28:31], v[80:83], v[88:91]
    v_mfma_f32_16x16x32_bf16 v[92:95], a[84:87], v[80:83], v[92:95]
    v_mfma_f32_16x16x32_bf16 v[96:99], a[140:143], v[80:83], v[96:99]
    v_mfma_f32_16x16x32_bf16 v[100:103], a[196:199], v[80:83], v[100:103]
    v_mfma_f32_16x16x32_bf16 v[104:107], a[28:31], v[84:87], v[104:107]
    v_mfma_f32_16x16x32_bf16 v[108:111], a[84:87], v[84:87], v[108:111]
    v_mfma_f32_16x16x32_bf16 v[112:115], a[140:143], v[84:87], v[112:115]
    v_mfma_f32_16x16x32_bf16 v[116:119], a[196:199], v[84:87], v[116:119]
    ds_read_b128 v[80:83], v5 offset:576
    ds_read_b128 v[84:87], v5 offset:15168
    s_waitcnt lgkmcnt(2)
    v_mfma_f32_16x16x32_bf16 v[88:91], a[32:35], v[72:75], v[88:91]
    v_mfma_f32_16x16x32_bf16 v[92:95], a[88:91], v[72:75], v[92:95]
    v_mfma_f32_16x16x32_bf16 v[96:99], a[144:147], v[72:75], v[96:99]
    v_mfma_f32_16x16x32_bf16 v[100:103], a[200:203], v[72:75], v[100:103]
    v_mfma_f32_16x16x32_bf16 v[104:107], a[32:35], v[76:79], v[104:107]
    v_mfma_f32_16x16x32_bf16 v[108:111], a[88:91], v[76:79], v[108:111]
    v_mfma_f32_16x16x32_bf16 v[112:115], a[144:147], v[76:79], v[112:115]
    v_mfma_f32_16x16x32_bf16 v[116:119], a[200:203], v[76:79], v[116:119]
    ds_read_b128 v[72:75], v5 offset:640
    ds_read_b128 v[76:79], v5 offset:15232
    s_waitcnt lgkmcnt(2)
    v_mfma_f32_16x16x32_bf16 v[88:91], a[36:39], v[80:83], v[88:91]
    v_mfma_f32_16x16x32_bf16 v[92:95], a[92:95], v[80:83], v[92:95]
    v_mfma_f32_16x16x32_bf16 v[96:99], a[148:151], v[80:83], v[96:99]
    v_mfma_f32_16x16x32_bf16 v[100:103], a[204:207], v[80:83], v[100:103]
    v_mfma_f32_16x16x32_bf16 v[104:107], a[36:39], v[84:87], v[104:107]
    v_mfma_f32_16x16x32_bf16 v[108:111], a[92:95], v[84:87], v[108:111]
    v_mfma_f32_16x16x32_bf16 v[112:115], a[148:151], v[84:87], v[112:115]
    v_mfma_f32_16x16x32_bf16 v[116:119], a[204:207], v[84:87], v[116:119]
    ds_read_b128 v[80:83], v5 offset:704
    ds_read_b128 v[84:87], v5 offset:15296
    s_waitcnt lgkmcnt(2)
    v_mfma_f32_16x16x32_bf16 v[88:91], a[40:43], v[72:75], v[88:91]
    v_mfma_f32_16x16x32_bf16 v[92:95], a[96:99], v[72:75], v[92:95]
    v_mfma_f32_16x16x32_bf16 v[96:99], a[152:155], v[72:75], v[96:99]
    v_mfma_f32_16x16x32_bf16 v[100:103], a[208:211], v[72:75], v[100:103]
    v_mfma_f32_16x16x32_bf16 v[104:107], a[40:43], v[76:79], v[104:107]
    v_mfma_f32_16x16x32_bf16 v[108:111], a[96:99], v[76:79], v[108:111]
    v_mfma_f32_16x16x32_bf16 v[112:115], a[152:155], v[76:79], v[112:115]
    v_mfma_f32_16x16x32_bf16 v[116:119], a[208:211], v[76:79], v[116:119]
    ds_read_b128 v[72:75], v5 offset:768
    ds_read_b128 v[76:79], v5 offset:15360
    s_waitcnt lgkmcnt(2)
    v_mfma_f32_16x16x32_bf16 v[88:91], a[44:47], v[80:83], v[88:91]
    v_mfma_f32_16x16x32_bf16 v[92:95], a[100:103], v[80:83], v[92:95]
    v_mfma_f32_16x16x32_bf16 v[96:99], a[156:159], v[80:83], v[96:99]
    v_mfma_f32_16x16x32_bf16 v[100:103], a[212:215], v[80:83], v[100:103]
    v_mfma_f32_16x16x32_bf16 v[104:107], a[44:47], v[84:87], v[104:107]
    v_mfma_f32_16x16x32_bf16 v[108:111], a[100:103], v[84:87], v[108:111]
    v_mfma_f32_16x16x32_bf16 v[112:115], a[156:159], v[84:87], v[112:115]
    v_mfma_f32_16x16x32_bf16 v[116:119], a[212:215], v[84:87], v[116:119]
    ds_read_b128 v[80:83], v5 offset:832
    ds_read_b128 v[84:87], v5 offset:15424
    s_waitcnt lgkmcnt(2)
    v_mfma_f32_16x16x32_bf16 v[88:91], a[48:51], v[72:75], v[88:91]
    v_mfma_f32_16x16x32_bf16 v[92:95], a[104:107], v[72:75], v[92:95]
    v_mfma_f32_16x16x32_bf16 v[96:99], a[160:163], v[72:75], v[96:99]
    v_mfma_f32_16x16x32_bf16 v[100:103], a[216:219], v[72:75], v[100:103]
    v_mfma_f32_16x16x32_bf16 v[104:107], a[48:51], v[76:79], v[104:107]
    v_mfma_f32_16x16x32_bf16 v[108:111], a[104:107], v[76:79], v[108:111]
    v_mfma_f32_16x16x32_bf16 v[112:115], a[160:163], v[76:79], v[112:115]
    v_mfma_f32_16x16x32_bf16 v[116:119], a[216:219], v[76:79], v[116:119]
    s_waitcnt lgkmcnt(0)
    v_mfma_f32_16x16x32_bf16 v[88:91], a[52:55], v[80:83], v[88:91]
    v_mfma_f32_16x16x32_bf16 v[92:95], a[108:111], v[80:83], v[92:95]
    v_mfma_f32_16x16x32_bf16 v[96:99], a[164:167], v[80:83], v[96:99]
    v_mfma_f32_16x16x32_bf16 v[100:103], a[220:223], v[80:83], v[100:103]
    v_mfma_f32_16x16x32_bf16 v[104:107], a[52:55], v[84:87], v[104:107]
    v_mfma_f32_16x16x32_bf16 v[108:111], a[108:111], v[84:87], v[108:111]
    v_mfma_f32_16x16x32_bf16 v[112:115], a[164:167], v[84:87], v[112:115]
    v_mfma_f32_16x16x32_bf16 v[116:119], a[220:223], v[84:87], v[116:119]
    s_waitcnt vmcnt(11)
    s_xor_b32 s41, s41, 29184
    v_add_u32 v5, s41, v8
    ds_write_b128 v5, v[44:47]
    v_add_u32 v5, s41, v9
    ds_write_b128 v5, v[48:51]
    v_add_u32 v5, s41, v10
    ds_write_b128 v5, v[52:55]
    v_add_u32 v5, s41, v11
    ds_write_b128 v5, v[56:59]
    v_add_u32 v5, s41, v12
    ds_write_b128 v5, v[60:63]
    v_add_u32 v5, s41, v13
    ds_write_b128 v5, v[64:67]
    v_add_u32 v5, s41, v14
    ds_write_b128 v5, v[68:71]
    s_lshl_b32 s38, s32, 12
    s_lshl_b32 s37, s42, 5
    s_add_u32 s38, s38, s37
    s_mul_i32 s38, s38, 896
    s_add_u32 s38, s38, 50331648
    s_add_u32 s37, s38, 0
    v_cvt_pk_bf16_f32 v120, v88, v89
    v_cvt_pk_bf16_f32 v121, v90, v91
    v_cvt_pk_bf16_f32 v122, v92, v93
    v_cvt_pk_bf16_f32 v123, v94, v95
    buffer_store_dwordx4 v[120:123], v2, s[16:19], s37 offen sc1
    s_add_u32 s37, s38, 14336
    v_cvt_pk_bf16_f32 v124, v104, v105
    v_cvt_pk_bf16_f32 v125, v106, v107
    v_cvt_pk_bf16_f32 v126, v108, v109
    v_cvt_pk_bf16_f32 v127, v110, v111
    buffer_store_dwordx4 v[124:127], v2, s[16:19], s37 offen sc1
    s_add_u32 s37, s38, 1835008
    v_cvt_pk_bf16_f32 v128, v96, v97
    v_cvt_pk_bf16_f32 v129, v98, v99
    v_cvt_pk_bf16_f32 v130, v100, v101
    v_cvt_pk_bf16_f32 v131, v102, v103
    buffer_store_dwordx4 v[128:131], v2, s[16:19], s37 offen sc1
    s_add_u32 s37, s38, 1849344
    v_cvt_pk_bf16_f32 v132, v112, v113
    v_cvt_pk_bf16_f32 v133, v114, v115
    v_cvt_pk_bf16_f32 v134, v116, v117
    v_cvt_pk_bf16_f32 v135, v118, v119
    buffer_store_dwordx4 v[132:135], v2, s[16:19], s37 offen sc1
    s_cmp_eq_u32 s40, 0
    s_cbranch_scc1 L_gemm_f0_wt
    s_waitcnt vmcnt(11)
    s_lshl_b32 s37, s42, 7
    s_add_u32 s37, s37, 100809728
    s_branch L_gemm_j0_wt
L_gemm_f0_wt:
    s_waitcnt vmcnt(0)
    s_lshl_b32 s37, s42, 7
    s_add_u32 s37, s37, 100810752
L_gemm_j0_wt:
    s_waitcnt lgkmcnt(0)
    s_barrier
    s_cmp_eq_u32 s40, 1
    s_cbranch_scc1 L_gemm_n0_wt
    s_cmp_lg_u32 s20, 0
    s_cbranch_scc1 L_gemm_n0_wt
    v_mov_b32 v72, 1
    v_mov_b32 v73, 0
    s_mov_b64 exec, 1
    buffer_atomic_add v72, v73, s[16:19], s37 offen sc1
    s_mov_b64 exec, -1
L_gemm_n0_wt:
    s_add_u32 s42, s42, 8
    s_add_u32 s40, s40, 1
    s_add_u32 s37, s39, 0
    buffer_load_dwordx4 v[44:47], v15, s[12:15], s37 offen
    s_add_u32 s37, s39, 4096
    buffer_load_dwordx4 v[48:51], v15, s[12:15], s37 offen
    s_add_u32 s37, s39, 8192
    buffer_load_dwordx4 v[52:55], v15, s[12:15], s37 offen
    s_add_u32 s37, s39, 12288
    buffer_load_dwordx4 v[56:59], v15, s[12:15], s37 offen
    s_add_u32 s37, s39, 16384
    buffer_load_dwordx4 v[60:63], v15, s[12:15], s37 offen
    s_add_u32 s37, s39, 20480
    buffer_load_dwordx4 v[64:67], v15, s[12:15], s37 offen
    s_add_u32 s37, s39, 24576
    buffer_load_dwordx4 v[68:71], v15, s[12:15], s37 offen
    s_add_u32 s39, s39, 229376
    v_add_u32 v5, s41, v6
    ds_read_b128 v[72:75], v5 offset:0
    ds_read_b128 v[76:79], v5 offset:14592
    ds_read_b128 v[80:83], v5 offset:64
    ds_read_b128 v[84:87], v5 offset:14656
    s_waitcnt lgkmcnt(2)
    v_mfma_f32_16x16x32_bf16 v[88:91], a[0:3], v[72:75], 0
    v_mfma_f32_16x16x32_bf16 v[92:95], a[56:59], v[72:75], 0
    v_mfma_f32_16x16x32_bf16 v[96:99], a[112:115], v[72:75], 0
    v_mfma_f32_16x16x32_bf16 v[100:103], a[168:171], v[72:75], 0
    v_mfma_f32_16x16x32_bf16 v[104:107], a[0:3], v[76:79], 0
    v_mfma_f32_16x16x32_bf16 v[108:111], a[56:59], v[76:79], 0
    v_mfma_f32_16x16x32_bf16 v[112:115], a[112:115], v[76:79], 0
    v_mfma_f32_16x16x32_bf16 v[116:119], a[168:171], v[76:79], 0
    ds_read_b128 v[72:75], v5 offset:128
    ds_read_b128 v[76:79], v5 offset:14720
    s_waitcnt lgkmcnt(2)
    v_mfma_f32_16x16x32_bf16 v[88:91], a[4:7], v[80:83], v[88:91]
    v_mfma_f32_16x16x32_bf16 v[92:95], a[60:63], v[80:83], v[92:95]
    v_mfma_f32_16x16x32_bf16 v[96:99], a[116:119], v[80:83], v[96:99]
    v_mfma_f32_16x16x32_bf16 v[100:103], a[172:175], v[80:83], v[100:103]
    v_mfma_f32_16x16x32_bf16 v[104:107], a[4:7], v[84:87], v[104:107]
    v_mfma_f32_16x16x32_bf16 v[108:111], a[60:63], v[84:87], v[108:111]
    v_mfma_f32_16x16x32_bf16 v[112:115], a[116:119], v[84:87], v[112:115]
    v_mfma_f32_16x16x32_bf16 v[116:119], a[172:175], v[84:87], v[116:119]
    ds_read_b128 v[80:83], v5 offset:192
    ds_read_b128 v[84:87], v5 offset:14784
    s_waitcnt lgkmcnt(2)
    v_mfma_f32_16x16x32_bf16 v[88:91], a[8:11], v[72:75], v[88:91]
    v_mfma_f32_16x16x32_bf16 v[92:95], a[64:67], v[72:75], v[92:95]
    v_mfma_f32_16x16x32_bf16 v[96:99], a[120:123], v[72:75], v[96:99]
    v_mfma_f32_16x16x32_bf16 v[100:103], a[176:179], v[72:75], v[100:103]
    v_mfma_f32_16x16x32_bf16 v[104:107], a[8:11], v[76:79], v[104:107]
    v_mfma_f32_16x16x32_bf16 v[108:111], a[64:67], v[76:79], v[108:111]
    v_mfma_f32_16x16x32_bf16 v[112:115], a[120:123], v[76:79], v[112:115]
    v_mfma_f32_16x16x32_bf16 v[116:119], a[176:179], v[76:79], v[116:119]
    ds_read_b128 v[72:75], v5 offset:256
    ds_read_b128 v[76:79], v5 offset:14848
    s_waitcnt lgkmcnt(2)
    v_mfma_f32_16x16x32_bf16 v[88:91], a[12:15], v[80:83], v[88:91]
    v_mfma_f32_16x16x32_bf16 v[92:95], a[68:71], v[80:83], v[92:95]
    v_mfma_f32_16x16x32_bf16 v[96:99], a[124:127], v[80:83], v[96:99]
    v_mfma_f32_16x16x32_bf16 v[100:103], a[180:183], v[80:83], v[100:103]
    v_mfma_f32_16x16x32_bf16 v[104:107], a[12:15], v[84:87], v[104:107]
    v_mfma_f32_16x16x32_bf16 v[108:111], a[68:71], v[84:87], v[108:111]
    v_mfma_f32_16x16x32_bf16 v[112:115], a[124:127], v[84:87], v[112:115]
    v_mfma_f32_16x16x32_bf16 v[116:119], a[180:183], v[84:87], v[116:119]
    ds_read_b128 v[80:83], v5 offset:320
    ds_read_b128 v[84:87], v5 offset:14912
    s_waitcnt lgkmcnt(2)
    v_mfma_f32_16x16x32_bf16 v[88:91], a[16:19], v[72:75], v[88:91]
    v_mfma_f32_16x16x32_bf16 v[92:95], a[72:75], v[72:75], v[92:95]
    v_mfma_f32_16x16x32_bf16 v[96:99], a[128:131], v[72:75], v[96:99]
    v_mfma_f32_16x16x32_bf16 v[100:103], a[184:187], v[72:75], v[100:103]
    v_mfma_f32_16x16x32_bf16 v[104:107], a[16:19], v[76:79], v[104:107]
    v_mfma_f32_16x16x32_bf16 v[108:111], a[72:75], v[76:79], v[108:111]
    v_mfma_f32_16x16x32_bf16 v[112:115], a[128:131], v[76:79], v[112:115]
    v_mfma_f32_16x16x32_bf16 v[116:119], a[184:187], v[76:79], v[116:119]
    ds_read_b128 v[72:75], v5 offset:384
    ds_read_b128 v[76:79], v5 offset:14976
    s_waitcnt lgkmcnt(2)
    v_mfma_f32_16x16x32_bf16 v[88:91], a[20:23], v[80:83], v[88:91]
    v_mfma_f32_16x16x32_bf16 v[92:95], a[76:79], v[80:83], v[92:95]
    v_mfma_f32_16x16x32_bf16 v[96:99], a[132:135], v[80:83], v[96:99]
    v_mfma_f32_16x16x32_bf16 v[100:103], a[188:191], v[80:83], v[100:103]
    v_mfma_f32_16x16x32_bf16 v[104:107], a[20:23], v[84:87], v[104:107]
    v_mfma_f32_16x16x32_bf16 v[108:111], a[76:79], v[84:87], v[108:111]
    v_mfma_f32_16x16x32_bf16 v[112:115], a[132:135], v[84:87], v[112:115]
    v_mfma_f32_16x16x32_bf16 v[116:119], a[188:191], v[84:87], v[116:119]
    ds_read_b128 v[80:83], v5 offset:448
    ds_read_b128 v[84:87], v5 offset:15040
    s_waitcnt lgkmcnt(2)
    v_mfma_f32_16x16x32_bf16 v[88:91], a[24:27], v[72:75], v[88:91]
    v_mfma_f32_16x16x32_bf16 v[92:95], a[80:83], v[72:75], v[92:95]
    v_mfma_f32_16x16x32_bf16 v[96:99], a[136:139], v[72:75], v[96:99]
    v_mfma_f32_16x16x32_bf16 v[100:103], a[192:195], v[72:75], v[100:103]
    v_mfma_f32_16x16x32_bf16 v[104:107], a[24:27], v[76:79], v[104:107]
    v_mfma_f32_16x16x32_bf16 v[108:111], a[80:83], v[76:79], v[108:111]
    v_mfma_f32_16x16x32_bf16 v[112:115], a[136:139], v[76:79], v[112:115]
    v_mfma_f32_16x16x32_bf16 v[116:119], a[192:195], v[76:79], v[116:119]
    ds_read_b128 v[72:75], v5 offset:512
    ds_read_b128 v[76:79], v5 offset:15104
    s_waitcnt lgkmcnt(2)
    v_mfma_f32_16x16x32_bf16 v[88:91], a[28:31], v[80:83], v[88:91]
    v_mfma_f32_16x16x32_bf16 v[92:95], a[84:87], v[80:83], v[92:95]
    v_mfma_f32_16x16x32_bf16 v[96:99], a[140:143], v[80:83], v[96:99]
    v_mfma_f32_16x16x32_bf16 v[100:103], a[196:199], v[80:83], v[100:103]
    v_mfma_f32_16x16x32_bf16 v[104:107], a[28:31], v[84:87], v[104:107]
    v_mfma_f32_16x16x32_bf16 v[108:111], a[84:87], v[84:87], v[108:111]
    v_mfma_f32_16x16x32_bf16 v[112:115], a[140:143], v[84:87], v[112:115]
    v_mfma_f32_16x16x32_bf16 v[116:119], a[196:199], v[84:87], v[116:119]
    ds_read_b128 v[80:83], v5 offset:576
    ds_read_b128 v[84:87], v5 offset:15168
    s_waitcnt lgkmcnt(2)
    v_mfma_f32_16x16x32_bf16 v[88:91], a[32:35], v[72:75], v[88:91]
    v_mfma_f32_16x16x32_bf16 v[92:95], a[88:91], v[72:75], v[92:95]
    v_mfma_f32_16x16x32_bf16 v[96:99], a[144:147], v[72:75], v[96:99]
    v_mfma_f32_16x16x32_bf16 v[100:103], a[200:203], v[72:75], v[100:103]
    v_mfma_f32_16x16x32_bf16 v[104:107], a[32:35], v[76:79], v[104:107]
    v_mfma_f32_16x16x32_bf16 v[108:111], a[88:91], v[76:79], v[108:111]
    v_mfma_f32_16x16x32_bf16 v[112:115], a[144:147], v[76:79], v[112:115]
    v_mfma_f32_16x16x32_bf16 v[116:119], a[200:203], v[76:79], v[116:119]
    ds_read_b128 v[72:75], v5 offset:640
    ds_read_b128 v[76:79], v5 offset:15232
    s_waitcnt lgkmcnt(2)
    v_mfma_f32_16x16x32_bf16 v[88:91], a[36:39], v[80:83], v[88:91]
    v_mfma_f32_16x16x32_bf16 v[92:95], a[92:95], v[80:83], v[92:95]
    v_mfma_f32_16x16x32_bf16 v[96:99], a[148:151], v[80:83], v[96:99]
    v_mfma_f32_16x16x32_bf16 v[100:103], a[204:207], v[80:83], v[100:103]
    v_mfma_f32_16x16x32_bf16 v[104:107], a[36:39], v[84:87], v[104:107]
    v_mfma_f32_16x16x32_bf16 v[108:111], a[92:95], v[84:87], v[108:111]
    v_mfma_f32_16x16x32_bf16 v[112:115], a[148:151], v[84:87], v[112:115]
    v_mfma_f32_16x16x32_bf16 v[116:119], a[204:207], v[84:87], v[116:119]
    ds_read_b128 v[80:83], v5 offset:704
    ds_read_b128 v[84:87], v5 offset:15296
    s_waitcnt lgkmcnt(2)
    v_mfma_f32_16x16x32_bf16 v[88:91], a[40:43], v[72:75], v[88:91]
    v_mfma_f32_16x16x32_bf16 v[92:95], a[96:99], v[72:75], v[92:95]
    v_mfma_f32_16x16x32_bf16 v[96:99], a[152:155], v[72:75], v[96:99]
    v_mfma_f32_16x16x32_bf16 v[100:103], a[208:211], v[72:75], v[100:103]
    v_mfma_f32_16x16x32_bf16 v[104:107], a[40:43], v[76:79], v[104:107]
    v_mfma_f32_16x16x32_bf16 v[108:111], a[96:99], v[76:79], v[108:111]
    v_mfma_f32_16x16x32_bf16 v[112:115], a[152:155], v[76:79], v[112:115]
    v_mfma_f32_16x16x32_bf16 v[116:119], a[208:211], v[76:79], v[116:119]
    ds_read_b128 v[72:75], v5 offset:768
    ds_read_b128 v[76:79], v5 offset:15360
    s_waitcnt lgkmcnt(2)
    v_mfma_f32_16x16x32_bf16 v[88:91], a[44:47], v[80:83], v[88:91]
    v_mfma_f32_16x16x32_bf16 v[92:95], a[100:103], v[80:83], v[92:95]
    v_mfma_f32_16x16x32_bf16 v[96:99], a[156:159], v[80:83], v[96:99]
    v_mfma_f32_16x16x32_bf16 v[100:103], a[212:215], v[80:83], v[100:103]
    v_mfma_f32_16x16x32_bf16 v[104:107], a[44:47], v[84:87], v[104:107]
    v_mfma_f32_16x16x32_bf16 v[108:111], a[100:103], v[84:87], v[108:111]
    v_mfma_f32_16x16x32_bf16 v[112:115], a[156:159], v[84:87], v[112:115]
    v_mfma_f32_16x16x32_bf16 v[116:119], a[212:215], v[84:87], v[116:119]
    ds_read_b128 v[80:83], v5 offset:832
    ds_read_b128 v[84:87], v5 offset:15424
    s_waitcnt lgkmcnt(2)
    v_mfma_f32_16x16x32_bf16 v[88:91], a[48:51], v[72:75], v[88:91]
    v_mfma_f32_16x16x32_bf16 v[92:95], a[104:107], v[72:75], v[92:95]
    v_mfma_f32_16x16x32_bf16 v[96:99], a[160:163], v[72:75], v[96:99]
    v_mfma_f32_16x16x32_bf16 v[100:103], a[216:219], v[72:75], v[100:103]
    v_mfma_f32_16x16x32_bf16 v[104:107], a[48:51], v[76:79], v[104:107]
    v_mfma_f32_16x16x32_bf16 v[108:111], a[104:107], v[76:79], v[108:111]
    v_mfma_f32_16x16x32_bf16 v[112:115], a[160:163], v[76:79], v[112:115]
    v_mfma_f32_16x16x32_bf16 v[116:119], a[216:219], v[76:79], v[116:119]
    s_waitcnt lgkmcnt(0)
    v_mfma_f32_16x16x32_bf16 v[88:91], a[52:55], v[80:83], v[88:91]
    v_mfma_f32_16x16x32_bf16 v[92:95], a[108:111], v[80:83], v[92:95]
    v_mfma_f32_16x16x32_bf16 v[96:99], a[164:167], v[80:83], v[96:99]
    v_mfma_f32_16x16x32_bf16 v[100:103], a[220:223], v[80:83], v[100:103]
    v_mfma_f32_16x16x32_bf16 v[104:107], a[52:55], v[84:87], v[104:107]
    v_mfma_f32_16x16x32_bf16 v[108:111], a[108:111], v[84:87], v[108:111]
    v_mfma_f32_16x16x32_bf16 v[112:115], a[164:167], v[84:87], v[112:115]
    v_mfma_f32_16x16x32_bf16 v[116:119], a[220:223], v[84:87], v[116:119]
    s_waitcnt vmcnt(11)
    s_xor_b32 s41, s41, 29184
    v_add_u32 v5, s41, v8
    ds_write_b128 v5, v[16:19]
    v_add_u32 v5, s41, v9
    ds_write_b128 v5, v[20:23]
    v_add_u32 v5, s41, v10
    ds_write_b128 v5, v[24:27]
    v_add_u32 v5, s41, v11
    ds_write_b128 v5, v[28:31]
    v_add_u32 v5, s41, v12
    ds_write_b128 v5, v[32:35]
    v_add_u32 v5, s41, v13
    ds_write_b128 v5, v[36:39]
    v_add_u32 v5, s41, v14
    ds_write_b128 v5, v[40:43]
    s_lshl_b32 s38, s32, 12
    s_lshl_b32 s37, s42, 5
    s_add_u32 s38, s38, s37
    s_mul_i32 s38, s38, 896
    s_add_u32 s38, s38, 50331648
    s_add_u32 s37, s38, 0
    v_cvt_pk_bf16_f32 v136, v88, v89
    v_cvt_pk_bf16_f32 v137, v90, v91
    v_cvt_pk_bf16_f32 v138, v92, v93
    v_cvt_pk_bf16_f32 v139, v94, v95
    buffer_store_dwordx4 v[136:139], v2, s[16:19], s37 offen sc1
    s_add_u32 s37, s38, 14336
    v_cvt_pk_bf16_f32 v140, v104, v105
    v_cvt_pk_bf16_f32 v141, v106, v107
    v_cvt_pk_bf16_f32 v142, v108, v109
    v_cvt_pk_bf16_f32 v143, v110, v111
    buffer_store_dwordx4 v[140:143], v2, s[16:19], s37 offen sc1
    s_add_u32 s37, s38, 1835008
    v_cvt_pk_bf16_f32 v144, v96, v97
    v_cvt_pk_bf16_f32 v145, v98, v99
    v_cvt_pk_bf16_f32 v146, v100, v101
    v_cvt_pk_bf16_f32 v147, v102, v103
    buffer_store_dwordx4 v[144:147], v2, s[16:19], s37 offen sc1
    s_add_u32 s37, s38, 1849344
    v_cvt_pk_bf16_f32 v148, v112, v113
    v_cvt_pk_bf16_f32 v149, v114, v115
    v_cvt_pk_bf16_f32 v150, v116, v117
    v_cvt_pk_bf16_f32 v151, v118, v119
    buffer_store_dwordx4 v[148:151], v2, s[16:19], s37 offen sc1
    s_cmp_eq_u32 s40, 0
    s_cbranch_scc1 L_gemm_f1_wt
    s_waitcnt vmcnt(11)
    s_lshl_b32 s37, s42, 7
    s_add_u32 s37, s37, 100809728
    s_branch L_gemm_j1_wt
L_gemm_f1_wt:
    s_waitcnt vmcnt(0)
    s_lshl_b32 s37, s42, 7
    s_add_u32 s37, s37, 100810752
L_gemm_j1_wt:
    s_waitcnt lgkmcnt(0)
    s_barrier
    s_cmp_eq_u32 s40, 1
    s_cbranch_scc1 L_gemm_n1_wt
    s_cmp_lg_u32 s20, 0
    s_cbranch_scc1 L_gemm_n1_wt
    v_mov_b32 v72, 1
    v_mov_b32 v73, 0
    s_mov_b64 exec, 1
    buffer_atomic_add v72, v73, s[16:19], s37 offen sc1
    s_mov_b64 exec, -1
L_gemm_n1_wt:
    s_add_u32 s42, s42, 8
    s_add_u32 s40, s40, 1
    s_cmp_lt_u32 s40, 8
    s_cbranch_scc1 L_gemm_loop_wt
    s_waitcnt vmcnt(0)
    s_barrier
    s_cmp_lg_u32 s20, 0
    s_cbranch_scc1 L_gemm_nf_wt
    s_lshl_b32 s37, s42, 7
    s_add_u32 s37, s37, 100809728
    v_mov_b32 v72, 1
    v_mov_b32 v73, 0
    s_mov_b64 exec, 1
    buffer_atomic_add v72, v73, s[16:19], s37 offen sc1
    s_mov_b64 exec, -1
L_gemm_nf_wt:
    s_waitcnt lgkmcnt(0)
    s_mov_b32 s12, s4
    s_mov_b32 s13, s5
    s_mov_b32 s14, 1835008
    s_mov_b32 s15, 0x00020000
    s_mov_b32 s24, s6
    s_mov_b32 s25, s7
    s_mov_b32 s26, 3670016
    s_mov_b32 s27, 0x00020000
    s_cmp_lt_u32 s21, 140
    s_cbranch_scc1 L_w_noum
    s_sub_u32 s3, s21, 140
    s_mul_hi_u32 s44, s3, 0x0924924a
    s_mul_i32 s31, s44, 28
    s_sub_u32 s31, s3, s31
    s_lshl_b32 s31, s31, 2
    s_add_u32 s31, s31, s20
    s_mul_hi_u32 s32, s31, 0x12492493
    s_mul_i32 s33, s32, 14
    s_sub_u32 s35, s31, s33
    s_mul_i32 s36, s32, 1792
    s_lshl_b32 s37, s35, 5
    s_add_u32 s36, s36, s37
    s_add_u32 s36, s36, 448
    v_add_u32 v5, s36, v4
    s_movk_i32 s37, 896
    v_mul_lo_u32 v5, v5, s37
    v_lshl_add_u32 v5, v3, 4, v5
    s_mov_b32 s37, 0
    buffer_load_dwordx4 a[0:3], v5, s[16:19], s37 offen offset:0
    buffer_load_dwordx4 a[4:7], v5, s[16:19], s37 offen offset:64
    buffer_load_dwordx4 a[8:11], v5, s[16:19], s37 offen offset:128
    buffer_load_dwordx4 a[12:15], v5, s[16:19], s37 offen offset:192
    buffer_load_dwordx4 a[16:19], v5, s[16:19], s37 offen offset:256
    buffer_load_dwordx4 a[20:23], v5, s[16:19], s37 offen offset:320
    buffer_load_dwordx4 a[24:27], v5, s[16:19], s37 offen offset:384
    buffer_load_dwordx4 a[28:31], v5, s[16:19], s37 offen offset:448
    buffer_load_dwordx4 a[32:35], v5, s[16:19], s37 offen offset:512
    buffer_load_dwordx4 a[36:39], v5, s[16:19], s37 offen offset:576
    buffer_load_dwordx4 a[40:43], v5, s[16:19], s37 offen offset:640
    buffer_load_dwordx4 a[44:47], v5, s[16:19], s37 offen offset:704
    buffer_load_dwordx4 a[48:51], v5, s[16:19], s37 offen offset:768
    buffer_load_dwordx4 a[52:55], v5, s[16:19], s37 offen offset:832
    s_mov_b32 s37, 14336
    buffer_load_dwordx4 a[56:59], v5, s[16:19], s37 offen offset:0
    buffer_load_dwordx4 a[60:63], v5, s[16:19], s37 offen offset:64
    buffer_load_dwordx4 a[64:67], v5, s[16:19], s37 offen offset:128
    buffer_load_dwordx4 a[68:71], v5, s[16:19], s37 offen offset:192
    buffer_load_dwordx4 a[72:75], v5, s[16:19], s37 offen offset:256
    buffer_load_dwordx4 a[76:79], v5, s[16:19], s37 offen offset:320
    buffer_load_dwordx4 a[80:83], v5, s[16:19], s37 offen offset:384
    buffer_load_dwordx4 a[84:87], v5, s[16:19], s37 offen offset:448
    buffer_load_dwordx4 a[88:91], v5, s[16:19], s37 offen offset:512
    buffer_load_dwordx4 a[92:95], v5, s[16:19], s37 offen offset:576
    buffer_load_dwordx4 a[96:99], v5, s[16:19], s37 offen offset:640
    buffer_load_dwordx4 a[100:103], v5, s[16:19], s37 offen offset:704
    buffer_load_dwordx4 a[104:107], v5, s[16:19], s37 offen offset:768
    buffer_load_dwordx4 a[108:111], v5, s[16:19], s37 offen offset:832
    s_mov_b32 s37, 802816
    buffer_load_dwordx4 a[112:115], v5, s[16:19], s37 offen offset:0
    buffer_load_dwordx4 a[116:119], v5, s[16:19], s37 offen offset:64
    buffer_load_dwordx4 a[120:123], v5, s[16:19], s37 offen offset:128
    buffer_load_dwordx4 a[124:127], v5, s[16:19], s37 offen offset:192
    buffer_load_dwordx4 a[128:131], v5, s[16:19], s37 offen offset:256
    buffer_load_dwordx4 a[132:135], v5, s[16:19], s37 offen offset:320
    buffer_load_dwordx4 a[136:139], v5, s[16:19], s37 offen offset:384
    buffer_load_dwordx4 a[140:143], v5, s[16:19], s37 offen offset:448
    buffer_load_dwordx4 a[144:147], v5, s[16:19], s37 offen offset:512
    buffer_load_dwordx4 a[148:151], v5, s[16:19], s37 offen offset:576
    buffer_load_dwordx4 a[152:155], v5, s[16:19], s37 offen offset:640
    buffer_load_dwordx4 a[156:159], v5, s[16:19], s37 offen offset:704
    buffer_load_dwordx4 a[160:163], v5, s[16:19], s37 offen offset:768
    buffer_load_dwordx4 a[164:167], v5, s[16:19], s37 offen offset:832
    s_mov_b32 s37, 817152
    buffer_load_dwordx4 a[168:171], v5, s[16:19], s37 offen offset:0
    buffer_load_dwordx4 a[172:175], v5, s[16:19], s37 offen offset:64
    buffer_load_dwordx4 a[176:179], v5, s[16:19], s37 offen offset:128
    buffer_load_dwordx4 a[180:183], v5, s[16:19], s37 offen offset:192
    buffer_load_dwordx4 a[184:187], v5, s[16:19], s37 offen offset:256
    buffer_load_dwordx4 a[188:191], v5, s[16:19], s37 offen offset:320
    buffer_load_dwordx4 a[192:195], v5, s[16:19], s37 offen offset:384
    buffer_load_dwordx4 a[196:199], v5, s[16:19], s37 offen offset:448
    buffer_load_dwordx4 a[200:203], v5, s[16:19], s37 offen offset:512
    buffer_load_dwordx4 a[204:207], v5, s[16:19], s37 offen offset:576
    buffer_load_dwordx4 a[208:211], v5, s[16:19], s37 offen offset:640
    buffer_load_dwordx4 a[212:215], v5, s[16:19], s37 offen offset:704
    buffer_load_dwordx4 a[216:219], v5, s[16:19], s37 offen offset:768
    buffer_load_dwordx4 a[220:223], v5, s[16:19], s37 offen offset:832
    v_and_b32 v6, 7, v4
    v_mul_u32_u24 v6, 896, v6
    v_lshl_add_u32 v6, v3, 4, v6
    v_and_b32 v7, 1, v3
    v_lshlrev_b32 v7, 3, v7
    v_lshl_add_u32 v7, v4, 4, v7
    s_mul_i32 s37, s32, 14336
    s_lshl_b32 s38, s35, 9
    s_add_u32 s37, s37, s38
    v_add_u32 v7, s37, v7
    v_add_u32 v8, 7168, v7
    s_mov_b32 s40, s44
    s_mul_i32 s41, s44, 122880
    s_add_u32 s42, s41, 117440512
    s_add_u32 s41, s41, 104857600
    s_lshl_b32 s43, s44, 7
    s_add_u32 s43, s43, 100818944
L_um_loop_w:
    s_mov_b32 s49, 1000000
L_um_p_w:
    buffer_load_dwordx4 v[68:71], v6, s[16:19], s41 offen offset:832 sc1
    s_waitcnt vmcnt(0)
    v_cmp_eq_u32 vcc, -1, v68
    s_cbranch_vccnz L_um_sl_w
    buffer_load_dwordx4 v[16:19], v6, s[16:19], s41 offen offset:0 sc1
    buffer_load_dwordx4 v[20:23], v6, s[16:19], s41 offen offset:64 sc1
    buffer_load_dwordx4 v[24:27], v6, s[16:19], s41 offen offset:128 sc1
    buffer_load_dwordx4 v[28:31], v6, s[16:19], s41 offen offset:192 sc1
    buffer_load_dwordx4 v[32:35], v6, s[16:19], s41 offen offset:256 sc1
    buffer_load_dwordx4 v[36:39], v6, s[16:19], s41 offen offset:320 sc1
    buffer_load_dwordx4 v[40:43], v6, s[16:19], s41 offen offset:384 sc1
    buffer_load_dwordx4 v[44:47], v6, s[16:19], s41 offen offset:448 sc1
    buffer_load_dwordx4 v[48:51], v6, s[16:19], s41 offen offset:512 sc1
    buffer_load_dwordx4 v[52:55], v6, s[16:19], s41 offen offset:576 sc1
    buffer_load_dwordx4 v[56:59], v6, s[16:19], s41 offen offset:640 sc1
    buffer_load_dwordx4 v[60:63], v6, s[16:19], s41 offen offset:704 sc1
    buffer_load_dwordx4 v[64:67], v6, s[16:19], s41 offen offset:768 sc1
    buffer_load_dwordx4 v[68:71], v6, s[16:19], s41 offen offset:832 sc1
    s_waitcnt vmcnt(0)
    v_max3_u32 v9, v16, v17, v18
    v_max3_u32 v9, v9, v19, v20
    v_max3_u32 v9, v9, v21, v22
    v_max3_u32 v9, v9, v23, v24
    v_max3_u32 v9, v9, v25, v26
    v_max3_u32 v9, v9, v27, v28
    v_max3_u32 v9, v9, v29, v30
    v_max3_u32 v9, v9, v31, v32
    v_max3_u32 v9, v9, v33, v34
    v_max3_u32 v9, v9, v35, v36
    v_max3_u32 v9, v9, v37, v38
    v_max3_u32 v9, v9, v39, v40
    v_max3_u32 v9, v9, v41, v42
    v_max3_u32 v9, v9, v43, v44
    v_max3_u32 v9, v9, v45, v46
    v_max3_u32 v9, v9, v47, v48
    v_max3_u32 v9, v9, v49, v50
    v_max3_u32 v9, v9, v51, v52
    v_max3_u32 v9, v9, v53, v54
    v_max3_u32 v9, v9, v55, v56
    v_max3_u32 v9, v9, v57, v58
    v_max3_u32 v9, v9, v59, v60
    v_max3_u32 v9, v9, v61, v62
    v_max3_u32 v9, v9, v63, v64
    v_max3_u32 v9, v9, v65, v66
    v_max3_u32 v9, v9, v67, v68
    v_max3_u32 v9, v9, v69, v70
    v_max_u32 v9, v9, v71
    v_cmp_eq_u32 vcc, -1, v9
    s_cbranch_vccz L_um_ok_w
L_um_sl_w:
    s_sleep 2
    s_sub_u32 s49, s49, 1
    s_cmp_lg_u32 s49, 0
    s_cbranch_scc1 L_um_p_w
L_um_ok_w:
    v_mfma_f32_16x16x32_bf16 v[72:75], v[16:19], a[0:3], 0
    v_mfma_f32_16x16x32_bf16 v[76:79], v[16:19], a[56:59], 0
    v_mfma_f32_16x16x32_bf16 v[80:83], v[16:19], a[112:115], 0
    v_mfma_f32_16x16x32_bf16 v[84:87], v[16:19], a[168:171], 0
    v_mfma_f32_16x16x32_bf16 v[72:75], v[20:23], a[4:7], v[72:75]
    v_mfma_f32_16x16x32_bf16 v[76:79], v[20:23], a[60:63], v[76:79]
    v_mfma_f32_16x16x32_bf16 v[80:83], v[20:23], a[116:119], v[80:83]
    v_mfma_f32_16x16x32_bf16 v[84:87], v[20:23], a[172:175], v[84:87]
    v_mfma_f32_16x16x32_bf16 v[72:75], v[24:27], a[8:11], v[72:75]
    v_mfma_f32_16x16x32_bf16 v[76:79], v[24:27], a[64:67], v[76:79]
    v_mfma_f32_16x16x32_bf16 v[80:83], v[24:27], a[120:123], v[80:83]
    v_mfma_f32_16x16x32_bf16 v[84:87], v[24:27], a[176:179], v[84:87]
    v_mfma_f32_16x16x32_bf16 v[72:75], v[28:31], a[12:15], v[72:75]
    v_mfma_f32_16x16x32_bf16 v[76:79], v[28:31], a[68:71], v[76:79]
    v_mfma_f32_16x16x32_bf16 v[80:83], v[28:31], a[124:127], v[80:83]
    v_mfma_f32_16x16x32_bf16 v[84:87], v[28:31], a[180:183], v[84:87]
    v_mfma_f32_16x16x32_bf16 v[72:75], v[32:35], a[16:19], v[72:75]
    v_mfma_f32_16x16x32_bf16 v[76:79], v[32:35], a[72:75], v[76:79]
    v_mfma_f32_16x16x32_bf16 v[80:83], v[32:35], a[128:131], v[80:83]
    v_mfma_f32_16x16x32_bf16 v[84:87], v[32:35], a[184:187], v[84:87]
    v_mfma_f32_16x16x32_bf16 v[72:75], v[36:39], a[20:23], v[72:75]
    v_mfma_f32_16x16x32_bf16 v[76:79], v[36:39], a[76:79], v[76:79]
    v_mfma_f32_16x16x32_bf16 v[80:83], v[36:39], a[132:135], v[80:83]
    v_mfma_f32_16x16x32_bf16 v[84:87], v[36:39], a[188:191], v[84:87]
    v_mfma_f32_16x16x32_bf16 v[72:75], v[40:43], a[24:27], v[72:75]
    v_mfma_f32_16x16x32_bf16 v[76:79], v[40:43], a[80:83], v[76:79]
    v_mfma_f32_16x16x32_bf16 v[80:83], v[40:43], a[136:139], v[80:83]
    v_mfma_f32_16x16x32_bf16 v[84:87], v[40:43], a[192:195], v[84:87]
    v_mfma_f32_16x16x32_bf16 v[72:75], v[44:47], a[28:31], v[72:75]
    v_mfma_f32_16x16x32_bf16 v[76:79], v[44:47], a[84:87], v[76:79]
    v_mfma_f32_16x16x32_bf16 v[80:83], v[44:47], a[140:143], v[80:83]
    v_mfma_f32_16x16x32_bf16 v[84:87], v[44:47], a[196:199], v[84:87]
    v_mfma_f32_16x16x32_bf16 v[72:75], v[48:51], a[32:35], v[72:75]
    v_mfma_f32_16x16x32_bf16 v[76:79], v[48:51], a[88:91], v[76:79]
    v_mfma_f32_16x16x32_bf16 v[80:83], v[48:51], a[144:147], v[80:83]
    v_mfma_f32_16x16x32_bf16 v[84:87], v[48:51], a[200:203], v[84:87]
    v_mfma_f32_16x16x32_bf16 v[72:75], v[52:55], a[36:39], v[72:75]
    v_mfma_f32_16x16x32_bf16 v[76:79], v[52:55], a[92:95], v[76:79]
    v_mfma_f32_16x16x32_bf16 v[80:83], v[52:55], a[148:151], v[80:83]
    v_mfma_f32_16x16x32_bf16 v[84:87], v[52:55], a[204:207], v[84:87]
    v_mfma_f32_16x16x32_bf16 v[72:75], v[56:59], a[40:43], v[72:75]
    v_mfma_f32_16x16x32_bf16 v[76:79], v[56:59], a[96:99], v[76:79]
    v_mfma_f32_16x16x32_bf16 v[80:83], v[56:59], a[152:155], v[80:83]
    v_mfma_f32_16x16x32_bf16 v[84:87], v[56:59], a[208:211], v[84:87]
    v_mfma_f32_16x16x32_bf16 v[72:75], v[60:63], a[44:47], v[72:75]
    v_mfma_f32_16x16x32_bf16 v[76:79], v[60:63], a[100:103], v[76:79]
    v_mfma_f32_16x16x32_bf16 v[80:83], v[60:63], a[156:159], v[80:83]
    v_mfma_f32_16x16x32_bf16 v[84:87], v[60:63], a[212:215], v[84:87]
    v_mfma_f32_16x16x32_bf16 v[72:75], v[64:67], a[48:51], v[72:75]
    v_mfma_f32_16x16x32_bf16 v[76:79], v[64:67], a[104:107], v[76:79]
    v_mfma_f32_16x16x32_bf16 v[80:83], v[64:67], a[160:163], v[80:83]
    v_mfma_f32_16x16x32_bf16 v[84:87], v[64:67], a[216:219], v[84:87]
    v_mfma_f32_16x16x32_bf16 v[72:75], v[68:71], a[52:55], v[72:75]
    v_mfma_f32_16x16x32_bf16 v[76:79], v[68:71], a[108:111], v[76:79]
    v_mfma_f32_16x16x32_bf16 v[80:83], v[68:71], a[164:167], v[80:83]
    v_mfma_f32_16x16x32_bf16 v[84:87], v[68:71], a[220:223], v[84:87]
    s_mov_b32 exec_hi, 0
    s_nop 3
    v_cvt_pk_bf16_f32 v88, v72, v73
    v_cvt_pk_bf16_f32 v89, v74, v75
    buffer_store_dwordx2 v[88:89], v7, s[16:19], s42 offen offset:0 sc1
    v_cvt_pk_bf16_f32 v90, v76, v77
    v_cvt_pk_bf16_f32 v91, v78, v79
    buffer_store_dwordx2 v[90:91], v7, s[16:19], s42 offen offset:256 sc1
    v_cvt_pk_bf16_f32 v92, v80, v81
    v_cvt_pk_bf16_f32 v93, v82, v83
    buffer_store_dwordx2 v[92:93], v8, s[16:19], s42 offen offset:0 sc1
    v_cvt_pk_bf16_f32 v94, v84, v85
    v_cvt_pk_bf16_f32 v95, v86, v87
    buffer_store_dwordx2 v[94:95], v8, s[16:19], s42 offen offset:256 sc1
    s_mov_b64 exec, -1
    s_waitcnt vmcnt(0)
    s_barrier
    s_cmp_lg_u32 s20, 0
    s_cbranch_scc1 L_um_n_w
    v_mov_b32 v96, 1
    v_mov_b32 v97, 0
    s_mov_b64 exec, 1
    buffer_atomic_add v96, v97, s[16:19], s43 offen sc1
    s_mov_b64 exec, -1
L_um_n_w:
    s_add_u32 s41, s41, 368640
    s_add_u32 s42, s42, 368640
    s_add_u32 s43, s43, 384
    s_add_u32 s40, s40, 3
    s_cmp_lt_u32 s40, 64
    s_cbranch_scc1 L_um_loop_w
    s_branch L_w_fin
L_w_noum:
    s_cmp_ge_u32 s21, 132
    s_cbranch_scc1 L_w_fin
    s_cmp_ge_u32 s21, 68
    s_cbranch_scc1 L_w_b2
    s_cmp_ge_u32 s21, 64
    s_cbranch_scc1 L_w_r
    s_and_b32 s30, s21, 3
    s_lshl_b32 s30, s30, 2
    s_add_u32 s30, s30, s20
    s_lshr_b32 s31, s21, 2
    s_lshl_b32 s36, s30, 5
    v_add_u32 v5, s36, v4
    s_movk_i32 s37, 896
    v_mul_lo_u32 v5, v5, s37
    v_lshl_add_u32 v5, v3, 4, v5
    s_mov_b32 s37, 14090240
    buffer_load_dwordx4 a[0:3], v5, s[16:19], s37 offen offset:0
    buffer_load_dwordx4 a[4:7], v5, s[16:19], s37 offen offset:64
    buffer_load_dwordx4 a[8:11], v5, s[16:19], s37 offen offset:128
    buffer_load_dwordx4 a[12:15], v5, s[16:19], s37 offen offset:192
    buffer_load_dwordx4 a[16:19], v5, s[16:19], s37 offen offset:256
    buffer_load_dwordx4 a[20:23], v5, s[16:19], s37 offen offset:320
    buffer_load_dwordx4 a[24:27], v5, s[16:19], s37 offen offset:384
    buffer_load_dwordx4 a[28:31], v5, s[16:19], s37 offen offset:448
    buffer_load_dwordx4 a[32:35], v5, s[16:19], s37 offen offset:512
    buffer_load_dwordx4 a[36:39], v5, s[16:19], s37 offen offset:576
    buffer_load_dwordx4 a[40:43], v5, s[16:19], s37 offen offset:640
    buffer_load_dwordx4 a[44:47], v5, s[16:19], s37 offen offset:704
    buffer_load_dwordx4 a[48:51], v5, s[16:19], s37 offen offset:768
    buffer_load_dwordx4 a[52:55], v5, s[16:19], s37 offen offset:832
    s_mov_b32 s37, 14104576
    buffer_load_dwordx4 a[56:59], v5, s[16:19], s37 offen offset:0
    buffer_load_dwordx4 a[60:63], v5, s[16:19], s37 offen offset:64
    buffer_load_dwordx4 a[64:67], v5, s[16:19], s37 offen offset:128
    buffer_load_dwordx4 a[68:71], v5, s[16:19], s37 offen offset:192
    buffer_load_dwordx4 a[72:75], v5, s[16:19], s37 offen offset:256
    buffer_load_dwordx4 a[76:79], v5, s[16:19], s37 offen offset:320
    buffer_load_dwordx4 a[80:83], v5, s[16:19], s37 offen offset:384
    buffer_load_dwordx4 a[84:87], v5, s[16:19], s37 offen offset:448
    buffer_load_dwordx4 a[88:91], v5, s[16:19], s37 offen offset:512
    buffer_load_dwordx4 a[92:95], v5, s[16:19], s37 offen offset:576
    buffer_load_dwordx4 a[96:99], v5, s[16:19], s37 offen offset:640
    buffer_load_dwordx4 a[100:103], v5, s[16:19], s37 offen offset:704
    buffer_load_dwordx4 a[104:107], v5, s[16:19], s37 offen offset:768
    buffer_load_dwordx4 a[108:111], v5, s[16:19], s37 offen offset:832
    s_mov_b32 s37, 14548992
    buffer_load_dwordx4 a[112:115], v5, s[16:19], s37 offen offset:0
    buffer_load_dwordx4 a[116:119], v5, s[16:19], s37 offen offset:64
    buffer_load_dwordx4 a[120:123], v5, s[16:19], s37 offen offset:128
    buffer_load_dwordx4 a[124:127], v5, s[16:19], s37 offen offset:192
    buffer_load_dwordx4 a[128:131], v5, s[16:19], s37 offen offset:256
    buffer_load_dwordx4 a[132:135], v5, s[16:19], s37 offen offset:320
    buffer_load_dwordx4 a[136:139], v5, s[16:19], s37 offen offset:384
    buffer_load_dwordx4 a[140:143], v5, s[16:19], s37 offen offset:448
    buffer_load_dwordx4 a[144:147], v5, s[16:19], s37 offen offset:512
    buffer_load_dwordx4 a[148:151], v5, s[16:19], s37 offen offset:576
    buffer_load_dwordx4 a[152:155], v5, s[16:19], s37 offen offset:640
    buffer_load_dwordx4 a[156:159], v5, s[16:19], s37 offen offset:704
    buffer_load_dwordx4 a[160:163], v5, s[16:19], s37 offen offset:768
    buffer_load_dwordx4 a[164:167], v5, s[16:19], s37 offen offset:832
    s_mov_b32 s37, 14563328
    buffer_load_dwordx4 a[168:171], v5, s[16:19], s37 offen offset:0
    buffer_load_dwordx4 a[172:175], v5, s[16:19], s37 offen offset:64
    buffer_load_dwordx4 a[176:179], v5, s[16:19], s37 offen offset:128
    buffer_load_dwordx4 a[180:183], v5, s[16:19], s37 offen offset:192
    buffer_load_dwordx4 a[184:187], v5, s[16:19], s37 offen offset:256
    buffer_load_dwordx4 a[188:191], v5, s[16:19], s37 offen offset:320
    buffer_load_dwordx4 a[192:195], v5, s[16:19], s37 offen offset:384
    buffer_load_dwordx4 a[196:199], v5, s[16:19], s37 offen offset:448
    buffer_load_dwordx4 a[200:203], v5, s[16:19], s37 offen offset:512
    buffer_load_dwordx4 a[204:207], v5, s[16:19], s37 offen offset:576
    buffer_load_dwordx4 a[208:211], v5, s[16:19], s37 offen offset:640
    buffer_load_dwordx4 a[212:215], v5, s[16:19], s37 offen offset:704
    buffer_load_dwordx4 a[216:219], v5, s[16:19], s37 offen offset:768
    buffer_load_dwordx4 a[220:223], v5, s[16:19], s37 offen offset:832
    v_add_u32 v6, 0, v0
    s_mov_b32 s37, 0x04924925
    v_mul_hi_u32 v7, v6, s37
    v_mul_u32_u24 v8, 56, v7
    v_sub_u32 v6, v6, v8
    v_mul_u32_u24 v8, 912, v7
    v_lshl_add_u32 v8, v6, 4, v8
    v_add_u32 v6, 256, v0
    s_mov_b32 s37, 0x04924925
    v_mul_hi_u32 v7, v6, s37
    v_mul_u32_u24 v9, 56, v7
    v_sub_u32 v6, v6, v9
    v_mul_u32_u24 v9, 912, v7
    v_lshl_add_u32 v9, v6, 4, v9
    v_add_u32 v6, 512, v0
    s_mov_b32 s37, 0x04924925
    v_mul_hi_u32 v7, v6, s37
    v_mul_u32_u24 v10, 56, v7
    v_sub_u32 v6, v6, v10
    v_mul_u32_u24 v10, 912, v7
    v_lshl_add_u32 v10, v6, 4, v10
    v_add_u32 v6, 768, v0
    s_mov_b32 s37, 0x04924925
    v_mul_hi_u32 v7, v6, s37
    v_mul_u32_u24 v11, 56, v7
    v_sub_u32 v6, v6, v11
    v_mul_u32_u24 v11, 912, v7
    v_lshl_add_u32 v11, v6, 4, v11
    v_add_u32 v6, 1024, v0
    s_mov_b32 s37, 0x04924925
    v_mul_hi_u32 v7, v6, s37
    v_mul_u32_u24 v12, 56, v7
    v_sub_u32 v6, v6, v12
    v_mul_u32_u24 v12, 912, v7
    v_lshl_add_u32 v12, v6, 4, v12
    v_add_u32 v6, 1280, v0
    s_mov_b32 s37, 0x04924925
    v_mul_hi_u32 v7, v6, s37
    v_mul_u32_u24 v13, 56, v7
    v_sub_u32 v6, v6, v13
    v_mul_u32_u24 v13, 912, v7
    v_lshl_add_u32 v13, v6, 4, v13
    v_add_u32 v6, 1536, v0
    s_mov_b32 s37, 0x04924925
    v_mul_hi_u32 v7, v6, s37
    v_mul_u32_u24 v14, 56, v7
    v_sub_u32 v6, v6, v14
    v_mul_u32_u24 v14, 912, v7
    v_lshl_add_u32 v14, v6, 4, v14
    v_lshlrev_b32 v15, 4, v0
    v_mul_u32_u24 v6, 912, v4
    v_lshl_add_u32 v6, v3, 4, v6
    s_mul_i32 s39, s31, 114688
    s_mov_b32 s40, 0
    s_mov_b32 s41, 0
    s_mov_b32 s43, 1069066811
    v_cmp_lt_u32 s[44:45], 11, v4
    v_cmp_eq_u32 s[46:47], 12, v4
    v_mov_b32 v2, 0xff800000
    v_mov_b32 v7, 0x7f800000
    v_mov_b32 v92, 0
    v_mov_b32 v93, 0
    v_mov_b32 v94, 0
    v_mov_b32 v95, 0
    v_mov_b32 v96, 0
    v_mov_b32 v97, 0
    v_mov_b32 v98, 0
    v_mov_b32 v99, 0
    v_mov_b32 v100, 0
    v_mov_b32 v101, 0
    v_mov_b32 v102, 0
    v_mov_b32 v103, 0
    v_mov_b32 v104, 0
    v_mov_b32 v105, 0
    v_mov_b32 v106, 0
    v_mov_b32 v107, 0
    v_mov_b32 v108, 0
    v_mov_b32 v109, 0
    v_mov_b32 v110, 0
    v_mov_b32 v111, 0
    v_mov_b32 v112, 0
    v_mov_b32 v113, 0
    v_mov_b32 v114, 0
    v_mov_b32 v115, 0
    v_mov_b32 v116, 0
    v_mov_b32 v117, 0
    v_mov_b32 v118, 0
    v_mov_b32 v119, 0
    v_mov_b32 v120, 0
    v_mov_b32 v121, 0
    v_mov_b32 v122, 0
    v_mov_b32 v123, 0
    s_add_u32 s37, s39, 0
    buffer_load_dwordx4 v[16:19], v15, s[12:15], s37 offen
    s_add_u32 s37, s39, 4096
    buffer_load_dwordx4 v[20:23], v15, s[12:15], s37 offen
    s_add_u32 s37, s39, 8192
    buffer_load_dwordx4 v[24:27], v15, s[12:15], s37 offen
    s_add_u32 s37, s39, 12288
    buffer_load_dwordx4 v[28:31], v15, s[12:15], s37 offen
    s_add_u32 s37, s39, 16384
    buffer_load_dwordx4 v[32:35], v15, s[12:15], s37 offen
    s_add_u32 s37, s39, 20480
    buffer_load_dwordx4 v[36:39], v15, s[12:15], s37 offen
    s_add_u32 s37, s39, 24576
    buffer_load_dwordx4 v[40:43], v15, s[12:15], s37 offen
    s_add_u32 s39, s39, 28672
    s_waitcnt vmcnt(0)
    v_add_u32 v5, s41, v8
    ds_write_b128 v5, v[16:19]
    v_add_u32 v5, s41, v9
    ds_write_b128 v5, v[20:23]
    v_add_u32 v5, s41, v10
    ds_write_b128 v5, v[24:27]
    v_add_u32 v5, s41, v11
    ds_write_b128 v5, v[28:31]
    v_add_u32 v5, s41, v12
    ds_write_b128 v5, v[32:35]
    v_add_u32 v5, s41, v13
    ds_write_b128 v5, v[36:39]
    v_add_u32 v5, s41, v14
    ds_write_b128 v5, v[40:43]
    s_waitcnt lgkmcnt(0)
    s_barrier
L_b1_loop_w:
    s_add_u32 s37, s39, 0
    buffer_load_dwordx4 v[16:19], v15, s[12:15], s37 offen
    s_add_u32 s37, s39, 4096
    buffer_load_dwordx4 v[20:23], v15, s[12:15], s37 offen
    s_add_u32 s37, s39, 8192
    buffer_load_dwordx4 v[24:27], v15, s[12:15], s37 offen
    s_add_u32 s37, s39, 12288
    buffer_load_dwordx4 v[28:31], v15, s[12:15], s37 offen
    s_add_u32 s37, s39, 16384
    buffer_load_dwordx4 v[32:35], v15, s[12:15], s37 offen
    s_add_u32 s37, s39, 20480
    buffer_load_dwordx4 v[36:39], v15, s[12:15], s37 offen
    s_add_u32 s37, s39, 24576
    buffer_load_dwordx4 v[40:43], v15, s[12:15], s37 offen
    s_add_u32 s39, s39, 28672
    v_add_u32 v5, s41, v6
    ds_read_b128 v[44:47], v5 offset:0
    ds_read_b128 v[48:51], v5 offset:14592
    ds_read_b128 v[52:55], v5 offset:64
    ds_read_b128 v[56:59], v5 offset:14656
    s_waitcnt lgkmcnt(2)
    v_mfma_f32_16x16x32_bf16 v[60:63], v[44:47], a[0:3], 0
    v_mfma_f32_16x16x32_bf16 v[64:67], v[44:47], a[56:59], 0
    v_mfma_f32_16x16x32_bf16 v[68:71], v[44:47], a[112:115], 0
    v_mfma_f32_16x16x32_bf16 v[72:75], v[44:47], a[168:171], 0
    v_mfma_f32_16x16x32_bf16 v[76:79], v[48:51], a[0:3], 0
    v_mfma_f32_16x16x32_bf16 v[80:83], v[48:51], a[56:59], 0
    v_mfma_f32_16x16x32_bf16 v[84:87], v[48:51], a[112:115], 0
    v_mfma_f32_16x16x32_bf16 v[88:91], v[48:51], a[168:171], 0
    ds_read_b128 v[44:47], v5 offset:128
    ds_read_b128 v[48:51], v5 offset:14720
    s_waitcnt lgkmcnt(2)
    v_mfma_f32_16x16x32_bf16 v[60:63], v[52:55], a[4:7], v[60:63]
    v_mfma_f32_16x16x32_bf16 v[64:67], v[52:55], a[60:63], v[64:67]
    v_mfma_f32_16x16x32_bf16 v[68:71], v[52:55], a[116:119], v[68:71]
    v_mfma_f32_16x16x32_bf16 v[72:75], v[52:55], a[172:175], v[72:75]
    v_mfma_f32_16x16x32_bf16 v[76:79], v[56:59], a[4:7], v[76:79]
    v_mfma_f32_16x16x32_bf16 v[80:83], v[56:59], a[60:63], v[80:83]
    v_mfma_f32_16x16x32_bf16 v[84:87], v[56:59], a[116:119], v[84:87]
    v_mfma_f32_16x16x32_bf16 v[88:91], v[56:59], a[172:175], v[88:91]
    ds_read_b128 v[52:55], v5 offset:192
    ds_read_b128 v[56:59], v5 offset:14784
    s_waitcnt lgkmcnt(2)
    v_mfma_f32_16x16x32_bf16 v[60:63], v[44:47], a[8:11], v[60:63]
    v_mfma_f32_16x16x32_bf16 v[64:67], v[44:47], a[64:67], v[64:67]
    v_mfma_f32_16x16x32_bf16 v[68:71], v[44:47], a[120:123], v[68:71]
    v_mfma_f32_16x16x32_bf16 v[72:75], v[44:47], a[176:179], v[72:75]
    v_mfma_f32_16x16x32_bf16 v[76:79], v[48:51], a[8:11], v[76:79]
    v_mfma_f32_16x16x32_bf16 v[80:83], v[48:51], a[64:67], v[80:83]
    v_mfma_f32_16x16x32_bf16 v[84:87], v[48:51], a[120:123], v[84:87]
    v_mfma_f32_16x16x32_bf16 v[88:91], v[48:51], a[176:179], v[88:91]
    ds_read_b128 v[44:47], v5 offset:256
    ds_read_b128 v[48:51], v5 offset:14848
    s_waitcnt lgkmcnt(2)
    v_mfma_f32_16x16x32_bf16 v[60:63], v[52:55], a[12:15], v[60:63]
    v_mfma_f32_16x16x32_bf16 v[64:67], v[52:55], a[68:71], v[64:67]
    v_mfma_f32_16x16x32_bf16 v[68:71], v[52:55], a[124:127], v[68:71]
    v_mfma_f32_16x16x32_bf16 v[72:75], v[52:55], a[180:183], v[72:75]
    v_mfma_f32_16x16x32_bf16 v[76:79], v[56:59], a[12:15], v[76:79]
    v_mfma_f32_16x16x32_bf16 v[80:83], v[56:59], a[68:71], v[80:83]
    v_mfma_f32_16x16x32_bf16 v[84:87], v[56:59], a[124:127], v[84:87]
    v_mfma_f32_16x16x32_bf16 v[88:91], v[56:59], a[180:183], v[88:91]
    ds_read_b128 v[52:55], v5 offset:320
    ds_read_b128 v[56:59], v5 offset:14912
    s_waitcnt lgkmcnt(2)
    v_mfma_f32_16x16x32_bf16 v[60:63], v[44:47], a[16:19], v[60:63]
    v_mfma_f32_16x16x32_bf16 v[64:67], v[44:47], a[72:75], v[64:67]
    v_mfma_f32_16x16x32_bf16 v[68:71], v[44:47], a[128:131], v[68:71]
    v_mfma_f32_16x16x32_bf16 v[72:75], v[44:47], a[184:187], v[72:75]
    v_mfma_f32_16x16x32_bf16 v[76:79], v[48:51], a[16:19], v[76:79]
    v_mfma_f32_16x16x32_bf16 v[80:83], v[48:51], a[72:75], v[80:83]
    v_mfma_f32_16x16x32_bf16 v[84:87], v[48:51], a[128:131], v[84:87]
    v_mfma_f32_16x16x32_bf16 v[88:91], v[48:51], a[184:187], v[88:91]
    ds_read_b128 v[44:47], v5 offset:384
    ds_read_b128 v[48:51], v5 offset:14976
    s_waitcnt lgkmcnt(2)
    v_mfma_f32_16x16x32_bf16 v[60:63], v[52:55], a[20:23], v[60:63]
    v_mfma_f32_16x16x32_bf16 v[64:67], v[52:55], a[76:79], v[64:67]
    v_mfma_f32_16x16x32_bf16 v[68:71], v[52:55], a[132:135], v[68:71]
    v_mfma_f32_16x16x32_bf16 v[72:75], v[52:55], a[188:191], v[72:75]
    v_mfma_f32_16x16x32_bf16 v[76:79], v[56:59], a[20:23], v[76:79]
    v_mfma_f32_16x16x32_bf16 v[80:83], v[56:59], a[76:79], v[80:83]
    v_mfma_f32_16x16x32_bf16 v[84:87], v[56:59], a[132:135], v[84:87]
    v_mfma_f32_16x16x32_bf16 v[88:91], v[56:59], a[188:191], v[88:91]
    ds_read_b128 v[52:55], v5 offset:448
    ds_read_b128 v[56:59], v5 offset:15040
    s_waitcnt lgkmcnt(2)
    v_mfma_f32_16x16x32_bf16 v[60:63], v[44:47], a[24:27], v[60:63]
    v_mfma_f32_16x16x32_bf16 v[64:67], v[44:47], a[80:83], v[64:67]
    v_mfma_f32_16x16x32_bf16 v[68:71], v[44:47], a[136:139], v[68:71]
    v_mfma_f32_16x16x32_bf16 v[72:75], v[44:47], a[192:195], v[72:75]
    v_mfma_f32_16x16x32_bf16 v[76:79], v[48:51], a[24:27], v[76:79]
    v_mfma_f32_16x16x32_bf16 v[80:83], v[48:51], a[80:83], v[80:83]
    v_mfma_f32_16x16x32_bf16 v[84:87], v[48:51], a[136:139], v[84:87]
    v_mfma_f32_16x16x32_bf16 v[88:91], v[48:51], a[192:195], v[88:91]
    ds_read_b128 v[44:47], v5 offset:512
    ds_read_b128 v[48:51], v5 offset:15104
    s_waitcnt lgkmcnt(2)
    v_mfma_f32_16x16x32_bf16 v[60:63], v[52:55], a[28:31], v[60:63]
    v_mfma_f32_16x16x32_bf16 v[64:67], v[52:55], a[84:87], v[64:67]
    v_mfma_f32_16x16x32_bf16 v[68:71], v[52:55], a[140:143], v[68:71]
    v_mfma_f32_16x16x32_bf16 v[72:75], v[52:55], a[196:199], v[72:75]
    v_mfma_f32_16x16x32_bf16 v[76:79], v[56:59], a[28:31], v[76:79]
    v_mfma_f32_16x16x32_bf16 v[80:83], v[56:59], a[84:87], v[80:83]
    v_mfma_f32_16x16x32_bf16 v[84:87], v[56:59], a[140:143], v[84:87]
    v_mfma_f32_16x16x32_bf16 v[88:91], v[56:59], a[196:199], v[88:91]
    ds_read_b128 v[52:55], v5 offset:576
    ds_read_b128 v[56:59], v5 offset:15168
    s_waitcnt lgkmcnt(2)
    v_mfma_f32_16x16x32_bf16 v[60:63], v[44:47], a[32:35], v[60:63]
    v_mfma_f32_16x16x32_bf16 v[64:67], v[44:47], a[88:91], v[64:67]
    v_mfma_f32_16x16x32_bf16 v[68:71], v[44:47], a[144:147], v[68:71]
    v_mfma_f32_16x16x32_bf16 v[72:75], v[44:47], a[200:203], v[72:75]
    v_mfma_f32_16x16x32_bf16 v[76:79], v[48:51], a[32:35], v[76:79]
    v_mfma_f32_16x16x32_bf16 v[80:83], v[48:51], a[88:91], v[80:83]
    v_mfma_f32_16x16x32_bf16 v[84:87], v[48:51], a[144:147], v[84:87]
    v_mfma_f32_16x16x32_bf16 v[88:91], v[48:51], a[200:203], v[88:91]
    ds_read_b128 v[44:47], v5 offset:640
    ds_read_b128 v[48:51], v5 offset:15232
    s_waitcnt lgkmcnt(2)
    v_mfma_f32_16x16x32_bf16 v[60:63], v[52:55], a[36:39], v[60:63]
    v_mfma_f32_16x16x32_bf16 v[64:67], v[52:55], a[92:95], v[64:67]
    v_mfma_f32_16x16x32_bf16 v[68:71], v[52:55], a[148:151], v[68:71]
    v_mfma_f32_16x16x32_bf16 v[72:75], v[52:55], a[204:207], v[72:75]
    v_mfma_f32_16x16x32_bf16 v[76:79], v[56:59], a[36:39], v[76:79]
    v_mfma_f32_16x16x32_bf16 v[80:83], v[56:59], a[92:95], v[80:83]
    v_mfma_f32_16x16x32_bf16 v[84:87], v[56:59], a[148:151], v[84:87]
    v_mfma_f32_16x16x32_bf16 v[88:91], v[56:59], a[204:207], v[88:91]
    ds_read_b128 v[52:55], v5 offset:704
    ds_read_b128 v[56:59], v5 offset:15296
    s_waitcnt lgkmcnt(2)
    v_mfma_f32_16x16x32_bf16 v[60:63], v[44:47], a[40:43], v[60:63]
    v_mfma_f32_16x16x32_bf16 v[64:67], v[44:47], a[96:99], v[64:67]
    v_mfma_f32_16x16x32_bf16 v[68:71], v[44:47], a[152:155], v[68:71]
    v_mfma_f32_16x16x32_bf16 v[72:75], v[44:47], a[208:211], v[72:75]
    v_mfma_f32_16x16x32_bf16 v[76:79], v[48:51], a[40:43], v[76:79]
    v_mfma_f32_16x16x32_bf16 v[80:83], v[48:51], a[96:99], v[80:83]
    v_mfma_f32_16x16x32_bf16 v[84:87], v[48:51], a[152:155], v[84:87]
    v_mfma_f32_16x16x32_bf16 v[88:91], v[48:51], a[208:211], v[88:91]
    ds_read_b128 v[44:47], v5 offset:768
    ds_read_b128 v[48:51], v5 offset:15360
    s_waitcnt lgkmcnt(2)
    v_mfma_f32_16x16x32_bf16 v[60:63], v[52:55], a[44:47], v[60:63]
    v_mfma_f32_16x16x32_bf16 v[64:67], v[52:55], a[100:103], v[64:67]
    v_mfma_f32_16x16x32_bf16 v[68:71], v[52:55], a[156:159], v[68:71]
    v_mfma_f32_16x16x32_bf16 v[72:75], v[52:55], a[212:215], v[72:75]
    v_mfma_f32_16x16x32_bf16 v[76:79], v[56:59], a[44:47], v[76:79]
    v_mfma_f32_16x16x32_bf16 v[80:83], v[56:59], a[100:103], v[80:83]
    v_mfma_f32_16x16x32_bf16 v[84:87], v[56:59], a[156:159], v[84:87]
    v_mfma_f32_16x16x32_bf16 v[88:91], v[56:59], a[212:215], v[88:91]
    ds_read_b128 v[52:55], v5 offset:832
    ds_read_b128 v[56:59], v5 offset:15424
    s_waitcnt lgkmcnt(2)
    v_mfma_f32_16x16x32_bf16 v[60:63], v[44:47], a[48:51], v[60:63]
    v_mfma_f32_16x16x32_bf16 v[64:67], v[44:47], a[104:107], v[64:67]
    v_mfma_f32_16x16x32_bf16 v[68:71], v[44:47], a[160:163], v[68:71]
    v_mfma_f32_16x16x32_bf16 v[72:75], v[44:47], a[216:219], v[72:75]
    v_mfma_f32_16x16x32_bf16 v[76:79], v[48:51], a[48:51], v[76:79]
    v_mfma_f32_16x16x32_bf16 v[80:83], v[48:51], a[104:107], v[80:83]
    v_mfma_f32_16x16x32_bf16 v[84:87], v[48:51], a[160:163], v[84:87]
    v_mfma_f32_16x16x32_bf16 v[88:91], v[48:51], a[216:219], v[88:91]
    s_waitcnt lgkmcnt(0)
    v_mfma_f32_16x16x32_bf16 v[60:63], v[52:55], a[52:55], v[60:63]
    v_mfma_f32_16x16x32_bf16 v[64:67], v[52:55], a[108:111], v[64:67]
    v_mfma_f32_16x16x32_bf16 v[68:71], v[52:55], a[164:167], v[68:71]
    v_mfma_f32_16x16x32_bf16 v[72:75], v[52:55], a[220:223], v[72:75]
    v_mfma_f32_16x16x32_bf16 v[76:79], v[56:59], a[52:55], v[76:79]
    v_mfma_f32_16x16x32_bf16 v[80:83], v[56:59], a[108:111], v[80:83]
    v_mfma_f32_16x16x32_bf16 v[84:87], v[56:59], a[164:167], v[84:87]
    v_mfma_f32_16x16x32_bf16 v[88:91], v[56:59], a[220:223], v[88:91]
    s_nop 1
    v_cndmask_b32 v180, v64, v2, s[44:45]
    v_cndmask_b32 v181, v64, v7, s[44:45]
    v_max_f32 v180, v180, v60
    v_min_f32 v181, v181, v60
    s_nop 0
    v_max_f32_dpp v180, v180, v180 quad_perm:[1,0,3,2] row_mask:0xf bank_mask:0xf
    v_min_f32_dpp v181, v181, v181 quad_perm:[1,0,3,2] row_mask:0xf bank_mask:0xf
    s_nop 0
    v_max_f32_dpp v180, v180, v180 quad_perm:[2,3,0,1] row_mask:0xf bank_mask:0xf
    v_min_f32_dpp v181, v181, v181 quad_perm:[2,3,0,1] row_mask:0xf bank_mask:0xf
    s_nop 0
    v_max_f32_dpp v180, v180, v180 row_half_mirror row_mask:0xf bank_mask:0xf
    v_min_f32_dpp v181, v181, v181 row_half_mirror row_mask:0xf bank_mask:0xf
    s_nop 0
    v_max_f32_dpp v180, v180, v180 row_mirror row_mask:0xf bank_mask:0xf
    v_min_f32_dpp v181, v181, v181 row_mirror row_mask:0xf bank_mask:0xf
    v_sub_f32 v148, v60, v180
    v_sub_f32 v149, v64, v180
    v_sub_f32 v150, v181, v60
    v_sub_f32 v151, v181, v64
    v_mul_f32 v148, s43, v148
    v_mul_f32 v149, s43, v149
    v_mul_f32 v150, s43, v150
    v_mul_f32 v151, s43, v151
    v_exp_f32 v148, v148
    v_exp_f32 v149, v149
    v_exp_f32 v150, v150
    v_exp_f32 v151, v151
    v_cndmask_b32 v149, v149, 0, s[44:45]
    v_cndmask_b32 v151, v151, 0, s[44:45]
    v_add_f32 v182, v148, v149
    v_add_f32 v183, v150, v151
    s_nop 0
    v_add_f32_dpp v182, v182, v182 quad_perm:[1,0,3,2] row_mask:0xf bank_mask:0xf
    v_add_f32_dpp v183, v183, v183 quad_perm:[1,0,3,2] row_mask:0xf bank_mask:0xf
    s_nop 0
    v_add_f32_dpp v182, v182, v182 quad_perm:[2,3,0,1] row_mask:0xf bank_mask:0xf
    v_add_f32_dpp v183, v183, v183 quad_perm:[2,3,0,1] row_mask:0xf bank_mask:0xf
    s_nop 0
    v_add_f32_dpp v182, v182, v182 row_half_mirror row_mask:0xf bank_mask:0xf
    v_add_f32_dpp v183, v183, v183 row_half_mirror row_mask:0xf bank_mask:0xf
    s_nop 0
    v_add_f32_dpp v182, v182, v182 row_mirror row_mask:0xf bank_mask:0xf
    v_add_f32_dpp v183, v183, v183 row_mirror row_mask:0xf bank_mask:0xf
    v_rcp_f32 v182, v182
    v_rcp_f32 v183, v183
    v_mul_f32 v148, v148, v182
    v_mul_f32 v149, v149, v182
    v_mul_f32 v150, v150, v183
    v_mul_f32 v151, v151, v183
    v_cndmask_b32 v72, v72, 1.0, s[46:47]
    v_cndmask_b32 v180, v65, v2, s[44:45]
    v_cndmask_b32 v181, v65, v7, s[44:45]
    v_max_f32 v180, v180, v61
    v_min_f32 v181, v181, v61
    s_nop 0
    v_max_f32_dpp v180, v180, v180 quad_perm:[1,0,3,2] row_mask:0xf bank_mask:0xf
    v_min_f32_dpp v181, v181, v181 quad_perm:[1,0,3,2] row_mask:0xf bank_mask:0xf
    s_nop 0
    v_max_f32_dpp v180, v180, v180 quad_perm:[2,3,0,1] row_mask:0xf bank_mask:0xf
    v_min_f32_dpp v181, v181, v181 quad_perm:[2,3,0,1] row_mask:0xf bank_mask:0xf
    s_nop 0
    v_max_f32_dpp v180, v180, v180 row_half_mirror row_mask:0xf bank_mask:0xf
    v_min_f32_dpp v181, v181, v181 row_half_mirror row_mask:0xf bank_mask:0xf
    s_nop 0
    v_max_f32_dpp v180, v180, v180 row_mirror row_mask:0xf bank_mask:0xf
    v_min_f32_dpp v181, v181, v181 row_mirror row_mask:0xf bank_mask:0xf
    v_sub_f32 v152, v61, v180
    v_sub_f32 v153, v65, v180
    v_sub_f32 v154, v181, v61
    v_sub_f32 v155, v181, v65
    v_mul_f32 v152, s43, v152
    v_mul_f32 v153, s43, v153
    v_mul_f32 v154, s43, v154
    v_mul_f32 v155, s43, v155
    v_exp_f32 v152, v152
    v_exp_f32 v153, v153
    v_exp_f32 v154, v154
    v_exp_f32 v155, v155
    v_cndmask_b32 v153, v153, 0, s[44:45]
    v_cndmask_b32 v155, v155, 0, s[44:45]
    v_add_f32 v182, v152, v153
    v_add_f32 v183, v154, v155
    s_nop 0
    v_add_f32_dpp v182, v182, v182 quad_perm:[1,0,3,2] row_mask:0xf bank_mask:0xf
    v_add_f32_dpp v183, v183, v183 quad_perm:[1,0,3,2] row_mask:0xf bank_mask:0xf
    s_nop 0
    v_add_f32_dpp v182, v182, v182 quad_perm:[2,3,0,1] row_mask:0xf bank_mask:0xf
    v_add_f32_dpp v183, v183, v183 quad_perm:[2,3,0,1] row_mask:0xf bank_mask:0xf
    s_nop 0
    v_add_f32_dpp v182, v182, v182 row_half_mirror row_mask:0xf bank_mask:0xf
    v_add_f32_dpp v183, v183, v183 row_half_mirror row_mask:0xf bank_mask:0xf
    s_nop 0
    v_add_f32_dpp v182, v182, v182 row_mirror row_mask:0xf bank_mask:0xf
    v_add_f32_dpp v183, v183, v183 row_mirror row_mask:0xf bank_mask:0xf
    v_rcp_f32 v182, v182
    v_rcp_f32 v183, v183
    v_mul_f32 v152, v152, v182
    v_mul_f32 v153, v153, v182
    v_mul_f32 v154, v154, v183
    v_mul_f32 v155, v155, v183
    v_cndmask_b32 v73, v73, 1.0, s[46:47]
    v_cndmask_b32 v180, v66, v2, s[44:45]
    v_cndmask_b32 v181, v66, v7, s[44:45]
    v_max_f32 v180, v180, v62
    v_min_f32 v181, v181, v62
    s_nop 0
    v_max_f32_dpp v180, v180, v180 quad_perm:[1,0,3,2] row_mask:0xf bank_mask:0xf
    v_min_f32_dpp v181, v181, v181 quad_perm:[1,0,3,2] row_mask:0xf bank_mask:0xf
    s_nop 0
    v_max_f32_dpp v180, v180, v180 quad_perm:[2,3,0,1] row_mask:0xf bank_mask:0xf
    v_min_f32_dpp v181, v181, v181 quad_perm:[2,3,0,1] row_mask:0xf bank_mask:0xf
    s_nop 0
    v_max_f32_dpp v180, v180, v180 row_half_mirror row_mask:0xf bank_mask:0xf
    v_min_f32_dpp v181, v181, v181 row_half_mirror row_mask:0xf bank_mask:0xf
    s_nop 0
    v_max_f32_dpp v180, v180, v180 row_mirror row_mask:0xf bank_mask:0xf
    v_min_f32_dpp v181, v181, v181 row_mirror row_mask:0xf bank_mask:0xf
    v_sub_f32 v156, v62, v180
    v_sub_f32 v157, v66, v180
    v_sub_f32 v158, v181, v62
    v_sub_f32 v159, v181, v66
    v_mul_f32 v156, s43, v156
    v_mul_f32 v157, s43, v157
    v_mul_f32 v158, s43, v158
    v_mul_f32 v159, s43, v159
    v_exp_f32 v156, v156
    v_exp_f32 v157, v157
    v_exp_f32 v158, v158
    v_exp_f32 v159, v159
    v_cndmask_b32 v157, v157, 0, s[44:45]
    v_cndmask_b32 v159, v159, 0, s[44:45]
    v_add_f32 v182, v156, v157
    v_add_f32 v183, v158, v159
    s_nop 0
    v_add_f32_dpp v182, v182, v182 quad_perm:[1,0,3,2] row_mask:0xf bank_mask:0xf
    v_add_f32_dpp v183, v183, v183 quad_perm:[1,0,3,2] row_mask:0xf bank_mask:0xf
    s_nop 0
    v_add_f32_dpp v182, v182, v182 quad_perm:[2,3,0,1] row_mask:0xf bank_mask:0xf
    v_add_f32_dpp v183, v183, v183 quad_perm:[2,3,0,1] row_mask:0xf bank_mask:0xf
    s_nop 0
    v_add_f32_dpp v182, v182, v182 row_half_mirror row_mask:0xf bank_mask:0xf
    v_add_f32_dpp v183, v183, v183 row_half_mirror row_mask:0xf bank_mask:0xf
    s_nop 0
    v_add_f32_dpp v182, v182, v182 row_mirror row_mask:0xf bank_mask:0xf
    v_add_f32_dpp v183, v183, v183 row_mirror row_mask:0xf bank_mask:0xf
    v_rcp_f32 v182, v182
    v_rcp_f32 v183, v183
    v_mul_f32 v156, v156, v182
    v_mul_f32 v157, v157, v182
    v_mul_f32 v158, v158, v183
    v_mul_f32 v159, v159, v183
    v_cndmask_b32 v74, v74, 1.0, s[46:47]
    v_cndmask_b32 v180, v67, v2, s[44:45]
    v_cndmask_b32 v181, v67, v7, s[44:45]
    v_max_f32 v180, v180, v63
    v_min_f32 v181, v181, v63
    s_nop 0
    v_max_f32_dpp v180, v180, v180 quad_perm:[1,0,3,2] row_mask:0xf bank_mask:0xf
    v_min_f32_dpp v181, v181, v181 quad_perm:[1,0,3,2] row_mask:0xf bank_mask:0xf
    s_nop 0
    v_max_f32_dpp v180, v180, v180 quad_perm:[2,3,0,1] row_mask:0xf bank_mask:0xf
    v_min_f32_dpp v181, v181, v181 quad_perm:[2,3,0,1] row_mask:0xf bank_mask:0xf
    s_nop 0
    v_max_f32_dpp v180, v180, v180 row_half_mirror row_mask:0xf bank_mask:0xf
    v_min_f32_dpp v181, v181, v181 row_half_mirror row_mask:0xf bank_mask:0xf
    s_nop 0
    v_max_f32_dpp v180, v180, v180 row_mirror row_mask:0xf bank_mask:0xf
    v_min_f32_dpp v181, v181, v181 row_mirror row_mask:0xf bank_mask:0xf
    v_sub_f32 v160, v63, v180
    v_sub_f32 v161, v67, v180
    v_sub_f32 v162, v181, v63
    v_sub_f32 v163, v181, v67
    v_mul_f32 v160, s43, v160
    v_mul_f32 v161, s43, v161
    v_mul_f32 v162, s43, v162
    v_mul_f32 v163, s43, v163
    v_exp_f32 v160, v160
    v_exp_f32 v161, v161
    v_exp_f32 v162, v162
    v_exp_f32 v163, v163
    v_cndmask_b32 v161, v161, 0, s[44:45]
    v_cndmask_b32 v163, v163, 0, s[44:45]
    v_add_f32 v182, v160, v161
    v_add_f32 v183, v162, v163
    s_nop 0
    v_add_f32_dpp v182, v182, v182 quad_perm:[1,0,3,2] row_mask:0xf bank_mask:0xf
    v_add_f32_dpp v183, v183, v183 quad_perm:[1,0,3,2] row_mask:0xf bank_mask:0xf
    s_nop 0
    v_add_f32_dpp v182, v182, v182 quad_perm:[2,3,0,1] row_mask:0xf bank_mask:0xf
    v_add_f32_dpp v183, v183, v183 quad_perm:[2,3,0,1] row_mask:0xf bank_mask:0xf
    s_nop 0
    v_add_f32_dpp v182, v182, v182 row_half_mirror row_mask:0xf bank_mask:0xf
    v_add_f32_dpp v183, v183, v183 row_half_mirror row_mask:0xf bank_mask:0xf
    s_nop 0
    v_add_f32_dpp v182, v182, v182 row_mirror row_mask:0xf bank_mask:0xf
    v_add_f32_dpp v183, v183, v183 row_mirror row_mask:0xf bank_mask:0xf
    v_rcp_f32 v182, v182
    v_rcp_f32 v183, v183
    v_mul_f32 v160, v160, v182
    v_mul_f32 v161, v161, v182
    v_mul_f32 v162, v162, v183
    v_mul_f32 v163, v163, v183
    v_cndmask_b32 v75, v75, 1.0, s[46:47]
    v_cndmask_b32 v180, v80, v2, s[44:45]
    v_cndmask_b32 v181, v80, v7, s[44:45]
    v_max_f32 v180, v180, v76
    v_min_f32 v181, v181, v76
    s_nop 0
    v_max_f32_dpp v180, v180, v180 quad_perm:[1,0,3,2] row_mask:0xf bank_mask:0xf
    v_min_f32_dpp v181, v181, v181 quad_perm:[1,0,3,2] row_mask:0xf bank_mask:0xf
    s_nop 0
    v_max_f32_dpp v180, v180, v180 quad_perm:[2,3,0,1] row_mask:0xf bank_mask:0xf
    v_min_f32_dpp v181, v181, v181 quad_perm:[2,3,0,1] row_mask:0xf bank_mask:0xf
    s_nop 0
    v_max_f32_dpp v180, v180, v180 row_half_mirror row_mask:0xf bank_mask:0xf
    v_min_f32_dpp v181, v181, v181 row_half_mirror row_mask:0xf bank_mask:0xf
    s_nop 0
    v_max_f32_dpp v180, v180, v180 row_mirror row_mask:0xf bank_mask:0xf
    v_min_f32_dpp v181, v181, v181 row_mirror row_mask:0xf bank_mask:0xf
    v_sub_f32 v164, v76, v180
    v_sub_f32 v165, v80, v180
    v_sub_f32 v166, v181, v76
    v_sub_f32 v167, v181, v80
    v_mul_f32 v164, s43, v164
    v_mul_f32 v165, s43, v165
    v_mul_f32 v166, s43, v166
    v_mul_f32 v167, s43, v167
    v_exp_f32 v164, v164
    v_exp_f32 v165, v165
    v_exp_f32 v166, v166
    v_exp_f32 v167, v167
    v_cndmask_b32 v165, v165, 0, s[44:45]
    v_cndmask_b32 v167, v167, 0, s[44:45]
    v_add_f32 v182, v164, v165
    v_add_f32 v183, v166, v167
    s_nop 0
    v_add_f32_dpp v182, v182, v182 quad_perm:[1,0,3,2] row_mask:0xf bank_mask:0xf
    v_add_f32_dpp v183, v183, v183 quad_perm:[1,0,3,2] row_mask:0xf bank_mask:0xf
    s_nop 0
    v_add_f32_dpp v182, v182, v182 quad_perm:[2,3,0,1] row_mask:0xf bank_mask:0xf
    v_add_f32_dpp v183, v183, v183 quad_perm:[2,3,0,1] row_mask:0xf bank_mask:0xf
    s_nop 0
    v_add_f32_dpp v182, v182, v182 row_half_mirror row_mask:0xf bank_mask:0xf
    v_add_f32_dpp v183, v183, v183 row_half_mirror row_mask:0xf bank_mask:0xf
    s_nop 0
    v_add_f32_dpp v182, v182, v182 row_mirror row_mask:0xf bank_mask:0xf
    v_add_f32_dpp v183, v183, v183 row_mirror row_mask:0xf bank_mask:0xf
    v_rcp_f32 v182, v182
    v_rcp_f32 v183, v183
    v_mul_f32 v164, v164, v182
    v_mul_f32 v165, v165, v182
    v_mul_f32 v166, v166, v183
    v_mul_f32 v167, v167, v183
    v_cndmask_b32 v88, v88, 1.0, s[46:47]
    v_cndmask_b32 v180, v81, v2, s[44:45]
    v_cndmask_b32 v181, v81, v7, s[44:45]
    v_max_f32 v180, v180, v77
    v_min_f32 v181, v181, v77
    s_nop 0
    v_max_f32_dpp v180, v180, v180 quad_perm:[1,0,3,2] row_mask:0xf bank_mask:0xf
    v_min_f32_dpp v181, v181, v181 quad_perm:[1,0,3,2] row_mask:0xf bank_mask:0xf
    s_nop 0
    v_max_f32_dpp v180, v180, v180 quad_perm:[2,3,0,1] row_mask:0xf bank_mask:0xf
    v_min_f32_dpp v181, v181, v181 quad_perm:[2,3,0,1] row_mask:0xf bank_mask:0xf
    s_nop 0
    v_max_f32_dpp v180, v180, v180 row_half_mirror row_mask:0xf bank_mask:0xf
    v_min_f32_dpp v181, v181, v181 row_half_mirror row_mask:0xf bank_mask:0xf
    s_nop 0
    v_max_f32_dpp v180, v180, v180 row_mirror row_mask:0xf bank_mask:0xf
    v_min_f32_dpp v181, v181, v181 row_mirror row_mask:0xf bank_mask:0xf
    v_sub_f32 v168, v77, v180
    v_sub_f32 v169, v81, v180
    v_sub_f32 v170, v181, v77
    v_sub_f32 v171, v181, v81
    v_mul_f32 v168, s43, v168
    v_mul_f32 v169, s43, v169
    v_mul_f32 v170, s43, v170
    v_mul_f32 v171, s43, v171
    v_exp_f32 v168, v168
    v_exp_f32 v169, v169
    v_exp_f32 v170, v170
    v_exp_f32 v171, v171
    v_cndmask_b32 v169, v169, 0, s[44:45]
    v_cndmask_b32 v171, v171, 0, s[44:45]
    v_add_f32 v182, v168, v169
    v_add_f32 v183, v170, v171
    s_nop 0
    v_add_f32_dpp v182, v182, v182 quad_perm:[1,0,3,2] row_mask:0xf bank_mask:0xf
    v_add_f32_dpp v183, v183, v183 quad_perm:[1,0,3,2] row_mask:0xf bank_mask:0xf
    s_nop 0
    v_add_f32_dpp v182, v182, v182 quad_perm:[2,3,0,1] row_mask:0xf bank_mask:0xf
    v_add_f32_dpp v183, v183, v183 quad_perm:[2,3,0,1] row_mask:0xf bank_mask:0xf
    s_nop 0
    v_add_f32_dpp v182, v182, v182 row_half_mirror row_mask:0xf bank_mask:0xf
    v_add_f32_dpp v183, v183, v183 row_half_mirror row_mask:0xf bank_mask:0xf
    s_nop 0
    v_add_f32_dpp v182, v182, v182 row_mirror row_mask:0xf bank_mask:0xf
    v_add_f32_dpp v183, v183, v183 row_mirror row_mask:0xf bank_mask:0xf
    v_rcp_f32 v182, v182
    v_rcp_f32 v183, v183
    v_mul_f32 v168, v168, v182
    v_mul_f32 v169, v169, v182
    v_mul_f32 v170, v170, v183
    v_mul_f32 v171, v171, v183
    v_cndmask_b32 v89, v89, 1.0, s[46:47]
    v_cndmask_b32 v180, v82, v2, s[44:45]
    v_cndmask_b32 v181, v82, v7, s[44:45]
    v_max_f32 v180, v180, v78
    v_min_f32 v181, v181, v78
    s_nop 0
    v_max_f32_dpp v180, v180, v180 quad_perm:[1,0,3,2] row_mask:0xf bank_mask:0xf
    v_min_f32_dpp v181, v181, v181 quad_perm:[1,0,3,2] row_mask:0xf bank_mask:0xf
    s_nop 0
    v_max_f32_dpp v180, v180, v180 quad_perm:[2,3,0,1] row_mask:0xf bank_mask:0xf
    v_min_f32_dpp v181, v181, v181 quad_perm:[2,3,0,1] row_mask:0xf bank_mask:0xf
    s_nop 0
    v_max_f32_dpp v180, v180, v180 row_half_mirror row_mask:0xf bank_mask:0xf
    v_min_f32_dpp v181, v181, v181 row_half_mirror row_mask:0xf bank_mask:0xf
    s_nop 0
    v_max_f32_dpp v180, v180, v180 row_mirror row_mask:0xf bank_mask:0xf
    v_min_f32_dpp v181, v181, v181 row_mirror row_mask:0xf bank_mask:0xf
    v_sub_f32 v172, v78, v180
    v_sub_f32 v173, v82, v180
    v_sub_f32 v174, v181, v78
    v_sub_f32 v175, v181, v82
    v_mul_f32 v172, s43, v172
    v_mul_f32 v173, s43, v173
    v_mul_f32 v174, s43, v174
    v_mul_f32 v175, s43, v175
    v_exp_f32 v172, v172
    v_exp_f32 v173, v173
    v_exp_f32 v174, v174
    v_exp_f32 v175, v175
    v_cndmask_b32 v173, v173, 0, s[44:45]
    v_cndmask_b32 v175, v175, 0, s[44:45]
    v_add_f32 v182, v172, v173
    v_add_f32 v183, v174, v175
    s_nop 0
    v_add_f32_dpp v182, v182, v182 quad_perm:[1,0,3,2] row_mask:0xf bank_mask:0xf
    v_add_f32_dpp v183, v183, v183 quad_perm:[1,0,3,2] row_mask:0xf bank_mask:0xf
    s_nop 0
    v_add_f32_dpp v182, v182, v182 quad_perm:[2,3,0,1] row_mask:0xf bank_mask:0xf
    v_add_f32_dpp v183, v183, v183 quad_perm:[2,3,0,1] row_mask:0xf bank_mask:0xf
    s_nop 0
    v_add_f32_dpp v182, v182, v182 row_half_mirror row_mask:0xf bank_mask:0xf
    v_add_f32_dpp v183, v183, v183 row_half_mirror row_mask:0xf bank_mask:0xf
    s_nop 0
    v_add_f32_dpp v182, v182, v182 row_mirror row_mask:0xf bank_mask:0xf
    v_add_f32_dpp v183, v183, v183 row_mirror row_mask:0xf bank_mask:0xf
    v_rcp_f32 v182, v182
    v_rcp_f32 v183, v183
    v_mul_f32 v172, v172, v182
    v_mul_f32 v173, v173, v182
    v_mul_f32 v174, v174, v183
    v_mul_f32 v175, v175, v183
    v_cndmask_b32 v90, v90, 1.0, s[46:47]
    v_cndmask_b32 v180, v83, v2, s[44:45]
    v_cndmask_b32 v181, v83, v7, s[44:45]
    v_max_f32 v180, v180, v79
    v_min_f32 v181, v181, v79
    s_nop 0
    v_max_f32_dpp v180, v180, v180 quad_perm:[1,0,3,2] row_mask:0xf bank_mask:0xf
    v_min_f32_dpp v181, v181, v181 quad_perm:[1,0,3,2] row_mask:0xf bank_mask:0xf
    s_nop 0
    v_max_f32_dpp v180, v180, v180 quad_perm:[2,3,0,1] row_mask:0xf bank_mask:0xf
    v_min_f32_dpp v181, v181, v181 quad_perm:[2,3,0,1] row_mask:0xf bank_mask:0xf
    s_nop 0
    v_max_f32_dpp v180, v180, v180 row_half_mirror row_mask:0xf bank_mask:0xf
    v_min_f32_dpp v181, v181, v181 row_half_mirror row_mask:0xf bank_mask:0xf
    s_nop 0
    v_max_f32_dpp v180, v180, v180 row_mirror row_mask:0xf bank_mask:0xf
    v_min_f32_dpp v181, v181, v181 row_mirror row_mask:0xf bank_mask:0xf
    v_sub_f32 v176, v79, v180
    v_sub_f32 v177, v83, v180
    v_sub_f32 v178, v181, v79
    v_sub_f32 v179, v181, v83
    v_mul_f32 v176, s43, v176
    v_mul_f32 v177, s43, v177
    v_mul_f32 v178, s43, v178
    v_mul_f32 v179, s43, v179
    v_exp_f32 v176, v176
    v_exp_f32 v177, v177
    v_exp_f32 v178, v178
    v_exp_f32 v179, v179
    v_cndmask_b32 v177, v177, 0, s[44:45]
    v_cndmask_b32 v179, v179, 0, s[44:45]
    v_add_f32 v182, v176, v177
    v_add_f32 v183, v178, v179
    s_nop 0
    v_add_f32_dpp v182, v182, v182 quad_perm:[1,0,3,2] row_mask:0xf bank_mask:0xf
    v_add_f32_dpp v183, v183, v183 quad_perm:[1,0,3,2] row_mask:0xf bank_mask:0xf
    s_nop 0
    v_add_f32_dpp v182, v182, v182 quad_perm:[2,3,0,1] row_mask:0xf bank_mask:0xf
    v_add_f32_dpp v183, v183, v183 quad_perm:[2,3,0,1] row_mask:0xf bank_mask:0xf
    s_nop 0
    v_add_f32_dpp v182, v182, v182 row_half_mirror row_mask:0xf bank_mask:0xf
    v_add_f32_dpp v183, v183, v183 row_half_mirror row_mask:0xf bank_mask:0xf
    s_nop 0
    v_add_f32_dpp v182, v182, v182 row_mirror row_mask:0xf bank_mask:0xf
    v_add_f32_dpp v183, v183, v183 row_mirror row_mask:0xf bank_mask:0xf
    v_rcp_f32 v182, v182
    v_rcp_f32 v183, v183
    v_mul_f32 v176, v176, v182
    v_mul_f32 v177, v177, v182
    v_mul_f32 v178, v178, v183
    v_mul_f32 v179, v179, v183
    v_cndmask_b32 v91, v91, 1.0, s[46:47]
    v_cvt_pk_bf16_f32 v124, v148, v152
    v_cvt_pk_bf16_f32 v125, v156, v160
    v_cvt_pk_bf16_f32 v126, v164, v168
    v_cvt_pk_bf16_f32 v127, v172, v176
    v_cvt_pk_bf16_f32 v128, v149, v153
    v_cvt_pk_bf16_f32 v129, v157, v161
    v_cvt_pk_bf16_f32 v130, v165, v169
    v_cvt_pk_bf16_f32 v131, v173, v177
    v_cvt_pk_bf16_f32 v132, v150, v154
    v_cvt_pk_bf16_f32 v133, v158, v162
    v_cvt_pk_bf16_f32 v134, v166, v170
    v_cvt_pk_bf16_f32 v135, v174, v178
    v_cvt_pk_bf16_f32 v136, v151, v155
    v_cvt_pk_bf16_f32 v137, v159, v163
    v_cvt_pk_bf16_f32 v138, v167, v171
    v_cvt_pk_bf16_f32 v139, v175, v179
    v_cvt_pk_bf16_f32 v140, v68, v69
    v_cvt_pk_bf16_f32 v141, v70, v71
    v_cvt_pk_bf16_f32 v142, v84, v85
    v_cvt_pk_bf16_f32 v143, v86, v87
    v_cvt_pk_bf16_f32 v144, v72, v73
    v_cvt_pk_bf16_f32 v145, v74, v75
    v_cvt_pk_bf16_f32 v146, v88, v89
    v_cvt_pk_bf16_f32 v147, v90, v91
    v_mfma_f32_16x16x32_bf16 v[92:95], v[124:127], v[140:143], v[92:95]
    s_nop 0
    v_mfma_f32_16x16x32_bf16 v[96:99], v[124:127], v[144:147], v[96:99]
    v_mfma_f32_16x16x32_bf16 v[100:103], v[128:131], v[140:143], v[100:103]
    v_mfma_f32_16x16x32_bf16 v[104:107], v[128:131], v[144:147], v[104:107]
    v_mfma_f32_16x16x32_bf16 v[108:111], v[132:135], v[140:143], v[108:111]
    v_mfma_f32_16x16x32_bf16 v[112:115], v[132:135], v[144:147], v[112:115]
    v_mfma_f32_16x16x32_bf16 v[116:119], v[136:139], v[140:143], v[116:119]
    v_mfma_f32_16x16x32_bf16 v[120:123], v[136:139], v[144:147], v[120:123]
    s_xor_b32 s41, s41, 29184
    s_waitcnt vmcnt(0)
    v_add_u32 v5, s41, v8
    ds_write_b128 v5, v[16:19]
    v_add_u32 v5, s41, v9
    ds_write_b128 v5, v[20:23]
    v_add_u32 v5, s41, v10
    ds_write_b128 v5, v[24:27]
    v_add_u32 v5, s41, v11
    ds_write_b128 v5, v[28:31]
    v_add_u32 v5, s41, v12
    ds_write_b128 v5, v[32:35]
    v_add_u32 v5, s41, v13
    ds_write_b128 v5, v[36:39]
    v_add_u32 v5, s41, v14
    ds_write_b128 v5, v[40:43]
    s_waitcnt lgkmcnt(0)
    s_barrier
    s_add_u32 s40, s40, 1
    s_cmp_lt_u32 s40, 4
    s_cbranch_scc1 L_b1_loop_w
    s_lshl_b32 s37, s31, 4
    s_add_u32 s37, s37, s30
    s_lshl_b32 s37, s37, 13
    s_add_u32 s37, s37, 96468992
    s_add_u32 s38, s37, 4096
    v_lshlrev_b32 v5, 8, v4
    v_lshl_add_u32 v5, v3, 4, v5
    buffer_store_dwordx4 v[92:95], v5, s[16:19], s37 offen offset:0 sc1
    buffer_store_dwordx4 v[96:99], v5, s[16:19], s38 offen offset:0 sc1
    buffer_store_dwordx4 v[100:103], v5, s[16:19], s37 offen offset:64 sc1
    buffer_store_dwordx4 v[104:107], v5, s[16:19], s38 offen offset:64 sc1
    buffer_store_dwordx4 v[108:111], v5, s[16:19], s37 offen offset:128 sc1
    buffer_store_dwordx4 v[112:115], v5, s[16:19], s38 offen offset:128 sc1
    buffer_store_dwordx4 v[116:119], v5, s[16:19], s37 offen offset:192 sc1
    buffer_store_dwordx4 v[120:123], v5, s[16:19], s38 offen offset:192 sc1
    s_waitcnt vmcnt(0)
    s_mov_b32 s37, 100796416
    v_mov_b32 v16, 1
    v_mov_b32 v17, 0
    s_mov_b64 exec, 1
    buffer_atomic_add v16, v17, s[16:19], s37 offen sc1
    s_mov_b64 exec, -1
    s_branch L_w_fin
L_w_r:
    v_mov_b32 v17, 100796416
    s_mov_b32 s49, 2000000
L_cw_b1_75:
    buffer_load_dword v16, v17, s[16:19], 0 offen sc1
    s_waitcnt vmcnt(0)
    v_cmp_gt_u32 vcc, 256, v16
    s_cbranch_vccz L_cwok_b1_76
    s_sleep 8
    s_sub_u32 s49, s49, 1
    s_cmp_lg_u32 s49, 0
    s_cbranch_scc1 L_cw_b1_75
L_cwok_b1_76:
    s_sub_u32 s3, s21, 64
    s_lshl_b32 s30, s3, 2
    s_add_u32 s30, s30, s20
    s_lshl_b32 s37, s30, 13
    s_add_u32 s37, s37, 96468992
    v_lshlrev_b32 v5, 8, v4
    v_lshl_add_u32 v5, v3, 4, v5
    v_add_u32 v6, 4096, v5
    s_mov_b32 s40, 0
    v_mov_b32 v16, 0
    v_mov_b32 v17, 0
    v_mov_b32 v18, 0
    v_mov_b32 v19, 0
    v_mov_b32 v20, 0
    v_mov_b32 v21, 0
    v_mov_b32 v22, 0
    v_mov_b32 v23, 0
    v_mov_b32 v24, 0
    v_mov_b32 v25, 0
    v_mov_b32 v26, 0
    v_mov_b32 v27, 0
    v_mov_b32 v28, 0
    v_mov_b32 v29, 0
    v_mov_b32 v30, 0
    v_mov_b32 v31, 0
    v_mov_b32 v32, 0
    v_mov_b32 v33, 0
    v_mov_b32 v34, 0
    v_mov_b32 v35, 0
    v_mov_b32 v36, 0
    v_mov_b32 v37, 0
    v_mov_b32 v38, 0
    v_mov_b32 v39, 0
    v_mov_b32 v40, 0
    v_mov_b32 v41, 0
    v_mov_b32 v42, 0
    v_mov_b32 v43, 0
    v_mov_b32 v44, 0
    v_mov_b32 v45, 0
    v_mov_b32 v46, 0
    v_mov_b32 v47, 0
L_r_loop_w:
    buffer_load_dwordx4 v[48:51], v5, s[16:19], s37 offen offset:0 sc1
    buffer_load_dwordx4 v[52:55], v5, s[16:19], s37 offen offset:64 sc1
    buffer_load_dwordx4 v[56:59], v5, s[16:19], s37 offen offset:128 sc1
    buffer_load_dwordx4 v[60:63], v5, s[16:19], s37 offen offset:192 sc1
    buffer_load_dwordx4 v[64:67], v6, s[16:19], s37 offen offset:0 sc1
    buffer_load_dwordx4 v[68:71], v6, s[16:19], s37 offen offset:64 sc1
    buffer_load_dwordx4 v[72:75], v6, s[16:19], s37 offen offset:128 sc1
    buffer_load_dwordx4 v[76:79], v6, s[16:19], s37 offen offset:192 sc1
    s_add_u32 s37, s37, 131072
    buffer_load_dwordx4 v[80:83], v5, s[16:19], s37 offen offset:0 sc1
    buffer_load_dwordx4 v[84:87], v5, s[16:19], s37 offen offset:64 sc1
    buffer_load_dwordx4 v[88:91], v5, s[16:19], s37 offen offset:128 sc1
    buffer_load_dwordx4 v[92:95], v5, s[16:19], s37 offen offset:192 sc1
    buffer_load_dwordx4 v[96:99], v6, s[16:19], s37 offen offset:0 sc1
    buffer_load_dwordx4 v[100:103], v6, s[16:19], s37 offen offset:64 sc1
    buffer_load_dwordx4 v[104:107], v6, s[16:19], s37 offen offset:128 sc1
    buffer_load_dwordx4 v[108:111], v6, s[16:19], s37 offen offset:192 sc1
    s_add_u32 s37, s37, 131072
    buffer_load_dwordx4 v[112:115], v5, s[16:19], s37 offen offset:0 sc1
    buffer_load_dwordx4 v[116:119], v5, s[16:19], s37 offen offset:64 sc1
    buffer_load_dwordx4 v[120:123], v5, s[16:19], s37 offen offset:128 sc1
    buffer_load_dwordx4 v[124:127], v5, s[16:19], s37 offen offset:192 sc1
    buffer_load_dwordx4 v[128:131], v6, s[16:19], s37 offen offset:0 sc1
    buffer_load_dwordx4 v[132:135], v6, s[16:19], s37 offen offset:64 sc1
    buffer_load_dwordx4 v[136:139], v6, s[16:19], s37 offen offset:128 sc1
    buffer_load_dwordx4 v[140:143], v6, s[16:19], s37 offen offset:192 sc1
    s_add_u32 s37, s37, 131072
    buffer_load_dwordx4 v[144:147], v5, s[16:19], s37 offen offset:0 sc1
    buffer_load_dwordx4 v[148:151], v5, s[16:19], s37 offen offset:64 sc1
    buffer_load_dwordx4 v[152:155], v5, s[16:19], s37 offen offset:128 sc1
    buffer_load_dwordx4 v[156:159], v5, s[16:19], s37 offen offset:192 sc1
    buffer_load_dwordx4 v[160:163], v6, s[16:19], s37 offen offset:0 sc1
    buffer_load_dwordx4 v[164:167], v6, s[16:19], s37 offen offset:64 sc1
    buffer_load_dwordx4 v[168:171], v6, s[16:19], s37 offen offset:128 sc1
    buffer_load_dwordx4 v[172:175], v6, s[16:19], s37 offen offset:192 sc1
    s_add_u32 s37, s37, 131072
    s_waitcnt vmcnt(0)
    v_pk_add_f32 v[16:17], v[16:17], v[48:49]
    v_pk_add_f32 v[18:19], v[18:19], v[50:51]
    v_pk_add_f32 v[20:21], v[20:21], v[52:53]
    v_pk_add_f32 v[22:23], v[22:23], v[54:55]
    v_pk_add_f32 v[24:25], v[24:25], v[56:57]
    v_pk_add_f32 v[26:27], v[26:27], v[58:59]
    v_pk_add_f32 v[28:29], v[28:29], v[60:61]
    v_pk_add_f32 v[30:31], v[30:31], v[62:63]
    v_pk_add_f32 v[32:33], v[32:33], v[64:65]
    v_pk_add_f32 v[34:35], v[34:35], v[66:67]
    v_pk_add_f32 v[36:37], v[36:37], v[68:69]
    v_pk_add_f32 v[38:39], v[38:39], v[70:71]
    v_pk_add_f32 v[40:41], v[40:41], v[72:73]
    v_pk_add_f32 v[42:43], v[42:43], v[74:75]
    v_pk_add_f32 v[44:45], v[44:45], v[76:77]
    v_pk_add_f32 v[46:47], v[46:47], v[78:79]
    v_pk_add_f32 v[16:17], v[16:17], v[80:81]
    v_pk_add_f32 v[18:19], v[18:19], v[82:83]
    v_pk_add_f32 v[20:21], v[20:21], v[84:85]
    v_pk_add_f32 v[22:23], v[22:23], v[86:87]
    v_pk_add_f32 v[24:25], v[24:25], v[88:89]
    v_pk_add_f32 v[26:27], v[26:27], v[90:91]
    v_pk_add_f32 v[28:29], v[28:29], v[92:93]
    v_pk_add_f32 v[30:31], v[30:31], v[94:95]
    v_pk_add_f32 v[32:33], v[32:33], v[96:97]
    v_pk_add_f32 v[34:35], v[34:35], v[98:99]
    v_pk_add_f32 v[36:37], v[36:37], v[100:101]
    v_pk_add_f32 v[38:39], v[38:39], v[102:103]
    v_pk_add_f32 v[40:41], v[40:41], v[104:105]
    v_pk_add_f32 v[42:43], v[42:43], v[106:107]
    v_pk_add_f32 v[44:45], v[44:45], v[108:109]
    v_pk_add_f32 v[46:47], v[46:47], v[110:111]
    v_pk_add_f32 v[16:17], v[16:17], v[112:113]
    v_pk_add_f32 v[18:19], v[18:19], v[114:115]
    v_pk_add_f32 v[20:21], v[20:21], v[116:117]
    v_pk_add_f32 v[22:23], v[22:23], v[118:119]
    v_pk_add_f32 v[24:25], v[24:25], v[120:121]
    v_pk_add_f32 v[26:27], v[26:27], v[122:123]
    v_pk_add_f32 v[28:29], v[28:29], v[124:125]
    v_pk_add_f32 v[30:31], v[30:31], v[126:127]
    v_pk_add_f32 v[32:33], v[32:33], v[128:129]
    v_pk_add_f32 v[34:35], v[34:35], v[130:131]
    v_pk_add_f32 v[36:37], v[36:37], v[132:133]
    v_pk_add_f32 v[38:39], v[38:39], v[134:135]
    v_pk_add_f32 v[40:41], v[40:41], v[136:137]
    v_pk_add_f32 v[42:43], v[42:43], v[138:139]
    v_pk_add_f32 v[44:45], v[44:45], v[140:141]
    v_pk_add_f32 v[46:47], v[46:47], v[142:143]
    v_pk_add_f32 v[16:17], v[16:17], v[144:145]
    v_pk_add_f32 v[18:19], v[18:19], v[146:147]
    v_pk_add_f32 v[20:21], v[20:21], v[148:149]
    v_pk_add_f32 v[22:23], v[22:23], v[150:151]
    v_pk_add_f32 v[24:25], v[24:25], v[152:153]
    v_pk_add_f32 v[26:27], v[26:27], v[154:155]
    v_pk_add_f32 v[28:29], v[28:29], v[156:157]
    v_pk_add_f32 v[30:31], v[30:31], v[158:159]
    v_pk_add_f32 v[32:33], v[32:33], v[160:161]
    v_pk_add_f32 v[34:35], v[34:35], v[162:163]
    v_pk_add_f32 v[36:37], v[36:37], v[164:165]
    v_pk_add_f32 v[38:39], v[38:39], v[166:167]
    v_pk_add_f32 v[40:41], v[40:41], v[168:169]
    v_pk_add_f32 v[42:43], v[42:43], v[170:171]
    v_pk_add_f32 v[44:45], v[44:45], v[172:173]
    v_pk_add_f32 v[46:47], v[46:47], v[174:175]
    s_add_u32 s40, s40, 1
    s_cmp_lt_u32 s40, 4
    s_cbranch_scc1 L_r_loop_w
    s_lshl_b32 s37, s30, 12
    s_add_u32 s37, s37, 99614720
    v_lshlrev_b32 v5, 4, v1
    v_cvt_pk_bf16_f32 v48, v16, v17
    v_cvt_pk_bf16_f32 v49, v18, v19
    v_cvt_pk_bf16_f32 v50, v20, v21
    v_cvt_pk_bf16_f32 v51, v22, v23
    buffer_store_dwordx4 v[48:51], v5, s[16:19], s37 offen offset:0 sc1
    v_cvt_pk_bf16_f32 v52, v24, v25
    v_cvt_pk_bf16_f32 v53, v26, v27
    v_cvt_pk_bf16_f32 v54, v28, v29
    v_cvt_pk_bf16_f32 v55, v30, v31
    buffer_store_dwordx4 v[52:55], v5, s[16:19], s37 offen offset:1024 sc1
    v_cvt_pk_bf16_f32 v56, v32, v33
    v_cvt_pk_bf16_f32 v57, v34, v35
    v_cvt_pk_bf16_f32 v58, v36, v37
    v_cvt_pk_bf16_f32 v59, v38, v39
    buffer_store_dwordx4 v[56:59], v5, s[16:19], s37 offen offset:2048 sc1
    v_cvt_pk_bf16_f32 v60, v40, v41
    v_cvt_pk_bf16_f32 v61, v42, v43
    v_cvt_pk_bf16_f32 v62, v44, v45
    v_cvt_pk_bf16_f32 v63, v46, v47
    buffer_store_dwordx4 v[60:63], v5, s[16:19], s37 offen offset:3072 sc1
    s_waitcnt vmcnt(0)
    s_mov_b32 s37, 100796544
    v_mov_b32 v16, 1
    v_mov_b32 v17, 0
    s_mov_b64 exec, 1
    buffer_atomic_add v16, v17, s[16:19], s37 offen sc1
    s_mov_b64 exec, -1
    s_branch L_w_fin
L_w_b2:
    v_mov_b32 v17, 100796544
    s_mov_b32 s49, 2000000
L_cw_r_77:
    buffer_load_dword v16, v17, s[16:19], 0 offen sc1
    s_waitcnt vmcnt(0)
    v_cmp_gt_u32 vcc, 16, v16
    s_cbranch_vccz L_cwok_r_78
    s_sleep 8
    s_sub_u32 s49, s49, 1
    s_cmp_lg_u32 s49, 0
    s_cbranch_scc1 L_cw_r_77
L_cwok_r_78:
    s_sub_u32 s3, s21, 68
    s_mul_i32 s33, s3, 28672
    s_add_u32 s34, s33, 14336
    v_mul_u32_u24 v5, 896, v4
    v_lshl_add_u32 v5, v3, 4, v5
    s_lshl_b32 s36, s20, 7
    s_mul_i32 s36, s36, 896
    s_add_u32 s36, s36, 13631488
    s_lshl_b32 s38, s20, 14
    s_add_u32 s38, s38, 99614720
    v_lshlrev_b32 v10, 4, v1
    s_lshl_b32 s37, s20, 13
    v_add_u32 v11, s37, v10
    s_mov_b32 s43, 1069066811
    s_mov_b32 s44, 0
    s_mov_b32 s45, 0xffff0000
    v_mov_b32 v2, 0xff800000
    v_mov_b32 v7, 0x7f800000
    s_mov_b32 s46, 0x358637bd
    buffer_load_dwordx4 a[0:3], v5, s[12:15], s33 offen offset:0
    buffer_load_dwordx4 a[4:7], v5, s[12:15], s33 offen offset:64
    buffer_load_dwordx4 a[8:11], v5, s[12:15], s33 offen offset:128
    buffer_load_dwordx4 a[12:15], v5, s[12:15], s33 offen offset:192
    buffer_load_dwordx4 a[16:19], v5, s[12:15], s33 offen offset:256
    buffer_load_dwordx4 a[20:23], v5, s[12:15], s33 offen offset:320
    buffer_load_dwordx4 a[24:27], v5, s[12:15], s33 offen offset:384
    buffer_load_dwordx4 a[28:31], v5, s[12:15], s33 offen offset:448
    buffer_load_dwordx4 a[32:35], v5, s[12:15], s33 offen offset:512
    buffer_load_dwordx4 a[36:39], v5, s[12:15], s33 offen offset:576
    buffer_load_dwordx4 a[40:43], v5, s[12:15], s33 offen offset:640
    buffer_load_dwordx4 a[44:47], v5, s[12:15], s33 offen offset:704
    buffer_load_dwordx4 a[48:51], v5, s[12:15], s33 offen offset:768
    buffer_load_dwordx4 a[52:55], v5, s[12:15], s33 offen offset:832
    buffer_load_dwordx4 a[56:59], v5, s[12:15], s34 offen offset:0
    buffer_load_dwordx4 a[60:63], v5, s[12:15], s34 offen offset:64
    buffer_load_dwordx4 a[64:67], v5, s[12:15], s34 offen offset:128
    buffer_load_dwordx4 a[68:71], v5, s[12:15], s34 offen offset:192
    buffer_load_dwordx4 a[72:75], v5, s[12:15], s34 offen offset:256
    buffer_load_dwordx4 a[76:79], v5, s[12:15], s34 offen offset:320
    buffer_load_dwordx4 a[80:83], v5, s[12:15], s34 offen offset:384
    buffer_load_dwordx4 a[84:87], v5, s[12:15], s34 offen offset:448
    buffer_load_dwordx4 a[88:91], v5, s[12:15], s34 offen offset:512
    buffer_load_dwordx4 a[92:95], v5, s[12:15], s34 offen offset:576
    buffer_load_dwordx4 a[96:99], v5, s[12:15], s34 offen offset:640
    buffer_load_dwordx4 a[100:103], v5, s[12:15], s34 offen offset:704
    buffer_load_dwordx4 a[104:107], v5, s[12:15], s34 offen offset:768
    buffer_load_dwordx4 a[108:111], v5, s[12:15], s34 offen offset:832
    buffer_load_dwordx4 v[16:19], v5, s[16:19], s36 offen offset:0
    buffer_load_dwordx4 v[20:23], v5, s[16:19], s36 offen offset:64
    buffer_load_dwordx4 v[24:27], v5, s[16:19], s36 offen offset:128
    buffer_load_dwordx4 v[28:31], v5, s[16:19], s36 offen offset:192
    buffer_load_dwordx4 v[32:35], v5, s[16:19], s36 offen offset:256
    buffer_load_dwordx4 v[36:39], v5, s[16:19], s36 offen offset:320
    buffer_load_dwordx4 v[40:43], v5, s[16:19], s36 offen offset:384
    buffer_load_dwordx4 v[44:47], v5, s[16:19], s36 offen offset:448
    buffer_load_dwordx4 v[48:51], v5, s[16:19], s36 offen offset:512
    buffer_load_dwordx4 v[52:55], v5, s[16:19], s36 offen offset:576
    buffer_load_dwordx4 v[56:59], v5, s[16:19], s36 offen offset:640
    buffer_load_dwordx4 v[60:63], v5, s[16:19], s36 offen offset:704
    buffer_load_dwordx4 v[64:67], v5, s[16:19], s36 offen offset:768
    buffer_load_dwordx4 v[68:71], v5, s[16:19], s36 offen offset:832
    s_add_u32 s36, s36, 14336
    buffer_load_dwordx4 v[72:75], v5, s[16:19], s36 offen offset:0
    buffer_load_dwordx4 v[76:79], v5, s[16:19], s36 offen offset:64
    buffer_load_dwordx4 v[80:83], v5, s[16:19], s36 offen offset:128
    buffer_load_dwordx4 v[84:87], v5, s[16:19], s36 offen offset:192
    buffer_load_dwordx4 v[88:91], v5, s[16:19], s36 offen offset:256
    buffer_load_dwordx4 v[92:95], v5, s[16:19], s36 offen offset:320
    buffer_load_dwordx4 v[96:99], v5, s[16:19], s36 offen offset:384
    buffer_load_dwordx4 v[100:103], v5, s[16:19], s36 offen offset:448
    buffer_load_dwordx4 v[104:107], v5, s[16:19], s36 offen offset:512
    buffer_load_dwordx4 v[108:111], v5, s[16:19], s36 offen offset:576
    buffer_load_dwordx4 v[112:115], v5, s[16:19], s36 offen offset:640
    buffer_load_dwordx4 v[116:119], v5, s[16:19], s36 offen offset:704
    buffer_load_dwordx4 v[120:123], v5, s[16:19], s36 offen offset:768
    buffer_load_dwordx4 v[124:127], v5, s[16:19], s36 offen offset:832
    s_add_u32 s36, s36, 14336
    buffer_load_dwordx4 v[144:147], v10, s[16:19], s38 offen offset:0 sc1
    buffer_load_dwordx4 v[148:151], v10, s[16:19], s38 offen offset:1024 sc1
    buffer_load_dwordx4 v[152:155], v10, s[16:19], s38 offen offset:2048 sc1
    buffer_load_dwordx4 v[156:159], v10, s[16:19], s38 offen offset:3072 sc1
    s_add_u32 s38, s38, 4096
    s_waitcnt vmcnt(4)
    v_mfma_f32_16x16x32_bf16 v[128:131], v[16:19], a[0:3], 0
    v_mfma_f32_16x16x32_bf16 v[136:139], v[16:19], a[56:59], 0
    v_mfma_f32_16x16x32_bf16 v[132:135], v[72:75], a[0:3], 0
    v_mfma_f32_16x16x32_bf16 v[140:143], v[72:75], a[56:59], 0
    v_mfma_f32_16x16x32_bf16 v[128:131], v[20:23], a[4:7], v[128:131]
    v_mfma_f32_16x16x32_bf16 v[136:139], v[20:23], a[60:63], v[136:139]
    v_mfma_f32_16x16x32_bf16 v[132:135], v[76:79], a[4:7], v[132:135]
    v_mfma_f32_16x16x32_bf16 v[140:143], v[76:79], a[60:63], v[140:143]
    v_mfma_f32_16x16x32_bf16 v[128:131], v[24:27], a[8:11], v[128:131]
    v_mfma_f32_16x16x32_bf16 v[136:139], v[24:27], a[64:67], v[136:139]
    v_mfma_f32_16x16x32_bf16 v[132:135], v[80:83], a[8:11], v[132:135]
    v_mfma_f32_16x16x32_bf16 v[140:143], v[80:83], a[64:67], v[140:143]
    v_mfma_f32_16x16x32_bf16 v[128:131], v[28:31], a[12:15], v[128:131]
    v_mfma_f32_16x16x32_bf16 v[136:139], v[28:31], a[68:71], v[136:139]
    v_mfma_f32_16x16x32_bf16 v[132:135], v[84:87], a[12:15], v[132:135]
    v_mfma_f32_16x16x32_bf16 v[140:143], v[84:87], a[68:71], v[140:143]
    v_mfma_f32_16x16x32_bf16 v[128:131], v[32:35], a[16:19], v[128:131]
    v_mfma_f32_16x16x32_bf16 v[136:139], v[32:35], a[72:75], v[136:139]
    v_mfma_f32_16x16x32_bf16 v[132:135], v[88:91], a[16:19], v[132:135]
    v_mfma_f32_16x16x32_bf16 v[140:143], v[88:91], a[72:75], v[140:143]
    v_mfma_f32_16x16x32_bf16 v[128:131], v[36:39], a[20:23], v[128:131]
    v_mfma_f32_16x16x32_bf16 v[136:139], v[36:39], a[76:79], v[136:139]
    v_mfma_f32_16x16x32_bf16 v[132:135], v[92:95], a[20:23], v[132:135]
    v_mfma_f32_16x16x32_bf16 v[140:143], v[92:95], a[76:79], v[140:143]
    v_mfma_f32_16x16x32_bf16 v[128:131], v[40:43], a[24:27], v[128:131]
    v_mfma_f32_16x16x32_bf16 v[136:139], v[40:43], a[80:83], v[136:139]
    v_mfma_f32_16x16x32_bf16 v[132:135], v[96:99], a[24:27], v[132:135]
    v_mfma_f32_16x16x32_bf16 v[140:143], v[96:99], a[80:83], v[140:143]
    v_mfma_f32_16x16x32_bf16 v[128:131], v[44:47], a[28:31], v[128:131]
    v_mfma_f32_16x16x32_bf16 v[136:139], v[44:47], a[84:87], v[136:139]
    v_mfma_f32_16x16x32_bf16 v[132:135], v[100:103], a[28:31], v[132:135]
    v_mfma_f32_16x16x32_bf16 v[140:143], v[100:103], a[84:87], v[140:143]
    v_mfma_f32_16x16x32_bf16 v[128:131], v[48:51], a[32:35], v[128:131]
    v_mfma_f32_16x16x32_bf16 v[136:139], v[48:51], a[88:91], v[136:139]
    v_mfma_f32_16x16x32_bf16 v[132:135], v[104:107], a[32:35], v[132:135]
    v_mfma_f32_16x16x32_bf16 v[140:143], v[104:107], a[88:91], v[140:143]
    v_mfma_f32_16x16x32_bf16 v[128:131], v[52:55], a[36:39], v[128:131]
    v_mfma_f32_16x16x32_bf16 v[136:139], v[52:55], a[92:95], v[136:139]
    v_mfma_f32_16x16x32_bf16 v[132:135], v[108:111], a[36:39], v[132:135]
    v_mfma_f32_16x16x32_bf16 v[140:143], v[108:111], a[92:95], v[140:143]
    v_mfma_f32_16x16x32_bf16 v[128:131], v[56:59], a[40:43], v[128:131]
    v_mfma_f32_16x16x32_bf16 v[136:139], v[56:59], a[96:99], v[136:139]
    v_mfma_f32_16x16x32_bf16 v[132:135], v[112:115], a[40:43], v[132:135]
    v_mfma_f32_16x16x32_bf16 v[140:143], v[112:115], a[96:99], v[140:143]
    v_mfma_f32_16x16x32_bf16 v[128:131], v[60:63], a[44:47], v[128:131]
    v_mfma_f32_16x16x32_bf16 v[136:139], v[60:63], a[100:103], v[136:139]
    v_mfma_f32_16x16x32_bf16 v[132:135], v[116:119], a[44:47], v[132:135]
    v_mfma_f32_16x16x32_bf16 v[140:143], v[116:119], a[100:103], v[140:143]
    v_mfma_f32_16x16x32_bf16 v[128:131], v[64:67], a[48:51], v[128:131]
    v_mfma_f32_16x16x32_bf16 v[136:139], v[64:67], a[104:107], v[136:139]
    v_mfma_f32_16x16x32_bf16 v[132:135], v[120:123], a[48:51], v[132:135]
    v_mfma_f32_16x16x32_bf16 v[140:143], v[120:123], a[104:107], v[140:143]
    v_mfma_f32_16x16x32_bf16 v[128:131], v[68:71], a[52:55], v[128:131]
    v_mfma_f32_16x16x32_bf16 v[136:139], v[68:71], a[108:111], v[136:139]
    v_mfma_f32_16x16x32_bf16 v[132:135], v[124:127], a[52:55], v[132:135]
    v_mfma_f32_16x16x32_bf16 v[140:143], v[124:127], a[108:111], v[140:143]
    s_waitcnt vmcnt(0)
    buffer_load_dwordx4 v[16:19], v5, s[16:19], s36 offen offset:0
    buffer_load_dwordx4 v[20:23], v5, s[16:19], s36 offen offset:64
    buffer_load_dwordx4 v[24:27], v5, s[16:19], s36 offen offset:128
    buffer_load_dwordx4 v[28:31], v5, s[16:19], s36 offen offset:192
    buffer_load_dwordx4 v[32:35], v5, s[16:19], s36 offen offset:256
    buffer_load_dwordx4 v[36:39], v5, s[16:19], s36 offen offset:320
    buffer_load_dwordx4 v[40:43], v5, s[16:19], s36 offen offset:384
    buffer_load_dwordx4 v[44:47], v5, s[16:19], s36 offen offset:448
    buffer_load_dwordx4 v[48:51], v5, s[16:19], s36 offen offset:512
    buffer_load_dwordx4 v[52:55], v5, s[16:19], s36 offen offset:576
    buffer_load_dwordx4 v[56:59], v5, s[16:19], s36 offen offset:640
    buffer_load_dwordx4 v[60:63], v5, s[16:19], s36 offen offset:704
    buffer_load_dwordx4 v[64:67], v5, s[16:19], s36 offen offset:768
    buffer_load_dwordx4 v[68:71], v5, s[16:19], s36 offen offset:832
    s_add_u32 s36, s36, 14336
    buffer_load_dwordx4 v[72:75], v5, s[16:19], s36 offen offset:0
    buffer_load_dwordx4 v[76:79], v5, s[16:19], s36 offen offset:64
    buffer_load_dwordx4 v[80:83], v5, s[16:19], s36 offen offset:128
    buffer_load_dwordx4 v[84:87], v5, s[16:19], s36 offen offset:192
    buffer_load_dwordx4 v[88:91], v5, s[16:19], s36 offen offset:256
    buffer_load_dwordx4 v[92:95], v5, s[16:19], s36 offen offset:320
    buffer_load_dwordx4 v[96:99], v5, s[16:19], s36 offen offset:384
    buffer_load_dwordx4 v[100:103], v5, s[16:19], s36 offen offset:448
    buffer_load_dwordx4 v[104:107], v5, s[16:19], s36 offen offset:512
    buffer_load_dwordx4 v[108:111], v5, s[16:19], s36 offen offset:576
    buffer_load_dwordx4 v[112:115], v5, s[16:19], s36 offen offset:640
    buffer_load_dwordx4 v[116:119], v5, s[16:19], s36 offen offset:704
    buffer_load_dwordx4 v[120:123], v5, s[16:19], s36 offen offset:768
    buffer_load_dwordx4 v[124:127], v5, s[16:19], s36 offen offset:832
    s_add_u32 s36, s36, 14336
    v_max3_f32 v192, v132, v133, v134
    v_max_f32 v192, v192, v135
    v_min3_f32 v193, v132, v133, v134
    v_min_f32 v193, v193, v135
    v_cndmask_b32 v192, v192, v2, s[44:45]
    v_cndmask_b32 v193, v193, v7, s[44:45]
    v_max3_f32 v192, v192, v128, v129
    v_max3_f32 v192, v192, v130, v131
    v_min3_f32 v193, v193, v128, v129
    v_min3_f32 v193, v193, v130, v131
    v_mov_b32 v194, v192
    v_mov_b32 v195, v192
    s_nop 1
    v_permlane16_swap_b32 v194, v195
    v_max_f32 v194, v194, v195
    v_mov_b32 v195, v194
    s_nop 1
    v_permlane32_swap_b32 v194, v195
    v_max_f32 v192, v194, v195
    v_mov_b32 v194, v193
    v_mov_b32 v195, v193
    s_nop 1
    v_permlane16_swap_b32 v194, v195
    v_min_f32 v194, v194, v195
    v_mov_b32 v195, v194
    s_nop 1
    v_permlane32_swap_b32 v194, v195
    v_min_f32 v193, v194, v195
    v_sub_f32 v196, v128, v192
    v_sub_f32 v204, v193, v128
    v_sub_f32 v197, v129, v192
    v_sub_f32 v205, v193, v129
    v_sub_f32 v198, v130, v192
    v_sub_f32 v206, v193, v130
    v_sub_f32 v199, v131, v192
    v_sub_f32 v207, v193, v131
    v_sub_f32 v200, v132, v192
    v_sub_f32 v208, v193, v132
    v_sub_f32 v201, v133, v192
    v_sub_f32 v209, v193, v133
    v_sub_f32 v202, v134, v192
    v_sub_f32 v210, v193, v134
    v_sub_f32 v203, v135, v192
    v_sub_f32 v211, v193, v135
    v_mul_f32 v196, s43, v196
    v_mul_f32 v197, s43, v197
    v_mul_f32 v198, s43, v198
    v_mul_f32 v199, s43, v199
    v_mul_f32 v200, s43, v200
    v_mul_f32 v201, s43, v201
    v_mul_f32 v202, s43, v202
    v_mul_f32 v203, s43, v203
    v_mul_f32 v204, s43, v204
    v_mul_f32 v205, s43, v205
    v_mul_f32 v206, s43, v206
    v_mul_f32 v207, s43, v207
    v_mul_f32 v208, s43, v208
    v_mul_f32 v209, s43, v209
    v_mul_f32 v210, s43, v210
    v_mul_f32 v211, s43, v211
    v_exp_f32 v196, v196
    v_exp_f32 v197, v197
    v_exp_f32 v198, v198
    v_exp_f32 v199, v199
    v_exp_f32 v200, v200
    v_exp_f32 v201, v201
    v_exp_f32 v202, v202
    v_exp_f32 v203, v203
    v_exp_f32 v204, v204
    v_exp_f32 v205, v205
    v_exp_f32 v206, v206
    v_exp_f32 v207, v207
    v_exp_f32 v208, v208
    v_exp_f32 v209, v209
    v_exp_f32 v210, v210
    v_exp_f32 v211, v211
    v_cndmask_b32 v200, v200, 0, s[44:45]
    v_cndmask_b32 v201, v201, 0, s[44:45]
    v_cndmask_b32 v202, v202, 0, s[44:45]
    v_cndmask_b32 v203, v203, 0, s[44:45]
    v_cndmask_b32 v208, v208, 0, s[44:45]
    v_cndmask_b32 v209, v209, 0, s[44:45]
    v_cndmask_b32 v210, v210, 0, s[44:45]
    v_cndmask_b32 v211, v211, 0, s[44:45]
    v_add_f32 v192, v196, v197
    v_add_f32 v192, v192, v198
    v_add_f32 v192, v192, v199
    v_add_f32 v192, v192, v200
    v_add_f32 v192, v192, v201
    v_add_f32 v192, v192, v202
    v_add_f32 v192, v192, v203
    v_mov_b32 v194, v192
    v_mov_b32 v195, v192
    s_nop 1
    v_permlane16_swap_b32 v194, v195
    v_add_f32 v194, v194, v195
    v_mov_b32 v195, v194
    s_nop 1
    v_permlane32_swap_b32 v194, v195
    v_add_f32 v192, v194, v195
    v_rcp_f32 v192, v192
    s_nop 0
    v_mul_f32 v196, v196, v192
    v_mul_f32 v197, v197, v192
    v_mul_f32 v198, v198, v192
    v_mul_f32 v199, v199, v192
    v_mul_f32 v200, v200, v192
    v_mul_f32 v201, v201, v192
    v_mul_f32 v202, v202, v192
    v_mul_f32 v203, v203, v192
    v_cvt_pk_bf16_f32 v160, v196, v197
    v_cvt_pk_bf16_f32 v161, v198, v199
    v_cvt_pk_bf16_f32 v162, v200, v201
    v_cvt_pk_bf16_f32 v163, v202, v203
    v_add_f32 v193, v204, v205
    v_add_f32 v193, v193, v206
    v_add_f32 v193, v193, v207
    v_add_f32 v193, v193, v208
    v_add_f32 v193, v193, v209
    v_add_f32 v193, v193, v210
    v_add_f32 v193, v193, v211
    v_mov_b32 v194, v193
    v_mov_b32 v195, v193
    s_nop 1
    v_permlane16_swap_b32 v194, v195
    v_add_f32 v194, v194, v195
    v_mov_b32 v195, v194
    s_nop 1
    v_permlane32_swap_b32 v194, v195
    v_add_f32 v193, v194, v195
    v_rcp_f32 v193, v193
    s_nop 0
    v_mul_f32 v204, v204, v193
    v_mul_f32 v205, v205, v193
    v_mul_f32 v206, v206, v193
    v_mul_f32 v207, v207, v193
    v_mul_f32 v208, v208, v193
    v_mul_f32 v209, v209, v193
    v_mul_f32 v210, v210, v193
    v_mul_f32 v211, v211, v193
    v_cvt_pk_bf16_f32 v164, v204, v205
    v_cvt_pk_bf16_f32 v165, v206, v207
    v_cvt_pk_bf16_f32 v166, v208, v209
    v_cvt_pk_bf16_f32 v167, v210, v211
    v_mfma_f32_16x16x32_bf16 v[176:179], v[144:147], v[160:163], 0
    s_nop 0
    v_mfma_f32_16x16x32_bf16 v[176:179], v[148:151], v[164:167], v[176:179]
    v_mfma_f32_16x16x32_bf16 v[180:183], v[152:155], v[160:163], 0
    v_mfma_f32_16x16x32_bf16 v[180:183], v[156:159], v[164:167], v[180:183]
    s_nop 7
    v_mov_b32 v194, v180
    v_mov_b32 v195, v180
    s_nop 1
    v_permlane32_swap_b32 v194, v195
    v_mov_b32 v194, v195
    s_nop 1
    v_permlane16_swap_b32 v194, v195
    v_add_f32 v195, s46, v195
    v_rcp_f32 v195, v195
    s_nop 0
    v_mul_f32 v176, v176, v195
    v_mul_f32 v177, v177, v195
    v_mul_f32 v178, v178, v195
    v_mul_f32 v179, v179, v195
    v_mul_f32 v180, v180, v195
    v_mul_f32 v181, v181, v195
    v_mul_f32 v182, v182, v195
    v_mul_f32 v183, v183, v195
    v_cvt_pk_bf16_f32 v196, v176, v177
    v_cvt_pk_bf16_f32 v197, v178, v179
    v_cvt_pk_bf16_f32 v198, v180, v181
    v_cvt_pk_bf16_f32 v199, v182, v183
    ds_write_b128 v11, v[196:199] offset:0
    v_max3_f32 v192, v140, v141, v142
    v_max_f32 v192, v192, v143
    v_min3_f32 v193, v140, v141, v142
    v_min_f32 v193, v193, v143
    v_cndmask_b32 v192, v192, v2, s[44:45]
    v_cndmask_b32 v193, v193, v7, s[44:45]
    v_max3_f32 v192, v192, v136, v137
    v_max3_f32 v192, v192, v138, v139
    v_min3_f32 v193, v193, v136, v137
    v_min3_f32 v193, v193, v138, v139
    v_mov_b32 v194, v192
    v_mov_b32 v195, v192
    s_nop 1
    v_permlane16_swap_b32 v194, v195
    v_max_f32 v194, v194, v195
    v_mov_b32 v195, v194
    s_nop 1
    v_permlane32_swap_b32 v194, v195
    v_max_f32 v192, v194, v195
    v_mov_b32 v194, v193
    v_mov_b32 v195, v193
    s_nop 1
    v_permlane16_swap_b32 v194, v195
    v_min_f32 v194, v194, v195
    v_mov_b32 v195, v194
    s_nop 1
    v_permlane32_swap_b32 v194, v195
    v_min_f32 v193, v194, v195
    v_sub_f32 v196, v136, v192
    v_sub_f32 v204, v193, v136
    v_sub_f32 v197, v137, v192
    v_sub_f32 v205, v193, v137
    v_sub_f32 v198, v138, v192
    v_sub_f32 v206, v193, v138
    v_sub_f32 v199, v139, v192
    v_sub_f32 v207, v193, v139
    v_sub_f32 v200, v140, v192
    v_sub_f32 v208, v193, v140
    v_sub_f32 v201, v141, v192
    v_sub_f32 v209, v193, v141
    v_sub_f32 v202, v142, v192
    v_sub_f32 v210, v193, v142
    v_sub_f32 v203, v143, v192
    v_sub_f32 v211, v193, v143
    v_mul_f32 v196, s43, v196
    v_mul_f32 v197, s43, v197
    v_mul_f32 v198, s43, v198
    v_mul_f32 v199, s43, v199
    v_mul_f32 v200, s43, v200
    v_mul_f32 v201, s43, v201
    v_mul_f32 v202, s43, v202
    v_mul_f32 v203, s43, v203
    v_mul_f32 v204, s43, v204
    v_mul_f32 v205, s43, v205
    v_mul_f32 v206, s43, v206
    v_mul_f32 v207, s43, v207
    v_mul_f32 v208, s43, v208
    v_mul_f32 v209, s43, v209
    v_mul_f32 v210, s43, v210
    v_mul_f32 v211, s43, v211
    v_exp_f32 v196, v196
    v_exp_f32 v197, v197
    v_exp_f32 v198, v198
    v_exp_f32 v199, v199
    v_exp_f32 v200, v200
    v_exp_f32 v201, v201
    v_exp_f32 v202, v202
    v_exp_f32 v203, v203
    v_exp_f32 v204, v204
    v_exp_f32 v205, v205
    v_exp_f32 v206, v206
    v_exp_f32 v207, v207
    v_exp_f32 v208, v208
    v_exp_f32 v209, v209
    v_exp_f32 v210, v210
    v_exp_f32 v211, v211
    v_cndmask_b32 v200, v200, 0, s[44:45]
    v_cndmask_b32 v201, v201, 0, s[44:45]
    v_cndmask_b32 v202, v202, 0, s[44:45]
    v_cndmask_b32 v203, v203, 0, s[44:45]
    v_cndmask_b32 v208, v208, 0, s[44:45]
    v_cndmask_b32 v209, v209, 0, s[44:45]
    v_cndmask_b32 v210, v210, 0, s[44:45]
    v_cndmask_b32 v211, v211, 0, s[44:45]
    v_add_f32 v192, v196, v197
    v_add_f32 v192, v192, v198
    v_add_f32 v192, v192, v199
    v_add_f32 v192, v192, v200
    v_add_f32 v192, v192, v201
    v_add_f32 v192, v192, v202
    v_add_f32 v192, v192, v203
    v_mov_b32 v194, v192
    v_mov_b32 v195, v192
    s_nop 1
    v_permlane16_swap_b32 v194, v195
    v_add_f32 v194, v194, v195
    v_mov_b32 v195, v194
    s_nop 1
    v_permlane32_swap_b32 v194, v195
    v_add_f32 v192, v194, v195
    v_rcp_f32 v192, v192
    s_nop 0
    v_mul_f32 v196, v196, v192
    v_mul_f32 v197, v197, v192
    v_mul_f32 v198, v198, v192
    v_mul_f32 v199, v199, v192
    v_mul_f32 v200, v200, v192
    v_mul_f32 v201, v201, v192
    v_mul_f32 v202, v202, v192
    v_mul_f32 v203, v203, v192
    v_cvt_pk_bf16_f32 v160, v196, v197
    v_cvt_pk_bf16_f32 v161, v198, v199
    v_cvt_pk_bf16_f32 v162, v200, v201
    v_cvt_pk_bf16_f32 v163, v202, v203
    v_add_f32 v193, v204, v205
    v_add_f32 v193, v193, v206
    v_add_f32 v193, v193, v207
    v_add_f32 v193, v193, v208
    v_add_f32 v193, v193, v209
    v_add_f32 v193, v193, v210
    v_add_f32 v193, v193, v211
    v_mov_b32 v194, v193
    v_mov_b32 v195, v193
    s_nop 1
    v_permlane16_swap_b32 v194, v195
    v_add_f32 v194, v194, v195
    v_mov_b32 v195, v194
    s_nop 1
    v_permlane32_swap_b32 v194, v195
    v_add_f32 v193, v194, v195
    v_rcp_f32 v193, v193
    s_nop 0
    v_mul_f32 v204, v204, v193
    v_mul_f32 v205, v205, v193
    v_mul_f32 v206, v206, v193
    v_mul_f32 v207, v207, v193
    v_mul_f32 v208, v208, v193
    v_mul_f32 v209, v209, v193
    v_mul_f32 v210, v210, v193
    v_mul_f32 v211, v211, v193
    v_cvt_pk_bf16_f32 v164, v204, v205
    v_cvt_pk_bf16_f32 v165, v206, v207
    v_cvt_pk_bf16_f32 v166, v208, v209
    v_cvt_pk_bf16_f32 v167, v210, v211
    v_mfma_f32_16x16x32_bf16 v[176:179], v[144:147], v[160:163], 0
    s_nop 0
    v_mfma_f32_16x16x32_bf16 v[176:179], v[148:151], v[164:167], v[176:179]
    v_mfma_f32_16x16x32_bf16 v[180:183], v[152:155], v[160:163], 0
    v_mfma_f32_16x16x32_bf16 v[180:183], v[156:159], v[164:167], v[180:183]
    s_nop 7
    v_mov_b32 v194, v180
    v_mov_b32 v195, v180
    s_nop 1
    v_permlane32_swap_b32 v194, v195
    v_mov_b32 v194, v195
    s_nop 1
    v_permlane16_swap_b32 v194, v195
    v_add_f32 v195, s46, v195
    v_rcp_f32 v195, v195
    s_nop 0
    v_mul_f32 v176, v176, v195
    v_mul_f32 v177, v177, v195
    v_mul_f32 v178, v178, v195
    v_mul_f32 v179, v179, v195
    v_mul_f32 v180, v180, v195
    v_mul_f32 v181, v181, v195
    v_mul_f32 v182, v182, v195
    v_mul_f32 v183, v183, v195
    v_cvt_pk_bf16_f32 v196, v176, v177
    v_cvt_pk_bf16_f32 v197, v178, v179
    v_cvt_pk_bf16_f32 v198, v180, v181
    v_cvt_pk_bf16_f32 v199, v182, v183
    ds_write_b128 v11, v[196:199] offset:1024
    buffer_load_dwordx4 v[144:147], v10, s[16:19], s38 offen offset:0 sc1
    buffer_load_dwordx4 v[148:151], v10, s[16:19], s38 offen offset:1024 sc1
    buffer_load_dwordx4 v[152:155], v10, s[16:19], s38 offen offset:2048 sc1
    buffer_load_dwordx4 v[156:159], v10, s[16:19], s38 offen offset:3072 sc1
    s_add_u32 s38, s38, 4096
    s_waitcnt vmcnt(4)
    v_mfma_f32_16x16x32_bf16 v[128:131], v[16:19], a[0:3], 0
    v_mfma_f32_16x16x32_bf16 v[136:139], v[16:19], a[56:59], 0
    v_mfma_f32_16x16x32_bf16 v[132:135], v[72:75], a[0:3], 0
    v_mfma_f32_16x16x32_bf16 v[140:143], v[72:75], a[56:59], 0
    v_mfma_f32_16x16x32_bf16 v[128:131], v[20:23], a[4:7], v[128:131]
    v_mfma_f32_16x16x32_bf16 v[136:139], v[20:23], a[60:63], v[136:139]
    v_mfma_f32_16x16x32_bf16 v[132:135], v[76:79], a[4:7], v[132:135]
    v_mfma_f32_16x16x32_bf16 v[140:143], v[76:79], a[60:63], v[140:143]
    v_mfma_f32_16x16x32_bf16 v[128:131], v[24:27], a[8:11], v[128:131]
    v_mfma_f32_16x16x32_bf16 v[136:139], v[24:27], a[64:67], v[136:139]
    v_mfma_f32_16x16x32_bf16 v[132:135], v[80:83], a[8:11], v[132:135]
    v_mfma_f32_16x16x32_bf16 v[140:143], v[80:83], a[64:67], v[140:143]
    v_mfma_f32_16x16x32_bf16 v[128:131], v[28:31], a[12:15], v[128:131]
    v_mfma_f32_16x16x32_bf16 v[136:139], v[28:31], a[68:71], v[136:139]
    v_mfma_f32_16x16x32_bf16 v[132:135], v[84:87], a[12:15], v[132:135]
    v_mfma_f32_16x16x32_bf16 v[140:143], v[84:87], a[68:71], v[140:143]
    v_mfma_f32_16x16x32_bf16 v[128:131], v[32:35], a[16:19], v[128:131]
    v_mfma_f32_16x16x32_bf16 v[136:139], v[32:35], a[72:75], v[136:139]
    v_mfma_f32_16x16x32_bf16 v[132:135], v[88:91], a[16:19], v[132:135]
    v_mfma_f32_16x16x32_bf16 v[140:143], v[88:91], a[72:75], v[140:143]
    v_mfma_f32_16x16x32_bf16 v[128:131], v[36:39], a[20:23], v[128:131]
    v_mfma_f32_16x16x32_bf16 v[136:139], v[36:39], a[76:79], v[136:139]
    v_mfma_f32_16x16x32_bf16 v[132:135], v[92:95], a[20:23], v[132:135]
    v_mfma_f32_16x16x32_bf16 v[140:143], v[92:95], a[76:79], v[140:143]
    v_mfma_f32_16x16x32_bf16 v[128:131], v[40:43], a[24:27], v[128:131]
    v_mfma_f32_16x16x32_bf16 v[136:139], v[40:43], a[80:83], v[136:139]
    v_mfma_f32_16x16x32_bf16 v[132:135], v[96:99], a[24:27], v[132:135]
    v_mfma_f32_16x16x32_bf16 v[140:143], v[96:99], a[80:83], v[140:143]
    v_mfma_f32_16x16x32_bf16 v[128:131], v[44:47], a[28:31], v[128:131]
    v_mfma_f32_16x16x32_bf16 v[136:139], v[44:47], a[84:87], v[136:139]
    v_mfma_f32_16x16x32_bf16 v[132:135], v[100:103], a[28:31], v[132:135]
    v_mfma_f32_16x16x32_bf16 v[140:143], v[100:103], a[84:87], v[140:143]
    v_mfma_f32_16x16x32_bf16 v[128:131], v[48:51], a[32:35], v[128:131]
    v_mfma_f32_16x16x32_bf16 v[136:139], v[48:51], a[88:91], v[136:139]
    v_mfma_f32_16x16x32_bf16 v[132:135], v[104:107], a[32:35], v[132:135]
    v_mfma_f32_16x16x32_bf16 v[140:143], v[104:107], a[88:91], v[140:143]
    v_mfma_f32_16x16x32_bf16 v[128:131], v[52:55], a[36:39], v[128:131]
    v_mfma_f32_16x16x32_bf16 v[136:139], v[52:55], a[92:95], v[136:139]
    v_mfma_f32_16x16x32_bf16 v[132:135], v[108:111], a[36:39], v[132:135]
    v_mfma_f32_16x16x32_bf16 v[140:143], v[108:111], a[92:95], v[140:143]
    v_mfma_f32_16x16x32_bf16 v[128:131], v[56:59], a[40:43], v[128:131]
    v_mfma_f32_16x16x32_bf16 v[136:139], v[56:59], a[96:99], v[136:139]
    v_mfma_f32_16x16x32_bf16 v[132:135], v[112:115], a[40:43], v[132:135]
    v_mfma_f32_16x16x32_bf16 v[140:143], v[112:115], a[96:99], v[140:143]
    v_mfma_f32_16x16x32_bf16 v[128:131], v[60:63], a[44:47], v[128:131]
    v_mfma_f32_16x16x32_bf16 v[136:139], v[60:63], a[100:103], v[136:139]
    v_mfma_f32_16x16x32_bf16 v[132:135], v[116:119], a[44:47], v[132:135]
    v_mfma_f32_16x16x32_bf16 v[140:143], v[116:119], a[100:103], v[140:143]
    v_mfma_f32_16x16x32_bf16 v[128:131], v[64:67], a[48:51], v[128:131]
    v_mfma_f32_16x16x32_bf16 v[136:139], v[64:67], a[104:107], v[136:139]
    v_mfma_f32_16x16x32_bf16 v[132:135], v[120:123], a[48:51], v[132:135]
    v_mfma_f32_16x16x32_bf16 v[140:143], v[120:123], a[104:107], v[140:143]
    v_mfma_f32_16x16x32_bf16 v[128:131], v[68:71], a[52:55], v[128:131]
    v_mfma_f32_16x16x32_bf16 v[136:139], v[68:71], a[108:111], v[136:139]
    v_mfma_f32_16x16x32_bf16 v[132:135], v[124:127], a[52:55], v[132:135]
    v_mfma_f32_16x16x32_bf16 v[140:143], v[124:127], a[108:111], v[140:143]
    s_waitcnt vmcnt(0)
    buffer_load_dwordx4 v[16:19], v5, s[16:19], s36 offen offset:0
    buffer_load_dwordx4 v[20:23], v5, s[16:19], s36 offen offset:64
    buffer_load_dwordx4 v[24:27], v5, s[16:19], s36 offen offset:128
    buffer_load_dwordx4 v[28:31], v5, s[16:19], s36 offen offset:192
    buffer_load_dwordx4 v[32:35], v5, s[16:19], s36 offen offset:256
    buffer_load_dwordx4 v[36:39], v5, s[16:19], s36 offen offset:320
    buffer_load_dwordx4 v[40:43], v5, s[16:19], s36 offen offset:384
    buffer_load_dwordx4 v[44:47], v5, s[16:19], s36 offen offset:448
    buffer_load_dwordx4 v[48:51], v5, s[16:19], s36 offen offset:512
    buffer_load_dwordx4 v[52:55], v5, s[16:19], s36 offen offset:576
    buffer_load_dwordx4 v[56:59], v5, s[16:19], s36 offen offset:640
    buffer_load_dwordx4 v[60:63], v5, s[16:19], s36 offen offset:704
    buffer_load_dwordx4 v[64:67], v5, s[16:19], s36 offen offset:768
    buffer_load_dwordx4 v[68:71], v5, s[16:19], s36 offen offset:832
    s_add_u32 s36, s36, 14336
    buffer_load_dwordx4 v[72:75], v5, s[16:19], s36 offen offset:0
    buffer_load_dwordx4 v[76:79], v5, s[16:19], s36 offen offset:64
    buffer_load_dwordx4 v[80:83], v5, s[16:19], s36 offen offset:128
    buffer_load_dwordx4 v[84:87], v5, s[16:19], s36 offen offset:192
    buffer_load_dwordx4 v[88:91], v5, s[16:19], s36 offen offset:256
    buffer_load_dwordx4 v[92:95], v5, s[16:19], s36 offen offset:320
    buffer_load_dwordx4 v[96:99], v5, s[16:19], s36 offen offset:384
    buffer_load_dwordx4 v[100:103], v5, s[16:19], s36 offen offset:448
    buffer_load_dwordx4 v[104:107], v5, s[16:19], s36 offen offset:512
    buffer_load_dwordx4 v[108:111], v5, s[16:19], s36 offen offset:576
    buffer_load_dwordx4 v[112:115], v5, s[16:19], s36 offen offset:640
    buffer_load_dwordx4 v[116:119], v5, s[16:19], s36 offen offset:704
    buffer_load_dwordx4 v[120:123], v5, s[16:19], s36 offen offset:768
    buffer_load_dwordx4 v[124:127], v5, s[16:19], s36 offen offset:832
    s_add_u32 s36, s36, 14336
    v_max3_f32 v192, v132, v133, v134
    v_max_f32 v192, v192, v135
    v_min3_f32 v193, v132, v133, v134
    v_min_f32 v193, v193, v135
    v_cndmask_b32 v192, v192, v2, s[44:45]
    v_cndmask_b32 v193, v193, v7, s[44:45]
    v_max3_f32 v192, v192, v128, v129
    v_max3_f32 v192, v192, v130, v131
    v_min3_f32 v193, v193, v128, v129
    v_min3_f32 v193, v193, v130, v131
    v_mov_b32 v194, v192
    v_mov_b32 v195, v192
    s_nop 1
    v_permlane16_swap_b32 v194, v195
    v_max_f32 v194, v194, v195
    v_mov_b32 v195, v194
    s_nop 1
    v_permlane32_swap_b32 v194, v195
    v_max_f32 v192, v194, v195
    v_mov_b32 v194, v193
    v_mov_b32 v195, v193
    s_nop 1
    v_permlane16_swap_b32 v194, v195
    v_min_f32 v194, v194, v195
    v_mov_b32 v195, v194
    s_nop 1
    v_permlane32_swap_b32 v194, v195
    v_min_f32 v193, v194, v195
    v_sub_f32 v196, v128, v192
    v_sub_f32 v204, v193, v128
    v_sub_f32 v197, v129, v192
    v_sub_f32 v205, v193, v129
    v_sub_f32 v198, v130, v192
    v_sub_f32 v206, v193, v130
    v_sub_f32 v199, v131, v192
    v_sub_f32 v207, v193, v131
    v_sub_f32 v200, v132, v192
    v_sub_f32 v208, v193, v132
    v_sub_f32 v201, v133, v192
    v_sub_f32 v209, v193, v133
    v_sub_f32 v202, v134, v192
    v_sub_f32 v210, v193, v134
    v_sub_f32 v203, v135, v192
    v_sub_f32 v211, v193, v135
    v_mul_f32 v196, s43, v196
    v_mul_f32 v197, s43, v197
    v_mul_f32 v198, s43, v198
    v_mul_f32 v199, s43, v199
    v_mul_f32 v200, s43, v200
    v_mul_f32 v201, s43, v201
    v_mul_f32 v202, s43, v202
    v_mul_f32 v203, s43, v203
    v_mul_f32 v204, s43, v204
    v_mul_f32 v205, s43, v205
    v_mul_f32 v206, s43, v206
    v_mul_f32 v207, s43, v207
    v_mul_f32 v208, s43, v208
    v_mul_f32 v209, s43, v209
    v_mul_f32 v210, s43, v210
    v_mul_f32 v211, s43, v211
    v_exp_f32 v196, v196
    v_exp_f32 v197, v197
    v_exp_f32 v198, v198
    v_exp_f32 v199, v199
    v_exp_f32 v200, v200
    v_exp_f32 v201, v201
    v_exp_f32 v202, v202
    v_exp_f32 v203, v203
    v_exp_f32 v204, v204
    v_exp_f32 v205, v205
    v_exp_f32 v206, v206
    v_exp_f32 v207, v207
    v_exp_f32 v208, v208
    v_exp_f32 v209, v209
    v_exp_f32 v210, v210
    v_exp_f32 v211, v211
    v_cndmask_b32 v200, v200, 0, s[44:45]
    v_cndmask_b32 v201, v201, 0, s[44:45]
    v_cndmask_b32 v202, v202, 0, s[44:45]
    v_cndmask_b32 v203, v203, 0, s[44:45]
    v_cndmask_b32 v208, v208, 0, s[44:45]
    v_cndmask_b32 v209, v209, 0, s[44:45]
    v_cndmask_b32 v210, v210, 0, s[44:45]
    v_cndmask_b32 v211, v211, 0, s[44:45]
    v_add_f32 v192, v196, v197
    v_add_f32 v192, v192, v198
    v_add_f32 v192, v192, v199
    v_add_f32 v192, v192, v200
    v_add_f32 v192, v192, v201
    v_add_f32 v192, v192, v202
    v_add_f32 v192, v192, v203
    v_mov_b32 v194, v192
    v_mov_b32 v195, v192
    s_nop 1
    v_permlane16_swap_b32 v194, v195
    v_add_f32 v194, v194, v195
    v_mov_b32 v195, v194
    s_nop 1
    v_permlane32_swap_b32 v194, v195
    v_add_f32 v192, v194, v195
    v_rcp_f32 v192, v192
    s_nop 0
    v_mul_f32 v196, v196, v192
    v_mul_f32 v197, v197, v192
    v_mul_f32 v198, v198, v192
    v_mul_f32 v199, v199, v192
    v_mul_f32 v200, v200, v192
    v_mul_f32 v201, v201, v192
    v_mul_f32 v202, v202, v192
    v_mul_f32 v203, v203, v192
    v_cvt_pk_bf16_f32 v160, v196, v197
    v_cvt_pk_bf16_f32 v161, v198, v199
    v_cvt_pk_bf16_f32 v162, v200, v201
    v_cvt_pk_bf16_f32 v163, v202, v203
    v_add_f32 v193, v204, v205
    v_add_f32 v193, v193, v206
    v_add_f32 v193, v193, v207
    v_add_f32 v193, v193, v208
    v_add_f32 v193, v193, v209
    v_add_f32 v193, v193, v210
    v_add_f32 v193, v193, v211
    v_mov_b32 v194, v193
    v_mov_b32 v195, v193
    s_nop 1
    v_permlane16_swap_b32 v194, v195
    v_add_f32 v194, v194, v195
    v_mov_b32 v195, v194
    s_nop 1
    v_permlane32_swap_b32 v194, v195
    v_add_f32 v193, v194, v195
    v_rcp_f32 v193, v193
    s_nop 0
    v_mul_f32 v204, v204, v193
    v_mul_f32 v205, v205, v193
    v_mul_f32 v206, v206, v193
    v_mul_f32 v207, v207, v193
    v_mul_f32 v208, v208, v193
    v_mul_f32 v209, v209, v193
    v_mul_f32 v210, v210, v193
    v_mul_f32 v211, v211, v193
    v_cvt_pk_bf16_f32 v164, v204, v205
    v_cvt_pk_bf16_f32 v165, v206, v207
    v_cvt_pk_bf16_f32 v166, v208, v209
    v_cvt_pk_bf16_f32 v167, v210, v211
    v_mfma_f32_16x16x32_bf16 v[176:179], v[144:147], v[160:163], 0
    s_nop 0
    v_mfma_f32_16x16x32_bf16 v[176:179], v[148:151], v[164:167], v[176:179]
    v_mfma_f32_16x16x32_bf16 v[180:183], v[152:155], v[160:163], 0
    v_mfma_f32_16x16x32_bf16 v[180:183], v[156:159], v[164:167], v[180:183]
    s_nop 7
    v_mov_b32 v194, v180
    v_mov_b32 v195, v180
    s_nop 1
    v_permlane32_swap_b32 v194, v195
    v_mov_b32 v194, v195
    s_nop 1
    v_permlane16_swap_b32 v194, v195
    v_add_f32 v195, s46, v195
    v_rcp_f32 v195, v195
    s_nop 0
    v_mul_f32 v176, v176, v195
    v_mul_f32 v177, v177, v195
    v_mul_f32 v178, v178, v195
    v_mul_f32 v179, v179, v195
    v_mul_f32 v180, v180, v195
    v_mul_f32 v181, v181, v195
    v_mul_f32 v182, v182, v195
    v_mul_f32 v183, v183, v195
    v_cvt_pk_bf16_f32 v196, v176, v177
    v_cvt_pk_bf16_f32 v197, v178, v179
    v_cvt_pk_bf16_f32 v198, v180, v181
    v_cvt_pk_bf16_f32 v199, v182, v183
    ds_write_b128 v11, v[196:199] offset:2048
    v_max3_f32 v192, v140, v141, v142
    v_max_f32 v192, v192, v143
    v_min3_f32 v193, v140, v141, v142
    v_min_f32 v193, v193, v143
    v_cndmask_b32 v192, v192, v2, s[44:45]
    v_cndmask_b32 v193, v193, v7, s[44:45]
    v_max3_f32 v192, v192, v136, v137
    v_max3_f32 v192, v192, v138, v139
    v_min3_f32 v193, v193, v136, v137
    v_min3_f32 v193, v193, v138, v139
    v_mov_b32 v194, v192
    v_mov_b32 v195, v192
    s_nop 1
    v_permlane16_swap_b32 v194, v195
    v_max_f32 v194, v194, v195
    v_mov_b32 v195, v194
    s_nop 1
    v_permlane32_swap_b32 v194, v195
    v_max_f32 v192, v194, v195
    v_mov_b32 v194, v193
    v_mov_b32 v195, v193
    s_nop 1
    v_permlane16_swap_b32 v194, v195
    v_min_f32 v194, v194, v195
    v_mov_b32 v195, v194
    s_nop 1
    v_permlane32_swap_b32 v194, v195
    v_min_f32 v193, v194, v195
    v_sub_f32 v196, v136, v192
    v_sub_f32 v204, v193, v136
    v_sub_f32 v197, v137, v192
    v_sub_f32 v205, v193, v137
    v_sub_f32 v198, v138, v192
    v_sub_f32 v206, v193, v138
    v_sub_f32 v199, v139, v192
    v_sub_f32 v207, v193, v139
    v_sub_f32 v200, v140, v192
    v_sub_f32 v208, v193, v140
    v_sub_f32 v201, v141, v192
    v_sub_f32 v209, v193, v141
    v_sub_f32 v202, v142, v192
    v_sub_f32 v210, v193, v142
    v_sub_f32 v203, v143, v192
    v_sub_f32 v211, v193, v143
    v_mul_f32 v196, s43, v196
    v_mul_f32 v197, s43, v197
    v_mul_f32 v198, s43, v198
    v_mul_f32 v199, s43, v199
    v_mul_f32 v200, s43, v200
    v_mul_f32 v201, s43, v201
    v_mul_f32 v202, s43, v202
    v_mul_f32 v203, s43, v203
    v_mul_f32 v204, s43, v204
    v_mul_f32 v205, s43, v205
    v_mul_f32 v206, s43, v206
    v_mul_f32 v207, s43, v207
    v_mul_f32 v208, s43, v208
    v_mul_f32 v209, s43, v209
    v_mul_f32 v210, s43, v210
    v_mul_f32 v211, s43, v211
    v_exp_f32 v196, v196
    v_exp_f32 v197, v197
    v_exp_f32 v198, v198
    v_exp_f32 v199, v199
    v_exp_f32 v200, v200
    v_exp_f32 v201, v201
    v_exp_f32 v202, v202
    v_exp_f32 v203, v203
    v_exp_f32 v204, v204
    v_exp_f32 v205, v205
    v_exp_f32 v206, v206
    v_exp_f32 v207, v207
    v_exp_f32 v208, v208
    v_exp_f32 v209, v209
    v_exp_f32 v210, v210
    v_exp_f32 v211, v211
    v_cndmask_b32 v200, v200, 0, s[44:45]
    v_cndmask_b32 v201, v201, 0, s[44:45]
    v_cndmask_b32 v202, v202, 0, s[44:45]
    v_cndmask_b32 v203, v203, 0, s[44:45]
    v_cndmask_b32 v208, v208, 0, s[44:45]
    v_cndmask_b32 v209, v209, 0, s[44:45]
    v_cndmask_b32 v210, v210, 0, s[44:45]
    v_cndmask_b32 v211, v211, 0, s[44:45]
    v_add_f32 v192, v196, v197
    v_add_f32 v192, v192, v198
    v_add_f32 v192, v192, v199
    v_add_f32 v192, v192, v200
    v_add_f32 v192, v192, v201
    v_add_f32 v192, v192, v202
    v_add_f32 v192, v192, v203
    v_mov_b32 v194, v192
    v_mov_b32 v195, v192
    s_nop 1
    v_permlane16_swap_b32 v194, v195
    v_add_f32 v194, v194, v195
    v_mov_b32 v195, v194
    s_nop 1
    v_permlane32_swap_b32 v194, v195
    v_add_f32 v192, v194, v195
    v_rcp_f32 v192, v192
    s_nop 0
    v_mul_f32 v196, v196, v192
    v_mul_f32 v197, v197, v192
    v_mul_f32 v198, v198, v192
    v_mul_f32 v199, v199, v192
    v_mul_f32 v200, v200, v192
    v_mul_f32 v201, v201, v192
    v_mul_f32 v202, v202, v192
    v_mul_f32 v203, v203, v192
    v_cvt_pk_bf16_f32 v160, v196, v197
    v_cvt_pk_bf16_f32 v161, v198, v199
    v_cvt_pk_bf16_f32 v162, v200, v201
    v_cvt_pk_bf16_f32 v163, v202, v203
    v_add_f32 v193, v204, v205
    v_add_f32 v193, v193, v206
    v_add_f32 v193, v193, v207
    v_add_f32 v193, v193, v208
    v_add_f32 v193, v193, v209
    v_add_f32 v193, v193, v210
    v_add_f32 v193, v193, v211
    v_mov_b32 v194, v193
    v_mov_b32 v195, v193
    s_nop 1
    v_permlane16_swap_b32 v194, v195
    v_add_f32 v194, v194, v195
    v_mov_b32 v195, v194
    s_nop 1
    v_permlane32_swap_b32 v194, v195
    v_add_f32 v193, v194, v195
    v_rcp_f32 v193, v193
    s_nop 0
    v_mul_f32 v204, v204, v193
    v_mul_f32 v205, v205, v193
    v_mul_f32 v206, v206, v193
    v_mul_f32 v207, v207, v193
    v_mul_f32 v208, v208, v193
    v_mul_f32 v209, v209, v193
    v_mul_f32 v210, v210, v193
    v_mul_f32 v211, v211, v193
    v_cvt_pk_bf16_f32 v164, v204, v205
    v_cvt_pk_bf16_f32 v165, v206, v207
    v_cvt_pk_bf16_f32 v166, v208, v209
    v_cvt_pk_bf16_f32 v167, v210, v211
    v_mfma_f32_16x16x32_bf16 v[176:179], v[144:147], v[160:163], 0
    s_nop 0
    v_mfma_f32_16x16x32_bf16 v[176:179], v[148:151], v[164:167], v[176:179]
    v_mfma_f32_16x16x32_bf16 v[180:183], v[152:155], v[160:163], 0
    v_mfma_f32_16x16x32_bf16 v[180:183], v[156:159], v[164:167], v[180:183]
    s_nop 7
    v_mov_b32 v194, v180
    v_mov_b32 v195, v180
    s_nop 1
    v_permlane32_swap_b32 v194, v195
    v_mov_b32 v194, v195
    s_nop 1
    v_permlane16_swap_b32 v194, v195
    v_add_f32 v195, s46, v195
    v_rcp_f32 v195, v195
    s_nop 0
    v_mul_f32 v176, v176, v195
    v_mul_f32 v177, v177, v195
    v_mul_f32 v178, v178, v195
    v_mul_f32 v179, v179, v195
    v_mul_f32 v180, v180, v195
    v_mul_f32 v181, v181, v195
    v_mul_f32 v182, v182, v195
    v_mul_f32 v183, v183, v195
    v_cvt_pk_bf16_f32 v196, v176, v177
    v_cvt_pk_bf16_f32 v197, v178, v179
    v_cvt_pk_bf16_f32 v198, v180, v181
    v_cvt_pk_bf16_f32 v199, v182, v183
    ds_write_b128 v11, v[196:199] offset:3072
    buffer_load_dwordx4 v[144:147], v10, s[16:19], s38 offen offset:0 sc1
    buffer_load_dwordx4 v[148:151], v10, s[16:19], s38 offen offset:1024 sc1
    buffer_load_dwordx4 v[152:155], v10, s[16:19], s38 offen offset:2048 sc1
    buffer_load_dwordx4 v[156:159], v10, s[16:19], s38 offen offset:3072 sc1
    s_add_u32 s38, s38, 4096
    s_waitcnt vmcnt(4)
    v_mfma_f32_16x16x32_bf16 v[128:131], v[16:19], a[0:3], 0
    v_mfma_f32_16x16x32_bf16 v[136:139], v[16:19], a[56:59], 0
    v_mfma_f32_16x16x32_bf16 v[132:135], v[72:75], a[0:3], 0
    v_mfma_f32_16x16x32_bf16 v[140:143], v[72:75], a[56:59], 0
    v_mfma_f32_16x16x32_bf16 v[128:131], v[20:23], a[4:7], v[128:131]
    v_mfma_f32_16x16x32_bf16 v[136:139], v[20:23], a[60:63], v[136:139]
    v_mfma_f32_16x16x32_bf16 v[132:135], v[76:79], a[4:7], v[132:135]
    v_mfma_f32_16x16x32_bf16 v[140:143], v[76:79], a[60:63], v[140:143]
    v_mfma_f32_16x16x32_bf16 v[128:131], v[24:27], a[8:11], v[128:131]
    v_mfma_f32_16x16x32_bf16 v[136:139], v[24:27], a[64:67], v[136:139]
    v_mfma_f32_16x16x32_bf16 v[132:135], v[80:83], a[8:11], v[132:135]
    v_mfma_f32_16x16x32_bf16 v[140:143], v[80:83], a[64:67], v[140:143]
    v_mfma_f32_16x16x32_bf16 v[128:131], v[28:31], a[12:15], v[128:131]
    v_mfma_f32_16x16x32_bf16 v[136:139], v[28:31], a[68:71], v[136:139]
    v_mfma_f32_16x16x32_bf16 v[132:135], v[84:87], a[12:15], v[132:135]
    v_mfma_f32_16x16x32_bf16 v[140:143], v[84:87], a[68:71], v[140:143]
    v_mfma_f32_16x16x32_bf16 v[128:131], v[32:35], a[16:19], v[128:131]
    v_mfma_f32_16x16x32_bf16 v[136:139], v[32:35], a[72:75], v[136:139]
    v_mfma_f32_16x16x32_bf16 v[132:135], v[88:91], a[16:19], v[132:135]
    v_mfma_f32_16x16x32_bf16 v[140:143], v[88:91], a[72:75], v[140:143]
    v_mfma_f32_16x16x32_bf16 v[128:131], v[36:39], a[20:23], v[128:131]
    v_mfma_f32_16x16x32_bf16 v[136:139], v[36:39], a[76:79], v[136:139]
    v_mfma_f32_16x16x32_bf16 v[132:135], v[92:95], a[20:23], v[132:135]
    v_mfma_f32_16x16x32_bf16 v[140:143], v[92:95], a[76:79], v[140:143]
    v_mfma_f32_16x16x32_bf16 v[128:131], v[40:43], a[24:27], v[128:131]
    v_mfma_f32_16x16x32_bf16 v[136:139], v[40:43], a[80:83], v[136:139]
    v_mfma_f32_16x16x32_bf16 v[132:135], v[96:99], a[24:27], v[132:135]
    v_mfma_f32_16x16x32_bf16 v[140:143], v[96:99], a[80:83], v[140:143]
    v_mfma_f32_16x16x32_bf16 v[128:131], v[44:47], a[28:31], v[128:131]
    v_mfma_f32_16x16x32_bf16 v[136:139], v[44:47], a[84:87], v[136:139]
    v_mfma_f32_16x16x32_bf16 v[132:135], v[100:103], a[28:31], v[132:135]
    v_mfma_f32_16x16x32_bf16 v[140:143], v[100:103], a[84:87], v[140:143]
    v_mfma_f32_16x16x32_bf16 v[128:131], v[48:51], a[32:35], v[128:131]
    v_mfma_f32_16x16x32_bf16 v[136:139], v[48:51], a[88:91], v[136:139]
    v_mfma_f32_16x16x32_bf16 v[132:135], v[104:107], a[32:35], v[132:135]
    v_mfma_f32_16x16x32_bf16 v[140:143], v[104:107], a[88:91], v[140:143]
    v_mfma_f32_16x16x32_bf16 v[128:131], v[52:55], a[36:39], v[128:131]
    v_mfma_f32_16x16x32_bf16 v[136:139], v[52:55], a[92:95], v[136:139]
    v_mfma_f32_16x16x32_bf16 v[132:135], v[108:111], a[36:39], v[132:135]
    v_mfma_f32_16x16x32_bf16 v[140:143], v[108:111], a[92:95], v[140:143]
    v_mfma_f32_16x16x32_bf16 v[128:131], v[56:59], a[40:43], v[128:131]
    v_mfma_f32_16x16x32_bf16 v[136:139], v[56:59], a[96:99], v[136:139]
    v_mfma_f32_16x16x32_bf16 v[132:135], v[112:115], a[40:43], v[132:135]
    v_mfma_f32_16x16x32_bf16 v[140:143], v[112:115], a[96:99], v[140:143]
    v_mfma_f32_16x16x32_bf16 v[128:131], v[60:63], a[44:47], v[128:131]
    v_mfma_f32_16x16x32_bf16 v[136:139], v[60:63], a[100:103], v[136:139]
    v_mfma_f32_16x16x32_bf16 v[132:135], v[116:119], a[44:47], v[132:135]
    v_mfma_f32_16x16x32_bf16 v[140:143], v[116:119], a[100:103], v[140:143]
    v_mfma_f32_16x16x32_bf16 v[128:131], v[64:67], a[48:51], v[128:131]
    v_mfma_f32_16x16x32_bf16 v[136:139], v[64:67], a[104:107], v[136:139]
    v_mfma_f32_16x16x32_bf16 v[132:135], v[120:123], a[48:51], v[132:135]
    v_mfma_f32_16x16x32_bf16 v[140:143], v[120:123], a[104:107], v[140:143]
    v_mfma_f32_16x16x32_bf16 v[128:131], v[68:71], a[52:55], v[128:131]
    v_mfma_f32_16x16x32_bf16 v[136:139], v[68:71], a[108:111], v[136:139]
    v_mfma_f32_16x16x32_bf16 v[132:135], v[124:127], a[52:55], v[132:135]
    v_mfma_f32_16x16x32_bf16 v[140:143], v[124:127], a[108:111], v[140:143]
    s_waitcnt vmcnt(0)
    buffer_load_dwordx4 v[16:19], v5, s[16:19], s36 offen offset:0
    buffer_load_dwordx4 v[20:23], v5, s[16:19], s36 offen offset:64
    buffer_load_dwordx4 v[24:27], v5, s[16:19], s36 offen offset:128
    buffer_load_dwordx4 v[28:31], v5, s[16:19], s36 offen offset:192
    buffer_load_dwordx4 v[32:35], v5, s[16:19], s36 offen offset:256
    buffer_load_dwordx4 v[36:39], v5, s[16:19], s36 offen offset:320
    buffer_load_dwordx4 v[40:43], v5, s[16:19], s36 offen offset:384
    buffer_load_dwordx4 v[44:47], v5, s[16:19], s36 offen offset:448
    buffer_load_dwordx4 v[48:51], v5, s[16:19], s36 offen offset:512
    buffer_load_dwordx4 v[52:55], v5, s[16:19], s36 offen offset:576
    buffer_load_dwordx4 v[56:59], v5, s[16:19], s36 offen offset:640
    buffer_load_dwordx4 v[60:63], v5, s[16:19], s36 offen offset:704
    buffer_load_dwordx4 v[64:67], v5, s[16:19], s36 offen offset:768
    buffer_load_dwordx4 v[68:71], v5, s[16:19], s36 offen offset:832
    s_add_u32 s36, s36, 14336
    buffer_load_dwordx4 v[72:75], v5, s[16:19], s36 offen offset:0
    buffer_load_dwordx4 v[76:79], v5, s[16:19], s36 offen offset:64
    buffer_load_dwordx4 v[80:83], v5, s[16:19], s36 offen offset:128
    buffer_load_dwordx4 v[84:87], v5, s[16:19], s36 offen offset:192
    buffer_load_dwordx4 v[88:91], v5, s[16:19], s36 offen offset:256
    buffer_load_dwordx4 v[92:95], v5, s[16:19], s36 offen offset:320
    buffer_load_dwordx4 v[96:99], v5, s[16:19], s36 offen offset:384
    buffer_load_dwordx4 v[100:103], v5, s[16:19], s36 offen offset:448
    buffer_load_dwordx4 v[104:107], v5, s[16:19], s36 offen offset:512
    buffer_load_dwordx4 v[108:111], v5, s[16:19], s36 offen offset:576
    buffer_load_dwordx4 v[112:115], v5, s[16:19], s36 offen offset:640
    buffer_load_dwordx4 v[116:119], v5, s[16:19], s36 offen offset:704
    buffer_load_dwordx4 v[120:123], v5, s[16:19], s36 offen offset:768
    buffer_load_dwordx4 v[124:127], v5, s[16:19], s36 offen offset:832
    s_add_u32 s36, s36, 14336
    v_max3_f32 v192, v132, v133, v134
    v_max_f32 v192, v192, v135
    v_min3_f32 v193, v132, v133, v134
    v_min_f32 v193, v193, v135
    v_cndmask_b32 v192, v192, v2, s[44:45]
    v_cndmask_b32 v193, v193, v7, s[44:45]
    v_max3_f32 v192, v192, v128, v129
    v_max3_f32 v192, v192, v130, v131
    v_min3_f32 v193, v193, v128, v129
    v_min3_f32 v193, v193, v130, v131
    v_mov_b32 v194, v192
    v_mov_b32 v195, v192
    s_nop 1
    v_permlane16_swap_b32 v194, v195
    v_max_f32 v194, v194, v195
    v_mov_b32 v195, v194
    s_nop 1
    v_permlane32_swap_b32 v194, v195
    v_max_f32 v192, v194, v195
    v_mov_b32 v194, v193
    v_mov_b32 v195, v193
    s_nop 1
    v_permlane16_swap_b32 v194, v195
    v_min_f32 v194, v194, v195
    v_mov_b32 v195, v194
    s_nop 1
    v_permlane32_swap_b32 v194, v195
    v_min_f32 v193, v194, v195
    v_sub_f32 v196, v128, v192
    v_sub_f32 v204, v193, v128
    v_sub_f32 v197, v129, v192
    v_sub_f32 v205, v193, v129
    v_sub_f32 v198, v130, v192
    v_sub_f32 v206, v193, v130
    v_sub_f32 v199, v131, v192
    v_sub_f32 v207, v193, v131
    v_sub_f32 v200, v132, v192
    v_sub_f32 v208, v193, v132
    v_sub_f32 v201, v133, v192
    v_sub_f32 v209, v193, v133
    v_sub_f32 v202, v134, v192
    v_sub_f32 v210, v193, v134
    v_sub_f32 v203, v135, v192
    v_sub_f32 v211, v193, v135
    v_mul_f32 v196, s43, v196
    v_mul_f32 v197, s43, v197
    v_mul_f32 v198, s43, v198
    v_mul_f32 v199, s43, v199
    v_mul_f32 v200, s43, v200
    v_mul_f32 v201, s43, v201
    v_mul_f32 v202, s43, v202
    v_mul_f32 v203, s43, v203
    v_mul_f32 v204, s43, v204
    v_mul_f32 v205, s43, v205
    v_mul_f32 v206, s43, v206
    v_mul_f32 v207, s43, v207
    v_mul_f32 v208, s43, v208
    v_mul_f32 v209, s43, v209
    v_mul_f32 v210, s43, v210
    v_mul_f32 v211, s43, v211
    v_exp_f32 v196, v196
    v_exp_f32 v197, v197
    v_exp_f32 v198, v198
    v_exp_f32 v199, v199
    v_exp_f32 v200, v200
    v_exp_f32 v201, v201
    v_exp_f32 v202, v202
    v_exp_f32 v203, v203
    v_exp_f32 v204, v204
    v_exp_f32 v205, v205
    v_exp_f32 v206, v206
    v_exp_f32 v207, v207
    v_exp_f32 v208, v208
    v_exp_f32 v209, v209
    v_exp_f32 v210, v210
    v_exp_f32 v211, v211
    v_cndmask_b32 v200, v200, 0, s[44:45]
    v_cndmask_b32 v201, v201, 0, s[44:45]
    v_cndmask_b32 v202, v202, 0, s[44:45]
    v_cndmask_b32 v203, v203, 0, s[44:45]
    v_cndmask_b32 v208, v208, 0, s[44:45]
    v_cndmask_b32 v209, v209, 0, s[44:45]
    v_cndmask_b32 v210, v210, 0, s[44:45]
    v_cndmask_b32 v211, v211, 0, s[44:45]
    v_add_f32 v192, v196, v197
    v_add_f32 v192, v192, v198
    v_add_f32 v192, v192, v199
    v_add_f32 v192, v192, v200
    v_add_f32 v192, v192, v201
    v_add_f32 v192, v192, v202
    v_add_f32 v192, v192, v203
    v_mov_b32 v194, v192
    v_mov_b32 v195, v192
    s_nop 1
    v_permlane16_swap_b32 v194, v195
    v_add_f32 v194, v194, v195
    v_mov_b32 v195, v194
    s_nop 1
    v_permlane32_swap_b32 v194, v195
    v_add_f32 v192, v194, v195
    v_rcp_f32 v192, v192
    s_nop 0
    v_mul_f32 v196, v196, v192
    v_mul_f32 v197, v197, v192
    v_mul_f32 v198, v198, v192
    v_mul_f32 v199, v199, v192
    v_mul_f32 v200, v200, v192
    v_mul_f32 v201, v201, v192
    v_mul_f32 v202, v202, v192
    v_mul_f32 v203, v203, v192
    v_cvt_pk_bf16_f32 v160, v196, v197
    v_cvt_pk_bf16_f32 v161, v198, v199
    v_cvt_pk_bf16_f32 v162, v200, v201
    v_cvt_pk_bf16_f32 v163, v202, v203
    v_add_f32 v193, v204, v205
    v_add_f32 v193, v193, v206
    v_add_f32 v193, v193, v207
    v_add_f32 v193, v193, v208
    v_add_f32 v193, v193, v209
    v_add_f32 v193, v193, v210
    v_add_f32 v193, v193, v211
    v_mov_b32 v194, v193
    v_mov_b32 v195, v193
    s_nop 1
    v_permlane16_swap_b32 v194, v195
    v_add_f32 v194, v194, v195
    v_mov_b32 v195, v194
    s_nop 1
    v_permlane32_swap_b32 v194, v195
    v_add_f32 v193, v194, v195
    v_rcp_f32 v193, v193
    s_nop 0
    v_mul_f32 v204, v204, v193
    v_mul_f32 v205, v205, v193
    v_mul_f32 v206, v206, v193
    v_mul_f32 v207, v207, v193
    v_mul_f32 v208, v208, v193
    v_mul_f32 v209, v209, v193
    v_mul_f32 v210, v210, v193
    v_mul_f32 v211, v211, v193
    v_cvt_pk_bf16_f32 v164, v204, v205
    v_cvt_pk_bf16_f32 v165, v206, v207
    v_cvt_pk_bf16_f32 v166, v208, v209
    v_cvt_pk_bf16_f32 v167, v210, v211
    v_mfma_f32_16x16x32_bf16 v[176:179], v[144:147], v[160:163], 0
    s_nop 0
    v_mfma_f32_16x16x32_bf16 v[176:179], v[148:151], v[164:167], v[176:179]
    v_mfma_f32_16x16x32_bf16 v[180:183], v[152:155], v[160:163], 0
    v_mfma_f32_16x16x32_bf16 v[180:183], v[156:159], v[164:167], v[180:183]
    s_nop 7
    v_mov_b32 v194, v180
    v_mov_b32 v195, v180
    s_nop 1
    v_permlane32_swap_b32 v194, v195
    v_mov_b32 v194, v195
    s_nop 1
    v_permlane16_swap_b32 v194, v195
    v_add_f32 v195, s46, v195
    v_rcp_f32 v195, v195
    s_nop 0
    v_mul_f32 v176, v176, v195
    v_mul_f32 v177, v177, v195
    v_mul_f32 v178, v178, v195
    v_mul_f32 v179, v179, v195
    v_mul_f32 v180, v180, v195
    v_mul_f32 v181, v181, v195
    v_mul_f32 v182, v182, v195
    v_mul_f32 v183, v183, v195
    v_cvt_pk_bf16_f32 v196, v176, v177
    v_cvt_pk_bf16_f32 v197, v178, v179
    v_cvt_pk_bf16_f32 v198, v180, v181
    v_cvt_pk_bf16_f32 v199, v182, v183
    ds_write_b128 v11, v[196:199] offset:4096
    v_max3_f32 v192, v140, v141, v142
    v_max_f32 v192, v192, v143
    v_min3_f32 v193, v140, v141, v142
    v_min_f32 v193, v193, v143
    v_cndmask_b32 v192, v192, v2, s[44:45]
    v_cndmask_b32 v193, v193, v7, s[44:45]
    v_max3_f32 v192, v192, v136, v137
    v_max3_f32 v192, v192, v138, v139
    v_min3_f32 v193, v193, v136, v137
    v_min3_f32 v193, v193, v138, v139
    v_mov_b32 v194, v192
    v_mov_b32 v195, v192
    s_nop 1
    v_permlane16_swap_b32 v194, v195
    v_max_f32 v194, v194, v195
    v_mov_b32 v195, v194
    s_nop 1
    v_permlane32_swap_b32 v194, v195
    v_max_f32 v192, v194, v195
    v_mov_b32 v194, v193
    v_mov_b32 v195, v193
    s_nop 1
    v_permlane16_swap_b32 v194, v195
    v_min_f32 v194, v194, v195
    v_mov_b32 v195, v194
    s_nop 1
    v_permlane32_swap_b32 v194, v195
    v_min_f32 v193, v194, v195
    v_sub_f32 v196, v136, v192
    v_sub_f32 v204, v193, v136
    v_sub_f32 v197, v137, v192
    v_sub_f32 v205, v193, v137
    v_sub_f32 v198, v138, v192
    v_sub_f32 v206, v193, v138
    v_sub_f32 v199, v139, v192
    v_sub_f32 v207, v193, v139
    v_sub_f32 v200, v140, v192
    v_sub_f32 v208, v193, v140
    v_sub_f32 v201, v141, v192
    v_sub_f32 v209, v193, v141
    v_sub_f32 v202, v142, v192
    v_sub_f32 v210, v193, v142
    v_sub_f32 v203, v143, v192
    v_sub_f32 v211, v193, v143
    v_mul_f32 v196, s43, v196
    v_mul_f32 v197, s43, v197
    v_mul_f32 v198, s43, v198
    v_mul_f32 v199, s43, v199
    v_mul_f32 v200, s43, v200
    v_mul_f32 v201, s43, v201
    v_mul_f32 v202, s43, v202
    v_mul_f32 v203, s43, v203
    v_mul_f32 v204, s43, v204
    v_mul_f32 v205, s43, v205
    v_mul_f32 v206, s43, v206
    v_mul_f32 v207, s43, v207
    v_mul_f32 v208, s43, v208
    v_mul_f32 v209, s43, v209
    v_mul_f32 v210, s43, v210
    v_mul_f32 v211, s43, v211
    v_exp_f32 v196, v196
    v_exp_f32 v197, v197
    v_exp_f32 v198, v198
    v_exp_f32 v199, v199
    v_exp_f32 v200, v200
    v_exp_f32 v201, v201
    v_exp_f32 v202, v202
    v_exp_f32 v203, v203
    v_exp_f32 v204, v204
    v_exp_f32 v205, v205
    v_exp_f32 v206, v206
    v_exp_f32 v207, v207
    v_exp_f32 v208, v208
    v_exp_f32 v209, v209
    v_exp_f32 v210, v210
    v_exp_f32 v211, v211
    v_cndmask_b32 v200, v200, 0, s[44:45]
    v_cndmask_b32 v201, v201, 0, s[44:45]
    v_cndmask_b32 v202, v202, 0, s[44:45]
    v_cndmask_b32 v203, v203, 0, s[44:45]
    v_cndmask_b32 v208, v208, 0, s[44:45]
    v_cndmask_b32 v209, v209, 0, s[44:45]
    v_cndmask_b32 v210, v210, 0, s[44:45]
    v_cndmask_b32 v211, v211, 0, s[44:45]
    v_add_f32 v192, v196, v197
    v_add_f32 v192, v192, v198
    v_add_f32 v192, v192, v199
    v_add_f32 v192, v192, v200
    v_add_f32 v192, v192, v201
    v_add_f32 v192, v192, v202
    v_add_f32 v192, v192, v203
    v_mov_b32 v194, v192
    v_mov_b32 v195, v192
    s_nop 1
    v_permlane16_swap_b32 v194, v195
    v_add_f32 v194, v194, v195
    v_mov_b32 v195, v194
    s_nop 1
    v_permlane32_swap_b32 v194, v195
    v_add_f32 v192, v194, v195
    v_rcp_f32 v192, v192
    s_nop 0
    v_mul_f32 v196, v196, v192
    v_mul_f32 v197, v197, v192
    v_mul_f32 v198, v198, v192
    v_mul_f32 v199, v199, v192
    v_mul_f32 v200, v200, v192
    v_mul_f32 v201, v201, v192
    v_mul_f32 v202, v202, v192
    v_mul_f32 v203, v203, v192
    v_cvt_pk_bf16_f32 v160, v196, v197
    v_cvt_pk_bf16_f32 v161, v198, v199
    v_cvt_pk_bf16_f32 v162, v200, v201
    v_cvt_pk_bf16_f32 v163, v202, v203
    v_add_f32 v193, v204, v205
    v_add_f32 v193, v193, v206
    v_add_f32 v193, v193, v207
    v_add_f32 v193, v193, v208
    v_add_f32 v193, v193, v209
    v_add_f32 v193, v193, v210
    v_add_f32 v193, v193, v211
    v_mov_b32 v194, v193
    v_mov_b32 v195, v193
    s_nop 1
    v_permlane16_swap_b32 v194, v195
    v_add_f32 v194, v194, v195
    v_mov_b32 v195, v194
    s_nop 1
    v_permlane32_swap_b32 v194, v195
    v_add_f32 v193, v194, v195
    v_rcp_f32 v193, v193
    s_nop 0
    v_mul_f32 v204, v204, v193
    v_mul_f32 v205, v205, v193
    v_mul_f32 v206, v206, v193
    v_mul_f32 v207, v207, v193
    v_mul_f32 v208, v208, v193
    v_mul_f32 v209, v209, v193
    v_mul_f32 v210, v210, v193
    v_mul_f32 v211, v211, v193
    v_cvt_pk_bf16_f32 v164, v204, v205
    v_cvt_pk_bf16_f32 v165, v206, v207
    v_cvt_pk_bf16_f32 v166, v208, v209
    v_cvt_pk_bf16_f32 v167, v210, v211
    v_mfma_f32_16x16x32_bf16 v[176:179], v[144:147], v[160:163], 0
    s_nop 0
    v_mfma_f32_16x16x32_bf16 v[176:179], v[148:151], v[164:167], v[176:179]
    v_mfma_f32_16x16x32_bf16 v[180:183], v[152:155], v[160:163], 0
    v_mfma_f32_16x16x32_bf16 v[180:183], v[156:159], v[164:167], v[180:183]
    s_nop 7
    v_mov_b32 v194, v180
    v_mov_b32 v195, v180
    s_nop 1
    v_permlane32_swap_b32 v194, v195
    v_mov_b32 v194, v195
    s_nop 1
    v_permlane16_swap_b32 v194, v195
    v_add_f32 v195, s46, v195
    v_rcp_f32 v195, v195
    s_nop 0
    v_mul_f32 v176, v176, v195
    v_mul_f32 v177, v177, v195
    v_mul_f32 v178, v178, v195
    v_mul_f32 v179, v179, v195
    v_mul_f32 v180, v180, v195
    v_mul_f32 v181, v181, v195
    v_mul_f32 v182, v182, v195
    v_mul_f32 v183, v183, v195
    v_cvt_pk_bf16_f32 v196, v176, v177
    v_cvt_pk_bf16_f32 v197, v178, v179
    v_cvt_pk_bf16_f32 v198, v180, v181
    v_cvt_pk_bf16_f32 v199, v182, v183
    ds_write_b128 v11, v[196:199] offset:5120
    buffer_load_dwordx4 v[144:147], v10, s[16:19], s38 offen offset:0 sc1
    buffer_load_dwordx4 v[148:151], v10, s[16:19], s38 offen offset:1024 sc1
    buffer_load_dwordx4 v[152:155], v10, s[16:19], s38 offen offset:2048 sc1
    buffer_load_dwordx4 v[156:159], v10, s[16:19], s38 offen offset:3072 sc1
    s_add_u32 s38, s38, 4096
    s_waitcnt vmcnt(4)
    v_mfma_f32_16x16x32_bf16 v[128:131], v[16:19], a[0:3], 0
    v_mfma_f32_16x16x32_bf16 v[136:139], v[16:19], a[56:59], 0
    v_mfma_f32_16x16x32_bf16 v[132:135], v[72:75], a[0:3], 0
    v_mfma_f32_16x16x32_bf16 v[140:143], v[72:75], a[56:59], 0
    v_mfma_f32_16x16x32_bf16 v[128:131], v[20:23], a[4:7], v[128:131]
    v_mfma_f32_16x16x32_bf16 v[136:139], v[20:23], a[60:63], v[136:139]
    v_mfma_f32_16x16x32_bf16 v[132:135], v[76:79], a[4:7], v[132:135]
    v_mfma_f32_16x16x32_bf16 v[140:143], v[76:79], a[60:63], v[140:143]
    v_mfma_f32_16x16x32_bf16 v[128:131], v[24:27], a[8:11], v[128:131]
    v_mfma_f32_16x16x32_bf16 v[136:139], v[24:27], a[64:67], v[136:139]
    v_mfma_f32_16x16x32_bf16 v[132:135], v[80:83], a[8:11], v[132:135]
    v_mfma_f32_16x16x32_bf16 v[140:143], v[80:83], a[64:67], v[140:143]
    v_mfma_f32_16x16x32_bf16 v[128:131], v[28:31], a[12:15], v[128:131]
    v_mfma_f32_16x16x32_bf16 v[136:139], v[28:31], a[68:71], v[136:139]
    v_mfma_f32_16x16x32_bf16 v[132:135], v[84:87], a[12:15], v[132:135]
    v_mfma_f32_16x16x32_bf16 v[140:143], v[84:87], a[68:71], v[140:143]
    v_mfma_f32_16x16x32_bf16 v[128:131], v[32:35], a[16:19], v[128:131]
    v_mfma_f32_16x16x32_bf16 v[136:139], v[32:35], a[72:75], v[136:139]
    v_mfma_f32_16x16x32_bf16 v[132:135], v[88:91], a[16:19], v[132:135]
    v_mfma_f32_16x16x32_bf16 v[140:143], v[88:91], a[72:75], v[140:143]
    v_mfma_f32_16x16x32_bf16 v[128:131], v[36:39], a[20:23], v[128:131]
    v_mfma_f32_16x16x32_bf16 v[136:139], v[36:39], a[76:79], v[136:139]
    v_mfma_f32_16x16x32_bf16 v[132:135], v[92:95], a[20:23], v[132:135]
    v_mfma_f32_16x16x32_bf16 v[140:143], v[92:95], a[76:79], v[140:143]
    v_mfma_f32_16x16x32_bf16 v[128:131], v[40:43], a[24:27], v[128:131]
    v_mfma_f32_16x16x32_bf16 v[136:139], v[40:43], a[80:83], v[136:139]
    v_mfma_f32_16x16x32_bf16 v[132:135], v[96:99], a[24:27], v[132:135]
    v_mfma_f32_16x16x32_bf16 v[140:143], v[96:99], a[80:83], v[140:143]
    v_mfma_f32_16x16x32_bf16 v[128:131], v[44:47], a[28:31], v[128:131]
    v_mfma_f32_16x16x32_bf16 v[136:139], v[44:47], a[84:87], v[136:139]
    v_mfma_f32_16x16x32_bf16 v[132:135], v[100:103], a[28:31], v[132:135]
    v_mfma_f32_16x16x32_bf16 v[140:143], v[100:103], a[84:87], v[140:143]
    v_mfma_f32_16x16x32_bf16 v[128:131], v[48:51], a[32:35], v[128:131]
    v_mfma_f32_16x16x32_bf16 v[136:139], v[48:51], a[88:91], v[136:139]
    v_mfma_f32_16x16x32_bf16 v[132:135], v[104:107], a[32:35], v[132:135]
    v_mfma_f32_16x16x32_bf16 v[140:143], v[104:107], a[88:91], v[140:143]
    v_mfma_f32_16x16x32_bf16 v[128:131], v[52:55], a[36:39], v[128:131]
    v_mfma_f32_16x16x32_bf16 v[136:139], v[52:55], a[92:95], v[136:139]
    v_mfma_f32_16x16x32_bf16 v[132:135], v[108:111], a[36:39], v[132:135]
    v_mfma_f32_16x16x32_bf16 v[140:143], v[108:111], a[92:95], v[140:143]
    v_mfma_f32_16x16x32_bf16 v[128:131], v[56:59], a[40:43], v[128:131]
    v_mfma_f32_16x16x32_bf16 v[136:139], v[56:59], a[96:99], v[136:139]
    v_mfma_f32_16x16x32_bf16 v[132:135], v[112:115], a[40:43], v[132:135]
    v_mfma_f32_16x16x32_bf16 v[140:143], v[112:115], a[96:99], v[140:143]
    v_mfma_f32_16x16x32_bf16 v[128:131], v[60:63], a[44:47], v[128:131]
    v_mfma_f32_16x16x32_bf16 v[136:139], v[60:63], a[100:103], v[136:139]
    v_mfma_f32_16x16x32_bf16 v[132:135], v[116:119], a[44:47], v[132:135]
    v_mfma_f32_16x16x32_bf16 v[140:143], v[116:119], a[100:103], v[140:143]
    v_mfma_f32_16x16x32_bf16 v[128:131], v[64:67], a[48:51], v[128:131]
    v_mfma_f32_16x16x32_bf16 v[136:139], v[64:67], a[104:107], v[136:139]
    v_mfma_f32_16x16x32_bf16 v[132:135], v[120:123], a[48:51], v[132:135]
    v_mfma_f32_16x16x32_bf16 v[140:143], v[120:123], a[104:107], v[140:143]
    v_mfma_f32_16x16x32_bf16 v[128:131], v[68:71], a[52:55], v[128:131]
    v_mfma_f32_16x16x32_bf16 v[136:139], v[68:71], a[108:111], v[136:139]
    v_mfma_f32_16x16x32_bf16 v[132:135], v[124:127], a[52:55], v[132:135]
    v_mfma_f32_16x16x32_bf16 v[140:143], v[124:127], a[108:111], v[140:143]
    s_waitcnt vmcnt(0)
    s_nop 5
    v_max3_f32 v192, v132, v133, v134
    v_max_f32 v192, v192, v135
    v_min3_f32 v193, v132, v133, v134
    v_min_f32 v193, v193, v135
    v_cndmask_b32 v192, v192, v2, s[44:45]
    v_cndmask_b32 v193, v193, v7, s[44:45]
    v_max3_f32 v192, v192, v128, v129
    v_max3_f32 v192, v192, v130, v131
    v_min3_f32 v193, v193, v128, v129
    v_min3_f32 v193, v193, v130, v131
    v_mov_b32 v194, v192
    v_mov_b32 v195, v192
    s_nop 1
    v_permlane16_swap_b32 v194, v195
    v_max_f32 v194, v194, v195
    v_mov_b32 v195, v194
    s_nop 1
    v_permlane32_swap_b32 v194, v195
    v_max_f32 v192, v194, v195
    v_mov_b32 v194, v193
    v_mov_b32 v195, v193
    s_nop 1
    v_permlane16_swap_b32 v194, v195
    v_min_f32 v194, v194, v195
    v_mov_b32 v195, v194
    s_nop 1
    v_permlane32_swap_b32 v194, v195
    v_min_f32 v193, v194, v195
    v_sub_f32 v196, v128, v192
    v_sub_f32 v204, v193, v128
    v_sub_f32 v197, v129, v192
    v_sub_f32 v205, v193, v129
    v_sub_f32 v198, v130, v192
    v_sub_f32 v206, v193, v130
    v_sub_f32 v199, v131, v192
    v_sub_f32 v207, v193, v131
    v_sub_f32 v200, v132, v192
    v_sub_f32 v208, v193, v132
    v_sub_f32 v201, v133, v192
    v_sub_f32 v209, v193, v133
    v_sub_f32 v202, v134, v192
    v_sub_f32 v210, v193, v134
    v_sub_f32 v203, v135, v192
    v_sub_f32 v211, v193, v135
    v_mul_f32 v196, s43, v196
    v_mul_f32 v197, s43, v197
    v_mul_f32 v198, s43, v198
    v_mul_f32 v199, s43, v199
    v_mul_f32 v200, s43, v200
    v_mul_f32 v201, s43, v201
    v_mul_f32 v202, s43, v202
    v_mul_f32 v203, s43, v203
    v_mul_f32 v204, s43, v204
    v_mul_f32 v205, s43, v205
    v_mul_f32 v206, s43, v206
    v_mul_f32 v207, s43, v207
    v_mul_f32 v208, s43, v208
    v_mul_f32 v209, s43, v209
    v_mul_f32 v210, s43, v210
    v_mul_f32 v211, s43, v211
    v_exp_f32 v196, v196
    v_exp_f32 v197, v197
    v_exp_f32 v198, v198
    v_exp_f32 v199, v199
    v_exp_f32 v200, v200
    v_exp_f32 v201, v201
    v_exp_f32 v202, v202
    v_exp_f32 v203, v203
    v_exp_f32 v204, v204
    v_exp_f32 v205, v205
    v_exp_f32 v206, v206
    v_exp_f32 v207, v207
    v_exp_f32 v208, v208
    v_exp_f32 v209, v209
    v_exp_f32 v210, v210
    v_exp_f32 v211, v211
    v_cndmask_b32 v200, v200, 0, s[44:45]
    v_cndmask_b32 v201, v201, 0, s[44:45]
    v_cndmask_b32 v202, v202, 0, s[44:45]
    v_cndmask_b32 v203, v203, 0, s[44:45]
    v_cndmask_b32 v208, v208, 0, s[44:45]
    v_cndmask_b32 v209, v209, 0, s[44:45]
    v_cndmask_b32 v210, v210, 0, s[44:45]
    v_cndmask_b32 v211, v211, 0, s[44:45]
    v_add_f32 v192, v196, v197
    v_add_f32 v192, v192, v198
    v_add_f32 v192, v192, v199
    v_add_f32 v192, v192, v200
    v_add_f32 v192, v192, v201
    v_add_f32 v192, v192, v202
    v_add_f32 v192, v192, v203
    v_mov_b32 v194, v192
    v_mov_b32 v195, v192
    s_nop 1
    v_permlane16_swap_b32 v194, v195
    v_add_f32 v194, v194, v195
    v_mov_b32 v195, v194
    s_nop 1
    v_permlane32_swap_b32 v194, v195
    v_add_f32 v192, v194, v195
    v_rcp_f32 v192, v192
    s_nop 0
    v_mul_f32 v196, v196, v192
    v_mul_f32 v197, v197, v192
    v_mul_f32 v198, v198, v192
    v_mul_f32 v199, v199, v192
    v_mul_f32 v200, v200, v192
    v_mul_f32 v201, v201, v192
    v_mul_f32 v202, v202, v192
    v_mul_f32 v203, v203, v192
    v_cvt_pk_bf16_f32 v160, v196, v197
    v_cvt_pk_bf16_f32 v161, v198, v199
    v_cvt_pk_bf16_f32 v162, v200, v201
    v_cvt_pk_bf16_f32 v163, v202, v203
    v_add_f32 v193, v204, v205
    v_add_f32 v193, v193, v206
    v_add_f32 v193, v193, v207
    v_add_f32 v193, v193, v208
    v_add_f32 v193, v193, v209
    v_add_f32 v193, v193, v210
    v_add_f32 v193, v193, v211
    v_mov_b32 v194, v193
    v_mov_b32 v195, v193
    s_nop 1
    v_permlane16_swap_b32 v194, v195
    v_add_f32 v194, v194, v195
    v_mov_b32 v195, v194
    s_nop 1
    v_permlane32_swap_b32 v194, v195
    v_add_f32 v193, v194, v195
    v_rcp_f32 v193, v193
    s_nop 0
    v_mul_f32 v204, v204, v193
    v_mul_f32 v205, v205, v193
    v_mul_f32 v206, v206, v193
    v_mul_f32 v207, v207, v193
    v_mul_f32 v208, v208, v193
    v_mul_f32 v209, v209, v193
    v_mul_f32 v210, v210, v193
    v_mul_f32 v211, v211, v193
    v_cvt_pk_bf16_f32 v164, v204, v205
    v_cvt_pk_bf16_f32 v165, v206, v207
    v_cvt_pk_bf16_f32 v166, v208, v209
    v_cvt_pk_bf16_f32 v167, v210, v211
    v_mfma_f32_16x16x32_bf16 v[176:179], v[144:147], v[160:163], 0
    s_nop 0
    v_mfma_f32_16x16x32_bf16 v[176:179], v[148:151], v[164:167], v[176:179]
    v_mfma_f32_16x16x32_bf16 v[180:183], v[152:155], v[160:163], 0
    v_mfma_f32_16x16x32_bf16 v[180:183], v[156:159], v[164:167], v[180:183]
    s_nop 7
    v_mov_b32 v194, v180
    v_mov_b32 v195, v180
    s_nop 1
    v_permlane32_swap_b32 v194, v195
    v_mov_b32 v194, v195
    s_nop 1
    v_permlane16_swap_b32 v194, v195
    v_add_f32 v195, s46, v195
    v_rcp_f32 v195, v195
    s_nop 0
    v_mul_f32 v176, v176, v195
    v_mul_f32 v177, v177, v195
    v_mul_f32 v178, v178, v195
    v_mul_f32 v179, v179, v195
    v_mul_f32 v180, v180, v195
    v_mul_f32 v181, v181, v195
    v_mul_f32 v182, v182, v195
    v_mul_f32 v183, v183, v195
    v_cvt_pk_bf16_f32 v196, v176, v177
    v_cvt_pk_bf16_f32 v197, v178, v179
    v_cvt_pk_bf16_f32 v198, v180, v181
    v_cvt_pk_bf16_f32 v199, v182, v183
    ds_write_b128 v11, v[196:199] offset:6144
    v_max3_f32 v192, v140, v141, v142
    v_max_f32 v192, v192, v143
    v_min3_f32 v193, v140, v141, v142
    v_min_f32 v193, v193, v143
    v_cndmask_b32 v192, v192, v2, s[44:45]
    v_cndmask_b32 v193, v193, v7, s[44:45]
    v_max3_f32 v192, v192, v136, v137
    v_max3_f32 v192, v192, v138, v139
    v_min3_f32 v193, v193, v136, v137
    v_min3_f32 v193, v193, v138, v139
    v_mov_b32 v194, v192
    v_mov_b32 v195, v192
    s_nop 1
    v_permlane16_swap_b32 v194, v195
    v_max_f32 v194, v194, v195
    v_mov_b32 v195, v194
    s_nop 1
    v_permlane32_swap_b32 v194, v195
    v_max_f32 v192, v194, v195
    v_mov_b32 v194, v193
    v_mov_b32 v195, v193
    s_nop 1
    v_permlane16_swap_b32 v194, v195
    v_min_f32 v194, v194, v195
    v_mov_b32 v195, v194
    s_nop 1
    v_permlane32_swap_b32 v194, v195
    v_min_f32 v193, v194, v195
    v_sub_f32 v196, v136, v192
    v_sub_f32 v204, v193, v136
    v_sub_f32 v197, v137, v192
    v_sub_f32 v205, v193, v137
    v_sub_f32 v198, v138, v192
    v_sub_f32 v206, v193, v138
    v_sub_f32 v199, v139, v192
    v_sub_f32 v207, v193, v139
    v_sub_f32 v200, v140, v192
    v_sub_f32 v208, v193, v140
    v_sub_f32 v201, v141, v192
    v_sub_f32 v209, v193, v141
    v_sub_f32 v202, v142, v192
    v_sub_f32 v210, v193, v142
    v_sub_f32 v203, v143, v192
    v_sub_f32 v211, v193, v143
    v_mul_f32 v196, s43, v196
    v_mul_f32 v197, s43, v197
    v_mul_f32 v198, s43, v198
    v_mul_f32 v199, s43, v199
    v_mul_f32 v200, s43, v200
    v_mul_f32 v201, s43, v201
    v_mul_f32 v202, s43, v202
    v_mul_f32 v203, s43, v203
    v_mul_f32 v204, s43, v204
    v_mul_f32 v205, s43, v205
    v_mul_f32 v206, s43, v206
    v_mul_f32 v207, s43, v207
    v_mul_f32 v208, s43, v208
    v_mul_f32 v209, s43, v209
    v_mul_f32 v210, s43, v210
    v_mul_f32 v211, s43, v211
    v_exp_f32 v196, v196
    v_exp_f32 v197, v197
    v_exp_f32 v198, v198
    v_exp_f32 v199, v199
    v_exp_f32 v200, v200
    v_exp_f32 v201, v201
    v_exp_f32 v202, v202
    v_exp_f32 v203, v203
    v_exp_f32 v204, v204
    v_exp_f32 v205, v205
    v_exp_f32 v206, v206
    v_exp_f32 v207, v207
    v_exp_f32 v208, v208
    v_exp_f32 v209, v209
    v_exp_f32 v210, v210
    v_exp_f32 v211, v211
    v_cndmask_b32 v200, v200, 0, s[44:45]
    v_cndmask_b32 v201, v201, 0, s[44:45]
    v_cndmask_b32 v202, v202, 0, s[44:45]
    v_cndmask_b32 v203, v203, 0, s[44:45]
    v_cndmask_b32 v208, v208, 0, s[44:45]
    v_cndmask_b32 v209, v209, 0, s[44:45]
    v_cndmask_b32 v210, v210, 0, s[44:45]
    v_cndmask_b32 v211, v211, 0, s[44:45]
    v_add_f32 v192, v196, v197
    v_add_f32 v192, v192, v198
    v_add_f32 v192, v192, v199
    v_add_f32 v192, v192, v200
    v_add_f32 v192, v192, v201
    v_add_f32 v192, v192, v202
    v_add_f32 v192, v192, v203
    v_mov_b32 v194, v192
    v_mov_b32 v195, v192
    s_nop 1
    v_permlane16_swap_b32 v194, v195
    v_add_f32 v194, v194, v195
    v_mov_b32 v195, v194
    s_nop 1
    v_permlane32_swap_b32 v194, v195
    v_add_f32 v192, v194, v195
    v_rcp_f32 v192, v192
    s_nop 0
    v_mul_f32 v196, v196, v192
    v_mul_f32 v197, v197, v192
    v_mul_f32 v198, v198, v192
    v_mul_f32 v199, v199, v192
    v_mul_f32 v200, v200, v192
    v_mul_f32 v201, v201, v192
    v_mul_f32 v202, v202, v192
    v_mul_f32 v203, v203, v192
    v_cvt_pk_bf16_f32 v160, v196, v197
    v_cvt_pk_bf16_f32 v161, v198, v199
    v_cvt_pk_bf16_f32 v162, v200, v201
    v_cvt_pk_bf16_f32 v163, v202, v203
    v_add_f32 v193, v204, v205
    v_add_f32 v193, v193, v206
    v_add_f32 v193, v193, v207
    v_add_f32 v193, v193, v208
    v_add_f32 v193, v193, v209
    v_add_f32 v193, v193, v210
    v_add_f32 v193, v193, v211
    v_mov_b32 v194, v193
    v_mov_b32 v195, v193
    s_nop 1
    v_permlane16_swap_b32 v194, v195
    v_add_f32 v194, v194, v195
    v_mov_b32 v195, v194
    s_nop 1
    v_permlane32_swap_b32 v194, v195
    v_add_f32 v193, v194, v195
    v_rcp_f32 v193, v193
    s_nop 0
    v_mul_f32 v204, v204, v193
    v_mul_f32 v205, v205, v193
    v_mul_f32 v206, v206, v193
    v_mul_f32 v207, v207, v193
    v_mul_f32 v208, v208, v193
    v_mul_f32 v209, v209, v193
    v_mul_f32 v210, v210, v193
    v_mul_f32 v211, v211, v193
    v_cvt_pk_bf16_f32 v164, v204, v205
    v_cvt_pk_bf16_f32 v165, v206, v207
    v_cvt_pk_bf16_f32 v166, v208, v209
    v_cvt_pk_bf16_f32 v167, v210, v211
    v_mfma_f32_16x16x32_bf16 v[176:179], v[144:147], v[160:163], 0
    s_nop 0
    v_mfma_f32_16x16x32_bf16 v[176:179], v[148:151], v[164:167], v[176:179]
    v_mfma_f32_16x16x32_bf16 v[180:183], v[152:155], v[160:163], 0
    v_mfma_f32_16x16x32_bf16 v[180:183], v[156:159], v[164:167], v[180:183]
    s_nop 7
    v_mov_b32 v194, v180
    v_mov_b32 v195, v180
    s_nop 1
    v_permlane32_swap_b32 v194, v195
    v_mov_b32 v194, v195
    s_nop 1
    v_permlane16_swap_b32 v194, v195
    v_add_f32 v195, s46, v195
    v_rcp_f32 v195, v195
    s_nop 0
    v_mul_f32 v176, v176, v195
    v_mul_f32 v177, v177, v195
    v_mul_f32 v178, v178, v195
    v_mul_f32 v179, v179, v195
    v_mul_f32 v180, v180, v195
    v_mul_f32 v181, v181, v195
    v_mul_f32 v182, v182, v195
    v_mul_f32 v183, v183, v195
    v_cvt_pk_bf16_f32 v196, v176, v177
    v_cvt_pk_bf16_f32 v197, v178, v179
    v_cvt_pk_bf16_f32 v198, v180, v181
    v_cvt_pk_bf16_f32 v199, v182, v183
    ds_write_b128 v11, v[196:199] offset:7168
    s_waitcnt lgkmcnt(0)
    s_barrier
    ds_read_b128 v[16:19], v10 offset:0
    ds_read_b128 v[20:23], v10 offset:1024
    ds_read_b128 v[24:27], v10 offset:2048
    ds_read_b128 v[28:31], v10 offset:3072
    ds_read_b128 v[32:35], v10 offset:4096
    ds_read_b128 v[36:39], v10 offset:5120
    ds_read_b128 v[40:43], v10 offset:6144
    ds_read_b128 v[44:47], v10 offset:7168
    ds_read_b128 v[48:51], v10 offset:8192
    ds_read_b128 v[52:55], v10 offset:9216
    ds_read_b128 v[56:59], v10 offset:10240
    ds_read_b128 v[60:63], v10 offset:11264
    ds_read_b128 v[64:67], v10 offset:12288
    ds_read_b128 v[68:71], v10 offset:13312
    ds_read_b128 v[72:75], v10 offset:14336
    ds_read_b128 v[76:79], v10 offset:15360
    ds_read_b128 v[80:83], v10 offset:16384
    ds_read_b128 v[84:87], v10 offset:17408
    ds_read_b128 v[88:91], v10 offset:18432
    ds_read_b128 v[92:95], v10 offset:19456
    ds_read_b128 v[96:99], v10 offset:20480
    ds_read_b128 v[100:103], v10 offset:21504
    ds_read_b128 v[104:107], v10 offset:22528
    ds_read_b128 v[108:111], v10 offset:23552
    ds_read_b128 v[112:115], v10 offset:24576
    ds_read_b128 v[116:119], v10 offset:25600
    ds_read_b128 v[120:123], v10 offset:26624
    ds_read_b128 v[124:127], v10 offset:27648
    ds_read_b128 v[128:131], v10 offset:28672
    ds_read_b128 v[132:135], v10 offset:29696
    ds_read_b128 v[136:139], v10 offset:30720
    ds_read_b128 v[140:143], v10 offset:31744
    v_lshlrev_b32 v12, 10, v4
    v_lshl_add_u32 v12, v3, 4, v12
    s_mul_i32 s37, s20, 114688
    s_add_u32 s37, s37, 15728640
    s_lshl_b32 s39, s3, 5
    v_add_u32 v13, s39, v4
    v_mul_u32_u24 v13, 1792, v13
    v_lshl_add_u32 v13, v3, 3, v13
    v_add_u32 v13, 896, v13
    v_add_u32 v14, 28672, v13
    s_mul_i32 s40, s20, 224
    s_mov_b32 s41, 0
L_b2_loop_w:
    buffer_load_dwordx4 v[144:147], v12, s[16:19], s37 offen offset:0
    buffer_load_dwordx4 v[148:151], v12, s[16:19], s37 offen offset:64
    buffer_load_dwordx4 v[152:155], v12, s[16:19], s37 offen offset:128
    buffer_load_dwordx4 v[156:159], v12, s[16:19], s37 offen offset:192
    buffer_load_dwordx4 v[160:163], v12, s[16:19], s37 offen offset:256
    buffer_load_dwordx4 v[164:167], v12, s[16:19], s37 offen offset:320
    buffer_load_dwordx4 v[168:171], v12, s[16:19], s37 offen offset:384
    buffer_load_dwordx4 v[172:175], v12, s[16:19], s37 offen offset:448
    buffer_load_dwordx4 v[176:179], v12, s[16:19], s37 offen offset:512
    buffer_load_dwordx4 v[180:183], v12, s[16:19], s37 offen offset:576
    buffer_load_dwordx4 v[184:187], v12, s[16:19], s37 offen offset:640
    buffer_load_dwordx4 v[188:191], v12, s[16:19], s37 offen offset:704
    buffer_load_dwordx4 v[192:195], v12, s[16:19], s37 offen offset:768
    buffer_load_dwordx4 v[196:199], v12, s[16:19], s37 offen offset:832
    buffer_load_dwordx4 v[200:203], v12, s[16:19], s37 offen offset:896
    buffer_load_dwordx4 v[204:207], v12, s[16:19], s37 offen offset:960
    s_waitcnt lgkmcnt(0)
    s_waitcnt vmcnt(15)
    v_mfma_f32_16x16x32_bf16 v[208:211], v[144:147], v[16:19], 0
    v_mfma_f32_16x16x32_bf16 v[212:215], v[144:147], v[20:23], 0
    s_waitcnt vmcnt(14)
    v_mfma_f32_16x16x32_bf16 v[208:211], v[148:151], v[24:27], v[208:211]
    v_mfma_f32_16x16x32_bf16 v[212:215], v[148:151], v[28:31], v[212:215]
    s_waitcnt vmcnt(13)
    v_mfma_f32_16x16x32_bf16 v[208:211], v[152:155], v[32:35], v[208:211]
    v_mfma_f32_16x16x32_bf16 v[212:215], v[152:155], v[36:39], v[212:215]
    s_waitcnt vmcnt(12)
    v_mfma_f32_16x16x32_bf16 v[208:211], v[156:159], v[40:43], v[208:211]
    v_mfma_f32_16x16x32_bf16 v[212:215], v[156:159], v[44:47], v[212:215]
    s_waitcnt vmcnt(11)
    v_mfma_f32_16x16x32_bf16 v[208:211], v[160:163], v[48:51], v[208:211]
    v_mfma_f32_16x16x32_bf16 v[212:215], v[160:163], v[52:55], v[212:215]
    s_waitcnt vmcnt(10)
    v_mfma_f32_16x16x32_bf16 v[208:211], v[164:167], v[56:59], v[208:211]
    v_mfma_f32_16x16x32_bf16 v[212:215], v[164:167], v[60:63], v[212:215]
    s_waitcnt vmcnt(9)
    v_mfma_f32_16x16x32_bf16 v[208:211], v[168:171], v[64:67], v[208:211]
    v_mfma_f32_16x16x32_bf16 v[212:215], v[168:171], v[68:71], v[212:215]
    s_waitcnt vmcnt(8)
    v_mfma_f32_16x16x32_bf16 v[208:211], v[172:175], v[72:75], v[208:211]
    v_mfma_f32_16x16x32_bf16 v[212:215], v[172:175], v[76:79], v[212:215]
    s_waitcnt vmcnt(7)
    v_mfma_f32_16x16x32_bf16 v[208:211], v[176:179], v[80:83], v[208:211]
    v_mfma_f32_16x16x32_bf16 v[212:215], v[176:179], v[84:87], v[212:215]
    s_waitcnt vmcnt(6)
    v_mfma_f32_16x16x32_bf16 v[208:211], v[180:183], v[88:91], v[208:211]
    v_mfma_f32_16x16x32_bf16 v[212:215], v[180:183], v[92:95], v[212:215]
    s_waitcnt vmcnt(5)
    v_mfma_f32_16x16x32_bf16 v[208:211], v[184:187], v[96:99], v[208:211]
    v_mfma_f32_16x16x32_bf16 v[212:215], v[184:187], v[100:103], v[212:215]
    s_waitcnt vmcnt(4)
    v_mfma_f32_16x16x32_bf16 v[208:211], v[188:191], v[104:107], v[208:211]
    v_mfma_f32_16x16x32_bf16 v[212:215], v[188:191], v[108:111], v[212:215]
    s_waitcnt vmcnt(3)
    v_mfma_f32_16x16x32_bf16 v[208:211], v[192:195], v[112:115], v[208:211]
    v_mfma_f32_16x16x32_bf16 v[212:215], v[192:195], v[116:119], v[212:215]
    s_waitcnt vmcnt(2)
    v_mfma_f32_16x16x32_bf16 v[208:211], v[196:199], v[120:123], v[208:211]
    v_mfma_f32_16x16x32_bf16 v[212:215], v[196:199], v[124:127], v[212:215]
    s_waitcnt vmcnt(1)
    v_mfma_f32_16x16x32_bf16 v[208:211], v[200:203], v[128:131], v[208:211]
    v_mfma_f32_16x16x32_bf16 v[212:215], v[200:203], v[132:135], v[212:215]
    s_waitcnt vmcnt(0)
    v_mfma_f32_16x16x32_bf16 v[208:211], v[204:207], v[136:139], v[208:211]
    v_mfma_f32_16x16x32_bf16 v[212:215], v[204:207], v[140:143], v[212:215]
    s_nop 6
    v_cvt_pk_bf16_f32 v216, v208, v209
    v_cvt_pk_bf16_f32 v217, v210, v211
    buffer_store_dwordx2 v[216:217], v13, s[24:27], s40 offen
    v_cvt_pk_bf16_f32 v218, v212, v213
    v_cvt_pk_bf16_f32 v219, v214, v215
    buffer_store_dwordx2 v[218:219], v14, s[24:27], s40 offen
    s_add_u32 s37, s37, 16384
    s_add_u32 s40, s40, 32
    s_add_u32 s41, s41, 1
    s_cmp_lt_u32 s41, 7
    s_cbranch_scc1 L_b2_loop_w
L_w_fin:
    s_load_dwordx2 s[4:5], s[0:1], 0
    s_waitcnt lgkmcnt(0)
    s_mov_b32 s12, s4
    s_mov_b32 s13, s5
    s_mov_b32 s14, 1835008
    s_mov_b32 s15, 0x00020000
L_w_finloop:
    s_waitcnt vmcnt(0) lgkmcnt(0)
    s_barrier
    s_cmp_lg_u32 s20, 0
    s_cbranch_scc1 L_w_fq
    s_mov_b64 exec, 1
    v_mov_b32 v16, 1
    v_mov_b32 v17, 100797056
    buffer_atomic_add v16, v17, s[16:19], 0 offen sc0 sc1
    s_waitcnt vmcnt(0)
    v_mov_b32 v17, 24576
    ds_write_b32 v17, v16
    s_waitcnt lgkmcnt(0)
    s_mov_b64 exec, -1
L_w_fq:
    s_barrier
    v_mov_b32 v17, 24576
    ds_read_b32 v16, v17
    s_waitcnt lgkmcnt(0)
    v_readfirstlane_b32 s3, v16
    s_nop 0
    s_cmp_ge_u32 s3, 256
    s_cbranch_scc1 L_chain_end
    s_lshr_b32 s48, s3, 2
    s_lshl_b32 s48, s48, 7
    s_cmp_lg_u32 s20, 0
    s_cbranch_scc1 L_fw_wa_79
    s_mov_b64 exec, 1
    v_mov_b32 v241, 100802560
    s_mov_b32 s49, 1000000
L_cw_wa_80:
    buffer_load_dword v240, v241, s[16:19], s48 offen sc1
    s_waitcnt vmcnt(0)
    v_cmp_gt_u32 vcc, 28, v240
    s_cbranch_vccz L_cwok_wa_81
    s_sleep 32
    s_sub_u32 s49, s49, 1
    s_cmp_lg_u32 s49, 0
    s_cbranch_scc1 L_cw_wa_80
L_cwok_wa_81:
    v_mov_b32 v241, 100810752
    s_mov_b32 s49, 1000000
L_cw_wa_82:
    buffer_load_dword v240, v241, s[16:19], s48 offen sc1
    s_waitcnt vmcnt(0)
    v_cmp_gt_u32 vcc, 28, v240
    s_cbranch_vccz L_cwok_wa_83
    s_sleep 32
    s_sub_u32 s49, s49, 1
    s_cmp_lg_u32 s49, 0
    s_cbranch_scc1 L_cw_wa_82
L_cwok_wa_83:
    s_mov_b64 exec, -1
L_fw_wa_79:
    s_barrier
    s_lshr_b32 s30, s3, 2
    s_bfe_u32 s31, s3, 0x10001
    s_and_b32 s32, s3, 1
    s_mul_i32 s33, s30, 28672
    s_add_u32 s35, s33, 14336
    s_mul_i32 s34, s30, 122880
    v_mul_u32_u24 v5, 896, v4
    v_lshl_add_u32 v5, v3, 4, v5
    v_and_b32 v6, 7, v4
    v_mul_u32_u24 v6, 896, v6
    v_lshl_add_u32 v6, v3, 4, v6
    s_lshl_b32 s36, s20, 13
    s_lshl_b32 s37, s30, 5
    s_add_u32 s36, s36, s37
    s_lshl_b32 s37, s31, 4
    s_add_u32 s36, s36, s37
    s_mul_i32 s36, s36, 896
    s_add_u32 s36, s36, 50331648
    buffer_load_dwordx4 a[0:3], v5, s[12:15], s33 offen offset:0
    buffer_load_dwordx4 a[4:7], v5, s[12:15], s33 offen offset:64
    buffer_load_dwordx4 a[8:11], v5, s[12:15], s33 offen offset:128
    buffer_load_dwordx4 a[12:15], v5, s[12:15], s33 offen offset:192
    buffer_load_dwordx4 a[16:19], v5, s[12:15], s33 offen offset:256
    buffer_load_dwordx4 a[20:23], v5, s[12:15], s33 offen offset:320
    buffer_load_dwordx4 a[24:27], v5, s[12:15], s33 offen offset:384
    buffer_load_dwordx4 a[28:31], v5, s[12:15], s33 offen offset:448
    buffer_load_dwordx4 a[32:35], v5, s[12:15], s33 offen offset:512
    buffer_load_dwordx4 a[36:39], v5, s[12:15], s33 offen offset:576
    buffer_load_dwordx4 a[40:43], v5, s[12:15], s33 offen offset:640
    buffer_load_dwordx4 a[44:47], v5, s[12:15], s33 offen offset:704
    buffer_load_dwordx4 a[48:51], v5, s[12:15], s33 offen offset:768
    buffer_load_dwordx4 a[52:55], v5, s[12:15], s33 offen offset:832
    buffer_load_dwordx4 a[56:59], v5, s[12:15], s35 offen offset:0
    buffer_load_dwordx4 a[60:63], v5, s[12:15], s35 offen offset:64
    buffer_load_dwordx4 a[64:67], v5, s[12:15], s35 offen offset:128
    buffer_load_dwordx4 a[68:71], v5, s[12:15], s35 offen offset:192
    buffer_load_dwordx4 a[72:75], v5, s[12:15], s35 offen offset:256
    buffer_load_dwordx4 a[76:79], v5, s[12:15], s35 offen offset:320
    buffer_load_dwordx4 a[80:83], v5, s[12:15], s35 offen offset:384
    buffer_load_dwordx4 a[84:87], v5, s[12:15], s35 offen offset:448
    buffer_load_dwordx4 a[88:91], v5, s[12:15], s35 offen offset:512
    buffer_load_dwordx4 a[92:95], v5, s[12:15], s35 offen offset:576
    buffer_load_dwordx4 a[96:99], v5, s[12:15], s35 offen offset:640
    buffer_load_dwordx4 a[100:103], v5, s[12:15], s35 offen offset:704
    buffer_load_dwordx4 a[104:107], v5, s[12:15], s35 offen offset:768
    buffer_load_dwordx4 a[108:111], v5, s[12:15], s35 offen offset:832
    buffer_load_dwordx4 v[16:19], v5, s[16:19], s36 offen offset:0
    buffer_load_dwordx4 v[20:23], v5, s[16:19], s36 offen offset:64
    buffer_load_dwordx4 v[24:27], v5, s[16:19], s36 offen offset:128
    buffer_load_dwordx4 v[28:31], v5, s[16:19], s36 offen offset:192
    buffer_load_dwordx4 v[32:35], v5, s[16:19], s36 offen offset:256
    buffer_load_dwordx4 v[36:39], v5, s[16:19], s36 offen offset:320
    buffer_load_dwordx4 v[40:43], v5, s[16:19], s36 offen offset:384
    buffer_load_dwordx4 v[44:47], v5, s[16:19], s36 offen offset:448
    buffer_load_dwordx4 v[48:51], v5, s[16:19], s36 offen offset:512
    buffer_load_dwordx4 v[52:55], v5, s[16:19], s36 offen offset:576
    buffer_load_dwordx4 v[56:59], v5, s[16:19], s36 offen offset:640
    buffer_load_dwordx4 v[60:63], v5, s[16:19], s36 offen offset:704
    buffer_load_dwordx4 v[64:67], v5, s[16:19], s36 offen offset:768
    buffer_load_dwordx4 v[68:71], v5, s[16:19], s36 offen offset:832
    s_add_u32 s36, s36, 1835008
    buffer_load_dwordx4 v[72:75], v5, s[16:19], s36 offen offset:0
    buffer_load_dwordx4 v[76:79], v5, s[16:19], s36 offen offset:64
    buffer_load_dwordx4 v[80:83], v5, s[16:19], s36 offen offset:128
    buffer_load_dwordx4 v[84:87], v5, s[16:19], s36 offen offset:192
    buffer_load_dwordx4 v[88:91], v5, s[16:19], s36 offen offset:256
    buffer_load_dwordx4 v[92:95], v5, s[16:19], s36 offen offset:320
    buffer_load_dwordx4 v[96:99], v5, s[16:19], s36 offen offset:384
    buffer_load_dwordx4 v[100:103], v5, s[16:19], s36 offen offset:448
    buffer_load_dwordx4 v[104:107], v5, s[16:19], s36 offen offset:512
    buffer_load_dwordx4 v[108:111], v5, s[16:19], s36 offen offset:576
    buffer_load_dwordx4 v[112:115], v5, s[16:19], s36 offen offset:640
    buffer_load_dwordx4 v[116:119], v5, s[16:19], s36 offen offset:704
    buffer_load_dwordx4 v[120:123], v5, s[16:19], s36 offen offset:768
    buffer_load_dwordx4 v[124:127], v5, s[16:19], s36 offen offset:832
    s_add_u32 s36, s36, 1835008
    buffer_load_dwordx4 v[128:131], v5, s[16:19], s36 offen offset:0
    buffer_load_dwordx4 v[132:135], v5, s[16:19], s36 offen offset:64
    buffer_load_dwordx4 v[136:139], v5, s[16:19], s36 offen offset:128
    buffer_load_dwordx4 v[140:143], v5, s[16:19], s36 offen offset:192
    buffer_load_dwordx4 v[144:147], v5, s[16:19], s36 offen offset:256
    buffer_load_dwordx4 v[148:151], v5, s[16:19], s36 offen offset:320
    buffer_load_dwordx4 v[152:155], v5, s[16:19], s36 offen offset:384
    buffer_load_dwordx4 v[156:159], v5, s[16:19], s36 offen offset:448
    buffer_load_dwordx4 v[160:163], v5, s[16:19], s36 offen offset:512
    buffer_load_dwordx4 v[164:167], v5, s[16:19], s36 offen offset:576
    buffer_load_dwordx4 v[168:171], v5, s[16:19], s36 offen offset:640
    buffer_load_dwordx4 v[172:175], v5, s[16:19], s36 offen offset:704
    buffer_load_dwordx4 v[176:179], v5, s[16:19], s36 offen offset:768
    buffer_load_dwordx4 v[180:183], v5, s[16:19], s36 offen offset:832
    s_add_u32 s36, s36, 1835008
    buffer_load_dwordx4 v[184:187], v5, s[16:19], s36 offen offset:0
    buffer_load_dwordx4 v[188:191], v5, s[16:19], s36 offen offset:64
    buffer_load_dwordx4 v[192:195], v5, s[16:19], s36 offen offset:128
    buffer_load_dwordx4 v[196:199], v5, s[16:19], s36 offen offset:192
    buffer_load_dwordx4 v[200:203], v5, s[16:19], s36 offen offset:256
    buffer_load_dwordx4 v[204:207], v5, s[16:19], s36 offen offset:320
    buffer_load_dwordx4 v[208:211], v5, s[16:19], s36 offen offset:384
    buffer_load_dwordx4 v[212:215], v5, s[16:19], s36 offen offset:448
    buffer_load_dwordx4 v[216:219], v5, s[16:19], s36 offen offset:512
    buffer_load_dwordx4 v[220:223], v5, s[16:19], s36 offen offset:576
    buffer_load_dwordx4 v[224:227], v5, s[16:19], s36 offen offset:640
    buffer_load_dwordx4 v[228:231], v5, s[16:19], s36 offen offset:704
    buffer_load_dwordx4 v[232:235], v5, s[16:19], s36 offen offset:768
    buffer_load_dwordx4 v[236:239], v5, s[16:19], s36 offen offset:832
    s_add_u32 s36, s36, 1835008
    s_mul_i32 s40, s30, 28
    s_mul_i32 s41, s32, 14
    s_add_u32 s40, s40, s41
    s_lshl_b32 s40, s40, 14
    s_mul_i32 s41, s20, 57344
    s_add_u32 s40, s40, s41
    s_add_u32 s40, s40, 16777216
    v_lshlrev_b32 v7, 7, v1
    buffer_load_dword v242, v7, s[16:19], s40 offen
    s_add_u32 s40, s40, 8192
    buffer_load_dword v242, v7, s[16:19], s40 offen
    s_add_u32 s40, s40, 8192
    buffer_load_dword v242, v7, s[16:19], s40 offen
    s_add_u32 s40, s40, 8192
    buffer_load_dword v242, v7, s[16:19], s40 offen
    s_add_u32 s40, s40, 8192
    buffer_load_dword v242, v7, s[16:19], s40 offen
    s_add_u32 s40, s40, 8192
    buffer_load_dword v242, v7, s[16:19], s40 offen
    s_add_u32 s40, s40, 8192
    buffer_load_dword v242, v7, s[16:19], s40 offen
    s_add_u32 s40, s40, 8192
    s_lshl_b32 s37, s31, 4
    v_add_u32 v7, s37, v4
    v_lshlrev_b32 v8, 2, v3
    v_sub_u32 v7, v7, v8
    v_subrev_u32 v8, 16, v7
    v_mov_b32 v9, 0xff800000
    v_lshlrev_b32 v10, 4, v1
    s_lshl_b32 s37, s20, 12
    v_add_u32 v11, s37, v10
    v_lshlrev_b32 v12, 4, v4
    v_lshl_add_u32 v12, v3, 3, v12
    s_lshl_b32 s37, s20, 10
    s_add_u32 s37, s37, 16384
    v_add_u32 v12, s37, v12
    s_waitcnt vmcnt(49)
    v_mfma_f32_16x16x32_bf16 a[112:115], a[0:3], v[16:19], 0
    v_mfma_f32_16x16x32_bf16 a[116:119], a[56:59], v[16:19], 0
    v_mfma_f32_16x16x32_bf16 a[112:115], a[4:7], v[20:23], a[112:115]
    v_mfma_f32_16x16x32_bf16 a[116:119], a[60:63], v[20:23], a[116:119]
    v_mfma_f32_16x16x32_bf16 a[112:115], a[8:11], v[24:27], a[112:115]
    v_mfma_f32_16x16x32_bf16 a[116:119], a[64:67], v[24:27], a[116:119]
    v_mfma_f32_16x16x32_bf16 a[112:115], a[12:15], v[28:31], a[112:115]
    v_mfma_f32_16x16x32_bf16 a[116:119], a[68:71], v[28:31], a[116:119]
    v_mfma_f32_16x16x32_bf16 a[112:115], a[16:19], v[32:35], a[112:115]
    v_mfma_f32_16x16x32_bf16 a[116:119], a[72:75], v[32:35], a[116:119]
    v_mfma_f32_16x16x32_bf16 a[112:115], a[20:23], v[36:39], a[112:115]
    v_mfma_f32_16x16x32_bf16 a[116:119], a[76:79], v[36:39], a[116:119]
    v_mfma_f32_16x16x32_bf16 a[112:115], a[24:27], v[40:43], a[112:115]
    v_mfma_f32_16x16x32_bf16 a[116:119], a[80:83], v[40:43], a[116:119]
    v_mfma_f32_16x16x32_bf16 a[112:115], a[28:31], v[44:47], a[112:115]
    v_mfma_f32_16x16x32_bf16 a[116:119], a[84:87], v[44:47], a[116:119]
    v_mfma_f32_16x16x32_bf16 a[112:115], a[32:35], v[48:51], a[112:115]
    v_mfma_f32_16x16x32_bf16 a[116:119], a[88:91], v[48:51], a[116:119]
    v_mfma_f32_16x16x32_bf16 a[112:115], a[36:39], v[52:55], a[112:115]
    v_mfma_f32_16x16x32_bf16 a[116:119], a[92:95], v[52:55], a[116:119]
    v_mfma_f32_16x16x32_bf16 a[112:115], a[40:43], v[56:59], a[112:115]
    v_mfma_f32_16x16x32_bf16 a[116:119], a[96:99], v[56:59], a[116:119]
    v_mfma_f32_16x16x32_bf16 a[112:115], a[44:47], v[60:63], a[112:115]
    v_mfma_f32_16x16x32_bf16 a[116:119], a[100:103], v[60:63], a[116:119]
    v_mfma_f32_16x16x32_bf16 a[112:115], a[48:51], v[64:67], a[112:115]
    v_mfma_f32_16x16x32_bf16 a[116:119], a[104:107], v[64:67], a[116:119]
    v_mfma_f32_16x16x32_bf16 a[112:115], a[52:55], v[68:71], a[112:115]
    v_mfma_f32_16x16x32_bf16 a[116:119], a[108:111], v[68:71], a[116:119]
    s_waitcnt vmcnt(35)
    v_mfma_f32_16x16x32_bf16 a[120:123], a[0:3], v[72:75], 0
    v_mfma_f32_16x16x32_bf16 a[124:127], a[56:59], v[72:75], 0
    v_mfma_f32_16x16x32_bf16 a[120:123], a[4:7], v[76:79], a[120:123]
    v_mfma_f32_16x16x32_bf16 a[124:127], a[60:63], v[76:79], a[124:127]
    v_mfma_f32_16x16x32_bf16 a[120:123], a[8:11], v[80:83], a[120:123]
    v_mfma_f32_16x16x32_bf16 a[124:127], a[64:67], v[80:83], a[124:127]
    v_mfma_f32_16x16x32_bf16 a[120:123], a[12:15], v[84:87], a[120:123]
    v_mfma_f32_16x16x32_bf16 a[124:127], a[68:71], v[84:87], a[124:127]
    v_mfma_f32_16x16x32_bf16 a[120:123], a[16:19], v[88:91], a[120:123]
    v_mfma_f32_16x16x32_bf16 a[124:127], a[72:75], v[88:91], a[124:127]
    v_mfma_f32_16x16x32_bf16 a[120:123], a[20:23], v[92:95], a[120:123]
    v_mfma_f32_16x16x32_bf16 a[124:127], a[76:79], v[92:95], a[124:127]
    v_mfma_f32_16x16x32_bf16 a[120:123], a[24:27], v[96:99], a[120:123]
    v_mfma_f32_16x16x32_bf16 a[124:127], a[80:83], v[96:99], a[124:127]
    v_mfma_f32_16x16x32_bf16 a[120:123], a[28:31], v[100:103], a[120:123]
    v_mfma_f32_16x16x32_bf16 a[124:127], a[84:87], v[100:103], a[124:127]
    v_mfma_f32_16x16x32_bf16 a[120:123], a[32:35], v[104:107], a[120:123]
    v_mfma_f32_16x16x32_bf16 a[124:127], a[88:91], v[104:107], a[124:127]
    v_mfma_f32_16x16x32_bf16 a[120:123], a[36:39], v[108:111], a[120:123]
    v_mfma_f32_16x16x32_bf16 a[124:127], a[92:95], v[108:111], a[124:127]
    v_mfma_f32_16x16x32_bf16 a[120:123], a[40:43], v[112:115], a[120:123]
    v_mfma_f32_16x16x32_bf16 a[124:127], a[96:99], v[112:115], a[124:127]
    v_mfma_f32_16x16x32_bf16 a[120:123], a[44:47], v[116:119], a[120:123]
    v_mfma_f32_16x16x32_bf16 a[124:127], a[100:103], v[116:119], a[124:127]
    v_mfma_f32_16x16x32_bf16 a[120:123], a[48:51], v[120:123], a[120:123]
    v_mfma_f32_16x16x32_bf16 a[124:127], a[104:107], v[120:123], a[124:127]
    v_mfma_f32_16x16x32_bf16 a[120:123], a[52:55], v[124:127], a[120:123]
    v_mfma_f32_16x16x32_bf16 a[124:127], a[108:111], v[124:127], a[124:127]
    s_waitcnt vmcnt(21)
    v_mfma_f32_16x16x32_bf16 a[128:131], a[0:3], v[128:131], 0
    v_mfma_f32_16x16x32_bf16 a[132:135], a[56:59], v[128:131], 0
    v_mfma_f32_16x16x32_bf16 a[128:131], a[4:7], v[132:135], a[128:131]
    v_mfma_f32_16x16x32_bf16 a[132:135], a[60:63], v[132:135], a[132:135]
    v_mfma_f32_16x16x32_bf16 a[128:131], a[8:11], v[136:139], a[128:131]
    v_mfma_f32_16x16x32_bf16 a[132:135], a[64:67], v[136:139], a[132:135]
    v_mfma_f32_16x16x32_bf16 a[128:131], a[12:15], v[140:143], a[128:131]
    v_mfma_f32_16x16x32_bf16 a[132:135], a[68:71], v[140:143], a[132:135]
    v_mfma_f32_16x16x32_bf16 a[128:131], a[16:19], v[144:147], a[128:131]
    v_mfma_f32_16x16x32_bf16 a[132:135], a[72:75], v[144:147], a[132:135]
    v_mfma_f32_16x16x32_bf16 a[128:131], a[20:23], v[148:151], a[128:131]
    v_mfma_f32_16x16x32_bf16 a[132:135], a[76:79], v[148:151], a[132:135]
    v_mfma_f32_16x16x32_bf16 a[128:131], a[24:27], v[152:155], a[128:131]
    v_mfma_f32_16x16x32_bf16 a[132:135], a[80:83], v[152:155], a[132:135]
    v_mfma_f32_16x16x32_bf16 a[128:131], a[28:31], v[156:159], a[128:131]
    v_mfma_f32_16x16x32_bf16 a[132:135], a[84:87], v[156:159], a[132:135]
    v_mfma_f32_16x16x32_bf16 a[128:131], a[32:35], v[160:163], a[128:131]
    v_mfma_f32_16x16x32_bf16 a[132:135], a[88:91], v[160:163], a[132:135]
    v_mfma_f32_16x16x32_bf16 a[128:131], a[36:39], v[164:167], a[128:131]
    v_mfma_f32_16x16x32_bf16 a[132:135], a[92:95], v[164:167], a[132:135]
    v_mfma_f32_16x16x32_bf16 a[128:131], a[40:43], v[168:171], a[128:131]
    v_mfma_f32_16x16x32_bf16 a[132:135], a[96:99], v[168:171], a[132:135]
    v_mfma_f32_16x16x32_bf16 a[128:131], a[44:47], v[172:175], a[128:131]
    v_mfma_f32_16x16x32_bf16 a[132:135], a[100:103], v[172:175], a[132:135]
    v_mfma_f32_16x16x32_bf16 a[128:131], a[48:51], v[176:179], a[128:131]
    v_mfma_f32_16x16x32_bf16 a[132:135], a[104:107], v[176:179], a[132:135]
    v_mfma_f32_16x16x32_bf16 a[128:131], a[52:55], v[180:183], a[128:131]
    v_mfma_f32_16x16x32_bf16 a[132:135], a[108:111], v[180:183], a[132:135]
    s_waitcnt vmcnt(7)
    v_mfma_f32_16x16x32_bf16 a[136:139], a[0:3], v[184:187], 0
    v_mfma_f32_16x16x32_bf16 a[140:143], a[56:59], v[184:187], 0
    v_mfma_f32_16x16x32_bf16 a[136:139], a[4:7], v[188:191], a[136:139]
    v_mfma_f32_16x16x32_bf16 a[140:143], a[60:63], v[188:191], a[140:143]
    v_mfma_f32_16x16x32_bf16 a[136:139], a[8:11], v[192:195], a[136:139]
    v_mfma_f32_16x16x32_bf16 a[140:143], a[64:67], v[192:195], a[140:143]
    v_mfma_f32_16x16x32_bf16 a[136:139], a[12:15], v[196:199], a[136:139]
    v_mfma_f32_16x16x32_bf16 a[140:143], a[68:71], v[196:199], a[140:143]
    v_mfma_f32_16x16x32_bf16 a[136:139], a[16:19], v[200:203], a[136:139]
    v_mfma_f32_16x16x32_bf16 a[140:143], a[72:75], v[200:203], a[140:143]
    v_mfma_f32_16x16x32_bf16 a[136:139], a[20:23], v[204:207], a[136:139]
    v_mfma_f32_16x16x32_bf16 a[140:143], a[76:79], v[204:207], a[140:143]
    v_mfma_f32_16x16x32_bf16 a[136:139], a[24:27], v[208:211], a[136:139]
    v_mfma_f32_16x16x32_bf16 a[140:143], a[80:83], v[208:211], a[140:143]
    v_mfma_f32_16x16x32_bf16 a[136:139], a[28:31], v[212:215], a[136:139]
    v_mfma_f32_16x16x32_bf16 a[140:143], a[84:87], v[212:215], a[140:143]
    v_mfma_f32_16x16x32_bf16 a[136:139], a[32:35], v[216:219], a[136:139]
    v_mfma_f32_16x16x32_bf16 a[140:143], a[88:91], v[216:219], a[140:143]
    v_mfma_f32_16x16x32_bf16 a[136:139], a[36:39], v[220:223], a[136:139]
    v_mfma_f32_16x16x32_bf16 a[140:143], a[92:95], v[220:223], a[140:143]
    v_mfma_f32_16x16x32_bf16 a[136:139], a[40:43], v[224:227], a[136:139]
    v_mfma_f32_16x16x32_bf16 a[140:143], a[96:99], v[224:227], a[140:143]
    v_mfma_f32_16x16x32_bf16 a[136:139], a[44:47], v[228:231], a[136:139]
    v_mfma_f32_16x16x32_bf16 a[140:143], a[100:103], v[228:231], a[140:143]
    v_mfma_f32_16x16x32_bf16 a[136:139], a[48:51], v[232:235], a[136:139]
    v_mfma_f32_16x16x32_bf16 a[140:143], a[104:107], v[232:235], a[140:143]
    v_mfma_f32_16x16x32_bf16 a[136:139], a[52:55], v[236:239], a[136:139]
    v_mfma_f32_16x16x32_bf16 a[140:143], a[108:111], v[236:239], a[140:143]
    s_add_u32 s37, s34, 104857600
    s_add_u32 s38, s37, 4096
    s_cmp_lg_u32 s20, 0
    s_cbranch_scc1 L_mw_w_84
    s_mov_b32 s49, 1000000
L_mp_w_85:
    buffer_load_dwordx4 v[244:247], v10, s[16:19], s38 offen offset:0 sc1
    buffer_load_dwordx4 v[248:251], v10, s[16:19], s38 offen offset:1024 sc1
    buffer_load_dwordx4 v[252:255], v10, s[16:19], s38 offen offset:2048 sc1
    s_waitcnt vmcnt(0)
    v_max3_u32 v243, v244, v245, v246
    v_max3_u32 v243, v243, v247, v248
    v_max3_u32 v243, v243, v249, v250
    v_max3_u32 v243, v243, v251, v252
    v_max3_u32 v243, v243, v253, v254
    v_max_u32 v243, v243, v255
    v_cmp_eq_u32 vcc, -1, v243
    s_cbranch_vccnz L_msl_w_87
    buffer_load_dwordx4 v[240:243], v10, s[16:19], s37 offen offset:0 sc1
    buffer_load_dwordx4 v[244:247], v10, s[16:19], s37 offen offset:1024 sc1
    buffer_load_dwordx4 v[248:251], v10, s[16:19], s37 offen offset:2048 sc1
    buffer_load_dwordx4 v[252:255], v10, s[16:19], s37 offen offset:3072 sc1
    s_waitcnt vmcnt(0)
    v_max3_u32 v240, v240, v241, v242
    v_max3_u32 v240, v240, v243, v244
    v_max3_u32 v240, v240, v245, v246
    v_max3_u32 v240, v240, v247, v248
    v_max3_u32 v240, v240, v249, v250
    v_max3_u32 v240, v240, v251, v252
    v_max3_u32 v240, v240, v253, v254
    v_max_u32 v240, v240, v255
    v_cmp_eq_u32 vcc, -1, v240
    s_cbranch_vccz L_mok_w_86
L_msl_w_87:
    s_sleep 12
    s_sub_u32 s49, s49, 1
    s_cmp_lg_u32 s49, 0
    s_cbranch_scc1 L_mp_w_85
L_mok_w_86:
L_mw_w_84:
    s_barrier
    buffer_load_dwordx4 a[144:147], v6, s[16:19], s37 offen offset:0 sc1
    buffer_load_dwordx4 a[148:151], v6, s[16:19], s37 offen offset:64 sc1
    buffer_load_dwordx4 a[152:155], v6, s[16:19], s37 offen offset:128 sc1
    buffer_load_dwordx4 a[156:159], v6, s[16:19], s37 offen offset:192 sc1
    buffer_load_dwordx4 a[160:163], v6, s[16:19], s37 offen offset:256 sc1
    buffer_load_dwordx4 a[164:167], v6, s[16:19], s37 offen offset:320 sc1
    buffer_load_dwordx4 a[168:171], v6, s[16:19], s37 offen offset:384 sc1
    buffer_load_dwordx4 a[172:175], v6, s[16:19], s37 offen offset:448 sc1
    buffer_load_dwordx4 a[176:179], v6, s[16:19], s37 offen offset:512 sc1
    buffer_load_dwordx4 a[180:183], v6, s[16:19], s37 offen offset:576 sc1
    buffer_load_dwordx4 a[184:187], v6, s[16:19], s37 offen offset:640 sc1
    buffer_load_dwordx4 a[188:191], v6, s[16:19], s37 offen offset:704 sc1
    buffer_load_dwordx4 a[192:195], v6, s[16:19], s37 offen offset:768 sc1
    buffer_load_dwordx4 a[196:199], v6, s[16:19], s37 offen offset:832 sc1
    s_waitcnt vmcnt(13)
    v_mfma_f32_16x16x32_bf16 a[200:203], a[144:147], v[16:19], 0
    v_mfma_f32_16x16x32_bf16 a[204:207], a[144:147], v[72:75], 0
    v_mfma_f32_16x16x32_bf16 a[208:211], a[144:147], v[128:131], 0
    v_mfma_f32_16x16x32_bf16 a[212:215], a[144:147], v[184:187], 0
    s_waitcnt vmcnt(12)
    v_mfma_f32_16x16x32_bf16 a[200:203], a[148:151], v[20:23], a[200:203]
    v_mfma_f32_16x16x32_bf16 a[204:207], a[148:151], v[76:79], a[204:207]
    v_mfma_f32_16x16x32_bf16 a[208:211], a[148:151], v[132:135], a[208:211]
    v_mfma_f32_16x16x32_bf16 a[212:215], a[148:151], v[188:191], a[212:215]
    s_waitcnt vmcnt(11)
    v_mfma_f32_16x16x32_bf16 a[200:203], a[152:155], v[24:27], a[200:203]
    v_mfma_f32_16x16x32_bf16 a[204:207], a[152:155], v[80:83], a[204:207]
    v_mfma_f32_16x16x32_bf16 a[208:211], a[152:155], v[136:139], a[208:211]
    v_mfma_f32_16x16x32_bf16 a[212:215], a[152:155], v[192:195], a[212:215]
    s_waitcnt vmcnt(10)
    v_mfma_f32_16x16x32_bf16 a[200:203], a[156:159], v[28:31], a[200:203]
    v_mfma_f32_16x16x32_bf16 a[204:207], a[156:159], v[84:87], a[204:207]
    v_mfma_f32_16x16x32_bf16 a[208:211], a[156:159], v[140:143], a[208:211]
    v_mfma_f32_16x16x32_bf16 a[212:215], a[156:159], v[196:199], a[212:215]
    s_waitcnt vmcnt(9)
    v_mfma_f32_16x16x32_bf16 a[200:203], a[160:163], v[32:35], a[200:203]
    v_mfma_f32_16x16x32_bf16 a[204:207], a[160:163], v[88:91], a[204:207]
    v_mfma_f32_16x16x32_bf16 a[208:211], a[160:163], v[144:147], a[208:211]
    v_mfma_f32_16x16x32_bf16 a[212:215], a[160:163], v[200:203], a[212:215]
    s_waitcnt vmcnt(8)
    v_mfma_f32_16x16x32_bf16 a[200:203], a[164:167], v[36:39], a[200:203]
    v_mfma_f32_16x16x32_bf16 a[204:207], a[164:167], v[92:95], a[204:207]
    v_mfma_f32_16x16x32_bf16 a[208:211], a[164:167], v[148:151], a[208:211]
    v_mfma_f32_16x16x32_bf16 a[212:215], a[164:167], v[204:207], a[212:215]
    s_waitcnt vmcnt(7)
    v_mfma_f32_16x16x32_bf16 a[200:203], a[168:171], v[40:43], a[200:203]
    v_mfma_f32_16x16x32_bf16 a[204:207], a[168:171], v[96:99], a[204:207]
    v_mfma_f32_16x16x32_bf16 a[208:211], a[168:171], v[152:155], a[208:211]
    v_mfma_f32_16x16x32_bf16 a[212:215], a[168:171], v[208:211], a[212:215]
    s_waitcnt vmcnt(6)
    v_mfma_f32_16x16x32_bf16 a[200:203], a[172:175], v[44:47], a[200:203]
    v_mfma_f32_16x16x32_bf16 a[204:207], a[172:175], v[100:103], a[204:207]
    v_mfma_f32_16x16x32_bf16 a[208:211], a[172:175], v[156:159], a[208:211]
    v_mfma_f32_16x16x32_bf16 a[212:215], a[172:175], v[212:215], a[212:215]
    s_waitcnt vmcnt(5)
    v_mfma_f32_16x16x32_bf16 a[200:203], a[176:179], v[48:51], a[200:203]
    v_mfma_f32_16x16x32_bf16 a[204:207], a[176:179], v[104:107], a[204:207]
    v_mfma_f32_16x16x32_bf16 a[208:211], a[176:179], v[160:163], a[208:211]
    v_mfma_f32_16x16x32_bf16 a[212:215], a[176:179], v[216:219], a[212:215]
    s_waitcnt vmcnt(4)
    v_mfma_f32_16x16x32_bf16 a[200:203], a[180:183], v[52:55], a[200:203]
    v_mfma_f32_16x16x32_bf16 a[204:207], a[180:183], v[108:111], a[204:207]
    v_mfma_f32_16x16x32_bf16 a[208:211], a[180:183], v[164:167], a[208:211]
    v_mfma_f32_16x16x32_bf16 a[212:215], a[180:183], v[220:223], a[212:215]
    s_waitcnt vmcnt(3)
    v_mfma_f32_16x16x32_bf16 a[200:203], a[184:187], v[56:59], a[200:203]
    v_mfma_f32_16x16x32_bf16 a[204:207], a[184:187], v[112:115], a[204:207]
    v_mfma_f32_16x16x32_bf16 a[208:211], a[184:187], v[168:171], a[208:211]
    v_mfma_f32_16x16x32_bf16 a[212:215], a[184:187], v[224:227], a[212:215]
    s_waitcnt vmcnt(2)
    v_mfma_f32_16x16x32_bf16 a[200:203], a[188:191], v[60:63], a[200:203]
    v_mfma_f32_16x16x32_bf16 a[204:207], a[188:191], v[116:119], a[204:207]
    v_mfma_f32_16x16x32_bf16 a[208:211], a[188:191], v[172:175], a[208:211]
    v_mfma_f32_16x16x32_bf16 a[212:215], a[188:191], v[228:231], a[212:215]
    s_waitcnt vmcnt(1)
    v_mfma_f32_16x16x32_bf16 a[200:203], a[192:195], v[64:67], a[200:203]
    v_mfma_f32_16x16x32_bf16 a[204:207], a[192:195], v[120:123], a[204:207]
    v_mfma_f32_16x16x32_bf16 a[208:211], a[192:195], v[176:179], a[208:211]
    v_mfma_f32_16x16x32_bf16 a[212:215], a[192:195], v[232:235], a[212:215]
    s_waitcnt vmcnt(0)
    v_mfma_f32_16x16x32_bf16 a[200:203], a[196:199], v[68:71], a[200:203]
    v_mfma_f32_16x16x32_bf16 a[204:207], a[196:199], v[124:127], a[204:207]
    v_mfma_f32_16x16x32_bf16 a[208:211], a[196:199], v[180:183], a[208:211]
    v_mfma_f32_16x16x32_bf16 a[212:215], a[196:199], v[236:239], a[212:215]
    v_lshlrev_b32 v13, 5, v1
    v_mul_u32_u24 v14, 7168, v3
    v_lshl_add_u32 v14, v4, 4, v14
    s_mul_i32 s37, s32, 14
    s_add_u32 s37, s37, s20
    s_lshl_b32 s39, s30, 5
    s_lshl_b32 s40, s31, 4
    s_add_u32 s39, s39, s40
    v_add_u32 v15, s39, v4
    v_mul_u32_u24 v15, 1792, v15
    v_lshl_add_u32 v15, v3, 3, v15
    s_nop 7
    s_mul_i32 s40, s30, 28
    s_add_u32 s40, s40, s37
    s_lshl_b32 s40, s40, 14
    s_add_u32 s40, s40, 16777216
    s_lshl_b32 s41, s37, 8
    s_add_u32 s41, s41, s34
    s_add_u32 s41, s41, 117440512
    buffer_load_dwordx4 v[96:99], v13, s[16:19], s40 offen offset:0
    buffer_load_dwordx4 v[100:103], v13, s[16:19], s40 offen offset:16
    buffer_load_dwordx4 v[104:107], v13, s[16:19], s40 offen offset:2048
    buffer_load_dwordx4 v[108:111], v13, s[16:19], s40 offen offset:2064
    s_add_u32 s40, s40, 4096
    buffer_load_dwordx4 v[112:115], v13, s[16:19], s40 offen offset:0
    buffer_load_dwordx4 v[116:119], v13, s[16:19], s40 offen offset:16
    buffer_load_dwordx4 v[120:123], v13, s[16:19], s40 offen offset:2048
    buffer_load_dwordx4 v[124:127], v13, s[16:19], s40 offen offset:2064
    s_add_u32 s40, s40, 4096
    buffer_load_dwordx4 v[128:131], v13, s[16:19], s40 offen offset:0
    buffer_load_dwordx4 v[132:135], v13, s[16:19], s40 offen offset:16
    buffer_load_dwordx4 v[136:139], v13, s[16:19], s40 offen offset:2048
    buffer_load_dwordx4 v[140:143], v13, s[16:19], s40 offen offset:2064
    s_add_u32 s40, s40, 4096
    buffer_load_dwordx4 v[144:147], v13, s[16:19], s40 offen offset:0
    buffer_load_dwordx4 v[148:151], v13, s[16:19], s40 offen offset:16
    buffer_load_dwordx4 v[152:155], v13, s[16:19], s40 offen offset:2048
    buffer_load_dwordx4 v[156:159], v13, s[16:19], s40 offen offset:2064
    s_add_u32 s38, s37, 4
    s_mul_i32 s40, s30, 28
    s_add_u32 s40, s40, s38
    s_lshl_b32 s40, s40, 14
    s_add_u32 s40, s40, 16777216
    s_lshl_b32 s41, s38, 8
    s_add_u32 s41, s41, s34
    s_add_u32 s41, s41, 117440512
    buffer_load_dwordx4 v[176:179], v13, s[16:19], s40 offen offset:0
    buffer_load_dwordx4 v[180:183], v13, s[16:19], s40 offen offset:16
    buffer_load_dwordx4 v[184:187], v13, s[16:19], s40 offen offset:2048
    buffer_load_dwordx4 v[188:191], v13, s[16:19], s40 offen offset:2064
    s_add_u32 s40, s40, 4096
    buffer_load_dwordx4 v[192:195], v13, s[16:19], s40 offen offset:0
    buffer_load_dwordx4 v[196:199], v13, s[16:19], s40 offen offset:16
    buffer_load_dwordx4 v[200:203], v13, s[16:19], s40 offen offset:2048
    buffer_load_dwordx4 v[204:207], v13, s[16:19], s40 offen offset:2064
    s_add_u32 s40, s40, 4096
    buffer_load_dwordx4 v[208:211], v13, s[16:19], s40 offen offset:0
    buffer_load_dwordx4 v[212:215], v13, s[16:19], s40 offen offset:16
    buffer_load_dwordx4 v[216:219], v13, s[16:19], s40 offen offset:2048
    buffer_load_dwordx4 v[220:223], v13, s[16:19], s40 offen offset:2064
    s_add_u32 s40, s40, 4096
    buffer_load_dwordx4 v[224:227], v13, s[16:19], s40 offen offset:0
    buffer_load_dwordx4 v[228:231], v13, s[16:19], s40 offen offset:16
    buffer_load_dwordx4 v[232:235], v13, s[16:19], s40 offen offset:2048
    buffer_load_dwordx4 v[236:239], v13, s[16:19], s40 offen offset:2064
    v_accvgpr_read_b32 v16, a112
    v_accvgpr_read_b32 v17, a113
    v_accvgpr_read_b32 v18, a114
    v_accvgpr_read_b32 v19, a115
    v_accvgpr_read_b32 v20, a116
    v_accvgpr_read_b32 v21, a117
    v_accvgpr_read_b32 v22, a118
    v_accvgpr_read_b32 v23, a119
    v_accvgpr_read_b32 v24, a200
    v_accvgpr_read_b32 v25, a201
    v_accvgpr_read_b32 v26, a202
    v_accvgpr_read_b32 v27, a203
    v_cmp_gt_i32 vcc, 0, v7
    s_nop 1
    v_cndmask_b32 v16, v16, v9, vcc
    v_cmp_gt_i32 vcc, 1, v7
    s_nop 1
    v_cndmask_b32 v17, v17, v9, vcc
    v_cmp_gt_i32 vcc, 2, v7
    s_nop 1
    v_cndmask_b32 v18, v18, v9, vcc
    v_cmp_gt_i32 vcc, 3, v7
    s_nop 1
    v_cndmask_b32 v19, v19, v9, vcc
    v_cmp_gt_i32 vcc, 0, v8
    s_nop 1
    v_cndmask_b32 v20, v20, v9, vcc
    v_cmp_gt_i32 vcc, 1, v8
    s_nop 1
    v_cndmask_b32 v21, v21, v9, vcc
    v_cmp_gt_i32 vcc, 2, v8
    s_nop 1
    v_cndmask_b32 v22, v22, v9, vcc
    v_cmp_gt_i32 vcc, 3, v8
    s_nop 1
    v_cndmask_b32 v23, v23, v9, vcc
    v_cmp_lt_u32 vcc, 1, v3
    s_nop 1
    v_cndmask_b32 v24, v24, v9, vcc
    v_cndmask_b32 v25, v25, v9, vcc
    v_cndmask_b32 v26, v26, v9, vcc
    v_cndmask_b32 v27, v27, v9, vcc
    v_max3_f32 v28, v16, v17, v18
    v_max3_f32 v28, v28, v19, v20
    v_max3_f32 v28, v28, v21, v22
    v_max3_f32 v28, v28, v23, v24
    v_max3_f32 v28, v28, v25, v26
    v_max_f32 v28, v28, v27
    v_mov_b32 v30, v28
    v_mov_b32 v31, v28
    s_nop 1
    v_permlane16_swap_b32 v30, v31
    v_max_f32 v30, v30, v31
    v_mov_b32 v31, v30
    s_nop 1
    v_permlane32_swap_b32 v30, v31
    v_max_f32 v28, v30, v31
    v_sub_f32 v16, v16, v28
    v_sub_f32 v17, v17, v28
    v_sub_f32 v18, v18, v28
    v_sub_f32 v19, v19, v28
    v_sub_f32 v20, v20, v28
    v_sub_f32 v21, v21, v28
    v_sub_f32 v22, v22, v28
    v_sub_f32 v23, v23, v28
    v_sub_f32 v24, v24, v28
    v_sub_f32 v25, v25, v28
    v_sub_f32 v26, v26, v28
    v_sub_f32 v27, v27, v28
    v_exp_f32 v16, v16
    v_exp_f32 v17, v17
    v_exp_f32 v18, v18
    v_exp_f32 v19, v19
    v_exp_f32 v20, v20
    v_exp_f32 v21, v21
    v_exp_f32 v22, v22
    v_exp_f32 v23, v23
    v_exp_f32 v24, v24
    v_exp_f32 v25, v25
    v_exp_f32 v26, v26
    v_exp_f32 v27, v27
    v_add_f32 v28, v16, v17
    v_add_f32 v28, v28, v18
    v_add_f32 v28, v28, v19
    v_add_f32 v28, v28, v20
    v_add_f32 v28, v28, v21
    v_add_f32 v28, v28, v22
    v_add_f32 v28, v28, v23
    v_add_f32 v28, v28, v24
    v_add_f32 v28, v28, v25
    v_add_f32 v28, v28, v26
    v_add_f32 v28, v28, v27
    v_mov_b32 v30, v28
    v_mov_b32 v31, v28
    s_nop 1
    v_permlane16_swap_b32 v30, v31
    v_add_f32 v30, v30, v31
    v_mov_b32 v31, v30
    s_nop 1
    v_permlane32_swap_b32 v30, v31
    v_add_f32 v28, v30, v31
    v_rcp_f32 v28, v28
    s_nop 0
    v_mul_f32 v16, v16, v28
    v_mul_f32 v17, v17, v28
    v_mul_f32 v18, v18, v28
    v_mul_f32 v19, v19, v28
    v_mul_f32 v20, v20, v28
    v_mul_f32 v21, v21, v28
    v_mul_f32 v22, v22, v28
    v_mul_f32 v23, v23, v28
    v_mul_f32 v24, v24, v28
    v_mul_f32 v25, v25, v28
    v_mul_f32 v26, v26, v28
    v_mul_f32 v27, v27, v28
    v_cvt_pk_bf16_f32 v40, v16, v17
    v_cvt_pk_bf16_f32 v42, v18, v19
    v_cvt_pk_bf16_f32 v44, v20, v21
    v_cvt_pk_bf16_f32 v46, v22, v23
    v_cvt_pk_bf16_f32 v30, v24, v25
    v_cvt_pk_bf16_f32 v31, v26, v27
    s_mov_b32 exec_hi, 0
    ds_write_b64 v12, v[30:31] offset:0
    s_mov_b64 exec, -1
    v_accvgpr_read_b32 v16, a120
    v_accvgpr_read_b32 v17, a121
    v_accvgpr_read_b32 v18, a122
    v_accvgpr_read_b32 v19, a123
    v_accvgpr_read_b32 v20, a124
    v_accvgpr_read_b32 v21, a125
    v_accvgpr_read_b32 v22, a126
    v_accvgpr_read_b32 v23, a127
    v_accvgpr_read_b32 v24, a204
    v_accvgpr_read_b32 v25, a205
    v_accvgpr_read_b32 v26, a206
    v_accvgpr_read_b32 v27, a207
    v_cmp_gt_i32 vcc, 0, v7
    s_nop 1
    v_cndmask_b32 v16, v16, v9, vcc
    v_cmp_gt_i32 vcc, 1, v7
    s_nop 1
    v_cndmask_b32 v17, v17, v9, vcc
    v_cmp_gt_i32 vcc, 2, v7
    s_nop 1
    v_cndmask_b32 v18, v18, v9, vcc
    v_cmp_gt_i32 vcc, 3, v7
    s_nop 1
    v_cndmask_b32 v19, v19, v9, vcc
    v_cmp_gt_i32 vcc, 0, v8
    s_nop 1
    v_cndmask_b32 v20, v20, v9, vcc
    v_cmp_gt_i32 vcc, 1, v8
    s_nop 1
    v_cndmask_b32 v21, v21, v9, vcc
    v_cmp_gt_i32 vcc, 2, v8
    s_nop 1
    v_cndmask_b32 v22, v22, v9, vcc
    v_cmp_gt_i32 vcc, 3, v8
    s_nop 1
    v_cndmask_b32 v23, v23, v9, vcc
    v_cmp_lt_u32 vcc, 1, v3
    s_nop 1
    v_cndmask_b32 v24, v24, v9, vcc
    v_cndmask_b32 v25, v25, v9, vcc
    v_cndmask_b32 v26, v26, v9, vcc
    v_cndmask_b32 v27, v27, v9, vcc
    v_max3_f32 v28, v16, v17, v18
    v_max3_f32 v28, v28, v19, v20
    v_max3_f32 v28, v28, v21, v22
    v_max3_f32 v28, v28, v23, v24
    v_max3_f32 v28, v28, v25, v26
    v_max_f32 v28, v28, v27
    v_mov_b32 v30, v28
    v_mov_b32 v31, v28
    s_nop 1
    v_permlane16_swap_b32 v30, v31
    v_max_f32 v30, v30, v31
    v_mov_b32 v31, v30
    s_nop 1
    v_permlane32_swap_b32 v30, v31
    v_max_f32 v28, v30, v31
    v_sub_f32 v16, v16, v28
    v_sub_f32 v17, v17, v28
    v_sub_f32 v18, v18, v28
    v_sub_f32 v19, v19, v28
    v_sub_f32 v20, v20, v28
    v_sub_f32 v21, v21, v28
    v_sub_f32 v22, v22, v28
    v_sub_f32 v23, v23, v28
    v_sub_f32 v24, v24, v28
    v_sub_f32 v25, v25, v28
    v_sub_f32 v26, v26, v28
    v_sub_f32 v27, v27, v28
    v_exp_f32 v16, v16
    v_exp_f32 v17, v17
    v_exp_f32 v18, v18
    v_exp_f32 v19, v19
    v_exp_f32 v20, v20
    v_exp_f32 v21, v21
    v_exp_f32 v22, v22
    v_exp_f32 v23, v23
    v_exp_f32 v24, v24
    v_exp_f32 v25, v25
    v_exp_f32 v26, v26
    v_exp_f32 v27, v27
    v_add_f32 v28, v16, v17
    v_add_f32 v28, v28, v18
    v_add_f32 v28, v28, v19
    v_add_f32 v28, v28, v20
    v_add_f32 v28, v28, v21
    v_add_f32 v28, v28, v22
    v_add_f32 v28, v28, v23
    v_add_f32 v28, v28, v24
    v_add_f32 v28, v28, v25
    v_add_f32 v28, v28, v26
    v_add_f32 v28, v28, v27
    v_mov_b32 v30, v28
    v_mov_b32 v31, v28
    s_nop 1
    v_permlane16_swap_b32 v30, v31
    v_add_f32 v30, v30, v31
    v_mov_b32 v31, v30
    s_nop 1
    v_permlane32_swap_b32 v30, v31
    v_add_f32 v28, v30, v31
    v_rcp_f32 v28, v28
    s_nop 0
    v_mul_f32 v16, v16, v28
    v_mul_f32 v17, v17, v28
    v_mul_f32 v18, v18, v28
    v_mul_f32 v19, v19, v28
    v_mul_f32 v20, v20, v28
    v_mul_f32 v21, v21, v28
    v_mul_f32 v22, v22, v28
    v_mul_f32 v23, v23, v28
    v_mul_f32 v24, v24, v28
    v_mul_f32 v25, v25, v28
    v_mul_f32 v26, v26, v28
    v_mul_f32 v27, v27, v28
    v_cvt_pk_bf16_f32 v41, v16, v17
    v_cvt_pk_bf16_f32 v43, v18, v19
    v_cvt_pk_bf16_f32 v45, v20, v21
    v_cvt_pk_bf16_f32 v47, v22, v23
    v_cvt_pk_bf16_f32 v30, v24, v25
    v_cvt_pk_bf16_f32 v31, v26, v27
    s_mov_b32 exec_hi, 0
    ds_write_b64 v12, v[30:31] offset:256
    s_mov_b64 exec, -1
    ds_write_b128 v11, v[40:43] offset:0
    ds_write_b128 v11, v[44:47] offset:1024
    v_accvgpr_read_b32 v16, a128
    v_accvgpr_read_b32 v17, a129
    v_accvgpr_read_b32 v18, a130
    v_accvgpr_read_b32 v19, a131
    v_accvgpr_read_b32 v20, a132
    v_accvgpr_read_b32 v21, a133
    v_accvgpr_read_b32 v22, a134
    v_accvgpr_read_b32 v23, a135
    v_accvgpr_read_b32 v24, a208
    v_accvgpr_read_b32 v25, a209
    v_accvgpr_read_b32 v26, a210
    v_accvgpr_read_b32 v27, a211
    v_cmp_gt_i32 vcc, 0, v7
    s_nop 1
    v_cndmask_b32 v16, v16, v9, vcc
    v_cmp_gt_i32 vcc, 1, v7
    s_nop 1
    v_cndmask_b32 v17, v17, v9, vcc
    v_cmp_gt_i32 vcc, 2, v7
    s_nop 1
    v_cndmask_b32 v18, v18, v9, vcc
    v_cmp_gt_i32 vcc, 3, v7
    s_nop 1
    v_cndmask_b32 v19, v19, v9, vcc
    v_cmp_gt_i32 vcc, 0, v8
    s_nop 1
    v_cndmask_b32 v20, v20, v9, vcc
    v_cmp_gt_i32 vcc, 1, v8
    s_nop 1
    v_cndmask_b32 v21, v21, v9, vcc
    v_cmp_gt_i32 vcc, 2, v8
    s_nop 1
    v_cndmask_b32 v22, v22, v9, vcc
    v_cmp_gt_i32 vcc, 3, v8
    s_nop 1
    v_cndmask_b32 v23, v23, v9, vcc
    v_cmp_lt_u32 vcc, 1, v3
    s_nop 1
    v_cndmask_b32 v24, v24, v9, vcc
    v_cndmask_b32 v25, v25, v9, vcc
    v_cndmask_b32 v26, v26, v9, vcc
    v_cndmask_b32 v27, v27, v9, vcc
    v_max3_f32 v28, v16, v17, v18
    v_max3_f32 v28, v28, v19, v20
    v_max3_f32 v28, v28, v21, v22
    v_max3_f32 v28, v28, v23, v24
    v_max3_f32 v28, v28, v25, v26
    v_max_f32 v28, v28, v27
    v_mov_b32 v30, v28
    v_mov_b32 v31, v28
    s_nop 1
    v_permlane16_swap_b32 v30, v31
    v_max_f32 v30, v30, v31
    v_mov_b32 v31, v30
    s_nop 1
    v_permlane32_swap_b32 v30, v31
    v_max_f32 v28, v30, v31
    v_sub_f32 v16, v16, v28
    v_sub_f32 v17, v17, v28
    v_sub_f32 v18, v18, v28
    v_sub_f32 v19, v19, v28
    v_sub_f32 v20, v20, v28
    v_sub_f32 v21, v21, v28
    v_sub_f32 v22, v22, v28
    v_sub_f32 v23, v23, v28
    v_sub_f32 v24, v24, v28
    v_sub_f32 v25, v25, v28
    v_sub_f32 v26, v26, v28
    v_sub_f32 v27, v27, v28
    v_exp_f32 v16, v16
    v_exp_f32 v17, v17
    v_exp_f32 v18, v18
    v_exp_f32 v19, v19
    v_exp_f32 v20, v20
    v_exp_f32 v21, v21
    v_exp_f32 v22, v22
    v_exp_f32 v23, v23
    v_exp_f32 v24, v24
    v_exp_f32 v25, v25
    v_exp_f32 v26, v26
    v_exp_f32 v27, v27
    v_add_f32 v28, v16, v17
    v_add_f32 v28, v28, v18
    v_add_f32 v28, v28, v19
    v_add_f32 v28, v28, v20
    v_add_f32 v28, v28, v21
    v_add_f32 v28, v28, v22
    v_add_f32 v28, v28, v23
    v_add_f32 v28, v28, v24
    v_add_f32 v28, v28, v25
    v_add_f32 v28, v28, v26
    v_add_f32 v28, v28, v27
    v_mov_b32 v30, v28
    v_mov_b32 v31, v28
    s_nop 1
    v_permlane16_swap_b32 v30, v31
    v_add_f32 v30, v30, v31
    v_mov_b32 v31, v30
    s_nop 1
    v_permlane32_swap_b32 v30, v31
    v_add_f32 v28, v30, v31
    v_rcp_f32 v28, v28
    s_nop 0
    v_mul_f32 v16, v16, v28
    v_mul_f32 v17, v17, v28
    v_mul_f32 v18, v18, v28
    v_mul_f32 v19, v19, v28
    v_mul_f32 v20, v20, v28
    v_mul_f32 v21, v21, v28
    v_mul_f32 v22, v22, v28
    v_mul_f32 v23, v23, v28
    v_mul_f32 v24, v24, v28
    v_mul_f32 v25, v25, v28
    v_mul_f32 v26, v26, v28
    v_mul_f32 v27, v27, v28
    v_cvt_pk_bf16_f32 v40, v16, v17
    v_cvt_pk_bf16_f32 v42, v18, v19
    v_cvt_pk_bf16_f32 v44, v20, v21
    v_cvt_pk_bf16_f32 v46, v22, v23
    v_cvt_pk_bf16_f32 v30, v24, v25
    v_cvt_pk_bf16_f32 v31, v26, v27
    s_mov_b32 exec_hi, 0
    ds_write_b64 v12, v[30:31] offset:512
    s_mov_b64 exec, -1
    v_accvgpr_read_b32 v16, a136
    v_accvgpr_read_b32 v17, a137
    v_accvgpr_read_b32 v18, a138
    v_accvgpr_read_b32 v19, a139
    v_accvgpr_read_b32 v20, a140
    v_accvgpr_read_b32 v21, a141
    v_accvgpr_read_b32 v22, a142
    v_accvgpr_read_b32 v23, a143
    v_accvgpr_read_b32 v24, a212
    v_accvgpr_read_b32 v25, a213
    v_accvgpr_read_b32 v26, a214
    v_accvgpr_read_b32 v27, a215
    v_cmp_gt_i32 vcc, 0, v7
    s_nop 1
    v_cndmask_b32 v16, v16, v9, vcc
    v_cmp_gt_i32 vcc, 1, v7
    s_nop 1
    v_cndmask_b32 v17, v17, v9, vcc
    v_cmp_gt_i32 vcc, 2, v7
    s_nop 1
    v_cndmask_b32 v18, v18, v9, vcc
    v_cmp_gt_i32 vcc, 3, v7
    s_nop 1
    v_cndmask_b32 v19, v19, v9, vcc
    v_cmp_gt_i32 vcc, 0, v8
    s_nop 1
    v_cndmask_b32 v20, v20, v9, vcc
    v_cmp_gt_i32 vcc, 1, v8
    s_nop 1
    v_cndmask_b32 v21, v21, v9, vcc
    v_cmp_gt_i32 vcc, 2, v8
    s_nop 1
    v_cndmask_b32 v22, v22, v9, vcc
    v_cmp_gt_i32 vcc, 3, v8
    s_nop 1
    v_cndmask_b32 v23, v23, v9, vcc
    v_cmp_lt_u32 vcc, 1, v3
    s_nop 1
    v_cndmask_b32 v24, v24, v9, vcc
    v_cndmask_b32 v25, v25, v9, vcc
    v_cndmask_b32 v26, v26, v9, vcc
    v_cndmask_b32 v27, v27, v9, vcc
    v_max3_f32 v28, v16, v17, v18
    v_max3_f32 v28, v28, v19, v20
    v_max3_f32 v28, v28, v21, v22
    v_max3_f32 v28, v28, v23, v24
    v_max3_f32 v28, v28, v25, v26
    v_max_f32 v28, v28, v27
    v_mov_b32 v30, v28
    v_mov_b32 v31, v28
    s_nop 1
    v_permlane16_swap_b32 v30, v31
    v_max_f32 v30, v30, v31
    v_mov_b32 v31, v30
    s_nop 1
    v_permlane32_swap_b32 v30, v31
    v_max_f32 v28, v30, v31
    v_sub_f32 v16, v16, v28
    v_sub_f32 v17, v17, v28
    v_sub_f32 v18, v18, v28
    v_sub_f32 v19, v19, v28
    v_sub_f32 v20, v20, v28
    v_sub_f32 v21, v21, v28
    v_sub_f32 v22, v22, v28
    v_sub_f32 v23, v23, v28
    v_sub_f32 v24, v24, v28
    v_sub_f32 v25, v25, v28
    v_sub_f32 v26, v26, v28
    v_sub_f32 v27, v27, v28
    v_exp_f32 v16, v16
    v_exp_f32 v17, v17
    v_exp_f32 v18, v18
    v_exp_f32 v19, v19
    v_exp_f32 v20, v20
    v_exp_f32 v21, v21
    v_exp_f32 v22, v22
    v_exp_f32 v23, v23
    v_exp_f32 v24, v24
    v_exp_f32 v25, v25
    v_exp_f32 v26, v26
    v_exp_f32 v27, v27
    v_add_f32 v28, v16, v17
    v_add_f32 v28, v28, v18
    v_add_f32 v28, v28, v19
    v_add_f32 v28, v28, v20
    v_add_f32 v28, v28, v21
    v_add_f32 v28, v28, v22
    v_add_f32 v28, v28, v23
    v_add_f32 v28, v28, v24
    v_add_f32 v28, v28, v25
    v_add_f32 v28, v28, v26
    v_add_f32 v28, v28, v27
    v_mov_b32 v30, v28
    v_mov_b32 v31, v28
    s_nop 1
    v_permlane16_swap_b32 v30, v31
    v_add_f32 v30, v30, v31
    v_mov_b32 v31, v30
    s_nop 1
    v_permlane32_swap_b32 v30, v31
    v_add_f32 v28, v30, v31
    v_rcp_f32 v28, v28
    s_nop 0
    v_mul_f32 v16, v16, v28
    v_mul_f32 v17, v17, v28
    v_mul_f32 v18, v18, v28
    v_mul_f32 v19, v19, v28
    v_mul_f32 v20, v20, v28
    v_mul_f32 v21, v21, v28
    v_mul_f32 v22, v22, v28
    v_mul_f32 v23, v23, v28
    v_mul_f32 v24, v24, v28
    v_mul_f32 v25, v25, v28
    v_mul_f32 v26, v26, v28
    v_mul_f32 v27, v27, v28
    v_cvt_pk_bf16_f32 v41, v16, v17
    v_cvt_pk_bf16_f32 v43, v18, v19
    v_cvt_pk_bf16_f32 v45, v20, v21
    v_cvt_pk_bf16_f32 v47, v22, v23
    v_cvt_pk_bf16_f32 v30, v24, v25
    v_cvt_pk_bf16_f32 v31, v26, v27
    s_mov_b32 exec_hi, 0
    ds_write_b64 v12, v[30:31] offset:768
    s_mov_b64 exec, -1
    ds_write_b128 v11, v[40:43] offset:2048
    ds_write_b128 v11, v[44:47] offset:3072
    s_waitcnt lgkmcnt(0)
    s_barrier
    ds_read_b128 v[16:19], v10 offset:0
    ds_read_b128 v[20:23], v10 offset:1024
    ds_read_b128 v[24:27], v10 offset:2048
    ds_read_b128 v[28:31], v10 offset:3072
    ds_read_b128 v[32:35], v10 offset:4096
    ds_read_b128 v[36:39], v10 offset:5120
    ds_read_b128 v[40:43], v10 offset:6144
    ds_read_b128 v[44:47], v10 offset:7168
    ds_read_b128 v[48:51], v10 offset:8192
    ds_read_b128 v[52:55], v10 offset:9216
    ds_read_b128 v[56:59], v10 offset:10240
    ds_read_b128 v[60:63], v10 offset:11264
    ds_read_b128 v[64:67], v10 offset:12288
    ds_read_b128 v[68:71], v10 offset:13312
    ds_read_b128 v[72:75], v10 offset:14336
    ds_read_b128 v[76:79], v10 offset:15360
    ds_read_b128 v[80:83], v10 offset:16384
    ds_read_b128 v[84:87], v10 offset:17408
    ds_read_b128 v[88:91], v10 offset:18432
    ds_read_b128 v[92:95], v10 offset:19456
    s_waitcnt lgkmcnt(0)
    s_waitcnt vmcnt(16)
    v_mfma_f32_16x16x32_bf16 a[216:219], v[96:99], v[16:19], 0
    v_mfma_f32_16x16x32_bf16 a[216:219], v[100:103], v[20:23], a[216:219]
    v_mfma_f32_16x16x32_bf16 a[216:219], v[104:107], v[24:27], a[216:219]
    v_mfma_f32_16x16x32_bf16 a[216:219], v[108:111], v[28:31], a[216:219]
    v_mfma_f32_16x16x32_bf16 a[216:219], v[112:115], v[32:35], a[216:219]
    v_mfma_f32_16x16x32_bf16 a[216:219], v[116:119], v[36:39], a[216:219]
    v_mfma_f32_16x16x32_bf16 a[216:219], v[120:123], v[40:43], a[216:219]
    v_mfma_f32_16x16x32_bf16 a[216:219], v[124:127], v[44:47], a[216:219]
    v_mfma_f32_16x16x32_bf16 a[216:219], v[128:131], v[48:51], a[216:219]
    v_mfma_f32_16x16x32_bf16 a[216:219], v[132:135], v[52:55], a[216:219]
    v_mfma_f32_16x16x32_bf16 a[216:219], v[136:139], v[56:59], a[216:219]
    v_mfma_f32_16x16x32_bf16 a[216:219], v[140:143], v[60:63], a[216:219]
    v_mfma_f32_16x16x32_bf16 a[216:219], v[144:147], v[64:67], a[216:219]
    v_mfma_f32_16x16x32_bf16 a[216:219], v[148:151], v[68:71], a[216:219]
    v_mfma_f32_16x16x32_bf16 a[216:219], v[152:155], v[72:75], a[216:219]
    v_mfma_f32_16x16x32_bf16 a[216:219], v[156:159], v[76:79], a[216:219]
    s_add_u32 s38, s37, 8
    s_mul_i32 s40, s30, 28
    s_add_u32 s40, s40, s38
    s_lshl_b32 s40, s40, 14
    s_add_u32 s40, s40, 16777216
    s_lshl_b32 s41, s38, 8
    s_add_u32 s41, s41, s34
    s_add_u32 s41, s41, 117440512
    buffer_load_dwordx4 v[96:99], v13, s[16:19], s40 offen offset:0
    buffer_load_dwordx4 v[100:103], v13, s[16:19], s40 offen offset:16
    buffer_load_dwordx4 v[104:107], v13, s[16:19], s40 offen offset:2048
    buffer_load_dwordx4 v[108:111], v13, s[16:19], s40 offen offset:2064
    s_add_u32 s40, s40, 4096
    buffer_load_dwordx4 v[112:115], v13, s[16:19], s40 offen offset:0
    buffer_load_dwordx4 v[116:119], v13, s[16:19], s40 offen offset:16
    buffer_load_dwordx4 v[120:123], v13, s[16:19], s40 offen offset:2048
    buffer_load_dwordx4 v[124:127], v13, s[16:19], s40 offen offset:2064
    s_add_u32 s40, s40, 4096
    buffer_load_dwordx4 v[128:131], v13, s[16:19], s40 offen offset:0
    buffer_load_dwordx4 v[132:135], v13, s[16:19], s40 offen offset:16
    buffer_load_dwordx4 v[136:139], v13, s[16:19], s40 offen offset:2048
    buffer_load_dwordx4 v[140:143], v13, s[16:19], s40 offen offset:2064
    s_add_u32 s40, s40, 4096
    buffer_load_dwordx4 v[144:147], v13, s[16:19], s40 offen offset:0
    buffer_load_dwordx4 v[148:151], v13, s[16:19], s40 offen offset:16
    buffer_load_dwordx4 v[152:155], v13, s[16:19], s40 offen offset:2048
    buffer_load_dwordx4 v[156:159], v13, s[16:19], s40 offen offset:2064
    s_waitcnt vmcnt(16)
    v_mfma_f32_16x16x32_bf16 a[220:223], v[176:179], v[16:19], 0
    v_mfma_f32_16x16x32_bf16 a[220:223], v[180:183], v[20:23], a[220:223]
    v_mfma_f32_16x16x32_bf16 a[220:223], v[184:187], v[24:27], a[220:223]
    v_mfma_f32_16x16x32_bf16 a[220:223], v[188:191], v[28:31], a[220:223]
    v_mfma_f32_16x16x32_bf16 a[220:223], v[192:195], v[32:35], a[220:223]
    v_mfma_f32_16x16x32_bf16 a[220:223], v[196:199], v[36:39], a[220:223]
    v_mfma_f32_16x16x32_bf16 a[220:223], v[200:203], v[40:43], a[220:223]
    v_mfma_f32_16x16x32_bf16 a[220:223], v[204:207], v[44:47], a[220:223]
    v_mfma_f32_16x16x32_bf16 a[220:223], v[208:211], v[48:51], a[220:223]
    v_mfma_f32_16x16x32_bf16 a[220:223], v[212:215], v[52:55], a[220:223]
    v_mfma_f32_16x16x32_bf16 a[220:223], v[216:219], v[56:59], a[220:223]
    v_mfma_f32_16x16x32_bf16 a[220:223], v[220:223], v[60:63], a[220:223]
    v_mfma_f32_16x16x32_bf16 a[220:223], v[224:227], v[64:67], a[220:223]
    v_mfma_f32_16x16x32_bf16 a[220:223], v[228:231], v[68:71], a[220:223]
    v_mfma_f32_16x16x32_bf16 a[220:223], v[232:235], v[72:75], a[220:223]
    v_mfma_f32_16x16x32_bf16 a[220:223], v[236:239], v[76:79], a[220:223]
    s_add_u32 s38, s37, 12
    s_mul_i32 s40, s30, 28
    s_add_u32 s40, s40, s38
    s_lshl_b32 s40, s40, 14
    s_add_u32 s40, s40, 16777216
    s_lshl_b32 s41, s38, 8
    s_add_u32 s41, s41, s34
    s_add_u32 s41, s41, 117440512
    buffer_load_dwordx4 v[176:179], v13, s[16:19], s40 offen offset:0
    buffer_load_dwordx4 v[180:183], v13, s[16:19], s40 offen offset:16
    buffer_load_dwordx4 v[184:187], v13, s[16:19], s40 offen offset:2048
    buffer_load_dwordx4 v[188:191], v13, s[16:19], s40 offen offset:2064
    s_add_u32 s40, s40, 4096
    buffer_load_dwordx4 v[192:195], v13, s[16:19], s40 offen offset:0
    buffer_load_dwordx4 v[196:199], v13, s[16:19], s40 offen offset:16
    buffer_load_dwordx4 v[200:203], v13, s[16:19], s40 offen offset:2048
    buffer_load_dwordx4 v[204:207], v13, s[16:19], s40 offen offset:2064
    s_add_u32 s40, s40, 4096
    buffer_load_dwordx4 v[208:211], v13, s[16:19], s40 offen offset:0
    buffer_load_dwordx4 v[212:215], v13, s[16:19], s40 offen offset:16
    buffer_load_dwordx4 v[216:219], v13, s[16:19], s40 offen offset:2048
    buffer_load_dwordx4 v[220:223], v13, s[16:19], s40 offen offset:2064
    s_add_u32 s40, s40, 4096
    buffer_load_dwordx4 v[224:227], v13, s[16:19], s40 offen offset:0
    buffer_load_dwordx4 v[228:231], v13, s[16:19], s40 offen offset:16
    buffer_load_dwordx4 v[232:235], v13, s[16:19], s40 offen offset:2048
    buffer_load_dwordx4 v[236:239], v13, s[16:19], s40 offen offset:2064
    s_waitcnt vmcnt(16)
    v_mfma_f32_16x16x32_bf16 a[224:227], v[96:99], v[16:19], 0
    v_mfma_f32_16x16x32_bf16 a[224:227], v[100:103], v[20:23], a[224:227]
    v_mfma_f32_16x16x32_bf16 a[224:227], v[104:107], v[24:27], a[224:227]
    v_mfma_f32_16x16x32_bf16 a[224:227], v[108:111], v[28:31], a[224:227]
    v_mfma_f32_16x16x32_bf16 a[224:227], v[112:115], v[32:35], a[224:227]
    v_mfma_f32_16x16x32_bf16 a[224:227], v[116:119], v[36:39], a[224:227]
    v_mfma_f32_16x16x32_bf16 a[224:227], v[120:123], v[40:43], a[224:227]
    v_mfma_f32_16x16x32_bf16 a[224:227], v[124:127], v[44:47], a[224:227]
    v_mfma_f32_16x16x32_bf16 a[224:227], v[128:131], v[48:51], a[224:227]
    v_mfma_f32_16x16x32_bf16 a[224:227], v[132:135], v[52:55], a[224:227]
    v_mfma_f32_16x16x32_bf16 a[224:227], v[136:139], v[56:59], a[224:227]
    v_mfma_f32_16x16x32_bf16 a[224:227], v[140:143], v[60:63], a[224:227]
    v_mfma_f32_16x16x32_bf16 a[224:227], v[144:147], v[64:67], a[224:227]
    v_mfma_f32_16x16x32_bf16 a[224:227], v[148:151], v[68:71], a[224:227]
    v_mfma_f32_16x16x32_bf16 a[224:227], v[152:155], v[72:75], a[224:227]
    v_mfma_f32_16x16x32_bf16 a[224:227], v[156:159], v[76:79], a[224:227]
    s_waitcnt vmcnt(0)
    v_mfma_f32_16x16x32_bf16 a[228:231], v[176:179], v[16:19], 0
    v_mfma_f32_16x16x32_bf16 a[228:231], v[180:183], v[20:23], a[228:231]
    v_mfma_f32_16x16x32_bf16 a[228:231], v[184:187], v[24:27], a[228:231]
    v_mfma_f32_16x16x32_bf16 a[228:231], v[188:191], v[28:31], a[228:231]
    v_mfma_f32_16x16x32_bf16 a[228:231], v[192:195], v[32:35], a[228:231]
    v_mfma_f32_16x16x32_bf16 a[228:231], v[196:199], v[36:39], a[228:231]
    v_mfma_f32_16x16x32_bf16 a[228:231], v[200:203], v[40:43], a[228:231]
    v_mfma_f32_16x16x32_bf16 a[228:231], v[204:207], v[44:47], a[228:231]
    v_mfma_f32_16x16x32_bf16 a[228:231], v[208:211], v[48:51], a[228:231]
    v_mfma_f32_16x16x32_bf16 a[228:231], v[212:215], v[52:55], a[228:231]
    v_mfma_f32_16x16x32_bf16 a[228:231], v[216:219], v[56:59], a[228:231]
    v_mfma_f32_16x16x32_bf16 a[228:231], v[220:223], v[60:63], a[228:231]
    v_mfma_f32_16x16x32_bf16 a[228:231], v[224:227], v[64:67], a[228:231]
    v_mfma_f32_16x16x32_bf16 a[228:231], v[228:231], v[68:71], a[228:231]
    v_mfma_f32_16x16x32_bf16 a[228:231], v[232:235], v[72:75], a[228:231]
    v_mfma_f32_16x16x32_bf16 a[228:231], v[236:239], v[76:79], a[228:231]
    s_cmp_lg_u32 s20, 0
    s_cbranch_scc1 L_fw_wb_88
    s_mov_b64 exec, 1
    v_mov_b32 v241, 100818944
    s_mov_b32 s49, 1000000
L_cw_wb_89:
    buffer_load_dword v240, v241, s[16:19], s48 offen sc1
    s_waitcnt vmcnt(0)
    v_cmp_gt_u32 vcc, 28, v240
    s_cbranch_vccz L_cwok_wb_90
    s_sleep 2
    s_sub_u32 s49, s49, 1
    s_cmp_lg_u32 s49, 0
    s_cbranch_scc1 L_cw_wb_89
L_cwok_wb_90:
    s_mov_b64 exec, -1
L_fw_wb_88:
    s_barrier
    s_add_u32 s41, s37, 0
    s_lshl_b32 s41, s41, 8
    s_add_u32 s41, s41, s34
    s_add_u32 s41, s41, 117440512
    buffer_load_dwordx4 v[96:99], v14, s[16:19], s41 offen
    s_add_u32 s41, s41, 28672
    buffer_load_dwordx4 v[100:103], v14, s[16:19], s41 offen
    s_add_u32 s41, s41, 28672
    buffer_load_dwordx4 v[104:107], v14, s[16:19], s41 offen
    s_add_u32 s41, s41, 28672
    buffer_load_dwordx4 v[108:111], v14, s[16:19], s41 offen
    s_add_u32 s41, s41, 28672
    s_add_u32 s41, s37, 4
    s_lshl_b32 s41, s41, 8
    s_add_u32 s41, s41, s34
    s_add_u32 s41, s41, 117440512
    buffer_load_dwordx4 v[112:115], v14, s[16:19], s41 offen
    s_add_u32 s41, s41, 28672
    buffer_load_dwordx4 v[116:119], v14, s[16:19], s41 offen
    s_add_u32 s41, s41, 28672
    buffer_load_dwordx4 v[120:123], v14, s[16:19], s41 offen
    s_add_u32 s41, s41, 28672
    buffer_load_dwordx4 v[124:127], v14, s[16:19], s41 offen
    s_add_u32 s41, s41, 28672
    s_add_u32 s41, s37, 8
    s_lshl_b32 s41, s41, 8
    s_add_u32 s41, s41, s34
    s_add_u32 s41, s41, 117440512
    buffer_load_dwordx4 v[128:131], v14, s[16:19], s41 offen
    s_add_u32 s41, s41, 28672
    buffer_load_dwordx4 v[132:135], v14, s[16:19], s41 offen
    s_add_u32 s41, s41, 28672
    buffer_load_dwordx4 v[136:139], v14, s[16:19], s41 offen
    s_add_u32 s41, s41, 28672
    buffer_load_dwordx4 v[140:143], v14, s[16:19], s41 offen
    s_add_u32 s41, s41, 28672
    s_add_u32 s41, s37, 12
    s_lshl_b32 s41, s41, 8
    s_add_u32 s41, s41, s34
    s_add_u32 s41, s41, 117440512
    buffer_load_dwordx4 v[144:147], v14, s[16:19], s41 offen
    s_add_u32 s41, s41, 28672
    buffer_load_dwordx4 v[148:151], v14, s[16:19], s41 offen
    s_add_u32 s41, s41, 28672
    buffer_load_dwordx4 v[152:155], v14, s[16:19], s41 offen
    s_add_u32 s41, s41, 28672
    buffer_load_dwordx4 v[156:159], v14, s[16:19], s41 offen
    s_add_u32 s41, s41, 28672
    s_waitcnt vmcnt(12)
    v_mfma_f32_16x16x32_bf16 a[216:219], v[96:99], v[80:83], a[216:219]
    v_mfma_f32_16x16x32_bf16 a[216:219], v[100:103], v[84:87], a[216:219]
    v_mfma_f32_16x16x32_bf16 a[216:219], v[104:107], v[88:91], a[216:219]
    v_mfma_f32_16x16x32_bf16 a[216:219], v[108:111], v[92:95], a[216:219]
    s_nop 7
    v_accvgpr_read_b32 v176, a216
    v_accvgpr_read_b32 v177, a217
    v_accvgpr_read_b32 v178, a218
    v_accvgpr_read_b32 v179, a219
    v_cvt_pk_bf16_f32 v176, v176, v177
    v_cvt_pk_bf16_f32 v177, v178, v179
    s_add_u32 s40, s37, 0
    s_lshl_b32 s40, s40, 5
    buffer_store_dwordx2 v[176:177], v15, s[24:27], s40 offen
    s_waitcnt vmcnt(9)
    v_mfma_f32_16x16x32_bf16 a[220:223], v[112:115], v[80:83], a[220:223]
    v_mfma_f32_16x16x32_bf16 a[220:223], v[116:119], v[84:87], a[220:223]
    v_mfma_f32_16x16x32_bf16 a[220:223], v[120:123], v[88:91], a[220:223]
    v_mfma_f32_16x16x32_bf16 a[220:223], v[124:127], v[92:95], a[220:223]
    s_nop 7
    v_accvgpr_read_b32 v180, a220
    v_accvgpr_read_b32 v181, a221
    v_accvgpr_read_b32 v182, a222
    v_accvgpr_read_b32 v183, a223
    v_cvt_pk_bf16_f32 v180, v180, v181
    v_cvt_pk_bf16_f32 v181, v182, v183
    s_add_u32 s40, s37, 4
    s_lshl_b32 s40, s40, 5
    buffer_store_dwordx2 v[180:181], v15, s[24:27], s40 offen
    s_waitcnt vmcnt(6)
    v_mfma_f32_16x16x32_bf16 a[224:227], v[128:131], v[80:83], a[224:227]
    v_mfma_f32_16x16x32_bf16 a[224:227], v[132:135], v[84:87], a[224:227]
    v_mfma_f32_16x16x32_bf16 a[224:227], v[136:139], v[88:91], a[224:227]
    v_mfma_f32_16x16x32_bf16 a[224:227], v[140:143], v[92:95], a[224:227]
    s_nop 7
    v_accvgpr_read_b32 v184, a224
    v_accvgpr_read_b32 v185, a225
    v_accvgpr_read_b32 v186, a226
    v_accvgpr_read_b32 v187, a227
    v_cvt_pk_bf16_f32 v184, v184, v185
    v_cvt_pk_bf16_f32 v185, v186, v187
    s_add_u32 s40, s37, 8
    s_lshl_b32 s40, s40, 5
    buffer_store_dwordx2 v[184:185], v15, s[24:27], s40 offen
    s_cmp_ge_u32 s20, 2
    s_cbranch_scc1 L_fin_done_w
    s_waitcnt vmcnt(3)
    v_mfma_f32_16x16x32_bf16 a[228:231], v[144:147], v[80:83], a[228:231]
    v_mfma_f32_16x16x32_bf16 a[228:231], v[148:151], v[84:87], a[228:231]
    v_mfma_f32_16x16x32_bf16 a[228:231], v[152:155], v[88:91], a[228:231]
    v_mfma_f32_16x16x32_bf16 a[228:231], v[156:159], v[92:95], a[228:231]
    s_nop 7
    v_accvgpr_read_b32 v188, a228
    v_accvgpr_read_b32 v189, a229
    v_accvgpr_read_b32 v190, a230
    v_accvgpr_read_b32 v191, a231
    v_cvt_pk_bf16_f32 v188, v188, v189
    v_cvt_pk_bf16_f32 v189, v190, v191
    s_add_u32 s40, s37, 12
    s_lshl_b32 s40, s40, 5
    buffer_store_dwordx2 v[188:189], v15, s[24:27], s40 offen
L_fin_done_w:
    s_branch L_w_finloop
L_chain_end:
    s_endpgm

.section .rodata,"a"
.p2align 6
.amdhsa_kernel main_kernel
  .amdhsa_next_free_vgpr 512
  .amdhsa_next_free_sgpr 102
  .amdhsa_accum_offset 256
  .amdhsa_group_segment_fixed_size 0
  .amdhsa_kernarg_size 112
  .amdhsa_user_sgpr_count 2
  .amdhsa_user_sgpr_kernarg_segment_ptr 1
  .amdhsa_system_sgpr_workgroup_id_x 1
.end_amdhsa_kernel
.text
```
